```python
import torch

def _softmax(x, axis=-1):
    return torch.softmax(x, dim=axis)

def _gelu(x):
    return torch.nn.functional.gelu(x, approximate='tanh')

def _silu(x):
    return torch.nn.functional.silu(x)

def _sigmoid(x):
    return torch.sigmoid(x)

def _layernorm(x, axis=-1, eps=1e-05):
    m = x.mean(dim=axis, keepdim=True)
    v = x.var(dim=axis, keepdim=True, unbiased=False)
    return (x - m) / torch.sqrt(v + eps)

def _scatter_add(tgt, idx, src, axis=0):
    return tgt.clone().index_add_(axis, idx, src)

def _segment_sum(src, seg, n):
    out = torch.zeros((n,) + src.shape[1:], dtype=src.dtype)
    return out.index_add_(0, seg, src)

def _pad(x, pw):
    flat = tuple((v for pair in reversed(pw) for v in pair))
    return torch.nn.functional.pad(x, flat)
kernel_name = 'recurrent_scan__memory_aug_recurrent_mem_tr__swiglu_ffn__prompt'

def setup_inputs():

    _w = lambda a: (lambda t: t.to(torch.bfloat16) if t.is_floating_point() else t)(torch.as_tensor(a))

    def _A_setup():
        B, S, Dm = (1, 2048, 640)
        H, Dh = (32, 192)
        M, seg = (8, 32)
        seg = min(seg, S)
        S = S // seg * seg
        return {'x': _w((lambda *s: torch.randn(*s, dtype=torch.bfloat16) * 0.05)(B, S, Dm)), 'mem0': _w((lambda *s: torch.randn(*s, dtype=torch.bfloat16) * 0.2)(B, M, Dm)), 'Wq': _w((lambda *s: torch.randn(*s, dtype=torch.bfloat16) * 0.8)(Dm, H, Dh) * Dm ** (-0.5)), 'Wk': _w((lambda *s: torch.randn(*s, dtype=torch.bfloat16) * 0.8)(Dm, H, Dh) * Dm ** (-0.5)), 'Wv': _w((lambda *s: torch.randn(*s, dtype=torch.bfloat16) * 0.2)(Dm, H, Dh) * Dm ** (-0.5)), 'Wo': _w((lambda *s: torch.randn(*s, dtype=torch.bfloat16) * 0.2)(H, Dh, Dm) * (H * Dh) ** (-0.5)), 'seg_len': seg}
    _A_in = _A_setup()

    def _B_setup():
        B, S, D, F = (1, 2048, 640, 1536)
        return {'x': _w((lambda *s: torch.randn(*s, dtype=torch.bfloat16) * 0.05)(B, S, D)), 'w_gate': _w((lambda *s: torch.randn(*s, dtype=torch.bfloat16) * 0.1)(D, F)), 'w_up': _w((lambda *s: torch.randn(*s, dtype=torch.bfloat16) * 0.1)(D, F)), 'w_down': _w((lambda *s: torch.randn(*s, dtype=torch.bfloat16) * 0.1)(F, D))}
    _B_in = _B_setup()
    return {'A_x': _A_in['x'], 'A_mem0': _A_in['mem0'], 'A_Wq': _A_in['Wq'], 'A_Wk': _A_in['Wk'], 'A_Wv': _A_in['Wv'], 'A_Wo': _A_in['Wo'], 'A_seg_len': _A_in['seg_len'], 'B_x': _B_in['x'], 'B_w_gate': _B_in['w_gate'], 'B_w_up': _B_in['w_up'], 'B_w_down': _B_in['w_down']}

def reference(A_x, A_mem0, A_Wq, A_Wk, A_Wv, A_Wo, A_seg_len, B_x, B_w_gate, B_w_up, B_w_down):

    def _A_ref(x, mem0, Wq, Wk, Wv, Wo, seg_len):
        B, S, Dm = x.shape
        H, Dh = (Wq.shape[1], Wq.shape[2])
        M = mem0.shape[1]
        scale = Dh ** (-0.5)
        n_seg = S // seg_len
        L = M + seg_len
        idx = torch.arange(L)
        mask = (idx[:, None] < M) | (idx[:, None] >= idx[None, :])
        mem = mem0
        outs = []
        for s in range(n_seg):
            xs = x[:, s * seg_len:(s + 1) * seg_len, :].clone()
            h = torch.concatenate([mem, xs], axis=1)
            q = torch.einsum('btd,dhe->bhte', h, Wq)
            k = torch.einsum('btd,dhe->bhte', h, Wk)
            v = torch.einsum('btd,dhe->bhte', h, Wv)
            scores = torch.einsum('bhqe,bhke->bhqk', q, k) * scale
            scores = torch.where(mask[None, None], scores, -1000000000.0)
            p = _softmax(scores, axis=-1)
            o = torch.einsum('bhqk,bhke->bhqe', p, v)
            o = torch.einsum('bhte,hed->btd', o, Wo)
            mem = o[:, :M, :].clone()
            outs.append(o[:, M:, :])
        return torch.concatenate(outs, axis=1)

    def _B_ref(x, w_gate, w_up, w_down):
        g = _silu(x @ w_gate)
        u = x @ w_up
        return g * u @ w_down
    x = A_x
    xn = _layernorm(x, axis=-1)
    s = _A_ref(xn, A_mem0, A_Wq, A_Wk, A_Wv, A_Wo, A_seg_len)
    g = _silu(_B_ref(xn, B_w_gate, B_w_up, B_w_down))
    return x + s * g
```

```asm
; @launch grid=(256,1,1) block=(256,1,1) lds=163840
.amdgcn_target "amdgcn-amd-amdhsa--gfx950"
.text
.globl recurrent_scan__memory_aug_recurrent_mem_tr__swiglu_ffn__prompt_kernel
.p2align 8
.type recurrent_scan__memory_aug_recurrent_mem_tr__swiglu_ffn__prompt_kernel,@function
recurrent_scan__memory_aug_recurrent_mem_tr__swiglu_ffn__prompt_kernel:
s_cmp_ge_u32 s2, 256
s_cbranch_scc1 Lexit
s_load_dwordx2 s[4:5], s[0:1], 104
s_load_dwordx2 s[20:21], s[0:1], 96
s_and_b32 s26, s2, 7
s_lshr_b32 s27, s2, 3
v_lshrrev_b32 v1, 6, v0
v_and_b32 v0, 63, v0
v_readfirstlane_b32 s28, v1
s_mov_b32 s6, 268435456
s_mov_b32 s7, 0x20000
s_mov_b32 s22, 256
s_mov_b32 s23, 0x20000
s_mov_b32 s25, 200000
s_mov_b32 s29, 0x05040100
s_mov_b32 s30, 0x07060302
s_mov_b32 s24, 0
s_waitcnt lgkmcnt(0)
s_and_b32 s5, s5, 0xffff
s_and_b32 s21, s21, 0xffff
s_add_u32 s88, s4, 2228223
s_and_b32 s88, s88, 4292870144
s_sub_u32 s88, s88, s4
s_add_u32 s89, s88, 2097152
s_cmp_ge_u32 s26, 4
s_cbranch_scc1 Lbulk
s_cmp_lt_u32 s27, 8
s_cbranch_scc1 Lqk
s_cmp_lt_u32 s27, 16
s_cbranch_scc1 Lvum
s_cmp_lt_u32 s27, 26
s_cbranch_scc1 Lpu
s_branch Lpx
Lbulk:
s_sub_u32 s26, s26, 4
s_cmp_lt_u32 s27, 18
s_cbranch_scc1 Lg1
s_cmp_lt_u32 s27, 26
s_cbranch_scc1 Lu
s_sub_u32 s32, s27, 26
s_lshl_b32 s32, s32, 2
s_add_u32 s32, s32, s26
s_cmp_lt_u32 s32, 12
s_cbranch_scc1 Lf1
s_cmp_lt_u32 s32, 22
s_cbranch_scc1 Lf2
Lexit:
s_endpgm
Lcal:
s_mul_i32 s46, s28, 2097152
s_add_u32 s40, s88, s46
s_add_u32 s40, s40, 1966080
v_lshlrev_b32 v2, 11, v0
v_mov_b32 v3, 0
buffer_store_dword v3, v2, s[4:7], s40 offen sc1
s_mov_b32 s44, -1
s_mov_b32 s45, -1
s_mov_b64 exec, 1
s_waitcnt vmcnt(0)
s_add_u32 s41, s40, 0
s_memtime s[42:43]
s_waitcnt lgkmcnt(0)
buffer_load_dword v3, off, s[4:7], s41 sc1
s_waitcnt vmcnt(0)
s_memtime s[46:47]
s_waitcnt lgkmcnt(0)
s_sub_u32 s46, s46, s42
s_min_u32 s44, s44, s46
s_add_u32 s41, s40, 8192
s_memtime s[42:43]
s_waitcnt lgkmcnt(0)
buffer_load_dword v3, off, s[4:7], s41 sc1
s_waitcnt vmcnt(0)
s_memtime s[46:47]
s_waitcnt lgkmcnt(0)
s_sub_u32 s46, s46, s42
s_min_u32 s45, s45, s46
s_add_u32 s41, s40, 16384
s_memtime s[42:43]
s_waitcnt lgkmcnt(0)
buffer_load_dword v3, off, s[4:7], s41 sc1
s_waitcnt vmcnt(0)
s_memtime s[46:47]
s_waitcnt lgkmcnt(0)
s_sub_u32 s46, s46, s42
s_min_u32 s44, s44, s46
s_add_u32 s41, s40, 24576
s_memtime s[42:43]
s_waitcnt lgkmcnt(0)
buffer_load_dword v3, off, s[4:7], s41 sc1
s_waitcnt vmcnt(0)
s_memtime s[46:47]
s_waitcnt lgkmcnt(0)
s_sub_u32 s46, s46, s42
s_min_u32 s45, s45, s46
s_add_u32 s41, s40, 36864
s_memtime s[42:43]
s_waitcnt lgkmcnt(0)
buffer_load_dword v3, off, s[4:7], s41 sc1
s_waitcnt vmcnt(0)
s_memtime s[46:47]
s_waitcnt lgkmcnt(0)
s_sub_u32 s46, s46, s42
s_min_u32 s44, s44, s46
s_add_u32 s41, s40, 45056
s_memtime s[42:43]
s_waitcnt lgkmcnt(0)
buffer_load_dword v3, off, s[4:7], s41 sc1
s_waitcnt vmcnt(0)
s_memtime s[46:47]
s_waitcnt lgkmcnt(0)
s_sub_u32 s46, s46, s42
s_min_u32 s45, s45, s46
s_add_u32 s41, s40, 53248
s_memtime s[42:43]
s_waitcnt lgkmcnt(0)
buffer_load_dword v3, off, s[4:7], s41 sc1
s_waitcnt vmcnt(0)
s_memtime s[46:47]
s_waitcnt lgkmcnt(0)
s_sub_u32 s46, s46, s42
s_min_u32 s44, s44, s46
s_add_u32 s41, s40, 61440
s_memtime s[42:43]
s_waitcnt lgkmcnt(0)
buffer_load_dword v3, off, s[4:7], s41 sc1
s_waitcnt vmcnt(0)
s_memtime s[46:47]
s_waitcnt lgkmcnt(0)
s_sub_u32 s46, s46, s42
s_min_u32 s45, s45, s46
s_add_u32 s41, s40, 65536
s_memtime s[42:43]
s_waitcnt lgkmcnt(0)
buffer_load_dword v3, off, s[4:7], s41 sc1
s_waitcnt vmcnt(0)
s_memtime s[46:47]
s_waitcnt lgkmcnt(0)
s_sub_u32 s46, s46, s42
s_min_u32 s44, s44, s46
s_add_u32 s41, s40, 73728
s_memtime s[42:43]
s_waitcnt lgkmcnt(0)
buffer_load_dword v3, off, s[4:7], s41 sc1
s_waitcnt vmcnt(0)
s_memtime s[46:47]
s_waitcnt lgkmcnt(0)
s_sub_u32 s46, s46, s42
s_min_u32 s45, s45, s46
s_add_u32 s41, s40, 81920
s_memtime s[42:43]
s_waitcnt lgkmcnt(0)
buffer_load_dword v3, off, s[4:7], s41 sc1
s_waitcnt vmcnt(0)
s_memtime s[46:47]
s_waitcnt lgkmcnt(0)
s_sub_u32 s46, s46, s42
s_min_u32 s44, s44, s46
s_add_u32 s41, s40, 90112
s_memtime s[42:43]
s_waitcnt lgkmcnt(0)
buffer_load_dword v3, off, s[4:7], s41 sc1
s_waitcnt vmcnt(0)
s_memtime s[46:47]
s_waitcnt lgkmcnt(0)
s_sub_u32 s46, s46, s42
s_min_u32 s45, s45, s46
s_add_u32 s41, s40, 102400
s_memtime s[42:43]
s_waitcnt lgkmcnt(0)
buffer_load_dword v3, off, s[4:7], s41 sc1
s_waitcnt vmcnt(0)
s_memtime s[46:47]
s_waitcnt lgkmcnt(0)
s_sub_u32 s46, s46, s42
s_min_u32 s44, s44, s46
s_add_u32 s41, s40, 110592
s_memtime s[42:43]
s_waitcnt lgkmcnt(0)
buffer_load_dword v3, off, s[4:7], s41 sc1
s_waitcnt vmcnt(0)
s_memtime s[46:47]
s_waitcnt lgkmcnt(0)
s_sub_u32 s46, s46, s42
s_min_u32 s45, s45, s46
s_add_u32 s41, s40, 118784
s_memtime s[42:43]
s_waitcnt lgkmcnt(0)
buffer_load_dword v3, off, s[4:7], s41 sc1
s_waitcnt vmcnt(0)
s_memtime s[46:47]
s_waitcnt lgkmcnt(0)
s_sub_u32 s46, s46, s42
s_min_u32 s44, s44, s46
s_add_u32 s41, s40, 126976
s_memtime s[42:43]
s_waitcnt lgkmcnt(0)
buffer_load_dword v3, off, s[4:7], s41 sc1
s_waitcnt vmcnt(0)
s_memtime s[46:47]
s_waitcnt lgkmcnt(0)
s_sub_u32 s46, s46, s42
s_min_u32 s45, s45, s46
s_cmp_lt_u32 s45, s44
s_cselect_b32 s46, 0x10000, 0
s_lshl_b32 s46, s46, s28
s_add_u32 s46, s46, 1
v_mov_b32 v3, s46
buffer_atomic_add v3, off, s[20:23], 0 offset:4 sc1
s_endpgm
Lqk:
s_load_dwordx2 s[8:9], s[0:1], 16
s_load_dwordx2 s[12:13], s[0:1], 24
s_mov_b32 s10, 7864320
s_mov_b32 s11, 0x20000
s_lshl_b32 s33, s26, 3
s_add_u32 s33, s33, s27
s_mul_i32 s53, s26, 11264
s_add_u32 s53, s53, 131072
v_lshlrev_b32 v2, 4, v0
s_lshl_b32 s46, s28, 15
v_add_u32 v3, s46, v2
v_and_b32 v9, 15, v0
v_lshrrev_b32 v10, 4, v0
v_mov_b32 v4, 0x44444444
v_mov_b32 v1, 0xeeeeeeee
v_cmp_lt_u32 vcc, 7, v9
s_nop 1
v_cndmask_b32 v4, v4, v1, vcc
v_and_b32 v11, 1, v10
v_lshlrev_b32 v8, 2, v11
v_lshrrev_b32 v1, 1, v10
v_add_u32 v11, v8, v1
v_lshl_add_u32 v8, v1, 4, v8
v_mov_b32 v12, -1
v_mov_b32 v13, -1
v_mov_b32 v14, -1
v_mov_b32 v15, -1
s_and_b32 s46, s28, 1
s_mul_i32 s47, s46, 192
s_mul_i32 s48, s33, 384
s_add_u32 s47, s47, s48
s_mov_b32 s56, s47
v_mul_u32_u24 v6, 192, v10
v_mad_u32_u24 v6, v9, 12, v6
s_mul_i32 s48, s33, 640
v_add_u32 v5, s48, v2
v_mov_b32 v1, 2146435072
v_cmp_gt_u32 vcc, 40, v0
s_nop 1
v_cndmask_b32 v5, v1, v5, vcc
s_and_b32 s46, s28, 1
s_mul_i32 s46, s46, 65536
s_lshr_b32 s47, s28, 1
s_lshl_b32 s47, s47, 13
s_add_u32 s46, s46, s47
s_add_u32 s46, s46, s53
s_add_u32 s46, s46, s89
buffer_store_dwordx4 v[12:15], v5, s[4:7], s46 offen sc1
s_waitcnt lgkmcnt(0)
s_cmp_ge_u32 s28, 2
s_cselect_b32 s8, s12, s8
s_cselect_b32 s9, s13, s9
s_and_b32 s9, s9, 0xffff
s_lshl_b32 s46, s33, 7
s_add_u32 s46, s46, 393216
v_lshl_add_u32 v15, v0, 14, s46
s_cmp_eq_u32 s28, 0
s_cselect_b32 s46, 40, 0
v_mov_b32 v1, 2146435072
v_cmp_gt_u32 vcc, s46, v0
s_nop 1
v_cndmask_b32 v15, v1, v15, vcc
v_mov_b32 v1, 0
s_add_u32 s46, s89, 8192
buffer_store_dword v1, v15, s[4:7], s89 offen sc1
buffer_store_dword v1, v15, s[4:7], s46 offen sc1
s_mul_i32 s34, s28, 11
s_add_u32 s34, s34, 1
s_lshr_b32 s34, s34, 2
s_mul_i32 s35, s34, 786432
s_mov_b32 s46, s34
s_lshl_b32 s47, s46, 10
s_add_u32 s93, s47, 153600
s_cmp_ge_u32 s46, 8
s_cselect_b32 s48, 8192, 0
s_add_u32 s90, s47, s48
s_add_u32 s46, s46, 1
s_cmp_eq_u32 s46, 10
s_cselect_b32 s46, 0, s46
s_lshl_b32 s47, s46, 10
s_add_u32 s94, s47, 153600
s_cmp_ge_u32 s46, 8
s_cselect_b32 s48, 8192, 0
s_add_u32 s91, s47, s48
s_add_u32 s46, s46, 1
s_cmp_eq_u32 s46, 10
s_cselect_b32 s46, 0, s46
s_lshl_b32 s47, s46, 10
s_add_u32 s95, s47, 153600
s_cmp_ge_u32 s46, 8
s_cselect_b32 s48, 8192, 0
s_add_u32 s92, s47, s48
s_add_u32 s46, s46, 1
s_cmp_eq_u32 s46, 10
s_cselect_b32 s46, 0, s46
s_lshl_b32 s47, s46, 10
s_add_u32 s96, s47, 153600
s_add_u32 s46, s46, 1
s_cmp_eq_u32 s46, 10
s_cselect_b32 s46, 0, s46
s_lshl_b32 s47, s46, 10
s_add_u32 s97, s47, 153600
s_add_u32 s46, s46, 1
s_cmp_eq_u32 s46, 10
s_cselect_b32 s46, 0, s46
s_lshl_b32 s47, s46, 10
s_add_u32 s98, s47, 153600
s_add_u32 s46, s46, 1
s_cmp_eq_u32 s46, 10
s_cselect_b32 s46, 0, s46
s_lshl_b32 s47, s46, 10
s_add_u32 s99, s47, 153600
s_add_u32 s46, s46, 1
s_cmp_eq_u32 s46, 10
s_cselect_b32 s46, 0, s46
s_lshl_b32 s47, s46, 10
s_add_u32 s100, s47, 153600
s_add_u32 s46, s46, 1
s_cmp_eq_u32 s46, 10
s_cselect_b32 s46, 0, s46
s_lshl_b32 s47, s46, 10
s_add_u32 s101, s47, 153600
s_add_u32 s46, s46, 1
s_cmp_eq_u32 s46, 10
s_cselect_b32 s46, 0, s46
s_lshl_b32 s47, s46, 10
s_add_u32 s32, s47, 153600
s_add_u32 s46, s46, 1
s_cmp_eq_u32 s46, 10
s_cselect_b32 s46, 0, s46
v_add_u32 v1, 0, v0
v_mul_u32_u24 v134, 5462, v1
v_lshrrev_b32 v134, 16, v134
v_mul_u32_u24 v135, 12, v134
v_sub_u32 v1, v1, v135
v_lshl_add_u32 v12, v1, 4, s56
v_bfe_u32 v1, v134, 0, 1
v_mul_u32_u24 v135, 49152, v1
v_add_u32 v12, v135, v12
v_bfe_u32 v1, v134, 1, 1
v_mul_u32_u24 v135, 196608, v1
v_add_u32 v12, v135, v12
v_bfe_u32 v1, v134, 2, 1
v_mul_u32_u24 v135, 12288, v1
v_add_u32 v12, v135, v12
v_bfe_u32 v1, v134, 3, 1
v_mul_u32_u24 v135, 24576, v1
v_add_u32 v12, v135, v12
v_add_u32 v1, 64, v0
v_mul_u32_u24 v134, 5462, v1
v_lshrrev_b32 v134, 16, v134
v_mul_u32_u24 v135, 12, v134
v_sub_u32 v1, v1, v135
v_lshl_add_u32 v13, v1, 4, s56
v_bfe_u32 v1, v134, 0, 1
v_mul_u32_u24 v135, 49152, v1
v_add_u32 v13, v135, v13
v_bfe_u32 v1, v134, 1, 1
v_mul_u32_u24 v135, 196608, v1
v_add_u32 v13, v135, v13
v_bfe_u32 v1, v134, 2, 1
v_mul_u32_u24 v135, 12288, v1
v_add_u32 v13, v135, v13
v_bfe_u32 v1, v134, 3, 1
v_mul_u32_u24 v135, 24576, v1
v_add_u32 v13, v135, v13
v_add_u32 v1, 128, v0
v_mul_u32_u24 v134, 5462, v1
v_lshrrev_b32 v134, 16, v134
v_mul_u32_u24 v135, 12, v134
v_sub_u32 v1, v1, v135
v_lshl_add_u32 v14, v1, 4, s56
v_bfe_u32 v1, v134, 0, 1
v_mul_u32_u24 v135, 49152, v1
v_add_u32 v14, v135, v14
v_bfe_u32 v1, v134, 1, 1
v_mul_u32_u24 v135, 196608, v1
v_add_u32 v14, v135, v14
v_bfe_u32 v1, v134, 2, 1
v_mul_u32_u24 v135, 12288, v1
v_add_u32 v14, v135, v14
v_bfe_u32 v1, v134, 3, 1
v_mul_u32_u24 v135, 24576, v1
v_add_u32 v14, v135, v14
s_lshl_b32 s16, s28, 15
s_lshl_b32 s18, s28, 13
s_add_u32 s16, s16, 16384
s_add_u32 s18, s18, 131072
s_add_u32 s17, s16, 6144
s_mov_b32 s37, 0
s_cmp_lt_u32 s37, 7864320
s_cselect_b32 s10, 7864320, 0
s_cselect_b32 s38, s37, 0
s_add_u32 m0, s16, 0
s_nop 0
buffer_load_dwordx4 v12, s[8:11], s38 offen lds
s_add_u32 m0, s16, 1024
s_nop 0
buffer_load_dwordx4 v13, s[8:11], s38 offen lds
s_add_u32 m0, s16, 2048
s_nop 0
buffer_load_dwordx4 v14, s[8:11], s38 offen lds
s_add_u32 m0, s16, 3072
s_add_u32 s38, s38, 98304
buffer_load_dwordx4 v12, s[8:11], s38 offen lds
s_add_u32 m0, s16, 4096
s_nop 0
buffer_load_dwordx4 v13, s[8:11], s38 offen lds
s_add_u32 m0, s16, 5120
s_nop 0
buffer_load_dwordx4 v14, s[8:11], s38 offen lds
s_add_u32 s37, s37, 393216
s_waitcnt vmcnt(6)
s_barrier
s_cmp_lg_u32 s28, 0
s_cbranch_scc1 Larr_1
v_mov_b32 v7, 1
s_mov_b64 exec, 1
buffer_atomic_add v7, off, s[20:23], 0 sc1
s_mov_b64 exec, -1
Larr_1:
s_cmp_lt_u32 s37, 7864320
s_cselect_b32 s10, 7864320, 0
s_cselect_b32 s38, s37, 0
s_add_u32 m0, s17, 0
s_nop 0
buffer_load_dwordx4 v12, s[8:11], s38 offen lds
s_add_u32 m0, s17, 1024
s_nop 0
buffer_load_dwordx4 v13, s[8:11], s38 offen lds
s_add_u32 m0, s17, 2048
s_nop 0
buffer_load_dwordx4 v14, s[8:11], s38 offen lds
s_add_u32 m0, s17, 3072
s_add_u32 s38, s38, 98304
buffer_load_dwordx4 v12, s[8:11], s38 offen lds
s_add_u32 m0, s17, 4096
s_nop 0
buffer_load_dwordx4 v13, s[8:11], s38 offen lds
s_add_u32 m0, s17, 5120
s_nop 0
buffer_load_dwordx4 v14, s[8:11], s38 offen lds
s_add_u32 s37, s37, 393216
s_cmp_lt_u32 s37, 7864320
s_cselect_b32 s10, 7864320, 0
s_cselect_b32 s38, s37, 0
s_add_u32 m0, s18, 0
s_nop 0
buffer_load_dwordx4 v12, s[8:11], s38 offen lds
s_add_u32 m0, s18, 1024
s_nop 0
buffer_load_dwordx4 v13, s[8:11], s38 offen lds
s_add_u32 m0, s18, 2048
s_nop 0
buffer_load_dwordx4 v14, s[8:11], s38 offen lds
s_add_u32 m0, s18, 3072
s_add_u32 s38, s38, 98304
buffer_load_dwordx4 v12, s[8:11], s38 offen lds
s_add_u32 m0, s18, 4096
s_nop 0
buffer_load_dwordx4 v13, s[8:11], s38 offen lds
s_add_u32 m0, s18, 5120
s_nop 0
buffer_load_dwordx4 v14, s[8:11], s38 offen lds
s_add_u32 s37, s37, 393216
s_waitcnt vmcnt(12)
v_add_u32 v1, s16, v6
v_add_u32 v154, 4, v1
v_add_u32 v155, 8, v1
ds_read2st64_b32 v[80:81], v1 offset0:0 offset1:3
ds_read2st64_b32 v[82:83], v1 offset0:12 offset1:15
ds_read2st64_b32 v[84:85], v1 offset0:6 offset1:9
ds_read2st64_b32 v[86:87], v1 offset0:18 offset1:21
ds_read2st64_b32 v[88:89], v154 offset0:0 offset1:3
ds_read2st64_b32 v[90:91], v154 offset0:12 offset1:15
ds_read2st64_b32 v[92:93], v154 offset0:6 offset1:9
ds_read2st64_b32 v[94:95], v154 offset0:18 offset1:21
ds_read2st64_b32 v[96:97], v155 offset0:0 offset1:3
ds_read2st64_b32 v[98:99], v155 offset0:12 offset1:15
ds_read2st64_b32 v[100:101], v155 offset0:6 offset1:9
ds_read2st64_b32 v[102:103], v155 offset0:18 offset1:21
s_mov_b32 s39, s16
s_mov_b32 s16, s17
s_mov_b32 s17, s18
s_mov_b32 s18, s39
s_cmp_eq_u32 s28, 0
s_cbranch_scc1 Lcirc_2_0
s_cmp_eq_u32 s28, 1
s_cbranch_scc1 Lcirc_2_7
s_cmp_eq_u32 s28, 2
s_cbranch_scc1 Lcirc_2_5
s_cmp_eq_u32 s28, 3
s_cbranch_scc1 Lcirc_2_2
Lcirc_2_top:
s_waitcnt vmcnt(6)
v_add_u32 v1, s16, v6
v_add_u32 v154, 4, v1
v_add_u32 v155, 8, v1
ds_read2st64_b32 v[80:81], v1 offset0:0 offset1:3
ds_read2st64_b32 v[82:83], v1 offset0:12 offset1:15
ds_read2st64_b32 v[84:85], v1 offset0:6 offset1:9
ds_read2st64_b32 v[86:87], v1 offset0:18 offset1:21
ds_read2st64_b32 v[88:89], v154 offset0:0 offset1:3
ds_read2st64_b32 v[90:91], v154 offset0:12 offset1:15
ds_read2st64_b32 v[92:93], v154 offset0:6 offset1:9
ds_read2st64_b32 v[94:95], v154 offset0:18 offset1:21
ds_read2st64_b32 v[96:97], v155 offset0:0 offset1:3
ds_read2st64_b32 v[98:99], v155 offset0:12 offset1:15
ds_read2st64_b32 v[100:101], v155 offset0:6 offset1:9
ds_read2st64_b32 v[102:103], v155 offset0:18 offset1:21
s_waitcnt lgkmcnt(12)
s_cmp_lt_u32 s37, 7864320
s_cselect_b32 s10, 7864320, 0
s_cselect_b32 s38, s37, 0
s_add_u32 m0, s18, 0
s_nop 0
buffer_load_dwordx4 v12, s[8:11], s38 offen lds
s_add_u32 m0, s18, 1024
s_nop 0
buffer_load_dwordx4 v13, s[8:11], s38 offen lds
s_add_u32 m0, s18, 2048
s_nop 0
buffer_load_dwordx4 v14, s[8:11], s38 offen lds
s_add_u32 m0, s18, 3072
s_add_u32 s38, s38, 98304
buffer_load_dwordx4 v12, s[8:11], s38 offen lds
s_add_u32 m0, s18, 4096
s_nop 0
buffer_load_dwordx4 v13, s[8:11], s38 offen lds
s_add_u32 m0, s18, 5120
s_nop 0
buffer_load_dwordx4 v14, s[8:11], s38 offen lds
s_add_u32 s37, s37, 393216
v_perm_b32 v152, v113, v112, s29
v_accvgpr_write_b32 a212, v152
v_perm_b32 v153, v115, v114, s29
v_accvgpr_write_b32 a213, v153
v_perm_b32 v152, v117, v116, s29
v_accvgpr_write_b32 a214, v152
v_perm_b32 v153, v119, v118, s29
v_accvgpr_write_b32 a215, v153
v_perm_b32 v152, v113, v112, s30
v_accvgpr_write_b32 a220, v152
v_perm_b32 v153, v115, v114, s30
v_accvgpr_write_b32 a221, v153
v_perm_b32 v152, v117, v116, s30
v_accvgpr_write_b32 a222, v152
v_perm_b32 v153, v119, v118, s30
v_accvgpr_write_b32 a223, v153
v_perm_b32 v212, v121, v120, s29
v_perm_b32 v213, v123, v122, s29
v_perm_b32 v214, v125, v124, s29
v_perm_b32 v215, v127, v126, s29
v_perm_b32 v220, v121, v120, s30
v_perm_b32 v221, v123, v122, s30
v_perm_b32 v222, v125, v124, s30
v_perm_b32 v223, v127, v126, s30
v_perm_b32 v68, v129, v128, s29
v_perm_b32 v69, v131, v130, s29
v_perm_b32 v70, v133, v132, s29
v_perm_b32 v71, v135, v134, s29
v_perm_b32 v76, v129, v128, s30
v_perm_b32 v77, v131, v130, s30
v_perm_b32 v78, v133, v132, s30
v_perm_b32 v79, v135, v134, s30
s_cmp_eq_u32 s37, 9043968
s_cbranch_scc1 Lcirc_2_end
s_mov_b32 s39, s16
s_mov_b32 s16, s17
s_mov_b32 s17, s18
s_mov_b32 s18, s39
Lcirc_2_0:
s_waitcnt vmcnt(6)
v_add_u32 v1, s16, v6
v_add_u32 v154, 4, v1
v_add_u32 v155, 8, v1
ds_read2st64_b32 v[112:113], v1 offset0:0 offset1:3
ds_read2st64_b32 v[114:115], v1 offset0:12 offset1:15
ds_read2st64_b32 v[116:117], v1 offset0:6 offset1:9
ds_read2st64_b32 v[118:119], v1 offset0:18 offset1:21
ds_read2st64_b32 v[120:121], v154 offset0:0 offset1:3
ds_read2st64_b32 v[122:123], v154 offset0:12 offset1:15
ds_read2st64_b32 v[124:125], v154 offset0:6 offset1:9
ds_read2st64_b32 v[126:127], v154 offset0:18 offset1:21
ds_read2st64_b32 v[128:129], v155 offset0:0 offset1:3
ds_read2st64_b32 v[130:131], v155 offset0:12 offset1:15
ds_read2st64_b32 v[132:133], v155 offset0:6 offset1:9
ds_read2st64_b32 v[134:135], v155 offset0:18 offset1:21
s_waitcnt lgkmcnt(12)
s_cmp_lt_u32 s37, 7864320
s_cselect_b32 s10, 7864320, 0
s_cselect_b32 s38, s37, 0
s_add_u32 m0, s18, 0
s_nop 0
buffer_load_dwordx4 v12, s[8:11], s38 offen lds
s_add_u32 m0, s18, 1024
s_nop 0
buffer_load_dwordx4 v13, s[8:11], s38 offen lds
s_add_u32 m0, s18, 2048
s_nop 0
buffer_load_dwordx4 v14, s[8:11], s38 offen lds
s_add_u32 m0, s18, 3072
s_add_u32 s38, s38, 98304
buffer_load_dwordx4 v12, s[8:11], s38 offen lds
s_add_u32 m0, s18, 4096
s_nop 0
buffer_load_dwordx4 v13, s[8:11], s38 offen lds
s_add_u32 m0, s18, 5120
s_nop 0
buffer_load_dwordx4 v14, s[8:11], s38 offen lds
s_add_u32 s37, s37, 393216
v_perm_b32 v144, v81, v80, s29
v_perm_b32 v145, v83, v82, s29
v_perm_b32 v146, v85, v84, s29
v_perm_b32 v147, v87, v86, s29
ds_write_b128 v3, v[144:147] offset:0
v_perm_b32 v148, v81, v80, s30
v_perm_b32 v149, v83, v82, s30
v_perm_b32 v150, v85, v84, s30
v_perm_b32 v151, v87, v86, s30
ds_write_b128 v3, v[148:151] offset:2048
v_perm_b32 v144, v89, v88, s29
v_perm_b32 v145, v91, v90, s29
v_perm_b32 v146, v93, v92, s29
v_perm_b32 v147, v95, v94, s29
ds_write_b128 v3, v[144:147] offset:4096
v_perm_b32 v148, v89, v88, s30
v_perm_b32 v149, v91, v90, s30
v_perm_b32 v150, v93, v92, s30
v_perm_b32 v151, v95, v94, s30
ds_write_b128 v3, v[148:151] offset:6144
v_perm_b32 v144, v97, v96, s29
v_perm_b32 v145, v99, v98, s29
v_perm_b32 v146, v101, v100, s29
v_perm_b32 v147, v103, v102, s29
ds_write_b128 v3, v[144:147] offset:8192
v_perm_b32 v148, v97, v96, s30
v_perm_b32 v149, v99, v98, s30
v_perm_b32 v150, v101, v100, s30
v_perm_b32 v151, v103, v102, s30
ds_write_b128 v3, v[148:151] offset:10240
s_mov_b32 s39, s16
s_mov_b32 s16, s17
s_mov_b32 s17, s18
s_mov_b32 s18, s39
s_waitcnt vmcnt(6)
v_add_u32 v1, s16, v6
v_add_u32 v154, 4, v1
v_add_u32 v155, 8, v1
ds_read2st64_b32 v[80:81], v1 offset0:0 offset1:3
ds_read2st64_b32 v[82:83], v1 offset0:12 offset1:15
ds_read2st64_b32 v[84:85], v1 offset0:6 offset1:9
ds_read2st64_b32 v[86:87], v1 offset0:18 offset1:21
ds_read2st64_b32 v[88:89], v154 offset0:0 offset1:3
ds_read2st64_b32 v[90:91], v154 offset0:12 offset1:15
ds_read2st64_b32 v[92:93], v154 offset0:6 offset1:9
ds_read2st64_b32 v[94:95], v154 offset0:18 offset1:21
ds_read2st64_b32 v[96:97], v155 offset0:0 offset1:3
ds_read2st64_b32 v[98:99], v155 offset0:12 offset1:15
ds_read2st64_b32 v[100:101], v155 offset0:6 offset1:9
ds_read2st64_b32 v[102:103], v155 offset0:18 offset1:21
s_waitcnt lgkmcnt(12)
s_cmp_lt_u32 s37, 7864320
s_cselect_b32 s10, 7864320, 0
s_cselect_b32 s38, s37, 0
s_add_u32 m0, s18, 0
s_nop 0
buffer_load_dwordx4 v12, s[8:11], s38 offen lds
s_add_u32 m0, s18, 1024
s_nop 0
buffer_load_dwordx4 v13, s[8:11], s38 offen lds
s_add_u32 m0, s18, 2048
s_nop 0
buffer_load_dwordx4 v14, s[8:11], s38 offen lds
s_add_u32 m0, s18, 3072
s_add_u32 s38, s38, 98304
buffer_load_dwordx4 v12, s[8:11], s38 offen lds
s_add_u32 m0, s18, 4096
s_nop 0
buffer_load_dwordx4 v13, s[8:11], s38 offen lds
s_add_u32 m0, s18, 5120
s_nop 0
buffer_load_dwordx4 v14, s[8:11], s38 offen lds
s_add_u32 s37, s37, 393216
v_perm_b32 v144, v113, v112, s29
v_perm_b32 v145, v115, v114, s29
v_perm_b32 v146, v117, v116, s29
v_perm_b32 v147, v119, v118, s29
ds_write_b128 v3, v[144:147] offset:1024
v_perm_b32 v148, v113, v112, s30
v_perm_b32 v149, v115, v114, s30
v_perm_b32 v150, v117, v116, s30
v_perm_b32 v151, v119, v118, s30
ds_write_b128 v3, v[148:151] offset:3072
v_perm_b32 v144, v121, v120, s29
v_perm_b32 v145, v123, v122, s29
v_perm_b32 v146, v125, v124, s29
v_perm_b32 v147, v127, v126, s29
ds_write_b128 v3, v[144:147] offset:5120
v_perm_b32 v148, v121, v120, s30
v_perm_b32 v149, v123, v122, s30
v_perm_b32 v150, v125, v124, s30
v_perm_b32 v151, v127, v126, s30
ds_write_b128 v3, v[148:151] offset:7168
v_perm_b32 v144, v129, v128, s29
v_perm_b32 v145, v131, v130, s29
v_perm_b32 v146, v133, v132, s29
v_perm_b32 v147, v135, v134, s29
ds_write_b128 v3, v[144:147] offset:9216
v_perm_b32 v148, v129, v128, s30
v_perm_b32 v149, v131, v130, s30
v_perm_b32 v150, v133, v132, s30
v_perm_b32 v151, v135, v134, s30
ds_write_b128 v3, v[148:151] offset:11264
s_cmp_eq_u32 s37, 9043968
s_cbranch_scc1 Lcirc_2_end
s_mov_b32 s39, s16
s_mov_b32 s16, s17
s_mov_b32 s17, s18
s_mov_b32 s18, s39
Lcirc_2_1:
s_waitcnt vmcnt(6)
v_add_u32 v1, s16, v6
v_add_u32 v154, 4, v1
v_add_u32 v155, 8, v1
ds_read2st64_b32 v[112:113], v1 offset0:0 offset1:3
ds_read2st64_b32 v[114:115], v1 offset0:12 offset1:15
ds_read2st64_b32 v[116:117], v1 offset0:6 offset1:9
ds_read2st64_b32 v[118:119], v1 offset0:18 offset1:21
ds_read2st64_b32 v[120:121], v154 offset0:0 offset1:3
ds_read2st64_b32 v[122:123], v154 offset0:12 offset1:15
ds_read2st64_b32 v[124:125], v154 offset0:6 offset1:9
ds_read2st64_b32 v[126:127], v154 offset0:18 offset1:21
ds_read2st64_b32 v[128:129], v155 offset0:0 offset1:3
ds_read2st64_b32 v[130:131], v155 offset0:12 offset1:15
ds_read2st64_b32 v[132:133], v155 offset0:6 offset1:9
ds_read2st64_b32 v[134:135], v155 offset0:18 offset1:21
s_waitcnt lgkmcnt(12)
s_cmp_lt_u32 s37, 7864320
s_cselect_b32 s10, 7864320, 0
s_cselect_b32 s38, s37, 0
s_add_u32 m0, s18, 0
s_nop 0
buffer_load_dwordx4 v12, s[8:11], s38 offen lds
s_add_u32 m0, s18, 1024
s_nop 0
buffer_load_dwordx4 v13, s[8:11], s38 offen lds
s_add_u32 m0, s18, 2048
s_nop 0
buffer_load_dwordx4 v14, s[8:11], s38 offen lds
s_add_u32 m0, s18, 3072
s_add_u32 s38, s38, 98304
buffer_load_dwordx4 v12, s[8:11], s38 offen lds
s_add_u32 m0, s18, 4096
s_nop 0
buffer_load_dwordx4 v13, s[8:11], s38 offen lds
s_add_u32 m0, s18, 5120
s_nop 0
buffer_load_dwordx4 v14, s[8:11], s38 offen lds
s_add_u32 s37, s37, 393216
v_perm_b32 v144, v81, v80, s29
v_perm_b32 v145, v83, v82, s29
v_perm_b32 v146, v85, v84, s29
v_perm_b32 v147, v87, v86, s29
ds_write_b128 v3, v[144:147] offset:12288
v_perm_b32 v148, v81, v80, s30
v_perm_b32 v149, v83, v82, s30
v_perm_b32 v150, v85, v84, s30
v_perm_b32 v151, v87, v86, s30
ds_write_b128 v3, v[148:151] offset:14336
v_perm_b32 v152, v89, v88, s29
v_accvgpr_write_b32 a0, v152
v_perm_b32 v153, v91, v90, s29
v_accvgpr_write_b32 a1, v153
v_perm_b32 v152, v93, v92, s29
v_accvgpr_write_b32 a2, v152
v_perm_b32 v153, v95, v94, s29
v_accvgpr_write_b32 a3, v153
v_perm_b32 v152, v89, v88, s30
v_accvgpr_write_b32 a8, v152
v_perm_b32 v153, v91, v90, s30
v_accvgpr_write_b32 a9, v153
v_perm_b32 v152, v93, v92, s30
v_accvgpr_write_b32 a10, v152
v_perm_b32 v153, v95, v94, s30
v_accvgpr_write_b32 a11, v153
v_perm_b32 v152, v97, v96, s29
v_accvgpr_write_b32 a16, v152
v_perm_b32 v153, v99, v98, s29
v_accvgpr_write_b32 a17, v153
v_perm_b32 v152, v101, v100, s29
v_accvgpr_write_b32 a18, v152
v_perm_b32 v153, v103, v102, s29
v_accvgpr_write_b32 a19, v153
v_perm_b32 v152, v97, v96, s30
v_accvgpr_write_b32 a24, v152
v_perm_b32 v153, v99, v98, s30
v_accvgpr_write_b32 a25, v153
v_perm_b32 v152, v101, v100, s30
v_accvgpr_write_b32 a26, v152
v_perm_b32 v153, v103, v102, s30
v_accvgpr_write_b32 a27, v153
s_mov_b32 s39, s16
s_mov_b32 s16, s17
s_mov_b32 s17, s18
s_mov_b32 s18, s39
s_waitcnt vmcnt(6)
v_add_u32 v1, s16, v6
v_add_u32 v154, 4, v1
v_add_u32 v155, 8, v1
ds_read2st64_b32 v[80:81], v1 offset0:0 offset1:3
ds_read2st64_b32 v[82:83], v1 offset0:12 offset1:15
ds_read2st64_b32 v[84:85], v1 offset0:6 offset1:9
ds_read2st64_b32 v[86:87], v1 offset0:18 offset1:21
ds_read2st64_b32 v[88:89], v154 offset0:0 offset1:3
ds_read2st64_b32 v[90:91], v154 offset0:12 offset1:15
ds_read2st64_b32 v[92:93], v154 offset0:6 offset1:9
ds_read2st64_b32 v[94:95], v154 offset0:18 offset1:21
ds_read2st64_b32 v[96:97], v155 offset0:0 offset1:3
ds_read2st64_b32 v[98:99], v155 offset0:12 offset1:15
ds_read2st64_b32 v[100:101], v155 offset0:6 offset1:9
ds_read2st64_b32 v[102:103], v155 offset0:18 offset1:21
s_waitcnt lgkmcnt(12)
s_cmp_lt_u32 s37, 7864320
s_cselect_b32 s10, 7864320, 0
s_cselect_b32 s38, s37, 0
s_add_u32 m0, s18, 0
s_nop 0
buffer_load_dwordx4 v12, s[8:11], s38 offen lds
s_add_u32 m0, s18, 1024
s_nop 0
buffer_load_dwordx4 v13, s[8:11], s38 offen lds
s_add_u32 m0, s18, 2048
s_nop 0
buffer_load_dwordx4 v14, s[8:11], s38 offen lds
s_add_u32 m0, s18, 3072
s_add_u32 s38, s38, 98304
buffer_load_dwordx4 v12, s[8:11], s38 offen lds
s_add_u32 m0, s18, 4096
s_nop 0
buffer_load_dwordx4 v13, s[8:11], s38 offen lds
s_add_u32 m0, s18, 5120
s_nop 0
buffer_load_dwordx4 v14, s[8:11], s38 offen lds
s_add_u32 s37, s37, 393216
v_perm_b32 v144, v113, v112, s29
v_perm_b32 v145, v115, v114, s29
v_perm_b32 v146, v117, v116, s29
v_perm_b32 v147, v119, v118, s29
ds_write_b128 v3, v[144:147] offset:13312
v_perm_b32 v148, v113, v112, s30
v_perm_b32 v149, v115, v114, s30
v_perm_b32 v150, v117, v116, s30
v_perm_b32 v151, v119, v118, s30
ds_write_b128 v3, v[148:151] offset:15360
v_perm_b32 v152, v121, v120, s29
v_accvgpr_write_b32 a4, v152
v_perm_b32 v153, v123, v122, s29
v_accvgpr_write_b32 a5, v153
v_perm_b32 v152, v125, v124, s29
v_accvgpr_write_b32 a6, v152
v_perm_b32 v153, v127, v126, s29
v_accvgpr_write_b32 a7, v153
v_perm_b32 v152, v121, v120, s30
v_accvgpr_write_b32 a12, v152
v_perm_b32 v153, v123, v122, s30
v_accvgpr_write_b32 a13, v153
v_perm_b32 v152, v125, v124, s30
v_accvgpr_write_b32 a14, v152
v_perm_b32 v153, v127, v126, s30
v_accvgpr_write_b32 a15, v153
v_perm_b32 v152, v129, v128, s29
v_accvgpr_write_b32 a20, v152
v_perm_b32 v153, v131, v130, s29
v_accvgpr_write_b32 a21, v153
v_perm_b32 v152, v133, v132, s29
v_accvgpr_write_b32 a22, v152
v_perm_b32 v153, v135, v134, s29
v_accvgpr_write_b32 a23, v153
v_perm_b32 v152, v129, v128, s30
v_accvgpr_write_b32 a28, v152
v_perm_b32 v153, v131, v130, s30
v_accvgpr_write_b32 a29, v153
v_perm_b32 v152, v133, v132, s30
v_accvgpr_write_b32 a30, v152
v_perm_b32 v153, v135, v134, s30
v_accvgpr_write_b32 a31, v153
s_cmp_eq_u32 s37, 9043968
s_cbranch_scc1 Lcirc_2_end
s_mov_b32 s39, s16
s_mov_b32 s16, s17
s_mov_b32 s17, s18
s_mov_b32 s18, s39
Lcirc_2_2:
s_waitcnt vmcnt(6)
v_add_u32 v1, s16, v6
v_add_u32 v154, 4, v1
v_add_u32 v155, 8, v1
ds_read2st64_b32 v[112:113], v1 offset0:0 offset1:3
ds_read2st64_b32 v[114:115], v1 offset0:12 offset1:15
ds_read2st64_b32 v[116:117], v1 offset0:6 offset1:9
ds_read2st64_b32 v[118:119], v1 offset0:18 offset1:21
ds_read2st64_b32 v[120:121], v154 offset0:0 offset1:3
ds_read2st64_b32 v[122:123], v154 offset0:12 offset1:15
ds_read2st64_b32 v[124:125], v154 offset0:6 offset1:9
ds_read2st64_b32 v[126:127], v154 offset0:18 offset1:21
ds_read2st64_b32 v[128:129], v155 offset0:0 offset1:3
ds_read2st64_b32 v[130:131], v155 offset0:12 offset1:15
ds_read2st64_b32 v[132:133], v155 offset0:6 offset1:9
ds_read2st64_b32 v[134:135], v155 offset0:18 offset1:21
s_waitcnt lgkmcnt(12)
s_cmp_lt_u32 s37, 7864320
s_cselect_b32 s10, 7864320, 0
s_cselect_b32 s38, s37, 0
s_add_u32 m0, s18, 0
s_nop 0
buffer_load_dwordx4 v12, s[8:11], s38 offen lds
s_add_u32 m0, s18, 1024
s_nop 0
buffer_load_dwordx4 v13, s[8:11], s38 offen lds
s_add_u32 m0, s18, 2048
s_nop 0
buffer_load_dwordx4 v14, s[8:11], s38 offen lds
s_add_u32 m0, s18, 3072
s_add_u32 s38, s38, 98304
buffer_load_dwordx4 v12, s[8:11], s38 offen lds
s_add_u32 m0, s18, 4096
s_nop 0
buffer_load_dwordx4 v13, s[8:11], s38 offen lds
s_add_u32 m0, s18, 5120
s_nop 0
buffer_load_dwordx4 v14, s[8:11], s38 offen lds
s_add_u32 s37, s37, 393216
v_perm_b32 v152, v81, v80, s29
v_accvgpr_write_b32 a32, v152
v_perm_b32 v153, v83, v82, s29
v_accvgpr_write_b32 a33, v153
v_perm_b32 v152, v85, v84, s29
v_accvgpr_write_b32 a34, v152
v_perm_b32 v153, v87, v86, s29
v_accvgpr_write_b32 a35, v153
v_perm_b32 v152, v81, v80, s30
v_accvgpr_write_b32 a40, v152
v_perm_b32 v153, v83, v82, s30
v_accvgpr_write_b32 a41, v153
v_perm_b32 v152, v85, v84, s30
v_accvgpr_write_b32 a42, v152
v_perm_b32 v153, v87, v86, s30
v_accvgpr_write_b32 a43, v153
v_perm_b32 v152, v89, v88, s29
v_accvgpr_write_b32 a48, v152
v_perm_b32 v153, v91, v90, s29
v_accvgpr_write_b32 a49, v153
v_perm_b32 v152, v93, v92, s29
v_accvgpr_write_b32 a50, v152
v_perm_b32 v153, v95, v94, s29
v_accvgpr_write_b32 a51, v153
v_perm_b32 v152, v89, v88, s30
v_accvgpr_write_b32 a56, v152
v_perm_b32 v153, v91, v90, s30
v_accvgpr_write_b32 a57, v153
v_perm_b32 v152, v93, v92, s30
v_accvgpr_write_b32 a58, v152
v_perm_b32 v153, v95, v94, s30
v_accvgpr_write_b32 a59, v153
v_perm_b32 v152, v97, v96, s29
v_accvgpr_write_b32 a64, v152
v_perm_b32 v153, v99, v98, s29
v_accvgpr_write_b32 a65, v153
v_perm_b32 v152, v101, v100, s29
v_accvgpr_write_b32 a66, v152
v_perm_b32 v153, v103, v102, s29
v_accvgpr_write_b32 a67, v153
v_perm_b32 v152, v97, v96, s30
v_accvgpr_write_b32 a72, v152
v_perm_b32 v153, v99, v98, s30
v_accvgpr_write_b32 a73, v153
v_perm_b32 v152, v101, v100, s30
v_accvgpr_write_b32 a74, v152
v_perm_b32 v153, v103, v102, s30
v_accvgpr_write_b32 a75, v153
s_mov_b32 s39, s16
s_mov_b32 s16, s17
s_mov_b32 s17, s18
s_mov_b32 s18, s39
s_waitcnt vmcnt(6)
v_add_u32 v1, s16, v6
v_add_u32 v154, 4, v1
v_add_u32 v155, 8, v1
ds_read2st64_b32 v[80:81], v1 offset0:0 offset1:3
ds_read2st64_b32 v[82:83], v1 offset0:12 offset1:15
ds_read2st64_b32 v[84:85], v1 offset0:6 offset1:9
ds_read2st64_b32 v[86:87], v1 offset0:18 offset1:21
ds_read2st64_b32 v[88:89], v154 offset0:0 offset1:3
ds_read2st64_b32 v[90:91], v154 offset0:12 offset1:15
ds_read2st64_b32 v[92:93], v154 offset0:6 offset1:9
ds_read2st64_b32 v[94:95], v154 offset0:18 offset1:21
ds_read2st64_b32 v[96:97], v155 offset0:0 offset1:3
ds_read2st64_b32 v[98:99], v155 offset0:12 offset1:15
ds_read2st64_b32 v[100:101], v155 offset0:6 offset1:9
ds_read2st64_b32 v[102:103], v155 offset0:18 offset1:21
s_waitcnt lgkmcnt(12)
s_cmp_lt_u32 s37, 7864320
s_cselect_b32 s10, 7864320, 0
s_cselect_b32 s38, s37, 0
s_add_u32 m0, s18, 0
s_nop 0
buffer_load_dwordx4 v12, s[8:11], s38 offen lds
s_add_u32 m0, s18, 1024
s_nop 0
buffer_load_dwordx4 v13, s[8:11], s38 offen lds
s_add_u32 m0, s18, 2048
s_nop 0
buffer_load_dwordx4 v14, s[8:11], s38 offen lds
s_add_u32 m0, s18, 3072
s_add_u32 s38, s38, 98304
buffer_load_dwordx4 v12, s[8:11], s38 offen lds
s_add_u32 m0, s18, 4096
s_nop 0
buffer_load_dwordx4 v13, s[8:11], s38 offen lds
s_add_u32 m0, s18, 5120
s_nop 0
buffer_load_dwordx4 v14, s[8:11], s38 offen lds
s_add_u32 s37, s37, 393216
v_perm_b32 v152, v113, v112, s29
v_accvgpr_write_b32 a36, v152
v_perm_b32 v153, v115, v114, s29
v_accvgpr_write_b32 a37, v153
v_perm_b32 v152, v117, v116, s29
v_accvgpr_write_b32 a38, v152
v_perm_b32 v153, v119, v118, s29
v_accvgpr_write_b32 a39, v153
v_perm_b32 v152, v113, v112, s30
v_accvgpr_write_b32 a44, v152
v_perm_b32 v153, v115, v114, s30
v_accvgpr_write_b32 a45, v153
v_perm_b32 v152, v117, v116, s30
v_accvgpr_write_b32 a46, v152
v_perm_b32 v153, v119, v118, s30
v_accvgpr_write_b32 a47, v153
v_perm_b32 v152, v121, v120, s29
v_accvgpr_write_b32 a52, v152
v_perm_b32 v153, v123, v122, s29
v_accvgpr_write_b32 a53, v153
v_perm_b32 v152, v125, v124, s29
v_accvgpr_write_b32 a54, v152
v_perm_b32 v153, v127, v126, s29
v_accvgpr_write_b32 a55, v153
v_perm_b32 v152, v121, v120, s30
v_accvgpr_write_b32 a60, v152
v_perm_b32 v153, v123, v122, s30
v_accvgpr_write_b32 a61, v153
v_perm_b32 v152, v125, v124, s30
v_accvgpr_write_b32 a62, v152
v_perm_b32 v153, v127, v126, s30
v_accvgpr_write_b32 a63, v153
v_perm_b32 v152, v129, v128, s29
v_accvgpr_write_b32 a68, v152
v_perm_b32 v153, v131, v130, s29
v_accvgpr_write_b32 a69, v153
v_perm_b32 v152, v133, v132, s29
v_accvgpr_write_b32 a70, v152
v_perm_b32 v153, v135, v134, s29
v_accvgpr_write_b32 a71, v153
v_perm_b32 v152, v129, v128, s30
v_accvgpr_write_b32 a76, v152
v_perm_b32 v153, v131, v130, s30
v_accvgpr_write_b32 a77, v153
v_perm_b32 v152, v133, v132, s30
v_accvgpr_write_b32 a78, v152
v_perm_b32 v153, v135, v134, s30
v_accvgpr_write_b32 a79, v153
s_cmp_eq_u32 s37, 9043968
s_cbranch_scc1 Lcirc_2_end
s_mov_b32 s39, s16
s_mov_b32 s16, s17
s_mov_b32 s17, s18
s_mov_b32 s18, s39
Lcirc_2_3:
s_waitcnt vmcnt(6)
v_add_u32 v1, s16, v6
v_add_u32 v154, 4, v1
v_add_u32 v155, 8, v1
ds_read2st64_b32 v[112:113], v1 offset0:0 offset1:3
ds_read2st64_b32 v[114:115], v1 offset0:12 offset1:15
ds_read2st64_b32 v[116:117], v1 offset0:6 offset1:9
ds_read2st64_b32 v[118:119], v1 offset0:18 offset1:21
ds_read2st64_b32 v[120:121], v154 offset0:0 offset1:3
ds_read2st64_b32 v[122:123], v154 offset0:12 offset1:15
ds_read2st64_b32 v[124:125], v154 offset0:6 offset1:9
ds_read2st64_b32 v[126:127], v154 offset0:18 offset1:21
ds_read2st64_b32 v[128:129], v155 offset0:0 offset1:3
ds_read2st64_b32 v[130:131], v155 offset0:12 offset1:15
ds_read2st64_b32 v[132:133], v155 offset0:6 offset1:9
ds_read2st64_b32 v[134:135], v155 offset0:18 offset1:21
s_waitcnt lgkmcnt(12)
s_cmp_lt_u32 s37, 7864320
s_cselect_b32 s10, 7864320, 0
s_cselect_b32 s38, s37, 0
s_add_u32 m0, s18, 0
s_nop 0
buffer_load_dwordx4 v12, s[8:11], s38 offen lds
s_add_u32 m0, s18, 1024
s_nop 0
buffer_load_dwordx4 v13, s[8:11], s38 offen lds
s_add_u32 m0, s18, 2048
s_nop 0
buffer_load_dwordx4 v14, s[8:11], s38 offen lds
s_add_u32 m0, s18, 3072
s_add_u32 s38, s38, 98304
buffer_load_dwordx4 v12, s[8:11], s38 offen lds
s_add_u32 m0, s18, 4096
s_nop 0
buffer_load_dwordx4 v13, s[8:11], s38 offen lds
s_add_u32 m0, s18, 5120
s_nop 0
buffer_load_dwordx4 v14, s[8:11], s38 offen lds
s_add_u32 s37, s37, 393216
v_perm_b32 v152, v81, v80, s29
v_accvgpr_write_b32 a80, v152
v_perm_b32 v153, v83, v82, s29
v_accvgpr_write_b32 a81, v153
v_perm_b32 v152, v85, v84, s29
v_accvgpr_write_b32 a82, v152
v_perm_b32 v153, v87, v86, s29
v_accvgpr_write_b32 a83, v153
v_perm_b32 v152, v81, v80, s30
v_accvgpr_write_b32 a88, v152
v_perm_b32 v153, v83, v82, s30
v_accvgpr_write_b32 a89, v153
v_perm_b32 v152, v85, v84, s30
v_accvgpr_write_b32 a90, v152
v_perm_b32 v153, v87, v86, s30
v_accvgpr_write_b32 a91, v153
v_perm_b32 v152, v89, v88, s29
v_accvgpr_write_b32 a96, v152
v_perm_b32 v153, v91, v90, s29
v_accvgpr_write_b32 a97, v153
v_perm_b32 v152, v93, v92, s29
v_accvgpr_write_b32 a98, v152
v_perm_b32 v153, v95, v94, s29
v_accvgpr_write_b32 a99, v153
v_perm_b32 v152, v89, v88, s30
v_accvgpr_write_b32 a104, v152
v_perm_b32 v153, v91, v90, s30
v_accvgpr_write_b32 a105, v153
v_perm_b32 v152, v93, v92, s30
v_accvgpr_write_b32 a106, v152
v_perm_b32 v153, v95, v94, s30
v_accvgpr_write_b32 a107, v153
v_perm_b32 v152, v97, v96, s29
v_accvgpr_write_b32 a112, v152
v_perm_b32 v153, v99, v98, s29
v_accvgpr_write_b32 a113, v153
v_perm_b32 v152, v101, v100, s29
v_accvgpr_write_b32 a114, v152
v_perm_b32 v153, v103, v102, s29
v_accvgpr_write_b32 a115, v153
v_perm_b32 v152, v97, v96, s30
v_accvgpr_write_b32 a120, v152
v_perm_b32 v153, v99, v98, s30
v_accvgpr_write_b32 a121, v153
v_perm_b32 v152, v101, v100, s30
v_accvgpr_write_b32 a122, v152
v_perm_b32 v153, v103, v102, s30
v_accvgpr_write_b32 a123, v153
s_mov_b32 s39, s16
s_mov_b32 s16, s17
s_mov_b32 s17, s18
s_mov_b32 s18, s39
s_waitcnt vmcnt(6)
v_add_u32 v1, s16, v6
v_add_u32 v154, 4, v1
v_add_u32 v155, 8, v1
ds_read2st64_b32 v[80:81], v1 offset0:0 offset1:3
ds_read2st64_b32 v[82:83], v1 offset0:12 offset1:15
ds_read2st64_b32 v[84:85], v1 offset0:6 offset1:9
ds_read2st64_b32 v[86:87], v1 offset0:18 offset1:21
ds_read2st64_b32 v[88:89], v154 offset0:0 offset1:3
ds_read2st64_b32 v[90:91], v154 offset0:12 offset1:15
ds_read2st64_b32 v[92:93], v154 offset0:6 offset1:9
ds_read2st64_b32 v[94:95], v154 offset0:18 offset1:21
ds_read2st64_b32 v[96:97], v155 offset0:0 offset1:3
ds_read2st64_b32 v[98:99], v155 offset0:12 offset1:15
ds_read2st64_b32 v[100:101], v155 offset0:6 offset1:9
ds_read2st64_b32 v[102:103], v155 offset0:18 offset1:21
s_waitcnt lgkmcnt(12)
s_cmp_lt_u32 s37, 7864320
s_cselect_b32 s10, 7864320, 0
s_cselect_b32 s38, s37, 0
s_add_u32 m0, s18, 0
s_nop 0
buffer_load_dwordx4 v12, s[8:11], s38 offen lds
s_add_u32 m0, s18, 1024
s_nop 0
buffer_load_dwordx4 v13, s[8:11], s38 offen lds
s_add_u32 m0, s18, 2048
s_nop 0
buffer_load_dwordx4 v14, s[8:11], s38 offen lds
s_add_u32 m0, s18, 3072
s_add_u32 s38, s38, 98304
buffer_load_dwordx4 v12, s[8:11], s38 offen lds
s_add_u32 m0, s18, 4096
s_nop 0
buffer_load_dwordx4 v13, s[8:11], s38 offen lds
s_add_u32 m0, s18, 5120
s_nop 0
buffer_load_dwordx4 v14, s[8:11], s38 offen lds
s_add_u32 s37, s37, 393216
v_perm_b32 v152, v113, v112, s29
v_accvgpr_write_b32 a84, v152
v_perm_b32 v153, v115, v114, s29
v_accvgpr_write_b32 a85, v153
v_perm_b32 v152, v117, v116, s29
v_accvgpr_write_b32 a86, v152
v_perm_b32 v153, v119, v118, s29
v_accvgpr_write_b32 a87, v153
v_perm_b32 v152, v113, v112, s30
v_accvgpr_write_b32 a92, v152
v_perm_b32 v153, v115, v114, s30
v_accvgpr_write_b32 a93, v153
v_perm_b32 v152, v117, v116, s30
v_accvgpr_write_b32 a94, v152
v_perm_b32 v153, v119, v118, s30
v_accvgpr_write_b32 a95, v153
v_perm_b32 v152, v121, v120, s29
v_accvgpr_write_b32 a100, v152
v_perm_b32 v153, v123, v122, s29
v_accvgpr_write_b32 a101, v153
v_perm_b32 v152, v125, v124, s29
v_accvgpr_write_b32 a102, v152
v_perm_b32 v153, v127, v126, s29
v_accvgpr_write_b32 a103, v153
v_perm_b32 v152, v121, v120, s30
v_accvgpr_write_b32 a108, v152
v_perm_b32 v153, v123, v122, s30
v_accvgpr_write_b32 a109, v153
v_perm_b32 v152, v125, v124, s30
v_accvgpr_write_b32 a110, v152
v_perm_b32 v153, v127, v126, s30
v_accvgpr_write_b32 a111, v153
v_perm_b32 v152, v129, v128, s29
v_accvgpr_write_b32 a116, v152
v_perm_b32 v153, v131, v130, s29
v_accvgpr_write_b32 a117, v153
v_perm_b32 v152, v133, v132, s29
v_accvgpr_write_b32 a118, v152
v_perm_b32 v153, v135, v134, s29
v_accvgpr_write_b32 a119, v153
v_perm_b32 v152, v129, v128, s30
v_accvgpr_write_b32 a124, v152
v_perm_b32 v153, v131, v130, s30
v_accvgpr_write_b32 a125, v153
v_perm_b32 v152, v133, v132, s30
v_accvgpr_write_b32 a126, v152
v_perm_b32 v153, v135, v134, s30
v_accvgpr_write_b32 a127, v153
s_cmp_eq_u32 s37, 9043968
s_cbranch_scc1 Lcirc_2_end
s_mov_b32 s39, s16
s_mov_b32 s16, s17
s_mov_b32 s17, s18
s_mov_b32 s18, s39
Lcirc_2_4:
s_waitcnt vmcnt(6)
v_add_u32 v1, s16, v6
v_add_u32 v154, 4, v1
v_add_u32 v155, 8, v1
ds_read2st64_b32 v[112:113], v1 offset0:0 offset1:3
ds_read2st64_b32 v[114:115], v1 offset0:12 offset1:15
ds_read2st64_b32 v[116:117], v1 offset0:6 offset1:9
ds_read2st64_b32 v[118:119], v1 offset0:18 offset1:21
ds_read2st64_b32 v[120:121], v154 offset0:0 offset1:3
ds_read2st64_b32 v[122:123], v154 offset0:12 offset1:15
ds_read2st64_b32 v[124:125], v154 offset0:6 offset1:9
ds_read2st64_b32 v[126:127], v154 offset0:18 offset1:21
ds_read2st64_b32 v[128:129], v155 offset0:0 offset1:3
ds_read2st64_b32 v[130:131], v155 offset0:12 offset1:15
ds_read2st64_b32 v[132:133], v155 offset0:6 offset1:9
ds_read2st64_b32 v[134:135], v155 offset0:18 offset1:21
s_waitcnt lgkmcnt(12)
s_cmp_lt_u32 s37, 7864320
s_cselect_b32 s10, 7864320, 0
s_cselect_b32 s38, s37, 0
s_add_u32 m0, s18, 0
s_nop 0
buffer_load_dwordx4 v12, s[8:11], s38 offen lds
s_add_u32 m0, s18, 1024
s_nop 0
buffer_load_dwordx4 v13, s[8:11], s38 offen lds
s_add_u32 m0, s18, 2048
s_nop 0
buffer_load_dwordx4 v14, s[8:11], s38 offen lds
s_add_u32 m0, s18, 3072
s_add_u32 s38, s38, 98304
buffer_load_dwordx4 v12, s[8:11], s38 offen lds
s_add_u32 m0, s18, 4096
s_nop 0
buffer_load_dwordx4 v13, s[8:11], s38 offen lds
s_add_u32 m0, s18, 5120
s_nop 0
buffer_load_dwordx4 v14, s[8:11], s38 offen lds
s_add_u32 s37, s37, 393216
v_perm_b32 v152, v81, v80, s29
v_accvgpr_write_b32 a128, v152
v_perm_b32 v153, v83, v82, s29
v_accvgpr_write_b32 a129, v153
v_perm_b32 v152, v85, v84, s29
v_accvgpr_write_b32 a130, v152
v_perm_b32 v153, v87, v86, s29
v_accvgpr_write_b32 a131, v153
v_perm_b32 v152, v81, v80, s30
v_accvgpr_write_b32 a136, v152
v_perm_b32 v153, v83, v82, s30
v_accvgpr_write_b32 a137, v153
v_perm_b32 v152, v85, v84, s30
v_accvgpr_write_b32 a138, v152
v_perm_b32 v153, v87, v86, s30
v_accvgpr_write_b32 a139, v153
v_perm_b32 v152, v89, v88, s29
v_accvgpr_write_b32 a224, v152
v_perm_b32 v153, v91, v90, s29
v_accvgpr_write_b32 a225, v153
v_perm_b32 v152, v93, v92, s29
v_accvgpr_write_b32 a226, v152
v_perm_b32 v153, v95, v94, s29
v_accvgpr_write_b32 a227, v153
v_perm_b32 v152, v89, v88, s30
v_accvgpr_write_b32 a232, v152
v_perm_b32 v153, v91, v90, s30
v_accvgpr_write_b32 a233, v153
v_perm_b32 v152, v93, v92, s30
v_accvgpr_write_b32 a234, v152
v_perm_b32 v153, v95, v94, s30
v_accvgpr_write_b32 a235, v153
v_perm_b32 v224, v97, v96, s29
v_perm_b32 v225, v99, v98, s29
v_perm_b32 v226, v101, v100, s29
v_perm_b32 v227, v103, v102, s29
v_perm_b32 v232, v97, v96, s30
v_perm_b32 v233, v99, v98, s30
v_perm_b32 v234, v101, v100, s30
v_perm_b32 v235, v103, v102, s30
s_mov_b32 s39, s16
s_mov_b32 s16, s17
s_mov_b32 s17, s18
s_mov_b32 s18, s39
s_waitcnt vmcnt(6)
v_add_u32 v1, s16, v6
v_add_u32 v154, 4, v1
v_add_u32 v155, 8, v1
ds_read2st64_b32 v[80:81], v1 offset0:0 offset1:3
ds_read2st64_b32 v[82:83], v1 offset0:12 offset1:15
ds_read2st64_b32 v[84:85], v1 offset0:6 offset1:9
ds_read2st64_b32 v[86:87], v1 offset0:18 offset1:21
ds_read2st64_b32 v[88:89], v154 offset0:0 offset1:3
ds_read2st64_b32 v[90:91], v154 offset0:12 offset1:15
ds_read2st64_b32 v[92:93], v154 offset0:6 offset1:9
ds_read2st64_b32 v[94:95], v154 offset0:18 offset1:21
ds_read2st64_b32 v[96:97], v155 offset0:0 offset1:3
ds_read2st64_b32 v[98:99], v155 offset0:12 offset1:15
ds_read2st64_b32 v[100:101], v155 offset0:6 offset1:9
ds_read2st64_b32 v[102:103], v155 offset0:18 offset1:21
s_waitcnt lgkmcnt(12)
s_cmp_lt_u32 s37, 7864320
s_cselect_b32 s10, 7864320, 0
s_cselect_b32 s38, s37, 0
s_add_u32 m0, s18, 0
s_nop 0
buffer_load_dwordx4 v12, s[8:11], s38 offen lds
s_add_u32 m0, s18, 1024
s_nop 0
buffer_load_dwordx4 v13, s[8:11], s38 offen lds
s_add_u32 m0, s18, 2048
s_nop 0
buffer_load_dwordx4 v14, s[8:11], s38 offen lds
s_add_u32 m0, s18, 3072
s_add_u32 s38, s38, 98304
buffer_load_dwordx4 v12, s[8:11], s38 offen lds
s_add_u32 m0, s18, 4096
s_nop 0
buffer_load_dwordx4 v13, s[8:11], s38 offen lds
s_add_u32 m0, s18, 5120
s_nop 0
buffer_load_dwordx4 v14, s[8:11], s38 offen lds
s_add_u32 s37, s37, 393216
v_perm_b32 v152, v113, v112, s29
v_accvgpr_write_b32 a132, v152
v_perm_b32 v153, v115, v114, s29
v_accvgpr_write_b32 a133, v153
v_perm_b32 v152, v117, v116, s29
v_accvgpr_write_b32 a134, v152
v_perm_b32 v153, v119, v118, s29
v_accvgpr_write_b32 a135, v153
v_perm_b32 v152, v113, v112, s30
v_accvgpr_write_b32 a140, v152
v_perm_b32 v153, v115, v114, s30
v_accvgpr_write_b32 a141, v153
v_perm_b32 v152, v117, v116, s30
v_accvgpr_write_b32 a142, v152
v_perm_b32 v153, v119, v118, s30
v_accvgpr_write_b32 a143, v153
v_perm_b32 v152, v121, v120, s29
v_accvgpr_write_b32 a228, v152
v_perm_b32 v153, v123, v122, s29
v_accvgpr_write_b32 a229, v153
v_perm_b32 v152, v125, v124, s29
v_accvgpr_write_b32 a230, v152
v_perm_b32 v153, v127, v126, s29
v_accvgpr_write_b32 a231, v153
v_perm_b32 v152, v121, v120, s30
v_accvgpr_write_b32 a236, v152
v_perm_b32 v153, v123, v122, s30
v_accvgpr_write_b32 a237, v153
v_perm_b32 v152, v125, v124, s30
v_accvgpr_write_b32 a238, v152
v_perm_b32 v153, v127, v126, s30
v_accvgpr_write_b32 a239, v153
v_perm_b32 v228, v129, v128, s29
v_perm_b32 v229, v131, v130, s29
v_perm_b32 v230, v133, v132, s29
v_perm_b32 v231, v135, v134, s29
v_perm_b32 v236, v129, v128, s30
v_perm_b32 v237, v131, v130, s30
v_perm_b32 v238, v133, v132, s30
v_perm_b32 v239, v135, v134, s30
s_cmp_eq_u32 s37, 9043968
s_cbranch_scc1 Lcirc_2_end
s_mov_b32 s39, s16
s_mov_b32 s16, s17
s_mov_b32 s17, s18
s_mov_b32 s18, s39
Lcirc_2_5:
s_waitcnt vmcnt(6)
v_add_u32 v1, s16, v6
v_add_u32 v154, 4, v1
v_add_u32 v155, 8, v1
ds_read2st64_b32 v[112:113], v1 offset0:0 offset1:3
ds_read2st64_b32 v[114:115], v1 offset0:12 offset1:15
ds_read2st64_b32 v[116:117], v1 offset0:6 offset1:9
ds_read2st64_b32 v[118:119], v1 offset0:18 offset1:21
ds_read2st64_b32 v[120:121], v154 offset0:0 offset1:3
ds_read2st64_b32 v[122:123], v154 offset0:12 offset1:15
ds_read2st64_b32 v[124:125], v154 offset0:6 offset1:9
ds_read2st64_b32 v[126:127], v154 offset0:18 offset1:21
ds_read2st64_b32 v[128:129], v155 offset0:0 offset1:3
ds_read2st64_b32 v[130:131], v155 offset0:12 offset1:15
ds_read2st64_b32 v[132:133], v155 offset0:6 offset1:9
ds_read2st64_b32 v[134:135], v155 offset0:18 offset1:21
s_waitcnt lgkmcnt(12)
s_cmp_lt_u32 s37, 7864320
s_cselect_b32 s10, 7864320, 0
s_cselect_b32 s38, s37, 0
s_add_u32 m0, s18, 0
s_nop 0
buffer_load_dwordx4 v12, s[8:11], s38 offen lds
s_add_u32 m0, s18, 1024
s_nop 0
buffer_load_dwordx4 v13, s[8:11], s38 offen lds
s_add_u32 m0, s18, 2048
s_nop 0
buffer_load_dwordx4 v14, s[8:11], s38 offen lds
s_add_u32 m0, s18, 3072
s_add_u32 s38, s38, 98304
buffer_load_dwordx4 v12, s[8:11], s38 offen lds
s_add_u32 m0, s18, 4096
s_nop 0
buffer_load_dwordx4 v13, s[8:11], s38 offen lds
s_add_u32 m0, s18, 5120
s_nop 0
buffer_load_dwordx4 v14, s[8:11], s38 offen lds
s_add_u32 s37, s37, 393216
v_perm_b32 v152, v81, v80, s29
v_accvgpr_write_b32 a144, v152
v_perm_b32 v153, v83, v82, s29
v_accvgpr_write_b32 a145, v153
v_perm_b32 v152, v85, v84, s29
v_accvgpr_write_b32 a146, v152
v_perm_b32 v153, v87, v86, s29
v_accvgpr_write_b32 a147, v153
v_perm_b32 v152, v81, v80, s30
v_accvgpr_write_b32 a152, v152
v_perm_b32 v153, v83, v82, s30
v_accvgpr_write_b32 a153, v153
v_perm_b32 v152, v85, v84, s30
v_accvgpr_write_b32 a154, v152
v_perm_b32 v153, v87, v86, s30
v_accvgpr_write_b32 a155, v153
v_perm_b32 v152, v89, v88, s29
v_accvgpr_write_b32 a240, v152
v_perm_b32 v153, v91, v90, s29
v_accvgpr_write_b32 a241, v153
v_perm_b32 v152, v93, v92, s29
v_accvgpr_write_b32 a242, v152
v_perm_b32 v153, v95, v94, s29
v_accvgpr_write_b32 a243, v153
v_perm_b32 v152, v89, v88, s30
v_accvgpr_write_b32 a248, v152
v_perm_b32 v153, v91, v90, s30
v_accvgpr_write_b32 a249, v153
v_perm_b32 v152, v93, v92, s30
v_accvgpr_write_b32 a250, v152
v_perm_b32 v153, v95, v94, s30
v_accvgpr_write_b32 a251, v153
v_perm_b32 v240, v97, v96, s29
v_perm_b32 v241, v99, v98, s29
v_perm_b32 v242, v101, v100, s29
v_perm_b32 v243, v103, v102, s29
v_perm_b32 v248, v97, v96, s30
v_perm_b32 v249, v99, v98, s30
v_perm_b32 v250, v101, v100, s30
v_perm_b32 v251, v103, v102, s30
s_mov_b32 s39, s16
s_mov_b32 s16, s17
s_mov_b32 s17, s18
s_mov_b32 s18, s39
s_waitcnt vmcnt(6)
v_add_u32 v1, s16, v6
v_add_u32 v154, 4, v1
v_add_u32 v155, 8, v1
ds_read2st64_b32 v[80:81], v1 offset0:0 offset1:3
ds_read2st64_b32 v[82:83], v1 offset0:12 offset1:15
ds_read2st64_b32 v[84:85], v1 offset0:6 offset1:9
ds_read2st64_b32 v[86:87], v1 offset0:18 offset1:21
ds_read2st64_b32 v[88:89], v154 offset0:0 offset1:3
ds_read2st64_b32 v[90:91], v154 offset0:12 offset1:15
ds_read2st64_b32 v[92:93], v154 offset0:6 offset1:9
ds_read2st64_b32 v[94:95], v154 offset0:18 offset1:21
ds_read2st64_b32 v[96:97], v155 offset0:0 offset1:3
ds_read2st64_b32 v[98:99], v155 offset0:12 offset1:15
ds_read2st64_b32 v[100:101], v155 offset0:6 offset1:9
ds_read2st64_b32 v[102:103], v155 offset0:18 offset1:21
s_waitcnt lgkmcnt(12)
s_cmp_lt_u32 s37, 7864320
s_cselect_b32 s10, 7864320, 0
s_cselect_b32 s38, s37, 0
s_add_u32 m0, s18, 0
s_nop 0
buffer_load_dwordx4 v12, s[8:11], s38 offen lds
s_add_u32 m0, s18, 1024
s_nop 0
buffer_load_dwordx4 v13, s[8:11], s38 offen lds
s_add_u32 m0, s18, 2048
s_nop 0
buffer_load_dwordx4 v14, s[8:11], s38 offen lds
s_add_u32 m0, s18, 3072
s_add_u32 s38, s38, 98304
buffer_load_dwordx4 v12, s[8:11], s38 offen lds
s_add_u32 m0, s18, 4096
s_nop 0
buffer_load_dwordx4 v13, s[8:11], s38 offen lds
s_add_u32 m0, s18, 5120
s_nop 0
buffer_load_dwordx4 v14, s[8:11], s38 offen lds
s_add_u32 s37, s37, 393216
v_perm_b32 v152, v113, v112, s29
v_accvgpr_write_b32 a148, v152
v_perm_b32 v153, v115, v114, s29
v_accvgpr_write_b32 a149, v153
v_perm_b32 v152, v117, v116, s29
v_accvgpr_write_b32 a150, v152
v_perm_b32 v153, v119, v118, s29
v_accvgpr_write_b32 a151, v153
v_perm_b32 v152, v113, v112, s30
v_accvgpr_write_b32 a156, v152
v_perm_b32 v153, v115, v114, s30
v_accvgpr_write_b32 a157, v153
v_perm_b32 v152, v117, v116, s30
v_accvgpr_write_b32 a158, v152
v_perm_b32 v153, v119, v118, s30
v_accvgpr_write_b32 a159, v153
v_perm_b32 v152, v121, v120, s29
v_accvgpr_write_b32 a244, v152
v_perm_b32 v153, v123, v122, s29
v_accvgpr_write_b32 a245, v153
v_perm_b32 v152, v125, v124, s29
v_accvgpr_write_b32 a246, v152
v_perm_b32 v153, v127, v126, s29
v_accvgpr_write_b32 a247, v153
v_perm_b32 v152, v121, v120, s30
v_accvgpr_write_b32 a252, v152
v_perm_b32 v153, v123, v122, s30
v_accvgpr_write_b32 a253, v153
v_perm_b32 v152, v125, v124, s30
v_accvgpr_write_b32 a254, v152
v_perm_b32 v153, v127, v126, s30
v_accvgpr_write_b32 a255, v153
v_perm_b32 v244, v129, v128, s29
v_perm_b32 v245, v131, v130, s29
v_perm_b32 v246, v133, v132, s29
v_perm_b32 v247, v135, v134, s29
v_perm_b32 v252, v129, v128, s30
v_perm_b32 v253, v131, v130, s30
v_perm_b32 v254, v133, v132, s30
v_perm_b32 v255, v135, v134, s30
s_cmp_eq_u32 s37, 9043968
s_cbranch_scc1 Lcirc_2_end
s_mov_b32 s39, s16
s_mov_b32 s16, s17
s_mov_b32 s17, s18
s_mov_b32 s18, s39
Lcirc_2_6:
s_waitcnt vmcnt(6)
v_add_u32 v1, s16, v6
v_add_u32 v154, 4, v1
v_add_u32 v155, 8, v1
ds_read2st64_b32 v[112:113], v1 offset0:0 offset1:3
ds_read2st64_b32 v[114:115], v1 offset0:12 offset1:15
ds_read2st64_b32 v[116:117], v1 offset0:6 offset1:9
ds_read2st64_b32 v[118:119], v1 offset0:18 offset1:21
ds_read2st64_b32 v[120:121], v154 offset0:0 offset1:3
ds_read2st64_b32 v[122:123], v154 offset0:12 offset1:15
ds_read2st64_b32 v[124:125], v154 offset0:6 offset1:9
ds_read2st64_b32 v[126:127], v154 offset0:18 offset1:21
ds_read2st64_b32 v[128:129], v155 offset0:0 offset1:3
ds_read2st64_b32 v[130:131], v155 offset0:12 offset1:15
ds_read2st64_b32 v[132:133], v155 offset0:6 offset1:9
ds_read2st64_b32 v[134:135], v155 offset0:18 offset1:21
s_waitcnt lgkmcnt(12)
s_cmp_lt_u32 s37, 7864320
s_cselect_b32 s10, 7864320, 0
s_cselect_b32 s38, s37, 0
s_add_u32 m0, s18, 0
s_nop 0
buffer_load_dwordx4 v12, s[8:11], s38 offen lds
s_add_u32 m0, s18, 1024
s_nop 0
buffer_load_dwordx4 v13, s[8:11], s38 offen lds
s_add_u32 m0, s18, 2048
s_nop 0
buffer_load_dwordx4 v14, s[8:11], s38 offen lds
s_add_u32 m0, s18, 3072
s_add_u32 s38, s38, 98304
buffer_load_dwordx4 v12, s[8:11], s38 offen lds
s_add_u32 m0, s18, 4096
s_nop 0
buffer_load_dwordx4 v13, s[8:11], s38 offen lds
s_add_u32 m0, s18, 5120
s_nop 0
buffer_load_dwordx4 v14, s[8:11], s38 offen lds
s_add_u32 s37, s37, 393216
v_perm_b32 v152, v81, v80, s29
v_accvgpr_write_b32 a160, v152
v_perm_b32 v153, v83, v82, s29
v_accvgpr_write_b32 a161, v153
v_perm_b32 v152, v85, v84, s29
v_accvgpr_write_b32 a162, v152
v_perm_b32 v153, v87, v86, s29
v_accvgpr_write_b32 a163, v153
v_perm_b32 v152, v81, v80, s30
v_accvgpr_write_b32 a168, v152
v_perm_b32 v153, v83, v82, s30
v_accvgpr_write_b32 a169, v153
v_perm_b32 v152, v85, v84, s30
v_accvgpr_write_b32 a170, v152
v_perm_b32 v153, v87, v86, s30
v_accvgpr_write_b32 a171, v153
v_perm_b32 v160, v89, v88, s29
v_perm_b32 v161, v91, v90, s29
v_perm_b32 v162, v93, v92, s29
v_perm_b32 v163, v95, v94, s29
v_perm_b32 v168, v89, v88, s30
v_perm_b32 v169, v91, v90, s30
v_perm_b32 v170, v93, v92, s30
v_perm_b32 v171, v95, v94, s30
v_perm_b32 v16, v97, v96, s29
v_perm_b32 v17, v99, v98, s29
v_perm_b32 v18, v101, v100, s29
v_perm_b32 v19, v103, v102, s29
v_perm_b32 v24, v97, v96, s30
v_perm_b32 v25, v99, v98, s30
v_perm_b32 v26, v101, v100, s30
v_perm_b32 v27, v103, v102, s30
s_mov_b32 s39, s16
s_mov_b32 s16, s17
s_mov_b32 s17, s18
s_mov_b32 s18, s39
s_waitcnt vmcnt(6)
v_add_u32 v1, s16, v6
v_add_u32 v154, 4, v1
v_add_u32 v155, 8, v1
ds_read2st64_b32 v[80:81], v1 offset0:0 offset1:3
ds_read2st64_b32 v[82:83], v1 offset0:12 offset1:15
ds_read2st64_b32 v[84:85], v1 offset0:6 offset1:9
ds_read2st64_b32 v[86:87], v1 offset0:18 offset1:21
ds_read2st64_b32 v[88:89], v154 offset0:0 offset1:3
ds_read2st64_b32 v[90:91], v154 offset0:12 offset1:15
ds_read2st64_b32 v[92:93], v154 offset0:6 offset1:9
ds_read2st64_b32 v[94:95], v154 offset0:18 offset1:21
ds_read2st64_b32 v[96:97], v155 offset0:0 offset1:3
ds_read2st64_b32 v[98:99], v155 offset0:12 offset1:15
ds_read2st64_b32 v[100:101], v155 offset0:6 offset1:9
ds_read2st64_b32 v[102:103], v155 offset0:18 offset1:21
s_waitcnt lgkmcnt(12)
s_cmp_lt_u32 s37, 7864320
s_cselect_b32 s10, 7864320, 0
s_cselect_b32 s38, s37, 0
s_add_u32 m0, s18, 0
s_nop 0
buffer_load_dwordx4 v12, s[8:11], s38 offen lds
s_add_u32 m0, s18, 1024
s_nop 0
buffer_load_dwordx4 v13, s[8:11], s38 offen lds
s_add_u32 m0, s18, 2048
s_nop 0
buffer_load_dwordx4 v14, s[8:11], s38 offen lds
s_add_u32 m0, s18, 3072
s_add_u32 s38, s38, 98304
buffer_load_dwordx4 v12, s[8:11], s38 offen lds
s_add_u32 m0, s18, 4096
s_nop 0
buffer_load_dwordx4 v13, s[8:11], s38 offen lds
s_add_u32 m0, s18, 5120
s_nop 0
buffer_load_dwordx4 v14, s[8:11], s38 offen lds
s_add_u32 s37, s37, 393216
v_perm_b32 v152, v113, v112, s29
v_accvgpr_write_b32 a164, v152
v_perm_b32 v153, v115, v114, s29
v_accvgpr_write_b32 a165, v153
v_perm_b32 v152, v117, v116, s29
v_accvgpr_write_b32 a166, v152
v_perm_b32 v153, v119, v118, s29
v_accvgpr_write_b32 a167, v153
v_perm_b32 v152, v113, v112, s30
v_accvgpr_write_b32 a172, v152
v_perm_b32 v153, v115, v114, s30
v_accvgpr_write_b32 a173, v153
v_perm_b32 v152, v117, v116, s30
v_accvgpr_write_b32 a174, v152
v_perm_b32 v153, v119, v118, s30
v_accvgpr_write_b32 a175, v153
v_perm_b32 v164, v121, v120, s29
v_perm_b32 v165, v123, v122, s29
v_perm_b32 v166, v125, v124, s29
v_perm_b32 v167, v127, v126, s29
v_perm_b32 v172, v121, v120, s30
v_perm_b32 v173, v123, v122, s30
v_perm_b32 v174, v125, v124, s30
v_perm_b32 v175, v127, v126, s30
v_perm_b32 v20, v129, v128, s29
v_perm_b32 v21, v131, v130, s29
v_perm_b32 v22, v133, v132, s29
v_perm_b32 v23, v135, v134, s29
v_perm_b32 v28, v129, v128, s30
v_perm_b32 v29, v131, v130, s30
v_perm_b32 v30, v133, v132, s30
v_perm_b32 v31, v135, v134, s30
s_cmp_eq_u32 s37, 9043968
s_cbranch_scc1 Lcirc_2_end
s_mov_b32 s39, s16
s_mov_b32 s16, s17
s_mov_b32 s17, s18
s_mov_b32 s18, s39
Lcirc_2_7:
s_waitcnt vmcnt(6)
v_add_u32 v1, s16, v6
v_add_u32 v154, 4, v1
v_add_u32 v155, 8, v1
ds_read2st64_b32 v[112:113], v1 offset0:0 offset1:3
ds_read2st64_b32 v[114:115], v1 offset0:12 offset1:15
ds_read2st64_b32 v[116:117], v1 offset0:6 offset1:9
ds_read2st64_b32 v[118:119], v1 offset0:18 offset1:21
ds_read2st64_b32 v[120:121], v154 offset0:0 offset1:3
ds_read2st64_b32 v[122:123], v154 offset0:12 offset1:15
ds_read2st64_b32 v[124:125], v154 offset0:6 offset1:9
ds_read2st64_b32 v[126:127], v154 offset0:18 offset1:21
ds_read2st64_b32 v[128:129], v155 offset0:0 offset1:3
ds_read2st64_b32 v[130:131], v155 offset0:12 offset1:15
ds_read2st64_b32 v[132:133], v155 offset0:6 offset1:9
ds_read2st64_b32 v[134:135], v155 offset0:18 offset1:21
s_waitcnt lgkmcnt(12)
s_cmp_lt_u32 s37, 7864320
s_cselect_b32 s10, 7864320, 0
s_cselect_b32 s38, s37, 0
s_add_u32 m0, s18, 0
s_nop 0
buffer_load_dwordx4 v12, s[8:11], s38 offen lds
s_add_u32 m0, s18, 1024
s_nop 0
buffer_load_dwordx4 v13, s[8:11], s38 offen lds
s_add_u32 m0, s18, 2048
s_nop 0
buffer_load_dwordx4 v14, s[8:11], s38 offen lds
s_add_u32 m0, s18, 3072
s_add_u32 s38, s38, 98304
buffer_load_dwordx4 v12, s[8:11], s38 offen lds
s_add_u32 m0, s18, 4096
s_nop 0
buffer_load_dwordx4 v13, s[8:11], s38 offen lds
s_add_u32 m0, s18, 5120
s_nop 0
buffer_load_dwordx4 v14, s[8:11], s38 offen lds
s_add_u32 s37, s37, 393216
v_perm_b32 v152, v81, v80, s29
v_accvgpr_write_b32 a176, v152
v_perm_b32 v153, v83, v82, s29
v_accvgpr_write_b32 a177, v153
v_perm_b32 v152, v85, v84, s29
v_accvgpr_write_b32 a178, v152
v_perm_b32 v153, v87, v86, s29
v_accvgpr_write_b32 a179, v153
v_perm_b32 v152, v81, v80, s30
v_accvgpr_write_b32 a184, v152
v_perm_b32 v153, v83, v82, s30
v_accvgpr_write_b32 a185, v153
v_perm_b32 v152, v85, v84, s30
v_accvgpr_write_b32 a186, v152
v_perm_b32 v153, v87, v86, s30
v_accvgpr_write_b32 a187, v153
v_perm_b32 v176, v89, v88, s29
v_perm_b32 v177, v91, v90, s29
v_perm_b32 v178, v93, v92, s29
v_perm_b32 v179, v95, v94, s29
v_perm_b32 v184, v89, v88, s30
v_perm_b32 v185, v91, v90, s30
v_perm_b32 v186, v93, v92, s30
v_perm_b32 v187, v95, v94, s30
v_perm_b32 v32, v97, v96, s29
v_perm_b32 v33, v99, v98, s29
v_perm_b32 v34, v101, v100, s29
v_perm_b32 v35, v103, v102, s29
v_perm_b32 v40, v97, v96, s30
v_perm_b32 v41, v99, v98, s30
v_perm_b32 v42, v101, v100, s30
v_perm_b32 v43, v103, v102, s30
s_mov_b32 s39, s16
s_mov_b32 s16, s17
s_mov_b32 s17, s18
s_mov_b32 s18, s39
s_waitcnt vmcnt(6)
v_add_u32 v1, s16, v6
v_add_u32 v154, 4, v1
v_add_u32 v155, 8, v1
ds_read2st64_b32 v[80:81], v1 offset0:0 offset1:3
ds_read2st64_b32 v[82:83], v1 offset0:12 offset1:15
ds_read2st64_b32 v[84:85], v1 offset0:6 offset1:9
ds_read2st64_b32 v[86:87], v1 offset0:18 offset1:21
ds_read2st64_b32 v[88:89], v154 offset0:0 offset1:3
ds_read2st64_b32 v[90:91], v154 offset0:12 offset1:15
ds_read2st64_b32 v[92:93], v154 offset0:6 offset1:9
ds_read2st64_b32 v[94:95], v154 offset0:18 offset1:21
ds_read2st64_b32 v[96:97], v155 offset0:0 offset1:3
ds_read2st64_b32 v[98:99], v155 offset0:12 offset1:15
ds_read2st64_b32 v[100:101], v155 offset0:6 offset1:9
ds_read2st64_b32 v[102:103], v155 offset0:18 offset1:21
s_waitcnt lgkmcnt(12)
s_cmp_lt_u32 s37, 7864320
s_cselect_b32 s10, 7864320, 0
s_cselect_b32 s38, s37, 0
s_add_u32 m0, s18, 0
s_nop 0
buffer_load_dwordx4 v12, s[8:11], s38 offen lds
s_add_u32 m0, s18, 1024
s_nop 0
buffer_load_dwordx4 v13, s[8:11], s38 offen lds
s_add_u32 m0, s18, 2048
s_nop 0
buffer_load_dwordx4 v14, s[8:11], s38 offen lds
s_add_u32 m0, s18, 3072
s_add_u32 s38, s38, 98304
buffer_load_dwordx4 v12, s[8:11], s38 offen lds
s_add_u32 m0, s18, 4096
s_nop 0
buffer_load_dwordx4 v13, s[8:11], s38 offen lds
s_add_u32 m0, s18, 5120
s_nop 0
buffer_load_dwordx4 v14, s[8:11], s38 offen lds
s_add_u32 s37, s37, 393216
v_perm_b32 v152, v113, v112, s29
v_accvgpr_write_b32 a180, v152
v_perm_b32 v153, v115, v114, s29
v_accvgpr_write_b32 a181, v153
v_perm_b32 v152, v117, v116, s29
v_accvgpr_write_b32 a182, v152
v_perm_b32 v153, v119, v118, s29
v_accvgpr_write_b32 a183, v153
v_perm_b32 v152, v113, v112, s30
v_accvgpr_write_b32 a188, v152
v_perm_b32 v153, v115, v114, s30
v_accvgpr_write_b32 a189, v153
v_perm_b32 v152, v117, v116, s30
v_accvgpr_write_b32 a190, v152
v_perm_b32 v153, v119, v118, s30
v_accvgpr_write_b32 a191, v153
v_perm_b32 v180, v121, v120, s29
v_perm_b32 v181, v123, v122, s29
v_perm_b32 v182, v125, v124, s29
v_perm_b32 v183, v127, v126, s29
v_perm_b32 v188, v121, v120, s30
v_perm_b32 v189, v123, v122, s30
v_perm_b32 v190, v125, v124, s30
v_perm_b32 v191, v127, v126, s30
v_perm_b32 v36, v129, v128, s29
v_perm_b32 v37, v131, v130, s29
v_perm_b32 v38, v133, v132, s29
v_perm_b32 v39, v135, v134, s29
v_perm_b32 v44, v129, v128, s30
v_perm_b32 v45, v131, v130, s30
v_perm_b32 v46, v133, v132, s30
v_perm_b32 v47, v135, v134, s30
s_cmp_eq_u32 s37, 9043968
s_cbranch_scc1 Lcirc_2_end
s_mov_b32 s39, s16
s_mov_b32 s16, s17
s_mov_b32 s17, s18
s_mov_b32 s18, s39
Lcirc_2_8:
s_waitcnt vmcnt(6)
v_add_u32 v1, s16, v6
v_add_u32 v154, 4, v1
v_add_u32 v155, 8, v1
ds_read2st64_b32 v[112:113], v1 offset0:0 offset1:3
ds_read2st64_b32 v[114:115], v1 offset0:12 offset1:15
ds_read2st64_b32 v[116:117], v1 offset0:6 offset1:9
ds_read2st64_b32 v[118:119], v1 offset0:18 offset1:21
ds_read2st64_b32 v[120:121], v154 offset0:0 offset1:3
ds_read2st64_b32 v[122:123], v154 offset0:12 offset1:15
ds_read2st64_b32 v[124:125], v154 offset0:6 offset1:9
ds_read2st64_b32 v[126:127], v154 offset0:18 offset1:21
ds_read2st64_b32 v[128:129], v155 offset0:0 offset1:3
ds_read2st64_b32 v[130:131], v155 offset0:12 offset1:15
ds_read2st64_b32 v[132:133], v155 offset0:6 offset1:9
ds_read2st64_b32 v[134:135], v155 offset0:18 offset1:21
s_waitcnt lgkmcnt(12)
s_cmp_lt_u32 s37, 7864320
s_cselect_b32 s10, 7864320, 0
s_cselect_b32 s38, s37, 0
s_add_u32 m0, s18, 0
s_nop 0
buffer_load_dwordx4 v12, s[8:11], s38 offen lds
s_add_u32 m0, s18, 1024
s_nop 0
buffer_load_dwordx4 v13, s[8:11], s38 offen lds
s_add_u32 m0, s18, 2048
s_nop 0
buffer_load_dwordx4 v14, s[8:11], s38 offen lds
s_add_u32 m0, s18, 3072
s_add_u32 s38, s38, 98304
buffer_load_dwordx4 v12, s[8:11], s38 offen lds
s_add_u32 m0, s18, 4096
s_nop 0
buffer_load_dwordx4 v13, s[8:11], s38 offen lds
s_add_u32 m0, s18, 5120
s_nop 0
buffer_load_dwordx4 v14, s[8:11], s38 offen lds
s_add_u32 s37, s37, 393216
v_perm_b32 v152, v81, v80, s29
v_accvgpr_write_b32 a192, v152
v_perm_b32 v153, v83, v82, s29
v_accvgpr_write_b32 a193, v153
v_perm_b32 v152, v85, v84, s29
v_accvgpr_write_b32 a194, v152
v_perm_b32 v153, v87, v86, s29
v_accvgpr_write_b32 a195, v153
v_perm_b32 v152, v81, v80, s30
v_accvgpr_write_b32 a200, v152
v_perm_b32 v153, v83, v82, s30
v_accvgpr_write_b32 a201, v153
v_perm_b32 v152, v85, v84, s30
v_accvgpr_write_b32 a202, v152
v_perm_b32 v153, v87, v86, s30
v_accvgpr_write_b32 a203, v153
v_perm_b32 v192, v89, v88, s29
v_perm_b32 v193, v91, v90, s29
v_perm_b32 v194, v93, v92, s29
v_perm_b32 v195, v95, v94, s29
v_perm_b32 v200, v89, v88, s30
v_perm_b32 v201, v91, v90, s30
v_perm_b32 v202, v93, v92, s30
v_perm_b32 v203, v95, v94, s30
v_perm_b32 v48, v97, v96, s29
v_perm_b32 v49, v99, v98, s29
v_perm_b32 v50, v101, v100, s29
v_perm_b32 v51, v103, v102, s29
v_perm_b32 v56, v97, v96, s30
v_perm_b32 v57, v99, v98, s30
v_perm_b32 v58, v101, v100, s30
v_perm_b32 v59, v103, v102, s30
s_mov_b32 s39, s16
s_mov_b32 s16, s17
s_mov_b32 s17, s18
s_mov_b32 s18, s39
s_waitcnt vmcnt(6)
v_add_u32 v1, s16, v6
v_add_u32 v154, 4, v1
v_add_u32 v155, 8, v1
ds_read2st64_b32 v[80:81], v1 offset0:0 offset1:3
ds_read2st64_b32 v[82:83], v1 offset0:12 offset1:15
ds_read2st64_b32 v[84:85], v1 offset0:6 offset1:9
ds_read2st64_b32 v[86:87], v1 offset0:18 offset1:21
ds_read2st64_b32 v[88:89], v154 offset0:0 offset1:3
ds_read2st64_b32 v[90:91], v154 offset0:12 offset1:15
ds_read2st64_b32 v[92:93], v154 offset0:6 offset1:9
ds_read2st64_b32 v[94:95], v154 offset0:18 offset1:21
ds_read2st64_b32 v[96:97], v155 offset0:0 offset1:3
ds_read2st64_b32 v[98:99], v155 offset0:12 offset1:15
ds_read2st64_b32 v[100:101], v155 offset0:6 offset1:9
ds_read2st64_b32 v[102:103], v155 offset0:18 offset1:21
s_waitcnt lgkmcnt(12)
s_cmp_lt_u32 s37, 7864320
s_cselect_b32 s10, 7864320, 0
s_cselect_b32 s38, s37, 0
s_add_u32 m0, s18, 0
s_nop 0
buffer_load_dwordx4 v12, s[8:11], s38 offen lds
s_add_u32 m0, s18, 1024
s_nop 0
buffer_load_dwordx4 v13, s[8:11], s38 offen lds
s_add_u32 m0, s18, 2048
s_nop 0
buffer_load_dwordx4 v14, s[8:11], s38 offen lds
s_add_u32 m0, s18, 3072
s_add_u32 s38, s38, 98304
buffer_load_dwordx4 v12, s[8:11], s38 offen lds
s_add_u32 m0, s18, 4096
s_nop 0
buffer_load_dwordx4 v13, s[8:11], s38 offen lds
s_add_u32 m0, s18, 5120
s_nop 0
buffer_load_dwordx4 v14, s[8:11], s38 offen lds
s_add_u32 s37, s37, 393216
v_perm_b32 v152, v113, v112, s29
v_accvgpr_write_b32 a196, v152
v_perm_b32 v153, v115, v114, s29
v_accvgpr_write_b32 a197, v153
v_perm_b32 v152, v117, v116, s29
v_accvgpr_write_b32 a198, v152
v_perm_b32 v153, v119, v118, s29
v_accvgpr_write_b32 a199, v153
v_perm_b32 v152, v113, v112, s30
v_accvgpr_write_b32 a204, v152
v_perm_b32 v153, v115, v114, s30
v_accvgpr_write_b32 a205, v153
v_perm_b32 v152, v117, v116, s30
v_accvgpr_write_b32 a206, v152
v_perm_b32 v153, v119, v118, s30
v_accvgpr_write_b32 a207, v153
v_perm_b32 v196, v121, v120, s29
v_perm_b32 v197, v123, v122, s29
v_perm_b32 v198, v125, v124, s29
v_perm_b32 v199, v127, v126, s29
v_perm_b32 v204, v121, v120, s30
v_perm_b32 v205, v123, v122, s30
v_perm_b32 v206, v125, v124, s30
v_perm_b32 v207, v127, v126, s30
v_perm_b32 v52, v129, v128, s29
v_perm_b32 v53, v131, v130, s29
v_perm_b32 v54, v133, v132, s29
v_perm_b32 v55, v135, v134, s29
v_perm_b32 v60, v129, v128, s30
v_perm_b32 v61, v131, v130, s30
v_perm_b32 v62, v133, v132, s30
v_perm_b32 v63, v135, v134, s30
s_cmp_eq_u32 s37, 9043968
s_cbranch_scc1 Lcirc_2_end
s_mov_b32 s39, s16
s_mov_b32 s16, s17
s_mov_b32 s17, s18
s_mov_b32 s18, s39
Lcirc_2_9:
s_waitcnt vmcnt(6)
v_add_u32 v1, s16, v6
v_add_u32 v154, 4, v1
v_add_u32 v155, 8, v1
ds_read2st64_b32 v[112:113], v1 offset0:0 offset1:3
ds_read2st64_b32 v[114:115], v1 offset0:12 offset1:15
ds_read2st64_b32 v[116:117], v1 offset0:6 offset1:9
ds_read2st64_b32 v[118:119], v1 offset0:18 offset1:21
ds_read2st64_b32 v[120:121], v154 offset0:0 offset1:3
ds_read2st64_b32 v[122:123], v154 offset0:12 offset1:15
ds_read2st64_b32 v[124:125], v154 offset0:6 offset1:9
ds_read2st64_b32 v[126:127], v154 offset0:18 offset1:21
ds_read2st64_b32 v[128:129], v155 offset0:0 offset1:3
ds_read2st64_b32 v[130:131], v155 offset0:12 offset1:15
ds_read2st64_b32 v[132:133], v155 offset0:6 offset1:9
ds_read2st64_b32 v[134:135], v155 offset0:18 offset1:21
s_waitcnt lgkmcnt(12)
s_cmp_lt_u32 s37, 7864320
s_cselect_b32 s10, 7864320, 0
s_cselect_b32 s38, s37, 0
s_add_u32 m0, s18, 0
s_nop 0
buffer_load_dwordx4 v12, s[8:11], s38 offen lds
s_add_u32 m0, s18, 1024
s_nop 0
buffer_load_dwordx4 v13, s[8:11], s38 offen lds
s_add_u32 m0, s18, 2048
s_nop 0
buffer_load_dwordx4 v14, s[8:11], s38 offen lds
s_add_u32 m0, s18, 3072
s_add_u32 s38, s38, 98304
buffer_load_dwordx4 v12, s[8:11], s38 offen lds
s_add_u32 m0, s18, 4096
s_nop 0
buffer_load_dwordx4 v13, s[8:11], s38 offen lds
s_add_u32 m0, s18, 5120
s_nop 0
buffer_load_dwordx4 v14, s[8:11], s38 offen lds
s_add_u32 s37, s37, 393216
v_perm_b32 v152, v81, v80, s29
v_accvgpr_write_b32 a208, v152
v_perm_b32 v153, v83, v82, s29
v_accvgpr_write_b32 a209, v153
v_perm_b32 v152, v85, v84, s29
v_accvgpr_write_b32 a210, v152
v_perm_b32 v153, v87, v86, s29
v_accvgpr_write_b32 a211, v153
v_perm_b32 v152, v81, v80, s30
v_accvgpr_write_b32 a216, v152
v_perm_b32 v153, v83, v82, s30
v_accvgpr_write_b32 a217, v153
v_perm_b32 v152, v85, v84, s30
v_accvgpr_write_b32 a218, v152
v_perm_b32 v153, v87, v86, s30
v_accvgpr_write_b32 a219, v153
v_perm_b32 v208, v89, v88, s29
v_perm_b32 v209, v91, v90, s29
v_perm_b32 v210, v93, v92, s29
v_perm_b32 v211, v95, v94, s29
v_perm_b32 v216, v89, v88, s30
v_perm_b32 v217, v91, v90, s30
v_perm_b32 v218, v93, v92, s30
v_perm_b32 v219, v95, v94, s30
v_perm_b32 v64, v97, v96, s29
v_perm_b32 v65, v99, v98, s29
v_perm_b32 v66, v101, v100, s29
v_perm_b32 v67, v103, v102, s29
v_perm_b32 v72, v97, v96, s30
v_perm_b32 v73, v99, v98, s30
v_perm_b32 v74, v101, v100, s30
v_perm_b32 v75, v103, v102, s30
s_mov_b32 s39, s16
s_mov_b32 s16, s17
s_mov_b32 s17, s18
s_mov_b32 s18, s39
s_branch Lcirc_2_top
Lcirc_2_end:
s_waitcnt vmcnt(0)
ds_write_b128 v3, v[16:19] offset:16384
ds_write_b128 v3, v[20:23] offset:17408
ds_write_b128 v3, v[24:27] offset:18432
ds_write_b128 v3, v[28:31] offset:19456
ds_write_b128 v3, v[32:35] offset:20480
ds_write_b128 v3, v[36:39] offset:21504
ds_write_b128 v3, v[40:43] offset:22528
ds_write_b128 v3, v[44:47] offset:23552
ds_write_b128 v3, v[48:51] offset:24576
ds_write_b128 v3, v[52:55] offset:25600
ds_write_b128 v3, v[56:59] offset:26624
ds_write_b128 v3, v[60:63] offset:27648
ds_write_b128 v3, v[64:67] offset:28672
ds_write_b128 v3, v[68:71] offset:29696
ds_write_b128 v3, v[72:75] offset:30720
ds_write_b128 v3, v[76:79] offset:31744
v_mov_b32 v152, v15
v_mov_b32 v6, v5
v_add_u32 v5, 131072, v2
v_mov_b32 v7, 0xff61b1e6
s_and_b32 s46, s28, 1
s_mul_i32 s46, s46, 48
v_mul_u32_u24 v16, 3, v9
v_add_u32 v16, s46, v16
s_cmp_lt_u32 s28, 2
s_cbranch_scc1 Lxq_3
v_add_u32 v17, 0, v16
v_lshrrev_b32 v18, 2, v17
v_and_b32 v17, 3, v17
v_lshlrev_b32 v18, 7, v18
v_lshl_add_u32 v17, v17, 2, v18
v_lshl_add_u32 v17, v11, 4, v17
v_add_u32 v156, 146432, v17
v_add_u32 v17, 1, v16
v_lshrrev_b32 v18, 2, v17
v_and_b32 v17, 3, v17
v_lshlrev_b32 v18, 7, v18
v_lshl_add_u32 v17, v17, 2, v18
v_lshl_add_u32 v17, v11, 4, v17
v_add_u32 v157, 146432, v17
v_add_u32 v17, 2, v16
v_lshrrev_b32 v18, 2, v17
v_and_b32 v17, 3, v17
v_lshlrev_b32 v18, 7, v18
v_lshl_add_u32 v17, v17, 2, v18
v_lshl_add_u32 v17, v11, 4, v17
v_add_u32 v158, 146432, v17
s_branch Lxd_4
Lxq_3:
v_add_u32 v17, 0, v16
v_lshrrev_b32 v18, 3, v17
v_lshlrev_b32 v18, 8, v18
v_and_b32 v19, 1, v17
v_lshl_add_u32 v18, v19, 7, v18
v_bfe_u32 v19, v17, 1, 2
v_lshl_add_u32 v18, v19, 2, v18
v_lshl_add_u32 v18, v11, 4, v18
v_add_u32 v156, 143360, v18
v_add_u32 v17, 1, v16
v_lshrrev_b32 v18, 3, v17
v_lshlrev_b32 v18, 8, v18
v_and_b32 v19, 1, v17
v_lshl_add_u32 v18, v19, 7, v18
v_bfe_u32 v19, v17, 1, 2
v_lshl_add_u32 v18, v19, 2, v18
v_lshl_add_u32 v18, v11, 4, v18
v_add_u32 v157, 143360, v18
v_add_u32 v17, 2, v16
v_lshrrev_b32 v18, 3, v17
v_lshlrev_b32 v18, 8, v18
v_and_b32 v19, 1, v17
v_lshl_add_u32 v18, v19, 7, v18
v_bfe_u32 v19, v17, 1, 2
v_lshl_add_u32 v18, v19, 2, v18
v_lshl_add_u32 v18, v11, 4, v18
v_add_u32 v158, 143360, v18
Lxd_4:
v_and_b32 v17, 7, v9
v_lshlrev_b32 v18, 7, v10
v_lshl_add_u32 v18, v17, 4, v18
v_add_u32 v159, 146432, v18
s_lshl_b32 s48, s28, 10
s_add_u32 s48, s48, 149504
s_mov_b32 s59, s48
s_mul_i32 s57, s33, 640
s_sub_u32 s57, s59, s57
v_lshrrev_b32 v18, 3, v9
v_lshlrev_b32 v19, 8, v18
v_and_b32 v20, 1, v9
v_lshl_add_u32 v19, v20, 7, v19
v_lshl_add_u32 v19, v11, 4, v19
v_bfe_u32 v21, v9, 1, 2
v_lshl_add_u32 v19, v21, 2, v19
v_add_u32 v154, s48, v19
v_lshl_add_u32 v18, v18, 1, v11
v_bfe_u32 v19, v9, 1, 1
v_lshlrev_b32 v19, 6, v19
v_lshl_add_u32 v19, v18, 3, v19
v_bfe_u32 v21, v9, 2, 1
v_lshl_add_u32 v20, v21, 1, v20
v_lshl_add_u32 v19, v20, 1, v19
s_add_u32 s48, s48, 512
v_add_u32 v155, s48, v19
v_and_b32 v17, 7, v0
v_min_u32 v17, 5, v17
s_lshl_b32 s46, s33, 11
s_add_u32 s46, s46, 0
v_lshl_add_u32 v153, v17, 7, s46
s_lshl_b32 s46, s28, 3
v_add_u32 v17, s46, v11
v_add_u32 v18, 2, v17
v_lshlrev_b32 v19, 1, v9
v_add_u32 v20, 1, v19
v_cmp_le_u32_e64 s[60:61], v19, v17
v_cmp_le_u32_e64 s[62:63], v20, v17
v_cmp_le_u32_e64 s[64:65], v19, v18
v_cmp_le_u32_e64 s[66:67], v20, v18
v_cmp_lt_u32_e64 s[68:69], 7, v9
s_mov_b32 s58, 0x3dd53b95
s_mul_i32 s46, s33, 12288
s_mul_i32 s47, s28, 3072
s_add_u32 s44, s46, s47
s_add_u32 s44, s44, 10002432
s_sub_u32 s47, s28, 1
s_lshl_b32 s47, s47, 12
s_add_u32 s45, s46, s47
s_add_u32 s45, s45, 35168256
s_add_u32 s52, s47, 131072
s_mul_i32 s49, s28, 20480
s_add_u32 s49, s49, 179183616
s_and_b32 s46, s27, 15
s_mul_i32 s47, s46, 32
s_lshr_b32 s47, s47, 8
s_mul_i32 s47, s47, 8
s_sub_u32 s46, s46, s47
s_lshl_b32 s46, s46, 2
s_add_u32 s46, s46, s26
s_lshl_b32 s46, s46, 14
s_add_u32 s46, s46, 1048576
s_mov_b32 s35, s46
s_lshl_b32 s34, s34, 6
v_mov_b32 v0, v152
v_mov_b32 v8, v153
v_mov_b32 v9, v154
v_mov_b32 v10, v155
v_mov_b32 v11, v156
v_mov_b32 v12, v157
v_mov_b32 v13, v158
v_mov_b32 v14, v159
s_cmp_lg_u32 s28, 0
s_cbranch_scc1 Lgwd_6
Lgw_5:
buffer_load_dwordx2 v[18:19], off, s[20:23], 0 sc1
s_waitcnt vmcnt(0)
v_cmp_gt_u32 vcc, 255, v18
v_mov_b32 v18, v19
v_and_b32 v19, 0xffff, v19
v_cmp_gt_u32_e64 s[46:47], 2, v19
s_or_b64 vcc, vcc, s[46:47]
s_cbranch_vccz Lgwe_7
s_cmp_eq_u32 s25, 0
s_cbranch_scc1 Lgwe_7
s_sub_u32 s25, s25, 1
s_sleep 4
s_branch Lgw_5
Lgwe_7:
v_mov_b32 v19, 163836
ds_write_b32 v19, v18
s_waitcnt lgkmcnt(0)
Lgwd_6:
s_barrier
v_mov_b32 v19, 163836
ds_read_b32 v18, v19
s_waitcnt lgkmcnt(0)
v_readfirstlane_b32 s46, v18
s_bfe_u32 s47, s46, 0x10010
s_lshl_b32 s47, s47, 13
s_add_u32 s88, s88, s47
s_bfe_u32 s47, s46, 0x10011
s_lshl_b32 s47, s47, 13
s_add_u32 s89, s89, s47
s_add_u32 s53, s53, s89
s_mov_b32 s43, s53
v_mov_b32 v144, -1
v_mov_b32 v145, -1
v_mov_b32 v146, -1
v_mov_b32 v147, -1
s_add_u32 s46, s49, 5160960
buffer_store_dwordx4 v[144:147], v6, s[4:7], s46 offen sc1
s_and_b32 s46, s24, 3
s_mul_i32 s46, s46, 32768
s_add_u32 s46, s46, s89
s_add_u32 s40, s46, s90
s_add_u32 s41, s46, s91
s_add_u32 s42, s46, s92
s_cmp_eq_u32 s28, 0
s_cbranch_scc1 Lk0_8
s_mov_b32 s50, 1
Lpl_9:
buffer_load_dword v17, v8, s[4:7], 0 offen sc1
s_waitcnt vmcnt(0)
v_cmp_gt_u32 vcc, s50, v17
s_cbranch_vccz Lpld_10
s_cmp_eq_u32 s25, 0
s_cbranch_scc1 Lpld_10
s_sub_u32 s25, s25, 1
s_sleep 1
s_branch Lpl_9
Lpld_10:
s_mov_b32 m0, s52
s_nop 0
buffer_load_dwordx4 v2, s[4:7], s45 offen offset:0 sc1 lds
buffer_load_dwordx4 v2, s[4:7], s45 offen offset:1024 sc1 lds
buffer_load_dwordx4 v2, s[4:7], s45 offen offset:2048 sc1 lds
buffer_load_dwordx4 v2, s[4:7], s45 offen offset:3072 sc1 lds
s_add_u32 s45, s45, 393216
Lk0_8:
s_cmp_lg_u32 s28, 0
s_cselect_b32 s46, 0, 64
v_mov_b32 v15, s46
ds_read_b128 v[96:99], v3 offset:0
ds_read_b128 v[100:103], v3 offset:1024
ds_read_b128 v[104:107], v3 offset:2048
ds_read_b128 v[108:111], v3 offset:3072
ds_read_b128 v[112:115], v3 offset:4096
ds_read_b128 v[116:119], v3 offset:5120
ds_read_b128 v[120:123], v3 offset:6144
ds_read_b128 v[124:127], v3 offset:7168
ds_read_b128 v[128:131], v3 offset:8192
ds_read_b128 v[132:135], v3 offset:9216
ds_read_b128 v[136:139], v3 offset:10240
ds_read_b128 v[140:143], v3 offset:11264
ds_read_b128 v[144:147], v3 offset:12288
ds_read_b128 v[148:151], v3 offset:13312
ds_read_b128 v[152:155], v3 offset:14336
ds_read_b128 v[156:159], v3 offset:15360
s_waitcnt vmcnt(0)
s_barrier
Lqk_loop:
buffer_load_dwordx4 v[16:19], v2, s[4:7], s40 offen sc1
buffer_load_dwordx4 v[20:23], v2, s[4:7], s41 offen sc1
buffer_load_dwordx4 v[24:27], v2, s[4:7], s42 offen sc1
v_add_u32 v53, s93, v2
v_add_u32 v54, s94, v2
v_add_u32 v55, s95, v2
v_add_u32 v28, s96, v2
v_add_u32 v32, s97, v2
v_add_u32 v36, s98, v2
v_add_u32 v40, s99, v2
v_add_u32 v44, s100, v2
v_add_u32 v48, s101, v2
v_add_u32 v52, s32, v2
v_mov_b64 v[56:57], 0
v_mov_b64 v[58:59], 0
v_mov_b64 v[60:61], 0
v_mov_b64 v[62:63], 0
v_mov_b64 v[64:65], 0
v_mov_b64 v[66:67], 0
v_mov_b64 v[68:69], 0
v_mov_b64 v[70:71], 0
v_mov_b64 v[72:73], 0
v_mov_b64 v[74:75], 0
v_mov_b64 v[76:77], 0
v_mov_b64 v[78:79], 0
s_add_u32 s50, s24, 1
s_waitcnt lgkmcnt(0)
s_waitcnt vmcnt(2)
v_cmp_eq_u32 vcc, -1, v16
s_cbranch_vccnz Lqk_R0
Lqk_G0:
v_smfmac_f32_16x16x64_bf16 v[56:59], v[16:19], v[96:103], v4
ds_write_b128 v53, v[16:19]
s_waitcnt vmcnt(1)
v_cmp_eq_u32 vcc, -1, v20
v_smfmac_f32_16x16x64_bf16 v[60:63], v[16:19], v[104:111], v4
s_cbranch_vccnz Lqk_R1
Lqk_G1:
v_smfmac_f32_16x16x64_bf16 v[64:67], v[16:19], v[112:119], v4
ds_write_b128 v54, v[20:23]
s_waitcnt vmcnt(0)
v_cmp_eq_u32 vcc, -1, v24
v_smfmac_f32_16x16x64_bf16 v[68:71], v[16:19], v[120:127], v4
s_cbranch_vccnz Lqk_R2
Lqk_G2:
v_smfmac_f32_16x16x64_bf16 v[72:75], v[16:19], v[128:135], v4
ds_write_b128 v55, v[24:27]
v_smfmac_f32_16x16x64_bf16 v[76:79], v[16:19], v[136:143], v4
v_smfmac_f32_16x16x64_bf16 v[56:59], v[20:23], v[144:151], v4
v_smfmac_f32_16x16x64_bf16 v[60:63], v[20:23], v[152:159], v4
v_smfmac_f32_16x16x64_bf16 v[64:67], v[20:23], a[0:7], v4
s_waitcnt lgkmcnt(0)
s_barrier
v_smfmac_f32_16x16x64_bf16 v[68:71], v[20:23], a[8:15], v4
ds_read_b128 v[28:31], v28
v_smfmac_f32_16x16x64_bf16 v[72:75], v[20:23], a[16:23], v4
ds_read_b128 v[32:35], v32
v_smfmac_f32_16x16x64_bf16 v[76:79], v[20:23], a[24:31], v4
ds_read_b128 v[36:39], v36
v_smfmac_f32_16x16x64_bf16 v[56:59], v[24:27], a[32:39], v4
ds_read_b128 v[40:43], v40
v_smfmac_f32_16x16x64_bf16 v[60:63], v[24:27], a[40:47], v4
ds_read_b128 v[44:47], v44
v_smfmac_f32_16x16x64_bf16 v[64:67], v[24:27], a[48:55], v4
ds_read_b128 v[48:51], v48
v_smfmac_f32_16x16x64_bf16 v[68:71], v[24:27], a[56:63], v4
ds_read_b128 v[52:55], v52
v_smfmac_f32_16x16x64_bf16 v[72:75], v[24:27], a[64:71], v4
v_smfmac_f32_16x16x64_bf16 v[76:79], v[24:27], a[72:79], v4
s_waitcnt lgkmcnt(6)
v_smfmac_f32_16x16x64_bf16 v[56:59], v[28:31], a[80:87], v4
ds_read_b128 v[96:99], v3 offset:16384
v_smfmac_f32_16x16x64_bf16 v[60:63], v[28:31], a[88:95], v4
ds_read_b128 v[100:103], v3 offset:17408
v_smfmac_f32_16x16x64_bf16 v[64:67], v[28:31], a[96:103], v4
ds_read_b128 v[104:107], v3 offset:18432
v_mov_b32 v1, s50
v_smfmac_f32_16x16x64_bf16 v[68:71], v[28:31], a[104:111], v4
ds_read_b128 v[108:111], v3 offset:19456
v_smfmac_f32_16x16x64_bf16 v[72:75], v[28:31], a[112:119], v4
ds_read_b128 v[112:115], v3 offset:20480
v_smfmac_f32_16x16x64_bf16 v[76:79], v[28:31], a[120:127], v4
ds_read_b128 v[116:119], v3 offset:21504
s_waitcnt lgkmcnt(11)
v_smfmac_f32_16x16x64_bf16 v[56:59], v[32:35], a[128:135], v4
ds_read_b128 v[120:123], v3 offset:22528
v_smfmac_f32_16x16x64_bf16 v[60:63], v[32:35], a[136:143], v4
ds_read_b128 v[124:127], v3 offset:23552
s_waitcnt lgkmcnt(12)
v_smfmac_f32_16x16x64_bf16 v[56:59], v[36:39], a[144:151], v4
ds_read_b128 v[128:131], v3 offset:24576
v_smfmac_f32_16x16x64_bf16 v[60:63], v[36:39], a[152:159], v4
ds_read_b128 v[132:135], v3 offset:25600
s_waitcnt lgkmcnt(13)
v_smfmac_f32_16x16x64_bf16 v[56:59], v[40:43], a[160:167], v4
ds_read_b128 v[136:139], v3 offset:26624
v_smfmac_f32_16x16x64_bf16 v[60:63], v[40:43], a[168:175], v4
ds_read_b128 v[140:143], v3 offset:27648
s_waitcnt lgkmcnt(14)
v_smfmac_f32_16x16x64_bf16 v[56:59], v[44:47], a[176:183], v4
ds_read_b128 v[144:147], v3 offset:28672
v_smfmac_f32_16x16x64_bf16 v[60:63], v[44:47], a[184:191], v4
ds_read_b128 v[148:151], v3 offset:29696
s_waitcnt lgkmcnt(15)
v_smfmac_f32_16x16x64_bf16 v[56:59], v[48:51], a[192:199], v4
ds_read_b128 v[152:155], v3 offset:30720
v_smfmac_f32_16x16x64_bf16 v[60:63], v[48:51], a[200:207], v4
ds_read_b128 v[156:159], v3 offset:31744
s_waitcnt lgkmcnt(15)
v_smfmac_f32_16x16x64_bf16 v[56:59], v[52:55], a[208:215], v4
ds_read_b128 v[80:83], v5 offset:0
v_smfmac_f32_16x16x64_bf16 v[60:63], v[52:55], a[216:223], v4
ds_read_b128 v[84:87], v5 offset:1024
v_smfmac_f32_16x16x64_bf16 v[64:67], v[32:35], a[224:231], v4
ds_read_b128 v[88:91], v5 offset:6144
v_smfmac_f32_16x16x64_bf16 v[68:71], v[32:35], a[232:239], v4
ds_read_b128 v[92:95], v5 offset:7168
v_permlane32_swap_b32 v56, v57
v_smfmac_f32_16x16x64_bf16 v[64:67], v[36:39], a[240:247], v4
ds_read_b128 v[16:19], v5 offset:2048
v_permlane32_swap_b32 v58, v59
v_smfmac_f32_16x16x64_bf16 v[68:71], v[36:39], a[248:255], v4
ds_read_b128 v[20:23], v5 offset:3072
v_permlane32_swap_b32 v60, v61
v_smfmac_f32_16x16x64_bf16 v[64:67], v[40:43], v[160:167], v4
ds_read_b128 v[24:27], v5 offset:8192
v_permlane32_swap_b32 v62, v63
v_smfmac_f32_16x16x64_bf16 v[68:71], v[40:43], v[168:175], v4
ds_read_b128 v[28:31], v5 offset:9216
v_add_f32 v56, v56, v57
v_smfmac_f32_16x16x64_bf16 v[64:67], v[44:47], v[176:183], v4
v_add_f32 v60, v60, v61
v_smfmac_f32_16x16x64_bf16 v[68:71], v[44:47], v[184:191], v4
v_add_f32 v58, v58, v59
v_smfmac_f32_16x16x64_bf16 v[64:67], v[48:51], v[192:199], v4
s_waitcnt lgkmcnt(8)
v_add_f32 v62, v62, v63
v_smfmac_f32_16x16x64_bf16 v[68:71], v[48:51], v[200:207], v4
v_cvt_pk_bf16_f32 v57, v56, v60
v_smfmac_f32_16x16x64_bf16 v[64:67], v[52:55], v[208:215], v4
v_cvt_pk_bf16_f32 v59, v58, v62
v_smfmac_f32_16x16x64_bf16 v[68:71], v[52:55], v[216:223], v4
ds_write2_b32 v11, v57, v59 offset1:8
v_smfmac_f32_16x16x64_bf16 v[72:75], v[32:35], v[224:231], v4
v_smfmac_f32_16x16x64_bf16 v[76:79], v[32:35], v[232:239], v4
v_permlane32_swap_b32 v64, v65
v_smfmac_f32_16x16x64_bf16 v[72:75], v[36:39], v[240:247], v4
v_permlane32_swap_b32 v66, v67
v_smfmac_f32_16x16x64_bf16 v[76:79], v[36:39], v[248:255], v4
v_permlane32_swap_b32 v68, v69
v_smfmac_f32_16x16x64_bf16 v[72:75], v[40:43], v[96:103], v4
ds_read_b128 v[32:35], v5 offset:4096
v_permlane32_swap_b32 v70, v71
v_smfmac_f32_16x16x64_bf16 v[76:79], v[40:43], v[104:111], v4
ds_read_b128 v[36:39], v5 offset:5120
v_add_f32 v64, v64, v65
v_smfmac_f32_16x16x64_bf16 v[72:75], v[44:47], v[112:119], v4
v_add_f32 v68, v68, v69
v_smfmac_f32_16x16x64_bf16 v[76:79], v[44:47], v[120:127], v4
v_add_f32 v66, v66, v67
v_smfmac_f32_16x16x64_bf16 v[72:75], v[48:51], v[128:135], v4
ds_read_b128 v[40:43], v5 offset:10240
v_add_f32 v70, v70, v71
v_smfmac_f32_16x16x64_bf16 v[76:79], v[48:51], v[136:143], v4
ds_read_b128 v[44:47], v5 offset:11264
v_cvt_pk_bf16_f32 v65, v64, v68
v_smfmac_f32_16x16x64_bf16 v[72:75], v[52:55], v[144:151], v4
v_cvt_pk_bf16_f32 v67, v66, v70
v_smfmac_f32_16x16x64_bf16 v[76:79], v[52:55], v[152:159], v4
ds_write2_b32 v12, v65, v67 offset1:8
s_nop 2
v_permlane32_swap_b32 v72, v73
v_permlane32_swap_b32 v74, v75
s_nop 1
v_permlane32_swap_b32 v76, v77
v_permlane32_swap_b32 v78, v79
v_add_f32 v72, v72, v73
v_add_f32 v76, v76, v77
v_add_f32 v74, v74, v75
v_add_f32 v78, v78, v79
v_cvt_pk_bf16_f32 v73, v72, v76
v_cvt_pk_bf16_f32 v75, v74, v78
ds_write2_b32 v13, v73, v75 offset1:8
v_mov_b64 v[132:133], 0
v_mov_b64 v[134:135], 0
v_mov_b64 v[136:137], 0
v_mov_b64 v[138:139], 0
v_mov_b64 v[140:141], 0
v_mov_b64 v[142:143], 0
s_waitcnt lgkmcnt(0)
s_barrier
s_cmp_lg_u32 s28, 0
s_cbranch_scc1 Loth_11
buffer_store_dword v1, v0, s[4:7], s89 offen sc1
Lrg_13:
ds_read_b128 v[96:99], v5 offset:12288
ds_read_b128 v[100:103], v5 offset:13312
ds_read_b128 v[104:107], v5 offset:14336
ds_read_b128 v[108:111], v14 offset:0
ds_read_b128 v[112:115], v14 offset:512
ds_read_b128 v[116:119], v14 offset:1024
ds_read_b128 v[120:123], v14 offset:1536
ds_read_b128 v[124:127], v14 offset:2048
ds_read_b128 v[128:131], v14 offset:2560
s_waitcnt lgkmcnt(8)
v_smfmac_f32_16x16x64_bf16 v[136:139], v[96:99], v[80:87], v4
v_smfmac_f32_16x16x64_bf16 v[140:143], v[96:99], v[88:95], v4
s_waitcnt lgkmcnt(7)
v_smfmac_f32_16x16x64_bf16 v[136:139], v[100:103], v[16:23], v4
v_smfmac_f32_16x16x64_bf16 v[140:143], v[100:103], v[24:31], v4
s_waitcnt lgkmcnt(6)
v_smfmac_f32_16x16x64_bf16 v[136:139], v[104:107], v[32:39], v4
v_smfmac_f32_16x16x64_bf16 v[140:143], v[104:107], v[40:47], v4
s_waitcnt lgkmcnt(4)
v_smfmac_f32_16x16x64_bf16 v[132:135], v[96:99], v[108:115], v4
v_subrev_u32 v151, s57, v9
v_subrev_u32 v152, s57, v10
s_waitcnt lgkmcnt(2)
v_smfmac_f32_16x16x64_bf16 v[132:135], v[100:103], v[116:123], v4
v_permlane32_swap_b32 v136, v137
v_permlane32_swap_b32 v138, v139
s_waitcnt lgkmcnt(0)
v_smfmac_f32_16x16x64_bf16 v[132:135], v[104:107], v[124:131], v4
v_permlane32_swap_b32 v140, v141
v_permlane32_swap_b32 v142, v143
v_add_f32 v136, v136, v137
v_add_f32 v138, v138, v139
v_add_f32 v140, v140, v141
v_add_f32 v142, v142, v143
s_nop 1
v_permlane32_swap_b32 v132, v133
v_permlane32_swap_b32 v134, v135
v_add_f32 v132, v132, v133
v_add_f32 v134, v134, v135
v_max3_f32 v144, v132, v136, v140
v_max3_f32 v145, v134, v138, v142
s_nop 0
v_max_f32_dpp v144, v144, v144 row_ror:8 row_mask:0xf bank_mask:0xf
v_max_f32_dpp v145, v145, v145 row_ror:8 row_mask:0xf bank_mask:0xf
s_nop 0
v_max_f32_dpp v144, v144, v144 row_ror:4 row_mask:0xf bank_mask:0xf
v_max_f32_dpp v145, v145, v145 row_ror:4 row_mask:0xf bank_mask:0xf
s_nop 0
v_max_f32_dpp v144, v144, v144 row_ror:2 row_mask:0xf bank_mask:0xf
v_max_f32_dpp v145, v145, v145 row_ror:2 row_mask:0xf bank_mask:0xf
s_nop 0
v_max_f32_dpp v144, v144, v144 row_ror:1 row_mask:0xf bank_mask:0xf
v_max_f32_dpp v145, v145, v145 row_ror:1 row_mask:0xf bank_mask:0xf
v_mul_f32 v144, s58, v144
v_mul_f32 v145, s58, v145
v_fma_f32 v136, v136, s58, -v144
v_fma_f32 v140, v140, s58, -v144
v_fma_f32 v132, v132, s58, -v144
v_fma_f32 v138, v138, s58, -v145
v_fma_f32 v142, v142, s58, -v145
v_fma_f32 v134, v134, s58, -v145
v_exp_f32 v136, v136
v_exp_f32 v140, v140
v_exp_f32 v132, v132
v_exp_f32 v138, v138
v_exp_f32 v142, v142
v_exp_f32 v134, v134
v_add_f32 v146, v136, v140
v_add_f32 v147, v138, v142
v_fma_f32 v146, v132, 0.5, v146
v_fma_f32 v147, v134, 0.5, v147
s_nop 0
v_add_f32_dpp v146, v146, v146 row_ror:8 row_mask:0xf bank_mask:0xf
v_add_f32_dpp v147, v147, v147 row_ror:8 row_mask:0xf bank_mask:0xf
s_nop 0
v_add_f32_dpp v146, v146, v146 row_ror:4 row_mask:0xf bank_mask:0xf
v_add_f32_dpp v147, v147, v147 row_ror:4 row_mask:0xf bank_mask:0xf
s_nop 0
v_add_f32_dpp v146, v146, v146 row_ror:2 row_mask:0xf bank_mask:0xf
v_add_f32_dpp v147, v147, v147 row_ror:2 row_mask:0xf bank_mask:0xf
s_nop 0
v_add_f32_dpp v146, v146, v146 row_ror:1 row_mask:0xf bank_mask:0xf
v_add_f32_dpp v147, v147, v147 row_ror:1 row_mask:0xf bank_mask:0xf
buffer_load_dwordx4 v[56:59], v2, s[4:7], s44 offen offset:0 sc1
buffer_load_dwordx4 v[60:63], v2, s[4:7], s44 offen offset:1024 sc1
buffer_load_dwordx4 v[64:67], v2, s[4:7], s44 offen offset:2048 sc1
v_rcp_f32 v146, v146
v_rcp_f32 v147, v147
v_mul_f32 v136, v136, v146
v_mul_f32 v140, v140, v146
v_mul_f32 v132, v132, v146
v_mul_f32 v138, v138, v147
v_mul_f32 v142, v142, v147
v_mul_f32 v134, v134, v147
v_cvt_pk_bf16_f32 v148, v136, v140
v_cvt_pk_bf16_f32 v149, v138, v142
v_cndmask_b32_e64 v150, v132, v134, s[68:69]
buffer_store_dword v148, v151, s[4:7], s43 offen sc1
v_cvt_pk_bf16_f32 v150, v150, v150
buffer_store_dword v149, v151, s[4:7], s43 offen offset:32 sc1
buffer_store_short v150, v152, s[4:7], s43 offen sc1
v_mov_b64 v[68:69], 0
v_mov_b64 v[70:71], 0
v_mov_b64 v[72:73], 0
v_mov_b64 v[74:75], 0
v_mov_b64 v[76:77], 0
v_mov_b64 v[78:79], 0
s_waitcnt vmcnt(3)
s_branch Ljoin_12
Loth_11:
v_mov_b64 v[68:69], 0
v_mov_b64 v[70:71], 0
v_mov_b64 v[72:73], 0
v_mov_b64 v[74:75], 0
v_mov_b64 v[76:77], 0
v_mov_b64 v[78:79], 0
buffer_load_dwordx4 v[56:59], v2, s[4:7], s44 offen offset:0 sc1
buffer_load_dwordx4 v[60:63], v2, s[4:7], s44 offen offset:1024 sc1
buffer_load_dwordx4 v[64:67], v2, s[4:7], s44 offen offset:2048 sc1
s_add_u32 s50, s24, 2
s_min_u32 s50, s50, 64
v_cmp_gt_u32 vcc, s50, v15
s_cbranch_vccz Lfl_14
Lpl_15:
buffer_load_dword v1, v8, s[4:7], 0 offen sc1
s_waitcnt vmcnt(0)
v_cmp_gt_u32 vcc, s50, v1
s_cbranch_vccz Lpld_16
s_cmp_eq_u32 s25, 0
s_cbranch_scc1 Lpld_16
s_sub_u32 s25, s25, 1
s_sleep 1
s_branch Lpl_15
Lpld_16:
Lfl_14:
s_waitcnt vmcnt(0)
ds_read_b128 v[108:111], v14 offset:0
ds_read_b128 v[112:115], v14 offset:512
ds_read_b128 v[116:119], v14 offset:1024
ds_read_b128 v[120:123], v14 offset:1536
ds_read_b128 v[124:127], v14 offset:2048
ds_read_b128 v[128:131], v14 offset:2560
Ljoin_12:
v_smfmac_f32_16x16x64_bf16 v[72:75], v[56:59], v[80:87], v4
v_smfmac_f32_16x16x64_bf16 v[76:79], v[56:59], v[88:95], v4
v_smfmac_f32_16x16x64_bf16 v[72:75], v[60:63], v[16:23], v4
v_smfmac_f32_16x16x64_bf16 v[76:79], v[60:63], v[24:31], v4
v_smfmac_f32_16x16x64_bf16 v[72:75], v[64:67], v[32:39], v4
v_smfmac_f32_16x16x64_bf16 v[76:79], v[64:67], v[40:47], v4
s_waitcnt lgkmcnt(4)
v_smfmac_f32_16x16x64_bf16 v[68:71], v[56:59], v[108:115], v4
v_add_u32 v151, s59, v2
s_waitcnt lgkmcnt(2)
v_smfmac_f32_16x16x64_bf16 v[68:71], v[60:63], v[116:123], v4
v_permlane32_swap_b32 v72, v73
v_permlane32_swap_b32 v74, v75
s_waitcnt lgkmcnt(0)
v_smfmac_f32_16x16x64_bf16 v[68:71], v[64:67], v[124:131], v4
s_cmp_eq_u32 s28, 0
s_cbranch_scc1 Lini_17
s_mov_b32 m0, s52
s_nop 0
buffer_load_dwordx4 v2, s[4:7], s45 offen offset:0 sc1 lds
buffer_load_dwordx4 v2, s[4:7], s45 offen offset:1024 sc1 lds
buffer_load_dwordx4 v2, s[4:7], s45 offen offset:2048 sc1 lds
buffer_load_dwordx4 v2, s[4:7], s45 offen offset:3072 sc1 lds
s_add_u32 s45, s45, 393216
s_add_u32 s46, s24, 2
s_and_b32 s46, s46, 3
s_mul_i32 s46, s46, 65536
s_add_u32 s46, s46, s53
s_cmp_lg_u32 s28, 1
s_cbranch_scc1 Lini_17
v_mov_b32 v144, -1
v_mov_b32 v145, -1
v_mov_b32 v146, -1
v_mov_b32 v147, -1
buffer_store_dwordx4 v[144:147], v6, s[4:7], s46 offen sc1
Lini_17:
v_permlane32_swap_b32 v76, v77
v_permlane32_swap_b32 v78, v79
v_add_f32 v72, v72, v73
v_add_f32 v74, v74, v75
v_add_f32 v76, v76, v77
v_add_f32 v78, v78, v79
v_permlane32_swap_b32 v68, v69
v_permlane32_swap_b32 v70, v71
v_add_f32 v68, v68, v69
v_add_f32 v70, v70, v71
v_cndmask_b32_e64 v72, v7, v72, s[60:61]
v_cndmask_b32_e64 v76, v7, v76, s[62:63]
v_cndmask_b32_e64 v74, v7, v74, s[64:65]
v_cndmask_b32_e64 v78, v7, v78, s[66:67]
v_max3_f32 v144, v68, v72, v76
v_max3_f32 v145, v70, v74, v78
s_nop 0
v_max_f32_dpp v144, v144, v144 row_ror:8 row_mask:0xf bank_mask:0xf
v_max_f32_dpp v145, v145, v145 row_ror:8 row_mask:0xf bank_mask:0xf
s_nop 0
v_max_f32_dpp v144, v144, v144 row_ror:4 row_mask:0xf bank_mask:0xf
v_max_f32_dpp v145, v145, v145 row_ror:4 row_mask:0xf bank_mask:0xf
s_nop 0
v_max_f32_dpp v144, v144, v144 row_ror:2 row_mask:0xf bank_mask:0xf
v_max_f32_dpp v145, v145, v145 row_ror:2 row_mask:0xf bank_mask:0xf
s_nop 0
v_max_f32_dpp v144, v144, v144 row_ror:1 row_mask:0xf bank_mask:0xf
v_max_f32_dpp v145, v145, v145 row_ror:1 row_mask:0xf bank_mask:0xf
v_mul_f32 v144, s58, v144
v_mul_f32 v145, s58, v145
v_fma_f32 v72, v72, s58, -v144
v_fma_f32 v76, v76, s58, -v144
v_fma_f32 v68, v68, s58, -v144
v_fma_f32 v74, v74, s58, -v145
v_fma_f32 v78, v78, s58, -v145
v_fma_f32 v70, v70, s58, -v145
v_exp_f32 v72, v72
v_exp_f32 v76, v76
v_exp_f32 v68, v68
v_exp_f32 v74, v74
v_exp_f32 v78, v78
v_exp_f32 v70, v70
v_add_f32 v146, v72, v76
v_add_f32 v147, v74, v78
v_fma_f32 v146, v68, 0.5, v146
v_fma_f32 v147, v70, 0.5, v147
s_nop 0
v_add_f32_dpp v146, v146, v146 row_ror:8 row_mask:0xf bank_mask:0xf
v_add_f32_dpp v147, v147, v147 row_ror:8 row_mask:0xf bank_mask:0xf
s_nop 0
v_add_f32_dpp v146, v146, v146 row_ror:4 row_mask:0xf bank_mask:0xf
v_add_f32_dpp v147, v147, v147 row_ror:4 row_mask:0xf bank_mask:0xf
s_nop 0
v_add_f32_dpp v146, v146, v146 row_ror:2 row_mask:0xf bank_mask:0xf
v_add_f32_dpp v147, v147, v147 row_ror:2 row_mask:0xf bank_mask:0xf
s_nop 0
v_add_f32_dpp v146, v146, v146 row_ror:1 row_mask:0xf bank_mask:0xf
v_add_f32_dpp v147, v147, v147 row_ror:1 row_mask:0xf bank_mask:0xf
v_rcp_f32 v146, v146
v_rcp_f32 v147, v147
v_mul_f32 v72, v72, v146
v_mul_f32 v76, v76, v146
v_mul_f32 v68, v68, v146
v_mul_f32 v74, v74, v147
v_mul_f32 v78, v78, v147
v_mul_f32 v70, v70, v147
v_cvt_pk_bf16_f32 v148, v72, v76
v_cvt_pk_bf16_f32 v149, v74, v78
v_cndmask_b32_e64 v150, v68, v70, s[68:69]
ds_write2_b32 v9, v148, v149 offset1:8
v_cvt_pk_bf16_f32 v150, v150, v150
ds_write_b16 v10, v150
ds_read_b128 v[144:147], v151
s_waitcnt lgkmcnt(0)
buffer_store_dwordx4 v[144:147], v6, s[4:7], s49 offen sc1
s_add_u32 s46, s24, 3
s_min_u32 s46, s46, 64
v_cmp_gt_u32 vcc, s46, v15
s_cbranch_vccz Lrf_18
buffer_load_dword v15, v8, s[4:7], 0 offen sc1
Lrf_18:
s_add_u32 s44, s44, 393216
s_add_u32 s49, s49, 81920
s_add_u32 s24, s24, 1
s_and_b32 s46, s24, 3
s_mul_i32 s46, s46, 32768
s_add_u32 s46, s46, s89
s_add_u32 s40, s46, s90
s_add_u32 s41, s46, s91
s_add_u32 s42, s46, s92
s_and_b32 s43, s24, 3
s_mul_i32 s43, s43, 65536
s_add_u32 s43, s43, s53
s_cmp_eq_u32 s24, 64
s_cbranch_scc1 Lqk_fin
ds_read_b128 v[96:99], v3 offset:0
ds_read_b128 v[100:103], v3 offset:1024
ds_read_b128 v[104:107], v3 offset:2048
ds_read_b128 v[108:111], v3 offset:3072
ds_read_b128 v[112:115], v3 offset:4096
ds_read_b128 v[116:119], v3 offset:5120
ds_read_b128 v[120:123], v3 offset:6144
ds_read_b128 v[124:127], v3 offset:7168
ds_read_b128 v[128:131], v3 offset:8192
ds_read_b128 v[132:135], v3 offset:9216
ds_read_b128 v[136:139], v3 offset:10240
ds_read_b128 v[140:143], v3 offset:11264
ds_read_b128 v[144:147], v3 offset:12288
ds_read_b128 v[148:151], v3 offset:13312
ds_read_b128 v[152:155], v3 offset:14336
ds_read_b128 v[156:159], v3 offset:15360
v_min_u32 v20, 176, v2
v_add_u32 v20, s34, v20
v_subrev_u32 v1, 640, v20
v_min_u32 v20, v1, v20
v_lshl_add_u32 v20, v20, 3, s35
buffer_load_dword v1, v20, s[4:7], s89 offen sc1
s_waitcnt vmcnt(0)
v_cmp_gt_u32 vcc, s24, v1
s_cbranch_vccz Lqk_open
s_mov_b64 exec, vcc
buffer_load_dword v1, v20, s[4:7], s89 offen sc1
s_sleep 6
Lqk_gate:
buffer_load_dword v21, v20, s[4:7], s89 offen sc1
s_waitcnt vmcnt(1)
v_cmp_gt_u32 vcc, s24, v1
s_cbranch_vccz Lqk_open
s_mov_b64 exec, vcc
buffer_load_dword v1, v20, s[4:7], s89 offen sc1
s_waitcnt vmcnt(1)
v_cmp_gt_u32 vcc, s24, v21
s_cbranch_vccz Lqk_open
s_mov_b64 exec, vcc
s_cmp_eq_u32 s25, 0
s_cbranch_scc1 Lqk_open
s_sub_u32 s25, s25, 1
s_branch Lqk_gate
Lqk_open:
s_mov_b64 exec, -1
s_branch Lqk_loop
Lqk_fin:
v_mov_b32 v1, 1
s_add_u32 s46, s89, 4096
buffer_store_dword v1, v0, s[4:7], s46 offen sc1
s_endpgm
Lqk_R0:
s_cmp_eq_u32 s25, 0
s_cbranch_scc1 Lqk_G0
s_sub_u32 s25, s25, 1
buffer_load_dwordx4 v[16:19], v2, s[4:7], s40 offen sc1
buffer_load_dwordx4 v[20:23], v2, s[4:7], s41 offen sc1
buffer_load_dwordx4 v[24:27], v2, s[4:7], s42 offen sc1
s_waitcnt vmcnt(2)
v_cmp_eq_u32 vcc, -1, v16
s_cbranch_vccnz Lqk_R0
s_branch Lqk_G0
Lqk_R1:
s_cmp_eq_u32 s25, 0
s_cbranch_scc1 Lqk_G1
s_sub_u32 s25, s25, 1
buffer_load_dwordx4 v[20:23], v2, s[4:7], s41 offen sc1
buffer_load_dwordx4 v[24:27], v2, s[4:7], s42 offen sc1
s_waitcnt vmcnt(1)
v_cmp_eq_u32 vcc, -1, v20
s_cbranch_vccnz Lqk_R1
s_branch Lqk_G1
Lqk_R2:
s_cmp_eq_u32 s25, 0
s_cbranch_scc1 Lqk_G2
s_sub_u32 s25, s25, 1
buffer_load_dwordx4 v[24:27], v2, s[4:7], s42 offen sc1
s_waitcnt vmcnt(0)
v_cmp_eq_u32 vcc, -1, v24
s_cbranch_vccnz Lqk_R2
s_branch Lqk_G2
Lvum:
s_load_dwordx2 s[8:9], s[0:1], 32
s_mov_b32 s10, 7864320
s_mov_b32 s11, 0x20000
s_load_dwordx2 s[12:13], s[0:1], 40
s_mov_b32 s14, 7864320
s_mov_b32 s15, 0x20000
s_lshl_b32 s33, s26, 3
s_add_u32 s33, s33, s27
s_sub_u32 s33, s33, 8
v_lshlrev_b32 v2, 4, v0
s_lshl_b32 s46, s28, 15
v_add_u32 v3, s46, v2
v_and_b32 v9, 15, v0
v_lshrrev_b32 v10, 4, v0
v_mov_b32 v4, 0x44444444
v_mov_b32 v1, 0xeeeeeeee
v_cmp_lt_u32 vcc, 7, v9
s_nop 1
v_cndmask_b32 v4, v4, v1, vcc
v_and_b32 v11, 1, v10
v_lshlrev_b32 v8, 2, v11
v_lshrrev_b32 v1, 1, v10
v_add_u32 v11, v8, v1
v_lshl_add_u32 v8, v1, 4, v8
v_mov_b32 v12, -1
v_mov_b32 v13, -1
v_mov_b32 v14, -1
v_mov_b32 v15, -1
s_mul_i32 s46, s28, 96
s_mul_i32 s47, s33, 384
s_add_u32 s56, s46, s47
v_mul_u32_u24 v17, 6, v9
v_and_b32 v17, -4, v17
v_mul_u32_u24 v6, 96, v10
v_add_u32 v6, v6, v17
v_lshlrev_b32 v17, 2, v9
v_mul_u32_u24 v7, 320, v10
v_add_u32 v7, v7, v17
s_mul_i32 s47, s33, 245760
s_mul_i32 s48, s28, 320
s_add_u32 s58, s47, s48
v_lshrrev_b32 v17, 3, v9
v_lshlrev_b32 v17, 14, v17
v_and_b32 v18, 7, v9
v_lshl_add_u32 v17, v18, 4, v17
v_lshrrev_b32 v18, 1, v10
v_lshl_add_u32 v17, v18, 7, v17
v_and_b32 v18, 1, v10
v_lshl_add_u32 v5, v18, 15, v17
v_mov_b32 v1, 2146435072
v_cmp_eq_u32 vcc, 0, v18
s_nop 1
v_cndmask_b32 v159, v1, v5, vcc
s_lshl_b32 s43, s33, 8
s_mul_i32 s46, s28, 163840
s_add_u32 s53, s43, s46
s_add_u32 s43, s53, s88
s_add_u32 s46, s43, 0
buffer_store_dwordx4 v[12:15], v5, s[4:7], s46 offen sc1
s_add_u32 s46, s43, 65536
buffer_store_dwordx4 v[12:15], v5, s[4:7], s46 offen sc1
s_add_u32 s46, s43, 131072
buffer_store_dwordx4 v[12:15], v159, s[4:7], s46 offen sc1
s_add_u32 s46, s43, 8192
buffer_store_dwordx4 v[12:15], v5, s[4:7], s46 offen sc1
s_add_u32 s46, s43, 73728
buffer_store_dwordx4 v[12:15], v5, s[4:7], s46 offen sc1
s_add_u32 s46, s43, 139264
buffer_store_dwordx4 v[12:15], v159, s[4:7], s46 offen sc1
s_add_u32 s46, s43, 655360
buffer_store_dwordx4 v[12:15], v5, s[4:7], s46 offen sc1
s_add_u32 s46, s43, 720896
buffer_store_dwordx4 v[12:15], v5, s[4:7], s46 offen sc1
s_add_u32 s46, s43, 786432
buffer_store_dwordx4 v[12:15], v159, s[4:7], s46 offen sc1
s_add_u32 s46, s43, 663552
buffer_store_dwordx4 v[12:15], v5, s[4:7], s46 offen sc1
s_add_u32 s46, s43, 729088
buffer_store_dwordx4 v[12:15], v5, s[4:7], s46 offen sc1
s_add_u32 s46, s43, 794624
buffer_store_dwordx4 v[12:15], v159, s[4:7], s46 offen sc1
s_add_u32 s47, s33, 32
s_lshl_b32 s46, s47, 7
s_add_u32 s46, s46, 393216
v_lshl_add_u32 v155, v0, 14, s46
s_cmp_eq_u32 s28, 0
s_cselect_b32 s46, 40, 0
v_mov_b32 v1, 2146435072
v_cmp_gt_u32 vcc, s46, v0
s_nop 1
v_cndmask_b32 v155, v1, v155, vcc
v_mov_b32 v1, 0
s_add_u32 s46, s89, 8192
buffer_store_dword v1, v155, s[4:7], s89 offen sc1
buffer_store_dword v1, v155, s[4:7], s46 offen sc1
s_lshl_b32 s46, s28, 9
s_add_u32 s46, s46, 131072
v_lshl_add_u32 v17, v11, 4, s46
v_lshrrev_b32 v18, 2, v9
v_lshl_add_u32 v17, v18, 7, v17
v_and_b32 v18, 3, v9
v_lshl_add_u32 v156, v18, 2, v17
s_lshl_b32 s46, s28, 8
s_add_u32 s46, s46, 133120
v_lshl_add_u32 v17, v11, 4, s46
v_lshrrev_b32 v18, 3, v9
v_lshl_add_u32 v17, v18, 7, v17
v_and_b32 v18, 7, v9
v_lshl_add_u32 v157, v18, 1, v17
v_add_u32 v1, 0, v0
v_mul_u32_u24 v134, 10923, v1
v_lshrrev_b32 v134, 16, v134
v_mul_u32_u24 v135, 6, v134
v_sub_u32 v1, v1, v135
v_lshl_add_u32 v12, v1, 4, s56
v_bfe_u32 v1, v134, 0, 1
v_mul_u32_u24 v135, 49152, v1
v_add_u32 v12, v135, v12
v_bfe_u32 v1, v134, 1, 1
v_mul_u32_u24 v135, 196608, v1
v_add_u32 v12, v135, v12
v_bfe_u32 v1, v134, 2, 1
v_mul_u32_u24 v135, 12288, v1
v_add_u32 v12, v135, v12
v_bfe_u32 v1, v134, 3, 1
v_mul_u32_u24 v135, 24576, v1
v_add_u32 v12, v135, v12
v_bfe_u32 v1, v134, 4, 1
v_mul_u32_u24 v135, 98304, v1
v_add_u32 v12, v135, v12
v_add_u32 v1, 64, v0
v_mul_u32_u24 v134, 10923, v1
v_lshrrev_b32 v134, 16, v134
v_mul_u32_u24 v135, 6, v134
v_sub_u32 v1, v1, v135
v_lshl_add_u32 v13, v1, 4, s56
v_bfe_u32 v1, v134, 0, 1
v_mul_u32_u24 v135, 49152, v1
v_add_u32 v13, v135, v13
v_bfe_u32 v1, v134, 1, 1
v_mul_u32_u24 v135, 196608, v1
v_add_u32 v13, v135, v13
v_bfe_u32 v1, v134, 2, 1
v_mul_u32_u24 v135, 12288, v1
v_add_u32 v13, v135, v13
v_bfe_u32 v1, v134, 3, 1
v_mul_u32_u24 v135, 24576, v1
v_add_u32 v13, v135, v13
v_bfe_u32 v1, v134, 4, 1
v_mul_u32_u24 v135, 98304, v1
v_add_u32 v13, v135, v13
v_add_u32 v1, 128, v0
v_mul_u32_u24 v134, 10923, v1
v_lshrrev_b32 v134, 16, v134
v_mul_u32_u24 v135, 6, v134
v_sub_u32 v1, v1, v135
v_lshl_add_u32 v14, v1, 4, s56
v_bfe_u32 v1, v134, 0, 1
v_mul_u32_u24 v135, 49152, v1
v_add_u32 v14, v135, v14
v_bfe_u32 v1, v134, 1, 1
v_mul_u32_u24 v135, 196608, v1
v_add_u32 v14, v135, v14
v_bfe_u32 v1, v134, 2, 1
v_mul_u32_u24 v135, 12288, v1
v_add_u32 v14, v135, v14
v_bfe_u32 v1, v134, 3, 1
v_mul_u32_u24 v135, 24576, v1
v_add_u32 v14, v135, v14
v_bfe_u32 v1, v134, 4, 1
v_mul_u32_u24 v135, 98304, v1
v_add_u32 v14, v135, v14
v_add_u32 v1, 0, v0
v_mul_u32_u24 v134, 3277, v1
v_lshrrev_b32 v134, 16, v134
v_mul_u32_u24 v135, 20, v134
v_sub_u32 v1, v1, v135
v_lshl_add_u32 v112, v1, 4, s58
v_lshl_add_u32 v117, v1, 4, s58
v_bfe_u32 v1, v134, 0, 1
v_mul_u32_u24 v135, 7680, v1
v_add_u32 v112, v135, v112
v_mul_u32_u24 v135, 15360, v1
v_add_u32 v117, v135, v117
v_bfe_u32 v1, v134, 1, 1
v_mul_u32_u24 v135, 30720, v1
v_add_u32 v112, v135, v112
v_mul_u32_u24 v135, 61440, v1
v_add_u32 v117, v135, v117
v_bfe_u32 v1, v134, 2, 1
v_mul_u32_u24 v135, 1280, v1
v_add_u32 v112, v135, v112
v_mul_u32_u24 v135, 3840, v1
v_add_u32 v117, v135, v117
v_bfe_u32 v1, v134, 3, 1
v_mul_u32_u24 v135, 3840, v1
v_add_u32 v112, v135, v112
v_mul_u32_u24 v135, 7680, v1
v_add_u32 v117, v135, v117
v_add_u32 v1, 64, v0
v_mul_u32_u24 v134, 3277, v1
v_lshrrev_b32 v134, 16, v134
v_mul_u32_u24 v135, 20, v134
v_sub_u32 v1, v1, v135
v_lshl_add_u32 v113, v1, 4, s58
v_lshl_add_u32 v118, v1, 4, s58
v_bfe_u32 v1, v134, 0, 1
v_mul_u32_u24 v135, 7680, v1
v_add_u32 v113, v135, v113
v_mul_u32_u24 v135, 15360, v1
v_add_u32 v118, v135, v118
v_bfe_u32 v1, v134, 1, 1
v_mul_u32_u24 v135, 30720, v1
v_add_u32 v113, v135, v113
v_mul_u32_u24 v135, 61440, v1
v_add_u32 v118, v135, v118
v_bfe_u32 v1, v134, 2, 1
v_mul_u32_u24 v135, 1280, v1
v_add_u32 v113, v135, v113
v_mul_u32_u24 v135, 3840, v1
v_add_u32 v118, v135, v118
v_bfe_u32 v1, v134, 3, 1
v_mul_u32_u24 v135, 3840, v1
v_add_u32 v113, v135, v113
v_mul_u32_u24 v135, 7680, v1
v_add_u32 v118, v135, v118
v_add_u32 v1, 128, v0
v_mul_u32_u24 v134, 3277, v1
v_lshrrev_b32 v134, 16, v134
v_mul_u32_u24 v135, 20, v134
v_sub_u32 v1, v1, v135
v_lshl_add_u32 v114, v1, 4, s58
v_lshl_add_u32 v119, v1, 4, s58
v_bfe_u32 v1, v134, 0, 1
v_mul_u32_u24 v135, 7680, v1
v_add_u32 v114, v135, v114
v_mul_u32_u24 v135, 15360, v1
v_add_u32 v119, v135, v119
v_bfe_u32 v1, v134, 1, 1
v_mul_u32_u24 v135, 30720, v1
v_add_u32 v114, v135, v114
v_mul_u32_u24 v135, 61440, v1
v_add_u32 v119, v135, v119
v_bfe_u32 v1, v134, 2, 1
v_mul_u32_u24 v135, 1280, v1
v_add_u32 v114, v135, v114
v_mul_u32_u24 v135, 3840, v1
v_add_u32 v119, v135, v119
v_bfe_u32 v1, v134, 3, 1
v_mul_u32_u24 v135, 3840, v1
v_add_u32 v114, v135, v114
v_mul_u32_u24 v135, 7680, v1
v_add_u32 v119, v135, v119
v_add_u32 v1, 192, v0
v_mul_u32_u24 v134, 3277, v1
v_lshrrev_b32 v134, 16, v134
v_mul_u32_u24 v135, 20, v134
v_sub_u32 v1, v1, v135
v_lshl_add_u32 v115, v1, 4, s58
v_lshl_add_u32 v120, v1, 4, s58
v_bfe_u32 v1, v134, 0, 1
v_mul_u32_u24 v135, 7680, v1
v_add_u32 v115, v135, v115
v_mul_u32_u24 v135, 15360, v1
v_add_u32 v120, v135, v120
v_bfe_u32 v1, v134, 1, 1
v_mul_u32_u24 v135, 30720, v1
v_add_u32 v115, v135, v115
v_mul_u32_u24 v135, 61440, v1
v_add_u32 v120, v135, v120
v_bfe_u32 v1, v134, 2, 1
v_mul_u32_u24 v135, 1280, v1
v_add_u32 v115, v135, v115
v_mul_u32_u24 v135, 3840, v1
v_add_u32 v120, v135, v120
v_bfe_u32 v1, v134, 3, 1
v_mul_u32_u24 v135, 3840, v1
v_add_u32 v115, v135, v115
v_mul_u32_u24 v135, 7680, v1
v_add_u32 v120, v135, v120
v_add_u32 v1, 256, v0
v_mul_u32_u24 v134, 3277, v1
v_lshrrev_b32 v134, 16, v134
v_mul_u32_u24 v135, 20, v134
v_sub_u32 v1, v1, v135
v_lshl_add_u32 v116, v1, 4, s58
v_lshl_add_u32 v121, v1, 4, s58
v_bfe_u32 v1, v134, 0, 1
v_mul_u32_u24 v135, 7680, v1
v_add_u32 v116, v135, v116
v_mul_u32_u24 v135, 15360, v1
v_add_u32 v121, v135, v121
v_bfe_u32 v1, v134, 1, 1
v_mul_u32_u24 v135, 30720, v1
v_add_u32 v116, v135, v116
v_mul_u32_u24 v135, 61440, v1
v_add_u32 v121, v135, v121
v_bfe_u32 v1, v134, 2, 1
v_mul_u32_u24 v135, 1280, v1
v_add_u32 v116, v135, v116
v_mul_u32_u24 v135, 3840, v1
v_add_u32 v121, v135, v121
v_bfe_u32 v1, v134, 3, 1
v_mul_u32_u24 v135, 3840, v1
v_add_u32 v116, v135, v116
v_mul_u32_u24 v135, 7680, v1
v_add_u32 v121, v135, v121
v_and_b32 v17, 1, v9
v_cmp_eq_u32_e64 s[60:61], 1, v17
v_mov_b32 v0, s29
v_mov_b32 v8, s30
v_cndmask_b32_e64 v17, v0, v8, s[60:61]
v_cndmask_b32_e64 v8, v8, v0, s[60:61]
v_mov_b32 v0, v17
s_waitcnt lgkmcnt(0)
s_and_b32 s9, s9, 0xffff
s_and_b32 s13, s13, 0xffff
s_mul_i32 s34, s28, 11
s_add_u32 s34, s34, 1
s_lshr_b32 s34, s34, 2
s_mul_i32 s35, s34, 786432
s_mov_b32 s46, s34
s_lshl_b32 s47, s46, 10
s_add_u32 s93, s47, 153600
s_cmp_ge_u32 s46, 8
s_cselect_b32 s48, 8192, 0
s_add_u32 s90, s47, s48
s_add_u32 s46, s46, 1
s_cmp_eq_u32 s46, 10
s_cselect_b32 s46, 0, s46
s_lshl_b32 s47, s46, 10
s_add_u32 s94, s47, 153600
s_cmp_ge_u32 s46, 8
s_cselect_b32 s48, 8192, 0
s_add_u32 s91, s47, s48
s_add_u32 s46, s46, 1
s_cmp_eq_u32 s46, 10
s_cselect_b32 s46, 0, s46
s_lshl_b32 s47, s46, 10
s_add_u32 s95, s47, 153600
s_cmp_ge_u32 s46, 8
s_cselect_b32 s48, 8192, 0
s_add_u32 s92, s47, s48
s_add_u32 s46, s46, 1
s_cmp_eq_u32 s46, 10
s_cselect_b32 s46, 0, s46
s_lshl_b32 s47, s46, 10
s_add_u32 s96, s47, 153600
s_add_u32 s46, s46, 1
s_cmp_eq_u32 s46, 10
s_cselect_b32 s46, 0, s46
s_lshl_b32 s47, s46, 10
s_add_u32 s97, s47, 153600
s_add_u32 s46, s46, 1
s_cmp_eq_u32 s46, 10
s_cselect_b32 s46, 0, s46
s_lshl_b32 s47, s46, 10
s_add_u32 s98, s47, 153600
s_add_u32 s46, s46, 1
s_cmp_eq_u32 s46, 10
s_cselect_b32 s46, 0, s46
s_lshl_b32 s47, s46, 10
s_add_u32 s99, s47, 153600
s_add_u32 s46, s46, 1
s_cmp_eq_u32 s46, 10
s_cselect_b32 s46, 0, s46
s_lshl_b32 s47, s46, 10
s_add_u32 s100, s47, 153600
s_add_u32 s46, s46, 1
s_cmp_eq_u32 s46, 10
s_cselect_b32 s46, 0, s46
s_lshl_b32 s47, s46, 10
s_add_u32 s101, s47, 153600
s_add_u32 s46, s46, 1
s_cmp_eq_u32 s46, 10
s_cselect_b32 s46, 0, s46
s_lshl_b32 s47, s46, 10
s_add_u32 s32, s47, 153600
s_add_u32 s46, s46, 1
s_cmp_eq_u32 s46, 10
s_cselect_b32 s46, 0, s46
s_lshl_b32 s54, s28, 15
s_lshl_b32 s16, s28, 13
s_add_u32 s16, s16, 131072
s_add_u32 s18, s54, 20480
s_add_u32 s17, s16, 3072
s_add_u32 s19, s18, 3072
s_add_u32 s36, s18, 6144
s_mov_b32 s37, 0
v_add_u32 v122, s54, v7
v_add_u32 v123, 64, v122
v_add_u32 v124, 128, v122
v_add_u32 v125, 192, v122
v_add_u32 v126, 256, v122
s_add_u32 m0, s54, 20480
s_mov_b32 s31, 0
buffer_load_dwordx4 v112, s[12:15], s31 offen lds
s_add_u32 m0, s54, 21504
s_nop 0
buffer_load_dwordx4 v113, s[12:15], s31 offen lds
s_add_u32 m0, s54, 22528
s_nop 0
buffer_load_dwordx4 v114, s[12:15], s31 offen lds
s_add_u32 m0, s54, 23552
s_nop 0
buffer_load_dwordx4 v115, s[12:15], s31 offen lds
s_add_u32 m0, s54, 24576
s_nop 0
buffer_load_dwordx4 v116, s[12:15], s31 offen lds
s_add_u32 m0, s54, 25600
s_mov_b32 s31, 15360
buffer_load_dwordx4 v112, s[12:15], s31 offen lds
s_waitcnt vmcnt(6)
s_barrier
s_cmp_lg_u32 s28, 0
s_cbranch_scc1 Larr_19
v_mov_b32 v1, 1
s_mov_b64 exec, 1
buffer_atomic_add v1, off, s[20:23], 0 sc1
s_mov_b64 exec, -1
Larr_19:
s_add_u32 m0, s54, 26624
s_nop 0
buffer_load_dwordx4 v113, s[12:15], s31 offen lds
s_add_u32 m0, s54, 27648
s_nop 0
buffer_load_dwordx4 v114, s[12:15], s31 offen lds
s_add_u32 m0, s54, 28672
s_nop 0
buffer_load_dwordx4 v115, s[12:15], s31 offen lds
s_add_u32 m0, s54, 29696
s_nop 0
buffer_load_dwordx4 v116, s[12:15], s31 offen lds
s_add_u32 m0, s54, 10240
s_mov_b32 s31, 61440
buffer_load_dwordx4 v112, s[12:15], s31 offen lds
s_add_u32 m0, s54, 11264
s_nop 0
buffer_load_dwordx4 v113, s[12:15], s31 offen lds
s_add_u32 m0, s54, 12288
s_nop 0
buffer_load_dwordx4 v114, s[12:15], s31 offen lds
s_add_u32 m0, s54, 13312
s_nop 0
buffer_load_dwordx4 v115, s[12:15], s31 offen lds
s_add_u32 m0, s54, 14336
s_nop 0
buffer_load_dwordx4 v116, s[12:15], s31 offen lds
s_add_u32 m0, s54, 15360
s_mov_b32 s31, 76800
buffer_load_dwordx4 v112, s[12:15], s31 offen lds
s_add_u32 m0, s54, 16384
s_nop 0
buffer_load_dwordx4 v113, s[12:15], s31 offen lds
s_add_u32 m0, s54, 17408
s_nop 0
buffer_load_dwordx4 v114, s[12:15], s31 offen lds
s_add_u32 m0, s54, 18432
s_nop 0
buffer_load_dwordx4 v115, s[12:15], s31 offen lds
s_add_u32 m0, s54, 19456
s_nop 0
buffer_load_dwordx4 v116, s[12:15], s31 offen lds
s_add_u32 m0, s54, 0
s_mov_b32 s31, 122880
buffer_load_dwordx4 v112, s[12:15], s31 offen lds
s_add_u32 m0, s54, 1024
s_nop 0
buffer_load_dwordx4 v113, s[12:15], s31 offen lds
s_add_u32 m0, s54, 2048
s_nop 0
buffer_load_dwordx4 v114, s[12:15], s31 offen lds
s_add_u32 m0, s54, 3072
s_nop 0
buffer_load_dwordx4 v115, s[12:15], s31 offen lds
s_add_u32 m0, s54, 4096
s_nop 0
buffer_load_dwordx4 v116, s[12:15], s31 offen lds
s_add_u32 m0, s54, 5120
s_mov_b32 s31, 138240
buffer_load_dwordx4 v112, s[12:15], s31 offen lds
s_add_u32 m0, s54, 6144
s_nop 0
buffer_load_dwordx4 v113, s[12:15], s31 offen lds
s_add_u32 m0, s54, 7168
s_nop 0
buffer_load_dwordx4 v114, s[12:15], s31 offen lds
s_add_u32 m0, s54, 8192
s_nop 0
buffer_load_dwordx4 v115, s[12:15], s31 offen lds
s_add_u32 m0, s54, 9216
s_nop 0
buffer_load_dwordx4 v116, s[12:15], s31 offen lds
s_waitcnt vmcnt(20)
ds_read2st64_b32 v[80:81], v122 offset0:80 offset1:85
ds_read2st64_b32 v[82:83], v122 offset0:100 offset1:105
ds_read2st64_b32 v[84:85], v122 offset0:90 offset1:95
ds_read2st64_b32 v[86:87], v122 offset0:110 offset1:115
ds_read2st64_b32 v[96:97], v123 offset0:80 offset1:85
ds_read2st64_b32 v[98:99], v123 offset0:100 offset1:105
ds_read2st64_b32 v[100:101], v123 offset0:90 offset1:95
ds_read2st64_b32 v[102:103], v123 offset0:110 offset1:115
s_waitcnt lgkmcnt(4)
v_perm_b32 v152, v81, v80, s29
v_accvgpr_write_b32 a176, v152
v_perm_b32 v153, v83, v82, s29
v_accvgpr_write_b32 a177, v153
v_perm_b32 v152, v85, v84, s29
v_accvgpr_write_b32 a178, v152
v_perm_b32 v153, v87, v86, s29
v_accvgpr_write_b32 a179, v153
v_perm_b32 v152, v81, v80, s30
v_accvgpr_write_b32 a184, v152
v_perm_b32 v153, v83, v82, s30
v_accvgpr_write_b32 a185, v153
v_perm_b32 v152, v85, v84, s30
v_accvgpr_write_b32 a186, v152
v_perm_b32 v153, v87, v86, s30
v_accvgpr_write_b32 a187, v153
ds_read2st64_b32 v[80:81], v124 offset0:80 offset1:85
ds_read2st64_b32 v[82:83], v124 offset0:100 offset1:105
ds_read2st64_b32 v[84:85], v124 offset0:90 offset1:95
ds_read2st64_b32 v[86:87], v124 offset0:110 offset1:115
s_waitcnt lgkmcnt(4)
v_perm_b32 v152, v97, v96, s29
v_accvgpr_write_b32 a224, v152
v_perm_b32 v153, v99, v98, s29
v_accvgpr_write_b32 a225, v153
v_perm_b32 v152, v101, v100, s29
v_accvgpr_write_b32 a226, v152
v_perm_b32 v153, v103, v102, s29
v_accvgpr_write_b32 a227, v153
v_perm_b32 v152, v97, v96, s30
v_accvgpr_write_b32 a232, v152
v_perm_b32 v153, v99, v98, s30
v_accvgpr_write_b32 a233, v153
v_perm_b32 v152, v101, v100, s30
v_accvgpr_write_b32 a234, v152
v_perm_b32 v153, v103, v102, s30
v_accvgpr_write_b32 a235, v153
ds_read2st64_b32 v[96:97], v125 offset0:80 offset1:85
ds_read2st64_b32 v[98:99], v125 offset0:100 offset1:105
ds_read2st64_b32 v[100:101], v125 offset0:90 offset1:95
ds_read2st64_b32 v[102:103], v125 offset0:110 offset1:115
s_waitcnt lgkmcnt(4)
v_perm_b32 v176, v81, v80, s29
v_perm_b32 v177, v83, v82, s29
v_perm_b32 v178, v85, v84, s29
v_perm_b32 v179, v87, v86, s29
v_perm_b32 v184, v81, v80, s30
v_perm_b32 v185, v83, v82, s30
v_perm_b32 v186, v85, v84, s30
v_perm_b32 v187, v87, v86, s30
ds_read2st64_b32 v[80:81], v126 offset0:80 offset1:85
ds_read2st64_b32 v[82:83], v126 offset0:100 offset1:105
ds_read2st64_b32 v[84:85], v126 offset0:90 offset1:95
ds_read2st64_b32 v[86:87], v126 offset0:110 offset1:115
s_waitcnt lgkmcnt(4)
v_perm_b32 v224, v97, v96, s29
v_perm_b32 v225, v99, v98, s29
v_perm_b32 v226, v101, v100, s29
v_perm_b32 v227, v103, v102, s29
v_perm_b32 v232, v97, v96, s30
v_perm_b32 v233, v99, v98, s30
v_perm_b32 v234, v101, v100, s30
v_perm_b32 v235, v103, v102, s30
s_waitcnt vmcnt(10)
ds_read2st64_b32 v[96:97], v122 offset0:40 offset1:45
ds_read2st64_b32 v[98:99], v122 offset0:60 offset1:65
ds_read2st64_b32 v[100:101], v122 offset0:50 offset1:55
ds_read2st64_b32 v[102:103], v122 offset0:70 offset1:75
s_waitcnt lgkmcnt(4)
s_add_u32 m0, s54, 20480
s_mov_b32 s31, 184320
buffer_load_dwordx4 v112, s[12:15], s31 offen lds
s_add_u32 m0, s54, 21504
s_nop 0
buffer_load_dwordx4 v113, s[12:15], s31 offen lds
s_add_u32 m0, s54, 22528
s_nop 0
buffer_load_dwordx4 v114, s[12:15], s31 offen lds
s_add_u32 m0, s54, 23552
s_nop 0
buffer_load_dwordx4 v115, s[12:15], s31 offen lds
s_add_u32 m0, s54, 24576
s_nop 0
buffer_load_dwordx4 v116, s[12:15], s31 offen lds
s_add_u32 m0, s54, 25600
s_mov_b32 s31, 199680
buffer_load_dwordx4 v112, s[12:15], s31 offen lds
s_add_u32 m0, s54, 26624
s_nop 0
buffer_load_dwordx4 v113, s[12:15], s31 offen lds
s_add_u32 m0, s54, 27648
s_nop 0
buffer_load_dwordx4 v114, s[12:15], s31 offen lds
s_add_u32 m0, s54, 28672
s_nop 0
buffer_load_dwordx4 v115, s[12:15], s31 offen lds
s_add_u32 m0, s54, 29696
s_nop 0
buffer_load_dwordx4 v116, s[12:15], s31 offen lds
v_perm_b32 v32, v81, v80, s29
v_perm_b32 v33, v83, v82, s29
v_perm_b32 v34, v85, v84, s29
v_perm_b32 v35, v87, v86, s29
v_perm_b32 v40, v81, v80, s30
v_perm_b32 v41, v83, v82, s30
v_perm_b32 v42, v85, v84, s30
v_perm_b32 v43, v87, v86, s30
ds_read2st64_b32 v[80:81], v123 offset0:40 offset1:45
ds_read2st64_b32 v[82:83], v123 offset0:60 offset1:65
ds_read2st64_b32 v[84:85], v123 offset0:50 offset1:55
ds_read2st64_b32 v[86:87], v123 offset0:70 offset1:75
s_waitcnt lgkmcnt(4)
v_perm_b32 v152, v97, v96, s29
v_accvgpr_write_b32 a180, v152
v_perm_b32 v153, v99, v98, s29
v_accvgpr_write_b32 a181, v153
v_perm_b32 v152, v101, v100, s29
v_accvgpr_write_b32 a182, v152
v_perm_b32 v153, v103, v102, s29
v_accvgpr_write_b32 a183, v153
v_perm_b32 v152, v97, v96, s30
v_accvgpr_write_b32 a188, v152
v_perm_b32 v153, v99, v98, s30
v_accvgpr_write_b32 a189, v153
v_perm_b32 v152, v101, v100, s30
v_accvgpr_write_b32 a190, v152
v_perm_b32 v153, v103, v102, s30
v_accvgpr_write_b32 a191, v153
ds_read2st64_b32 v[96:97], v124 offset0:40 offset1:45
ds_read2st64_b32 v[98:99], v124 offset0:60 offset1:65
ds_read2st64_b32 v[100:101], v124 offset0:50 offset1:55
ds_read2st64_b32 v[102:103], v124 offset0:70 offset1:75
s_waitcnt lgkmcnt(4)
v_perm_b32 v152, v81, v80, s29
v_accvgpr_write_b32 a228, v152
v_perm_b32 v153, v83, v82, s29
v_accvgpr_write_b32 a229, v153
v_perm_b32 v152, v85, v84, s29
v_accvgpr_write_b32 a230, v152
v_perm_b32 v153, v87, v86, s29
v_accvgpr_write_b32 a231, v153
v_perm_b32 v152, v81, v80, s30
v_accvgpr_write_b32 a236, v152
v_perm_b32 v153, v83, v82, s30
v_accvgpr_write_b32 a237, v153
v_perm_b32 v152, v85, v84, s30
v_accvgpr_write_b32 a238, v152
v_perm_b32 v153, v87, v86, s30
v_accvgpr_write_b32 a239, v153
ds_read2st64_b32 v[80:81], v125 offset0:40 offset1:45
ds_read2st64_b32 v[82:83], v125 offset0:60 offset1:65
ds_read2st64_b32 v[84:85], v125 offset0:50 offset1:55
ds_read2st64_b32 v[86:87], v125 offset0:70 offset1:75
s_waitcnt lgkmcnt(4)
v_perm_b32 v180, v97, v96, s29
v_perm_b32 v181, v99, v98, s29
v_perm_b32 v182, v101, v100, s29
v_perm_b32 v183, v103, v102, s29
v_perm_b32 v188, v97, v96, s30
v_perm_b32 v189, v99, v98, s30
v_perm_b32 v190, v101, v100, s30
v_perm_b32 v191, v103, v102, s30
ds_read2st64_b32 v[96:97], v126 offset0:40 offset1:45
ds_read2st64_b32 v[98:99], v126 offset0:60 offset1:65
ds_read2st64_b32 v[100:101], v126 offset0:50 offset1:55
ds_read2st64_b32 v[102:103], v126 offset0:70 offset1:75
s_waitcnt lgkmcnt(4)
v_perm_b32 v228, v81, v80, s29
v_perm_b32 v229, v83, v82, s29
v_perm_b32 v230, v85, v84, s29
v_perm_b32 v231, v87, v86, s29
v_perm_b32 v236, v81, v80, s30
v_perm_b32 v237, v83, v82, s30
v_perm_b32 v238, v85, v84, s30
v_perm_b32 v239, v87, v86, s30
s_waitcnt vmcnt(10)
ds_read2st64_b32 v[80:81], v122 offset0:0 offset1:5
ds_read2st64_b32 v[82:83], v122 offset0:20 offset1:25
ds_read2st64_b32 v[84:85], v122 offset0:10 offset1:15
ds_read2st64_b32 v[86:87], v122 offset0:30 offset1:35
s_waitcnt lgkmcnt(4)
s_add_u32 m0, s54, 10240
s_mov_b32 s31, 2560
buffer_load_dwordx4 v117, s[12:15], s31 offen lds
s_add_u32 m0, s54, 11264
s_nop 0
buffer_load_dwordx4 v118, s[12:15], s31 offen lds
s_add_u32 m0, s54, 12288
s_nop 0
buffer_load_dwordx4 v119, s[12:15], s31 offen lds
s_add_u32 m0, s54, 13312
s_nop 0
buffer_load_dwordx4 v120, s[12:15], s31 offen lds
s_add_u32 m0, s54, 14336
s_nop 0
buffer_load_dwordx4 v121, s[12:15], s31 offen lds
s_add_u32 m0, s54, 15360
s_mov_b32 s31, 33280
buffer_load_dwordx4 v117, s[12:15], s31 offen lds
s_add_u32 m0, s54, 16384
s_nop 0
buffer_load_dwordx4 v118, s[12:15], s31 offen lds
s_add_u32 m0, s54, 17408
s_nop 0
buffer_load_dwordx4 v119, s[12:15], s31 offen lds
s_add_u32 m0, s54, 18432
s_nop 0
buffer_load_dwordx4 v120, s[12:15], s31 offen lds
s_add_u32 m0, s54, 19456
s_nop 0
buffer_load_dwordx4 v121, s[12:15], s31 offen lds
v_perm_b32 v36, v97, v96, s29
v_perm_b32 v37, v99, v98, s29
v_perm_b32 v38, v101, v100, s29
v_perm_b32 v39, v103, v102, s29
v_perm_b32 v44, v97, v96, s30
v_perm_b32 v45, v99, v98, s30
v_perm_b32 v46, v101, v100, s30
v_perm_b32 v47, v103, v102, s30
ds_read2st64_b32 v[96:97], v123 offset0:0 offset1:5
ds_read2st64_b32 v[98:99], v123 offset0:20 offset1:25
ds_read2st64_b32 v[100:101], v123 offset0:10 offset1:15
ds_read2st64_b32 v[102:103], v123 offset0:30 offset1:35
s_waitcnt lgkmcnt(4)
v_perm_b32 v152, v81, v80, s29
v_accvgpr_write_b32 a192, v152
v_perm_b32 v153, v83, v82, s29
v_accvgpr_write_b32 a193, v153
v_perm_b32 v152, v85, v84, s29
v_accvgpr_write_b32 a194, v152
v_perm_b32 v153, v87, v86, s29
v_accvgpr_write_b32 a195, v153
v_perm_b32 v152, v81, v80, s30
v_accvgpr_write_b32 a200, v152
v_perm_b32 v153, v83, v82, s30
v_accvgpr_write_b32 a201, v153
v_perm_b32 v152, v85, v84, s30
v_accvgpr_write_b32 a202, v152
v_perm_b32 v153, v87, v86, s30
v_accvgpr_write_b32 a203, v153
ds_read2st64_b32 v[80:81], v124 offset0:0 offset1:5
ds_read2st64_b32 v[82:83], v124 offset0:20 offset1:25
ds_read2st64_b32 v[84:85], v124 offset0:10 offset1:15
ds_read2st64_b32 v[86:87], v124 offset0:30 offset1:35
s_waitcnt lgkmcnt(4)
v_perm_b32 v152, v97, v96, s29
v_accvgpr_write_b32 a240, v152
v_perm_b32 v153, v99, v98, s29
v_accvgpr_write_b32 a241, v153
v_perm_b32 v152, v101, v100, s29
v_accvgpr_write_b32 a242, v152
v_perm_b32 v153, v103, v102, s29
v_accvgpr_write_b32 a243, v153
v_perm_b32 v152, v97, v96, s30
v_accvgpr_write_b32 a248, v152
v_perm_b32 v153, v99, v98, s30
v_accvgpr_write_b32 a249, v153
v_perm_b32 v152, v101, v100, s30
v_accvgpr_write_b32 a250, v152
v_perm_b32 v153, v103, v102, s30
v_accvgpr_write_b32 a251, v153
ds_read2st64_b32 v[96:97], v125 offset0:0 offset1:5
ds_read2st64_b32 v[98:99], v125 offset0:20 offset1:25
ds_read2st64_b32 v[100:101], v125 offset0:10 offset1:15
ds_read2st64_b32 v[102:103], v125 offset0:30 offset1:35
s_waitcnt lgkmcnt(4)
v_perm_b32 v192, v81, v80, s29
v_perm_b32 v193, v83, v82, s29
v_perm_b32 v194, v85, v84, s29
v_perm_b32 v195, v87, v86, s29
v_perm_b32 v200, v81, v80, s30
v_perm_b32 v201, v83, v82, s30
v_perm_b32 v202, v85, v84, s30
v_perm_b32 v203, v87, v86, s30
ds_read2st64_b32 v[80:81], v126 offset0:0 offset1:5
ds_read2st64_b32 v[82:83], v126 offset0:20 offset1:25
ds_read2st64_b32 v[84:85], v126 offset0:10 offset1:15
ds_read2st64_b32 v[86:87], v126 offset0:30 offset1:35
s_waitcnt lgkmcnt(4)
v_perm_b32 v240, v97, v96, s29
v_perm_b32 v241, v99, v98, s29
v_perm_b32 v242, v101, v100, s29
v_perm_b32 v243, v103, v102, s29
v_perm_b32 v248, v97, v96, s30
v_perm_b32 v249, v99, v98, s30
v_perm_b32 v250, v101, v100, s30
v_perm_b32 v251, v103, v102, s30
s_waitcnt vmcnt(10)
ds_read2st64_b32 v[96:97], v122 offset0:80 offset1:85
ds_read2st64_b32 v[98:99], v122 offset0:100 offset1:105
ds_read2st64_b32 v[100:101], v122 offset0:90 offset1:95
ds_read2st64_b32 v[102:103], v122 offset0:110 offset1:115
s_waitcnt lgkmcnt(4)
s_add_u32 m0, s54, 0
s_mov_b32 s31, 125440
buffer_load_dwordx4 v117, s[12:15], s31 offen lds
s_add_u32 m0, s54, 1024
s_nop 0
buffer_load_dwordx4 v118, s[12:15], s31 offen lds
s_add_u32 m0, s54, 2048
s_nop 0
buffer_load_dwordx4 v119, s[12:15], s31 offen lds
s_add_u32 m0, s54, 3072
s_nop 0
buffer_load_dwordx4 v120, s[12:15], s31 offen lds
s_add_u32 m0, s54, 4096
s_nop 0
buffer_load_dwordx4 v121, s[12:15], s31 offen lds
s_add_u32 m0, s54, 5120
s_mov_b32 s31, 156160
buffer_load_dwordx4 v117, s[12:15], s31 offen lds
s_add_u32 m0, s54, 6144
s_nop 0
buffer_load_dwordx4 v118, s[12:15], s31 offen lds
s_add_u32 m0, s54, 7168
s_nop 0
buffer_load_dwordx4 v119, s[12:15], s31 offen lds
s_add_u32 m0, s54, 8192
s_nop 0
buffer_load_dwordx4 v120, s[12:15], s31 offen lds
s_add_u32 m0, s54, 9216
s_nop 0
buffer_load_dwordx4 v121, s[12:15], s31 offen lds
v_perm_b32 v48, v81, v80, s29
v_perm_b32 v49, v83, v82, s29
v_perm_b32 v50, v85, v84, s29
v_perm_b32 v51, v87, v86, s29
v_perm_b32 v56, v81, v80, s30
v_perm_b32 v57, v83, v82, s30
v_perm_b32 v58, v85, v84, s30
v_perm_b32 v59, v87, v86, s30
ds_read2st64_b32 v[80:81], v123 offset0:80 offset1:85
ds_read2st64_b32 v[82:83], v123 offset0:100 offset1:105
ds_read2st64_b32 v[84:85], v123 offset0:90 offset1:95
ds_read2st64_b32 v[86:87], v123 offset0:110 offset1:115
s_waitcnt lgkmcnt(4)
v_perm_b32 v152, v97, v96, s29
v_accvgpr_write_b32 a196, v152
v_perm_b32 v153, v99, v98, s29
v_accvgpr_write_b32 a197, v153
v_perm_b32 v152, v101, v100, s29
v_accvgpr_write_b32 a198, v152
v_perm_b32 v153, v103, v102, s29
v_accvgpr_write_b32 a199, v153
v_perm_b32 v152, v97, v96, s30
v_accvgpr_write_b32 a204, v152
v_perm_b32 v153, v99, v98, s30
v_accvgpr_write_b32 a205, v153
v_perm_b32 v152, v101, v100, s30
v_accvgpr_write_b32 a206, v152
v_perm_b32 v153, v103, v102, s30
v_accvgpr_write_b32 a207, v153
ds_read2st64_b32 v[96:97], v124 offset0:80 offset1:85
ds_read2st64_b32 v[98:99], v124 offset0:100 offset1:105
ds_read2st64_b32 v[100:101], v124 offset0:90 offset1:95
ds_read2st64_b32 v[102:103], v124 offset0:110 offset1:115
s_waitcnt lgkmcnt(4)
v_perm_b32 v152, v81, v80, s29
v_accvgpr_write_b32 a244, v152
v_perm_b32 v153, v83, v82, s29
v_accvgpr_write_b32 a245, v153
v_perm_b32 v152, v85, v84, s29
v_accvgpr_write_b32 a246, v152
v_perm_b32 v153, v87, v86, s29
v_accvgpr_write_b32 a247, v153
v_perm_b32 v152, v81, v80, s30
v_accvgpr_write_b32 a252, v152
v_perm_b32 v153, v83, v82, s30
v_accvgpr_write_b32 a253, v153
v_perm_b32 v152, v85, v84, s30
v_accvgpr_write_b32 a254, v152
v_perm_b32 v153, v87, v86, s30
v_accvgpr_write_b32 a255, v153
ds_read2st64_b32 v[80:81], v125 offset0:80 offset1:85
ds_read2st64_b32 v[82:83], v125 offset0:100 offset1:105
ds_read2st64_b32 v[84:85], v125 offset0:90 offset1:95
ds_read2st64_b32 v[86:87], v125 offset0:110 offset1:115
s_waitcnt lgkmcnt(4)
v_perm_b32 v196, v97, v96, s29
v_perm_b32 v197, v99, v98, s29
v_perm_b32 v198, v101, v100, s29
v_perm_b32 v199, v103, v102, s29
v_perm_b32 v204, v97, v96, s30
v_perm_b32 v205, v99, v98, s30
v_perm_b32 v206, v101, v100, s30
v_perm_b32 v207, v103, v102, s30
ds_read2st64_b32 v[96:97], v126 offset0:80 offset1:85
ds_read2st64_b32 v[98:99], v126 offset0:100 offset1:105
ds_read2st64_b32 v[100:101], v126 offset0:90 offset1:95
ds_read2st64_b32 v[102:103], v126 offset0:110 offset1:115
s_waitcnt lgkmcnt(4)
v_perm_b32 v244, v81, v80, s29
v_perm_b32 v245, v83, v82, s29
v_perm_b32 v246, v85, v84, s29
v_perm_b32 v247, v87, v86, s29
v_perm_b32 v252, v81, v80, s30
v_perm_b32 v253, v83, v82, s30
v_perm_b32 v254, v85, v84, s30
v_perm_b32 v255, v87, v86, s30
s_waitcnt vmcnt(10)
ds_read2st64_b32 v[80:81], v122 offset0:40 offset1:45
ds_read2st64_b32 v[82:83], v122 offset0:60 offset1:65
ds_read2st64_b32 v[84:85], v122 offset0:50 offset1:55
ds_read2st64_b32 v[86:87], v122 offset0:70 offset1:75
s_waitcnt lgkmcnt(4)
s_cmp_lt_u32 s37, 7864320
s_cselect_b32 s10, 7864320, 0
s_cselect_b32 s38, s37, 0
s_add_u32 m0, s16, 0
s_nop 0
buffer_load_dwordx4 v12, s[8:11], s38 offen lds
s_add_u32 m0, s16, 1024
s_nop 0
buffer_load_dwordx4 v13, s[8:11], s38 offen lds
s_add_u32 m0, s16, 2048
s_nop 0
buffer_load_dwordx4 v14, s[8:11], s38 offen lds
s_add_u32 s37, s37, 393216
s_cmp_lt_u32 s37, 7864320
s_cselect_b32 s10, 7864320, 0
s_cselect_b32 s38, s37, 0
s_add_u32 m0, s17, 0
s_nop 0
buffer_load_dwordx4 v12, s[8:11], s38 offen lds
s_add_u32 m0, s17, 1024
s_nop 0
buffer_load_dwordx4 v13, s[8:11], s38 offen lds
s_add_u32 m0, s17, 2048
s_nop 0
buffer_load_dwordx4 v14, s[8:11], s38 offen lds
s_add_u32 s37, s37, 393216
s_cmp_lt_u32 s37, 7864320
s_cselect_b32 s10, 7864320, 0
s_cselect_b32 s38, s37, 0
s_add_u32 m0, s18, 0
s_nop 0
buffer_load_dwordx4 v12, s[8:11], s38 offen lds
s_add_u32 m0, s18, 1024
s_nop 0
buffer_load_dwordx4 v13, s[8:11], s38 offen lds
s_add_u32 m0, s18, 2048
s_nop 0
buffer_load_dwordx4 v14, s[8:11], s38 offen lds
s_add_u32 s37, s37, 393216
s_cmp_lt_u32 s37, 7864320
s_cselect_b32 s10, 7864320, 0
s_cselect_b32 s38, s37, 0
s_add_u32 m0, s19, 0
s_nop 0
buffer_load_dwordx4 v12, s[8:11], s38 offen lds
s_add_u32 m0, s19, 1024
s_nop 0
buffer_load_dwordx4 v13, s[8:11], s38 offen lds
s_add_u32 m0, s19, 2048
s_nop 0
buffer_load_dwordx4 v14, s[8:11], s38 offen lds
s_add_u32 s37, s37, 393216
s_cmp_lt_u32 s37, 7864320
s_cselect_b32 s10, 7864320, 0
s_cselect_b32 s38, s37, 0
s_add_u32 m0, s36, 0
s_nop 0
buffer_load_dwordx4 v12, s[8:11], s38 offen lds
s_add_u32 m0, s36, 1024
s_nop 0
buffer_load_dwordx4 v13, s[8:11], s38 offen lds
s_add_u32 m0, s36, 2048
s_nop 0
buffer_load_dwordx4 v14, s[8:11], s38 offen lds
s_add_u32 s37, s37, 393216
v_perm_b32 v52, v97, v96, s29
v_perm_b32 v53, v99, v98, s29
v_perm_b32 v54, v101, v100, s29
v_perm_b32 v55, v103, v102, s29
v_perm_b32 v60, v97, v96, s30
v_perm_b32 v61, v99, v98, s30
v_perm_b32 v62, v101, v100, s30
v_perm_b32 v63, v103, v102, s30
ds_read2st64_b32 v[96:97], v123 offset0:40 offset1:45
ds_read2st64_b32 v[98:99], v123 offset0:60 offset1:65
ds_read2st64_b32 v[100:101], v123 offset0:50 offset1:55
ds_read2st64_b32 v[102:103], v123 offset0:70 offset1:75
s_waitcnt lgkmcnt(4)
v_perm_b32 v152, v81, v80, s29
v_accvgpr_write_b32 a208, v152
v_perm_b32 v153, v83, v82, s29
v_accvgpr_write_b32 a209, v153
v_perm_b32 v152, v85, v84, s29
v_accvgpr_write_b32 a210, v152
v_perm_b32 v153, v87, v86, s29
v_accvgpr_write_b32 a211, v153
v_perm_b32 v152, v81, v80, s30
v_accvgpr_write_b32 a216, v152
v_perm_b32 v153, v83, v82, s30
v_accvgpr_write_b32 a217, v153
v_perm_b32 v152, v85, v84, s30
v_accvgpr_write_b32 a218, v152
v_perm_b32 v153, v87, v86, s30
v_accvgpr_write_b32 a219, v153
ds_read2st64_b32 v[80:81], v124 offset0:40 offset1:45
ds_read2st64_b32 v[82:83], v124 offset0:60 offset1:65
ds_read2st64_b32 v[84:85], v124 offset0:50 offset1:55
ds_read2st64_b32 v[86:87], v124 offset0:70 offset1:75
s_waitcnt lgkmcnt(4)
v_perm_b32 v160, v97, v96, s29
v_perm_b32 v161, v99, v98, s29
v_perm_b32 v162, v101, v100, s29
v_perm_b32 v163, v103, v102, s29
v_perm_b32 v168, v97, v96, s30
v_perm_b32 v169, v99, v98, s30
v_perm_b32 v170, v101, v100, s30
v_perm_b32 v171, v103, v102, s30
ds_read2st64_b32 v[96:97], v125 offset0:40 offset1:45
ds_read2st64_b32 v[98:99], v125 offset0:60 offset1:65
ds_read2st64_b32 v[100:101], v125 offset0:50 offset1:55
ds_read2st64_b32 v[102:103], v125 offset0:70 offset1:75
s_waitcnt lgkmcnt(4)
v_perm_b32 v208, v81, v80, s29
v_perm_b32 v209, v83, v82, s29
v_perm_b32 v210, v85, v84, s29
v_perm_b32 v211, v87, v86, s29
v_perm_b32 v216, v81, v80, s30
v_perm_b32 v217, v83, v82, s30
v_perm_b32 v218, v85, v84, s30
v_perm_b32 v219, v87, v86, s30
ds_read2st64_b32 v[80:81], v126 offset0:40 offset1:45
ds_read2st64_b32 v[82:83], v126 offset0:60 offset1:65
ds_read2st64_b32 v[84:85], v126 offset0:50 offset1:55
ds_read2st64_b32 v[86:87], v126 offset0:70 offset1:75
s_waitcnt lgkmcnt(4)
v_perm_b32 v16, v97, v96, s29
v_perm_b32 v17, v99, v98, s29
v_perm_b32 v18, v101, v100, s29
v_perm_b32 v19, v103, v102, s29
v_perm_b32 v24, v97, v96, s30
v_perm_b32 v25, v99, v98, s30
v_perm_b32 v26, v101, v100, s30
v_perm_b32 v27, v103, v102, s30
s_waitcnt vmcnt(15)
ds_read2st64_b32 v[96:97], v122 offset0:0 offset1:5
ds_read2st64_b32 v[98:99], v122 offset0:20 offset1:25
ds_read2st64_b32 v[100:101], v122 offset0:10 offset1:15
ds_read2st64_b32 v[102:103], v122 offset0:30 offset1:35
s_waitcnt lgkmcnt(4)
v_perm_b32 v64, v81, v80, s29
v_perm_b32 v65, v83, v82, s29
v_perm_b32 v66, v85, v84, s29
v_perm_b32 v67, v87, v86, s29
v_perm_b32 v72, v81, v80, s30
v_perm_b32 v73, v83, v82, s30
v_perm_b32 v74, v85, v84, s30
v_perm_b32 v75, v87, v86, s30
ds_read2st64_b32 v[80:81], v123 offset0:0 offset1:5
ds_read2st64_b32 v[82:83], v123 offset0:20 offset1:25
ds_read2st64_b32 v[84:85], v123 offset0:10 offset1:15
ds_read2st64_b32 v[86:87], v123 offset0:30 offset1:35
s_waitcnt lgkmcnt(4)
v_perm_b32 v152, v97, v96, s29
v_accvgpr_write_b32 a212, v152
v_perm_b32 v153, v99, v98, s29
v_accvgpr_write_b32 a213, v153
v_perm_b32 v152, v101, v100, s29
v_accvgpr_write_b32 a214, v152
v_perm_b32 v153, v103, v102, s29
v_accvgpr_write_b32 a215, v153
v_perm_b32 v152, v97, v96, s30
v_accvgpr_write_b32 a220, v152
v_perm_b32 v153, v99, v98, s30
v_accvgpr_write_b32 a221, v153
v_perm_b32 v152, v101, v100, s30
v_accvgpr_write_b32 a222, v152
v_perm_b32 v153, v103, v102, s30
v_accvgpr_write_b32 a223, v153
ds_read2st64_b32 v[96:97], v124 offset0:0 offset1:5
ds_read2st64_b32 v[98:99], v124 offset0:20 offset1:25
ds_read2st64_b32 v[100:101], v124 offset0:10 offset1:15
ds_read2st64_b32 v[102:103], v124 offset0:30 offset1:35
s_waitcnt lgkmcnt(4)
v_perm_b32 v164, v81, v80, s29
v_perm_b32 v165, v83, v82, s29
v_perm_b32 v166, v85, v84, s29
v_perm_b32 v167, v87, v86, s29
v_perm_b32 v172, v81, v80, s30
v_perm_b32 v173, v83, v82, s30
v_perm_b32 v174, v85, v84, s30
v_perm_b32 v175, v87, v86, s30
ds_read2st64_b32 v[80:81], v125 offset0:0 offset1:5
ds_read2st64_b32 v[82:83], v125 offset0:20 offset1:25
ds_read2st64_b32 v[84:85], v125 offset0:10 offset1:15
ds_read2st64_b32 v[86:87], v125 offset0:30 offset1:35
s_waitcnt lgkmcnt(4)
v_perm_b32 v212, v97, v96, s29
v_perm_b32 v213, v99, v98, s29
v_perm_b32 v214, v101, v100, s29
v_perm_b32 v215, v103, v102, s29
v_perm_b32 v220, v97, v96, s30
v_perm_b32 v221, v99, v98, s30
v_perm_b32 v222, v101, v100, s30
v_perm_b32 v223, v103, v102, s30
ds_read2st64_b32 v[96:97], v126 offset0:0 offset1:5
ds_read2st64_b32 v[98:99], v126 offset0:20 offset1:25
ds_read2st64_b32 v[100:101], v126 offset0:10 offset1:15
ds_read2st64_b32 v[102:103], v126 offset0:30 offset1:35
s_waitcnt lgkmcnt(4)
v_perm_b32 v20, v81, v80, s29
v_perm_b32 v21, v83, v82, s29
v_perm_b32 v22, v85, v84, s29
v_perm_b32 v23, v87, v86, s29
v_perm_b32 v28, v81, v80, s30
v_perm_b32 v29, v83, v82, s30
v_perm_b32 v30, v85, v84, s30
v_perm_b32 v31, v87, v86, s30
s_waitcnt vmcnt(12)
v_add_u32 v1, s16, v6
v_add_u32 v127, 1152, v1
v_add_u32 v128, 2304, v1
ds_read2_b32 v[80:81], v1 offset0:0 offset1:1
ds_read2_b32 v[82:83], v1 offset0:96 offset1:97
ds_read2_b32 v[84:85], v127 offset0:96 offset1:97
ds_read2_b32 v[86:87], v127 offset0:192 offset1:193
ds_read2_b32 v[88:89], v1 offset0:192 offset1:193
ds_read2_b32 v[90:91], v127 offset0:0 offset1:1
ds_read2_b32 v[92:93], v128 offset0:0 offset1:1
ds_read2_b32 v[94:95], v128 offset0:96 offset1:97
s_waitcnt lgkmcnt(8)
v_perm_b32 v68, v97, v96, s29
v_perm_b32 v69, v99, v98, s29
v_perm_b32 v70, v101, v100, s29
v_perm_b32 v71, v103, v102, s29
v_perm_b32 v76, v97, v96, s30
v_perm_b32 v77, v99, v98, s30
v_perm_b32 v78, v101, v100, s30
v_perm_b32 v79, v103, v102, s30
s_mov_b32 s39, s16
s_mov_b32 s16, s17
s_mov_b32 s17, s18
s_mov_b32 s18, s19
s_mov_b32 s19, s36
s_mov_b32 s36, s39
s_cmp_eq_u32 s28, 0
s_cbranch_scc1 Lcirc_20_0
s_cmp_eq_u32 s28, 1
s_cbranch_scc1 Lcirc_20_7
s_cmp_eq_u32 s28, 2
s_cbranch_scc1 Lcirc_20_5
s_cmp_eq_u32 s28, 3
s_cbranch_scc1 Lcirc_20_2
Lcirc_20_top:
s_waitcnt vmcnt(9)
v_add_u32 v1, s16, v6
v_add_u32 v127, 1152, v1
v_add_u32 v128, 2304, v1
ds_read2_b32 v[80:81], v1 offset0:0 offset1:1
ds_read2_b32 v[82:83], v1 offset0:96 offset1:97
ds_read2_b32 v[84:85], v127 offset0:96 offset1:97
ds_read2_b32 v[86:87], v127 offset0:192 offset1:193
ds_read2_b32 v[88:89], v1 offset0:192 offset1:193
ds_read2_b32 v[90:91], v127 offset0:0 offset1:1
ds_read2_b32 v[92:93], v128 offset0:0 offset1:1
ds_read2_b32 v[94:95], v128 offset0:96 offset1:97
s_waitcnt lgkmcnt(8)
s_cmp_lt_u32 s37, 7864320
s_cselect_b32 s10, 7864320, 0
s_cselect_b32 s38, s37, 0
s_add_u32 m0, s36, 0
s_nop 0
buffer_load_dwordx4 v12, s[8:11], s38 offen lds
s_add_u32 m0, s36, 1024
s_nop 0
buffer_load_dwordx4 v13, s[8:11], s38 offen lds
s_add_u32 m0, s36, 2048
s_nop 0
buffer_load_dwordx4 v14, s[8:11], s38 offen lds
s_add_u32 s37, s37, 393216
v_perm_b32 v152, v98, v96, v0
v_accvgpr_write_b32 a164, v152
v_perm_b32 v153, v102, v100, v0
v_accvgpr_write_b32 a165, v153
v_perm_b32 v152, v106, v104, v0
v_accvgpr_write_b32 a166, v152
v_perm_b32 v153, v110, v108, v0
v_accvgpr_write_b32 a167, v153
v_perm_b32 v152, v99, v97, v0
v_accvgpr_write_b32 a108, v152
v_perm_b32 v153, v103, v101, v0
v_accvgpr_write_b32 a109, v153
v_perm_b32 v152, v107, v105, v0
v_accvgpr_write_b32 a110, v152
v_perm_b32 v153, v111, v109, v0
v_accvgpr_write_b32 a111, v153
v_cndmask_b32_e64 v96, v96, v97, s[60:61]
v_cndmask_b32_e64 v98, v98, v99, s[60:61]
v_cndmask_b32_e64 v100, v100, v101, s[60:61]
v_cndmask_b32_e64 v102, v102, v103, s[60:61]
v_cndmask_b32_e64 v104, v104, v105, s[60:61]
v_cndmask_b32_e64 v106, v106, v107, s[60:61]
v_cndmask_b32_e64 v108, v108, v109, s[60:61]
v_cndmask_b32_e64 v110, v110, v111, s[60:61]
v_perm_b32 v152, v98, v96, v8
v_accvgpr_write_b32 a172, v152
v_perm_b32 v153, v102, v100, v8
v_accvgpr_write_b32 a173, v153
v_perm_b32 v152, v106, v104, v8
v_accvgpr_write_b32 a174, v152
v_perm_b32 v153, v110, v108, v8
v_accvgpr_write_b32 a175, v153
s_cmp_eq_u32 s37, 9830400
s_cbranch_scc1 Lcirc_20_end
s_mov_b32 s39, s16
s_mov_b32 s16, s17
s_mov_b32 s17, s18
s_mov_b32 s18, s19
s_mov_b32 s19, s36
s_mov_b32 s36, s39
Lcirc_20_0:
s_waitcnt vmcnt(9)
v_add_u32 v1, s16, v6
v_add_u32 v127, 1152, v1
v_add_u32 v128, 2304, v1
ds_read2_b32 v[96:97], v1 offset0:0 offset1:1
ds_read2_b32 v[98:99], v1 offset0:96 offset1:97
ds_read2_b32 v[100:101], v127 offset0:96 offset1:97
ds_read2_b32 v[102:103], v127 offset0:192 offset1:193
ds_read2_b32 v[104:105], v1 offset0:192 offset1:193
ds_read2_b32 v[106:107], v127 offset0:0 offset1:1
ds_read2_b32 v[108:109], v128 offset0:0 offset1:1
ds_read2_b32 v[110:111], v128 offset0:96 offset1:97
s_waitcnt lgkmcnt(8)
s_cmp_lt_u32 s37, 7864320
s_cselect_b32 s10, 7864320, 0
s_cselect_b32 s38, s37, 0
s_add_u32 m0, s36, 0
s_nop 0
buffer_load_dwordx4 v12, s[8:11], s38 offen lds
s_add_u32 m0, s36, 1024
s_nop 0
buffer_load_dwordx4 v13, s[8:11], s38 offen lds
s_add_u32 m0, s36, 2048
s_nop 0
buffer_load_dwordx4 v14, s[8:11], s38 offen lds
s_add_u32 s37, s37, 393216
v_perm_b32 v144, v82, v80, v0
v_perm_b32 v145, v86, v84, v0
v_perm_b32 v146, v90, v88, v0
v_perm_b32 v147, v94, v92, v0
ds_write_b128 v3, v[144:147] offset:0
v_perm_b32 v148, v83, v81, v0
v_perm_b32 v149, v87, v85, v0
v_perm_b32 v150, v91, v89, v0
v_perm_b32 v151, v95, v93, v0
ds_write_b128 v3, v[148:151] offset:4096
v_cndmask_b32_e64 v80, v80, v81, s[60:61]
v_cndmask_b32_e64 v82, v82, v83, s[60:61]
v_cndmask_b32_e64 v84, v84, v85, s[60:61]
v_cndmask_b32_e64 v86, v86, v87, s[60:61]
v_cndmask_b32_e64 v88, v88, v89, s[60:61]
v_cndmask_b32_e64 v90, v90, v91, s[60:61]
v_cndmask_b32_e64 v92, v92, v93, s[60:61]
v_cndmask_b32_e64 v94, v94, v95, s[60:61]
v_perm_b32 v144, v82, v80, v8
v_perm_b32 v145, v86, v84, v8
v_perm_b32 v146, v90, v88, v8
v_perm_b32 v147, v94, v92, v8
ds_write_b128 v3, v[144:147] offset:2048
s_mov_b32 s39, s16
s_mov_b32 s16, s17
s_mov_b32 s17, s18
s_mov_b32 s18, s19
s_mov_b32 s19, s36
s_mov_b32 s36, s39
s_waitcnt vmcnt(9)
v_add_u32 v1, s16, v6
v_add_u32 v127, 1152, v1
v_add_u32 v128, 2304, v1
ds_read2_b32 v[80:81], v1 offset0:0 offset1:1
ds_read2_b32 v[82:83], v1 offset0:96 offset1:97
ds_read2_b32 v[84:85], v127 offset0:96 offset1:97
ds_read2_b32 v[86:87], v127 offset0:192 offset1:193
ds_read2_b32 v[88:89], v1 offset0:192 offset1:193
ds_read2_b32 v[90:91], v127 offset0:0 offset1:1
ds_read2_b32 v[92:93], v128 offset0:0 offset1:1
ds_read2_b32 v[94:95], v128 offset0:96 offset1:97
s_waitcnt lgkmcnt(8)
s_cmp_lt_u32 s37, 7864320
s_cselect_b32 s10, 7864320, 0
s_cselect_b32 s38, s37, 0
s_add_u32 m0, s36, 0
s_nop 0
buffer_load_dwordx4 v12, s[8:11], s38 offen lds
s_add_u32 m0, s36, 1024
s_nop 0
buffer_load_dwordx4 v13, s[8:11], s38 offen lds
s_add_u32 m0, s36, 2048
s_nop 0
buffer_load_dwordx4 v14, s[8:11], s38 offen lds
s_add_u32 s37, s37, 393216
v_perm_b32 v148, v98, v96, v0
v_perm_b32 v149, v102, v100, v0
v_perm_b32 v150, v106, v104, v0
v_perm_b32 v151, v110, v108, v0
ds_write_b128 v3, v[148:151] offset:1024
v_perm_b32 v144, v99, v97, v0
v_perm_b32 v145, v103, v101, v0
v_perm_b32 v146, v107, v105, v0
v_perm_b32 v147, v111, v109, v0
ds_write_b128 v3, v[144:147] offset:5120
v_cndmask_b32_e64 v96, v96, v97, s[60:61]
v_cndmask_b32_e64 v98, v98, v99, s[60:61]
v_cndmask_b32_e64 v100, v100, v101, s[60:61]
v_cndmask_b32_e64 v102, v102, v103, s[60:61]
v_cndmask_b32_e64 v104, v104, v105, s[60:61]
v_cndmask_b32_e64 v106, v106, v107, s[60:61]
v_cndmask_b32_e64 v108, v108, v109, s[60:61]
v_cndmask_b32_e64 v110, v110, v111, s[60:61]
v_perm_b32 v148, v98, v96, v8
v_perm_b32 v149, v102, v100, v8
v_perm_b32 v150, v106, v104, v8
v_perm_b32 v151, v110, v108, v8
ds_write_b128 v3, v[148:151] offset:3072
s_cmp_eq_u32 s37, 9830400
s_cbranch_scc1 Lcirc_20_end
s_mov_b32 s39, s16
s_mov_b32 s16, s17
s_mov_b32 s17, s18
s_mov_b32 s18, s19
s_mov_b32 s19, s36
s_mov_b32 s36, s39
Lcirc_20_1:
s_waitcnt vmcnt(9)
v_add_u32 v1, s16, v6
v_add_u32 v127, 1152, v1
v_add_u32 v128, 2304, v1
ds_read2_b32 v[96:97], v1 offset0:0 offset1:1
ds_read2_b32 v[98:99], v1 offset0:96 offset1:97
ds_read2_b32 v[100:101], v127 offset0:96 offset1:97
ds_read2_b32 v[102:103], v127 offset0:192 offset1:193
ds_read2_b32 v[104:105], v1 offset0:192 offset1:193
ds_read2_b32 v[106:107], v127 offset0:0 offset1:1
ds_read2_b32 v[108:109], v128 offset0:0 offset1:1
ds_read2_b32 v[110:111], v128 offset0:96 offset1:97
s_waitcnt lgkmcnt(8)
s_cmp_lt_u32 s37, 7864320
s_cselect_b32 s10, 7864320, 0
s_cselect_b32 s38, s37, 0
s_add_u32 m0, s36, 0
s_nop 0
buffer_load_dwordx4 v12, s[8:11], s38 offen lds
s_add_u32 m0, s36, 1024
s_nop 0
buffer_load_dwordx4 v13, s[8:11], s38 offen lds
s_add_u32 m0, s36, 2048
s_nop 0
buffer_load_dwordx4 v14, s[8:11], s38 offen lds
s_add_u32 s37, s37, 393216
v_perm_b32 v144, v82, v80, v0
v_perm_b32 v145, v86, v84, v0
v_perm_b32 v146, v90, v88, v0
v_perm_b32 v147, v94, v92, v0
ds_write_b128 v3, v[144:147] offset:6144
v_perm_b32 v148, v83, v81, v0
v_perm_b32 v149, v87, v85, v0
v_perm_b32 v150, v91, v89, v0
v_perm_b32 v151, v95, v93, v0
ds_write_b128 v3, v[148:151] offset:10240
v_cndmask_b32_e64 v80, v80, v81, s[60:61]
v_cndmask_b32_e64 v82, v82, v83, s[60:61]
v_cndmask_b32_e64 v84, v84, v85, s[60:61]
v_cndmask_b32_e64 v86, v86, v87, s[60:61]
v_cndmask_b32_e64 v88, v88, v89, s[60:61]
v_cndmask_b32_e64 v90, v90, v91, s[60:61]
v_cndmask_b32_e64 v92, v92, v93, s[60:61]
v_cndmask_b32_e64 v94, v94, v95, s[60:61]
v_perm_b32 v144, v82, v80, v8
v_perm_b32 v145, v86, v84, v8
v_perm_b32 v146, v90, v88, v8
v_perm_b32 v147, v94, v92, v8
ds_write_b128 v3, v[144:147] offset:8192
s_mov_b32 s39, s16
s_mov_b32 s16, s17
s_mov_b32 s17, s18
s_mov_b32 s18, s19
s_mov_b32 s19, s36
s_mov_b32 s36, s39
s_waitcnt vmcnt(9)
v_add_u32 v1, s16, v6
v_add_u32 v127, 1152, v1
v_add_u32 v128, 2304, v1
ds_read2_b32 v[80:81], v1 offset0:0 offset1:1
ds_read2_b32 v[82:83], v1 offset0:96 offset1:97
ds_read2_b32 v[84:85], v127 offset0:96 offset1:97
ds_read2_b32 v[86:87], v127 offset0:192 offset1:193
ds_read2_b32 v[88:89], v1 offset0:192 offset1:193
ds_read2_b32 v[90:91], v127 offset0:0 offset1:1
ds_read2_b32 v[92:93], v128 offset0:0 offset1:1
ds_read2_b32 v[94:95], v128 offset0:96 offset1:97
s_waitcnt lgkmcnt(8)
s_cmp_lt_u32 s37, 7864320
s_cselect_b32 s10, 7864320, 0
s_cselect_b32 s38, s37, 0
s_add_u32 m0, s36, 0
s_nop 0
buffer_load_dwordx4 v12, s[8:11], s38 offen lds
s_add_u32 m0, s36, 1024
s_nop 0
buffer_load_dwordx4 v13, s[8:11], s38 offen lds
s_add_u32 m0, s36, 2048
s_nop 0
buffer_load_dwordx4 v14, s[8:11], s38 offen lds
s_add_u32 s37, s37, 393216
v_perm_b32 v148, v98, v96, v0
v_perm_b32 v149, v102, v100, v0
v_perm_b32 v150, v106, v104, v0
v_perm_b32 v151, v110, v108, v0
ds_write_b128 v3, v[148:151] offset:7168
v_perm_b32 v144, v99, v97, v0
v_perm_b32 v145, v103, v101, v0
v_perm_b32 v146, v107, v105, v0
v_perm_b32 v147, v111, v109, v0
ds_write_b128 v3, v[144:147] offset:11264
v_cndmask_b32_e64 v96, v96, v97, s[60:61]
v_cndmask_b32_e64 v98, v98, v99, s[60:61]
v_cndmask_b32_e64 v100, v100, v101, s[60:61]
v_cndmask_b32_e64 v102, v102, v103, s[60:61]
v_cndmask_b32_e64 v104, v104, v105, s[60:61]
v_cndmask_b32_e64 v106, v106, v107, s[60:61]
v_cndmask_b32_e64 v108, v108, v109, s[60:61]
v_cndmask_b32_e64 v110, v110, v111, s[60:61]
v_perm_b32 v148, v98, v96, v8
v_perm_b32 v149, v102, v100, v8
v_perm_b32 v150, v106, v104, v8
v_perm_b32 v151, v110, v108, v8
ds_write_b128 v3, v[148:151] offset:9216
s_cmp_eq_u32 s37, 9830400
s_cbranch_scc1 Lcirc_20_end
s_mov_b32 s39, s16
s_mov_b32 s16, s17
s_mov_b32 s17, s18
s_mov_b32 s18, s19
s_mov_b32 s19, s36
s_mov_b32 s36, s39
Lcirc_20_2:
s_waitcnt vmcnt(9)
v_add_u32 v1, s16, v6
v_add_u32 v127, 1152, v1
v_add_u32 v128, 2304, v1
ds_read2_b32 v[96:97], v1 offset0:0 offset1:1
ds_read2_b32 v[98:99], v1 offset0:96 offset1:97
ds_read2_b32 v[100:101], v127 offset0:96 offset1:97
ds_read2_b32 v[102:103], v127 offset0:192 offset1:193
ds_read2_b32 v[104:105], v1 offset0:192 offset1:193
ds_read2_b32 v[106:107], v127 offset0:0 offset1:1
ds_read2_b32 v[108:109], v128 offset0:0 offset1:1
ds_read2_b32 v[110:111], v128 offset0:96 offset1:97
s_waitcnt lgkmcnt(8)
s_cmp_lt_u32 s37, 7864320
s_cselect_b32 s10, 7864320, 0
s_cselect_b32 s38, s37, 0
s_add_u32 m0, s36, 0
s_nop 0
buffer_load_dwordx4 v12, s[8:11], s38 offen lds
s_add_u32 m0, s36, 1024
s_nop 0
buffer_load_dwordx4 v13, s[8:11], s38 offen lds
s_add_u32 m0, s36, 2048
s_nop 0
buffer_load_dwordx4 v14, s[8:11], s38 offen lds
s_add_u32 s37, s37, 393216
v_perm_b32 v144, v82, v80, v0
v_perm_b32 v145, v86, v84, v0
v_perm_b32 v146, v90, v88, v0
v_perm_b32 v147, v94, v92, v0
ds_write_b128 v3, v[144:147] offset:12288
v_perm_b32 v152, v83, v81, v0
v_accvgpr_write_b32 a0, v152
v_perm_b32 v153, v87, v85, v0
v_accvgpr_write_b32 a1, v153
v_perm_b32 v152, v91, v89, v0
v_accvgpr_write_b32 a2, v152
v_perm_b32 v153, v95, v93, v0
v_accvgpr_write_b32 a3, v153
v_cndmask_b32_e64 v80, v80, v81, s[60:61]
v_cndmask_b32_e64 v82, v82, v83, s[60:61]
v_cndmask_b32_e64 v84, v84, v85, s[60:61]
v_cndmask_b32_e64 v86, v86, v87, s[60:61]
v_cndmask_b32_e64 v88, v88, v89, s[60:61]
v_cndmask_b32_e64 v90, v90, v91, s[60:61]
v_cndmask_b32_e64 v92, v92, v93, s[60:61]
v_cndmask_b32_e64 v94, v94, v95, s[60:61]
v_perm_b32 v148, v82, v80, v8
v_perm_b32 v149, v86, v84, v8
v_perm_b32 v150, v90, v88, v8
v_perm_b32 v151, v94, v92, v8
ds_write_b128 v3, v[148:151] offset:14336
s_mov_b32 s39, s16
s_mov_b32 s16, s17
s_mov_b32 s17, s18
s_mov_b32 s18, s19
s_mov_b32 s19, s36
s_mov_b32 s36, s39
s_waitcnt vmcnt(9)
v_add_u32 v1, s16, v6
v_add_u32 v127, 1152, v1
v_add_u32 v128, 2304, v1
ds_read2_b32 v[80:81], v1 offset0:0 offset1:1
ds_read2_b32 v[82:83], v1 offset0:96 offset1:97
ds_read2_b32 v[84:85], v127 offset0:96 offset1:97
ds_read2_b32 v[86:87], v127 offset0:192 offset1:193
ds_read2_b32 v[88:89], v1 offset0:192 offset1:193
ds_read2_b32 v[90:91], v127 offset0:0 offset1:1
ds_read2_b32 v[92:93], v128 offset0:0 offset1:1
ds_read2_b32 v[94:95], v128 offset0:96 offset1:97
s_waitcnt lgkmcnt(8)
s_cmp_lt_u32 s37, 7864320
s_cselect_b32 s10, 7864320, 0
s_cselect_b32 s38, s37, 0
s_add_u32 m0, s36, 0
s_nop 0
buffer_load_dwordx4 v12, s[8:11], s38 offen lds
s_add_u32 m0, s36, 1024
s_nop 0
buffer_load_dwordx4 v13, s[8:11], s38 offen lds
s_add_u32 m0, s36, 2048
s_nop 0
buffer_load_dwordx4 v14, s[8:11], s38 offen lds
s_add_u32 s37, s37, 393216
v_perm_b32 v144, v98, v96, v0
v_perm_b32 v145, v102, v100, v0
v_perm_b32 v146, v106, v104, v0
v_perm_b32 v147, v110, v108, v0
ds_write_b128 v3, v[144:147] offset:13312
v_perm_b32 v152, v99, v97, v0
v_accvgpr_write_b32 a4, v152
v_perm_b32 v153, v103, v101, v0
v_accvgpr_write_b32 a5, v153
v_perm_b32 v152, v107, v105, v0
v_accvgpr_write_b32 a6, v152
v_perm_b32 v153, v111, v109, v0
v_accvgpr_write_b32 a7, v153
v_cndmask_b32_e64 v96, v96, v97, s[60:61]
v_cndmask_b32_e64 v98, v98, v99, s[60:61]
v_cndmask_b32_e64 v100, v100, v101, s[60:61]
v_cndmask_b32_e64 v102, v102, v103, s[60:61]
v_cndmask_b32_e64 v104, v104, v105, s[60:61]
v_cndmask_b32_e64 v106, v106, v107, s[60:61]
v_cndmask_b32_e64 v108, v108, v109, s[60:61]
v_cndmask_b32_e64 v110, v110, v111, s[60:61]
v_perm_b32 v148, v98, v96, v8
v_perm_b32 v149, v102, v100, v8
v_perm_b32 v150, v106, v104, v8
v_perm_b32 v151, v110, v108, v8
ds_write_b128 v3, v[148:151] offset:15360
s_cmp_eq_u32 s37, 9830400
s_cbranch_scc1 Lcirc_20_end
s_mov_b32 s39, s16
s_mov_b32 s16, s17
s_mov_b32 s17, s18
s_mov_b32 s18, s19
s_mov_b32 s19, s36
s_mov_b32 s36, s39
Lcirc_20_3:
s_waitcnt vmcnt(9)
v_add_u32 v1, s16, v6
v_add_u32 v127, 1152, v1
v_add_u32 v128, 2304, v1
ds_read2_b32 v[96:97], v1 offset0:0 offset1:1
ds_read2_b32 v[98:99], v1 offset0:96 offset1:97
ds_read2_b32 v[100:101], v127 offset0:96 offset1:97
ds_read2_b32 v[102:103], v127 offset0:192 offset1:193
ds_read2_b32 v[104:105], v1 offset0:192 offset1:193
ds_read2_b32 v[106:107], v127 offset0:0 offset1:1
ds_read2_b32 v[108:109], v128 offset0:0 offset1:1
ds_read2_b32 v[110:111], v128 offset0:96 offset1:97
s_waitcnt lgkmcnt(8)
s_cmp_lt_u32 s37, 7864320
s_cselect_b32 s10, 7864320, 0
s_cselect_b32 s38, s37, 0
s_add_u32 m0, s36, 0
s_nop 0
buffer_load_dwordx4 v12, s[8:11], s38 offen lds
s_add_u32 m0, s36, 1024
s_nop 0
buffer_load_dwordx4 v13, s[8:11], s38 offen lds
s_add_u32 m0, s36, 2048
s_nop 0
buffer_load_dwordx4 v14, s[8:11], s38 offen lds
s_add_u32 s37, s37, 393216
v_perm_b32 v152, v82, v80, v0
v_accvgpr_write_b32 a16, v152
v_perm_b32 v153, v86, v84, v0
v_accvgpr_write_b32 a17, v153
v_perm_b32 v152, v90, v88, v0
v_accvgpr_write_b32 a18, v152
v_perm_b32 v153, v94, v92, v0
v_accvgpr_write_b32 a19, v153
v_perm_b32 v152, v83, v81, v0
v_accvgpr_write_b32 a8, v152
v_perm_b32 v153, v87, v85, v0
v_accvgpr_write_b32 a9, v153
v_perm_b32 v152, v91, v89, v0
v_accvgpr_write_b32 a10, v152
v_perm_b32 v153, v95, v93, v0
v_accvgpr_write_b32 a11, v153
v_cndmask_b32_e64 v80, v80, v81, s[60:61]
v_cndmask_b32_e64 v82, v82, v83, s[60:61]
v_cndmask_b32_e64 v84, v84, v85, s[60:61]
v_cndmask_b32_e64 v86, v86, v87, s[60:61]
v_cndmask_b32_e64 v88, v88, v89, s[60:61]
v_cndmask_b32_e64 v90, v90, v91, s[60:61]
v_cndmask_b32_e64 v92, v92, v93, s[60:61]
v_cndmask_b32_e64 v94, v94, v95, s[60:61]
v_perm_b32 v152, v82, v80, v8
v_accvgpr_write_b32 a32, v152
v_perm_b32 v153, v86, v84, v8
v_accvgpr_write_b32 a33, v153
v_perm_b32 v152, v90, v88, v8
v_accvgpr_write_b32 a34, v152
v_perm_b32 v153, v94, v92, v8
v_accvgpr_write_b32 a35, v153
s_mov_b32 s39, s16
s_mov_b32 s16, s17
s_mov_b32 s17, s18
s_mov_b32 s18, s19
s_mov_b32 s19, s36
s_mov_b32 s36, s39
s_waitcnt vmcnt(9)
v_add_u32 v1, s16, v6
v_add_u32 v127, 1152, v1
v_add_u32 v128, 2304, v1
ds_read2_b32 v[80:81], v1 offset0:0 offset1:1
ds_read2_b32 v[82:83], v1 offset0:96 offset1:97
ds_read2_b32 v[84:85], v127 offset0:96 offset1:97
ds_read2_b32 v[86:87], v127 offset0:192 offset1:193
ds_read2_b32 v[88:89], v1 offset0:192 offset1:193
ds_read2_b32 v[90:91], v127 offset0:0 offset1:1
ds_read2_b32 v[92:93], v128 offset0:0 offset1:1
ds_read2_b32 v[94:95], v128 offset0:96 offset1:97
s_waitcnt lgkmcnt(8)
s_cmp_lt_u32 s37, 7864320
s_cselect_b32 s10, 7864320, 0
s_cselect_b32 s38, s37, 0
s_add_u32 m0, s36, 0
s_nop 0
buffer_load_dwordx4 v12, s[8:11], s38 offen lds
s_add_u32 m0, s36, 1024
s_nop 0
buffer_load_dwordx4 v13, s[8:11], s38 offen lds
s_add_u32 m0, s36, 2048
s_nop 0
buffer_load_dwordx4 v14, s[8:11], s38 offen lds
s_add_u32 s37, s37, 393216
v_perm_b32 v152, v98, v96, v0
v_accvgpr_write_b32 a20, v152
v_perm_b32 v153, v102, v100, v0
v_accvgpr_write_b32 a21, v153
v_perm_b32 v152, v106, v104, v0
v_accvgpr_write_b32 a22, v152
v_perm_b32 v153, v110, v108, v0
v_accvgpr_write_b32 a23, v153
v_perm_b32 v152, v99, v97, v0
v_accvgpr_write_b32 a12, v152
v_perm_b32 v153, v103, v101, v0
v_accvgpr_write_b32 a13, v153
v_perm_b32 v152, v107, v105, v0
v_accvgpr_write_b32 a14, v152
v_perm_b32 v153, v111, v109, v0
v_accvgpr_write_b32 a15, v153
v_cndmask_b32_e64 v96, v96, v97, s[60:61]
v_cndmask_b32_e64 v98, v98, v99, s[60:61]
v_cndmask_b32_e64 v100, v100, v101, s[60:61]
v_cndmask_b32_e64 v102, v102, v103, s[60:61]
v_cndmask_b32_e64 v104, v104, v105, s[60:61]
v_cndmask_b32_e64 v106, v106, v107, s[60:61]
v_cndmask_b32_e64 v108, v108, v109, s[60:61]
v_cndmask_b32_e64 v110, v110, v111, s[60:61]
v_perm_b32 v152, v98, v96, v8
v_accvgpr_write_b32 a36, v152
v_perm_b32 v153, v102, v100, v8
v_accvgpr_write_b32 a37, v153
v_perm_b32 v152, v106, v104, v8
v_accvgpr_write_b32 a38, v152
v_perm_b32 v153, v110, v108, v8
v_accvgpr_write_b32 a39, v153
s_cmp_eq_u32 s37, 9830400
s_cbranch_scc1 Lcirc_20_end
s_mov_b32 s39, s16
s_mov_b32 s16, s17
s_mov_b32 s17, s18
s_mov_b32 s18, s19
s_mov_b32 s19, s36
s_mov_b32 s36, s39
Lcirc_20_4:
s_waitcnt vmcnt(9)
v_add_u32 v1, s16, v6
v_add_u32 v127, 1152, v1
v_add_u32 v128, 2304, v1
ds_read2_b32 v[96:97], v1 offset0:0 offset1:1
ds_read2_b32 v[98:99], v1 offset0:96 offset1:97
ds_read2_b32 v[100:101], v127 offset0:96 offset1:97
ds_read2_b32 v[102:103], v127 offset0:192 offset1:193
ds_read2_b32 v[104:105], v1 offset0:192 offset1:193
ds_read2_b32 v[106:107], v127 offset0:0 offset1:1
ds_read2_b32 v[108:109], v128 offset0:0 offset1:1
ds_read2_b32 v[110:111], v128 offset0:96 offset1:97
s_waitcnt lgkmcnt(8)
s_cmp_lt_u32 s37, 7864320
s_cselect_b32 s10, 7864320, 0
s_cselect_b32 s38, s37, 0
s_add_u32 m0, s36, 0
s_nop 0
buffer_load_dwordx4 v12, s[8:11], s38 offen lds
s_add_u32 m0, s36, 1024
s_nop 0
buffer_load_dwordx4 v13, s[8:11], s38 offen lds
s_add_u32 m0, s36, 2048
s_nop 0
buffer_load_dwordx4 v14, s[8:11], s38 offen lds
s_add_u32 s37, s37, 393216
v_perm_b32 v152, v82, v80, v0
v_accvgpr_write_b32 a48, v152
v_perm_b32 v153, v86, v84, v0
v_accvgpr_write_b32 a49, v153
v_perm_b32 v152, v90, v88, v0
v_accvgpr_write_b32 a50, v152
v_perm_b32 v153, v94, v92, v0
v_accvgpr_write_b32 a51, v153
v_perm_b32 v152, v83, v81, v0
v_accvgpr_write_b32 a24, v152
v_perm_b32 v153, v87, v85, v0
v_accvgpr_write_b32 a25, v153
v_perm_b32 v152, v91, v89, v0
v_accvgpr_write_b32 a26, v152
v_perm_b32 v153, v95, v93, v0
v_accvgpr_write_b32 a27, v153
v_cndmask_b32_e64 v80, v80, v81, s[60:61]
v_cndmask_b32_e64 v82, v82, v83, s[60:61]
v_cndmask_b32_e64 v84, v84, v85, s[60:61]
v_cndmask_b32_e64 v86, v86, v87, s[60:61]
v_cndmask_b32_e64 v88, v88, v89, s[60:61]
v_cndmask_b32_e64 v90, v90, v91, s[60:61]
v_cndmask_b32_e64 v92, v92, v93, s[60:61]
v_cndmask_b32_e64 v94, v94, v95, s[60:61]
v_perm_b32 v152, v82, v80, v8
v_accvgpr_write_b32 a64, v152
v_perm_b32 v153, v86, v84, v8
v_accvgpr_write_b32 a65, v153
v_perm_b32 v152, v90, v88, v8
v_accvgpr_write_b32 a66, v152
v_perm_b32 v153, v94, v92, v8
v_accvgpr_write_b32 a67, v153
s_mov_b32 s39, s16
s_mov_b32 s16, s17
s_mov_b32 s17, s18
s_mov_b32 s18, s19
s_mov_b32 s19, s36
s_mov_b32 s36, s39
s_waitcnt vmcnt(9)
v_add_u32 v1, s16, v6
v_add_u32 v127, 1152, v1
v_add_u32 v128, 2304, v1
ds_read2_b32 v[80:81], v1 offset0:0 offset1:1
ds_read2_b32 v[82:83], v1 offset0:96 offset1:97
ds_read2_b32 v[84:85], v127 offset0:96 offset1:97
ds_read2_b32 v[86:87], v127 offset0:192 offset1:193
ds_read2_b32 v[88:89], v1 offset0:192 offset1:193
ds_read2_b32 v[90:91], v127 offset0:0 offset1:1
ds_read2_b32 v[92:93], v128 offset0:0 offset1:1
ds_read2_b32 v[94:95], v128 offset0:96 offset1:97
s_waitcnt lgkmcnt(8)
s_cmp_lt_u32 s37, 7864320
s_cselect_b32 s10, 7864320, 0
s_cselect_b32 s38, s37, 0
s_add_u32 m0, s36, 0
s_nop 0
buffer_load_dwordx4 v12, s[8:11], s38 offen lds
s_add_u32 m0, s36, 1024
s_nop 0
buffer_load_dwordx4 v13, s[8:11], s38 offen lds
s_add_u32 m0, s36, 2048
s_nop 0
buffer_load_dwordx4 v14, s[8:11], s38 offen lds
s_add_u32 s37, s37, 393216
v_perm_b32 v152, v98, v96, v0
v_accvgpr_write_b32 a52, v152
v_perm_b32 v153, v102, v100, v0
v_accvgpr_write_b32 a53, v153
v_perm_b32 v152, v106, v104, v0
v_accvgpr_write_b32 a54, v152
v_perm_b32 v153, v110, v108, v0
v_accvgpr_write_b32 a55, v153
v_perm_b32 v152, v99, v97, v0
v_accvgpr_write_b32 a28, v152
v_perm_b32 v153, v103, v101, v0
v_accvgpr_write_b32 a29, v153
v_perm_b32 v152, v107, v105, v0
v_accvgpr_write_b32 a30, v152
v_perm_b32 v153, v111, v109, v0
v_accvgpr_write_b32 a31, v153
v_cndmask_b32_e64 v96, v96, v97, s[60:61]
v_cndmask_b32_e64 v98, v98, v99, s[60:61]
v_cndmask_b32_e64 v100, v100, v101, s[60:61]
v_cndmask_b32_e64 v102, v102, v103, s[60:61]
v_cndmask_b32_e64 v104, v104, v105, s[60:61]
v_cndmask_b32_e64 v106, v106, v107, s[60:61]
v_cndmask_b32_e64 v108, v108, v109, s[60:61]
v_cndmask_b32_e64 v110, v110, v111, s[60:61]
v_perm_b32 v152, v98, v96, v8
v_accvgpr_write_b32 a68, v152
v_perm_b32 v153, v102, v100, v8
v_accvgpr_write_b32 a69, v153
v_perm_b32 v152, v106, v104, v8
v_accvgpr_write_b32 a70, v152
v_perm_b32 v153, v110, v108, v8
v_accvgpr_write_b32 a71, v153
s_cmp_eq_u32 s37, 9830400
s_cbranch_scc1 Lcirc_20_end
s_mov_b32 s39, s16
s_mov_b32 s16, s17
s_mov_b32 s17, s18
s_mov_b32 s18, s19
s_mov_b32 s19, s36
s_mov_b32 s36, s39
Lcirc_20_5:
s_waitcnt vmcnt(9)
v_add_u32 v1, s16, v6
v_add_u32 v127, 1152, v1
v_add_u32 v128, 2304, v1
ds_read2_b32 v[96:97], v1 offset0:0 offset1:1
ds_read2_b32 v[98:99], v1 offset0:96 offset1:97
ds_read2_b32 v[100:101], v127 offset0:96 offset1:97
ds_read2_b32 v[102:103], v127 offset0:192 offset1:193
ds_read2_b32 v[104:105], v1 offset0:192 offset1:193
ds_read2_b32 v[106:107], v127 offset0:0 offset1:1
ds_read2_b32 v[108:109], v128 offset0:0 offset1:1
ds_read2_b32 v[110:111], v128 offset0:96 offset1:97
s_waitcnt lgkmcnt(8)
s_cmp_lt_u32 s37, 7864320
s_cselect_b32 s10, 7864320, 0
s_cselect_b32 s38, s37, 0
s_add_u32 m0, s36, 0
s_nop 0
buffer_load_dwordx4 v12, s[8:11], s38 offen lds
s_add_u32 m0, s36, 1024
s_nop 0
buffer_load_dwordx4 v13, s[8:11], s38 offen lds
s_add_u32 m0, s36, 2048
s_nop 0
buffer_load_dwordx4 v14, s[8:11], s38 offen lds
s_add_u32 s37, s37, 393216
v_perm_b32 v152, v82, v80, v0
v_accvgpr_write_b32 a80, v152
v_perm_b32 v153, v86, v84, v0
v_accvgpr_write_b32 a81, v153
v_perm_b32 v152, v90, v88, v0
v_accvgpr_write_b32 a82, v152
v_perm_b32 v153, v94, v92, v0
v_accvgpr_write_b32 a83, v153
v_perm_b32 v152, v83, v81, v0
v_accvgpr_write_b32 a40, v152
v_perm_b32 v153, v87, v85, v0
v_accvgpr_write_b32 a41, v153
v_perm_b32 v152, v91, v89, v0
v_accvgpr_write_b32 a42, v152
v_perm_b32 v153, v95, v93, v0
v_accvgpr_write_b32 a43, v153
v_cndmask_b32_e64 v80, v80, v81, s[60:61]
v_cndmask_b32_e64 v82, v82, v83, s[60:61]
v_cndmask_b32_e64 v84, v84, v85, s[60:61]
v_cndmask_b32_e64 v86, v86, v87, s[60:61]
v_cndmask_b32_e64 v88, v88, v89, s[60:61]
v_cndmask_b32_e64 v90, v90, v91, s[60:61]
v_cndmask_b32_e64 v92, v92, v93, s[60:61]
v_cndmask_b32_e64 v94, v94, v95, s[60:61]
v_perm_b32 v152, v82, v80, v8
v_accvgpr_write_b32 a96, v152
v_perm_b32 v153, v86, v84, v8
v_accvgpr_write_b32 a97, v153
v_perm_b32 v152, v90, v88, v8
v_accvgpr_write_b32 a98, v152
v_perm_b32 v153, v94, v92, v8
v_accvgpr_write_b32 a99, v153
s_mov_b32 s39, s16
s_mov_b32 s16, s17
s_mov_b32 s17, s18
s_mov_b32 s18, s19
s_mov_b32 s19, s36
s_mov_b32 s36, s39
s_waitcnt vmcnt(9)
v_add_u32 v1, s16, v6
v_add_u32 v127, 1152, v1
v_add_u32 v128, 2304, v1
ds_read2_b32 v[80:81], v1 offset0:0 offset1:1
ds_read2_b32 v[82:83], v1 offset0:96 offset1:97
ds_read2_b32 v[84:85], v127 offset0:96 offset1:97
ds_read2_b32 v[86:87], v127 offset0:192 offset1:193
ds_read2_b32 v[88:89], v1 offset0:192 offset1:193
ds_read2_b32 v[90:91], v127 offset0:0 offset1:1
ds_read2_b32 v[92:93], v128 offset0:0 offset1:1
ds_read2_b32 v[94:95], v128 offset0:96 offset1:97
s_waitcnt lgkmcnt(8)
s_cmp_lt_u32 s37, 7864320
s_cselect_b32 s10, 7864320, 0
s_cselect_b32 s38, s37, 0
s_add_u32 m0, s36, 0
s_nop 0
buffer_load_dwordx4 v12, s[8:11], s38 offen lds
s_add_u32 m0, s36, 1024
s_nop 0
buffer_load_dwordx4 v13, s[8:11], s38 offen lds
s_add_u32 m0, s36, 2048
s_nop 0
buffer_load_dwordx4 v14, s[8:11], s38 offen lds
s_add_u32 s37, s37, 393216
v_perm_b32 v152, v98, v96, v0
v_accvgpr_write_b32 a84, v152
v_perm_b32 v153, v102, v100, v0
v_accvgpr_write_b32 a85, v153
v_perm_b32 v152, v106, v104, v0
v_accvgpr_write_b32 a86, v152
v_perm_b32 v153, v110, v108, v0
v_accvgpr_write_b32 a87, v153
v_perm_b32 v152, v99, v97, v0
v_accvgpr_write_b32 a44, v152
v_perm_b32 v153, v103, v101, v0
v_accvgpr_write_b32 a45, v153
v_perm_b32 v152, v107, v105, v0
v_accvgpr_write_b32 a46, v152
v_perm_b32 v153, v111, v109, v0
v_accvgpr_write_b32 a47, v153
v_cndmask_b32_e64 v96, v96, v97, s[60:61]
v_cndmask_b32_e64 v98, v98, v99, s[60:61]
v_cndmask_b32_e64 v100, v100, v101, s[60:61]
v_cndmask_b32_e64 v102, v102, v103, s[60:61]
v_cndmask_b32_e64 v104, v104, v105, s[60:61]
v_cndmask_b32_e64 v106, v106, v107, s[60:61]
v_cndmask_b32_e64 v108, v108, v109, s[60:61]
v_cndmask_b32_e64 v110, v110, v111, s[60:61]
v_perm_b32 v152, v98, v96, v8
v_accvgpr_write_b32 a100, v152
v_perm_b32 v153, v102, v100, v8
v_accvgpr_write_b32 a101, v153
v_perm_b32 v152, v106, v104, v8
v_accvgpr_write_b32 a102, v152
v_perm_b32 v153, v110, v108, v8
v_accvgpr_write_b32 a103, v153
s_cmp_eq_u32 s37, 9830400
s_cbranch_scc1 Lcirc_20_end
s_mov_b32 s39, s16
s_mov_b32 s16, s17
s_mov_b32 s17, s18
s_mov_b32 s18, s19
s_mov_b32 s19, s36
s_mov_b32 s36, s39
Lcirc_20_6:
s_waitcnt vmcnt(9)
v_add_u32 v1, s16, v6
v_add_u32 v127, 1152, v1
v_add_u32 v128, 2304, v1
ds_read2_b32 v[96:97], v1 offset0:0 offset1:1
ds_read2_b32 v[98:99], v1 offset0:96 offset1:97
ds_read2_b32 v[100:101], v127 offset0:96 offset1:97
ds_read2_b32 v[102:103], v127 offset0:192 offset1:193
ds_read2_b32 v[104:105], v1 offset0:192 offset1:193
ds_read2_b32 v[106:107], v127 offset0:0 offset1:1
ds_read2_b32 v[108:109], v128 offset0:0 offset1:1
ds_read2_b32 v[110:111], v128 offset0:96 offset1:97
s_waitcnt lgkmcnt(8)
s_cmp_lt_u32 s37, 7864320
s_cselect_b32 s10, 7864320, 0
s_cselect_b32 s38, s37, 0
s_add_u32 m0, s36, 0
s_nop 0
buffer_load_dwordx4 v12, s[8:11], s38 offen lds
s_add_u32 m0, s36, 1024
s_nop 0
buffer_load_dwordx4 v13, s[8:11], s38 offen lds
s_add_u32 m0, s36, 2048
s_nop 0
buffer_load_dwordx4 v14, s[8:11], s38 offen lds
s_add_u32 s37, s37, 393216
v_perm_b32 v152, v82, v80, v0
v_accvgpr_write_b32 a112, v152
v_perm_b32 v153, v86, v84, v0
v_accvgpr_write_b32 a113, v153
v_perm_b32 v152, v90, v88, v0
v_accvgpr_write_b32 a114, v152
v_perm_b32 v153, v94, v92, v0
v_accvgpr_write_b32 a115, v153
v_perm_b32 v152, v83, v81, v0
v_accvgpr_write_b32 a56, v152
v_perm_b32 v153, v87, v85, v0
v_accvgpr_write_b32 a57, v153
v_perm_b32 v152, v91, v89, v0
v_accvgpr_write_b32 a58, v152
v_perm_b32 v153, v95, v93, v0
v_accvgpr_write_b32 a59, v153
v_cndmask_b32_e64 v80, v80, v81, s[60:61]
v_cndmask_b32_e64 v82, v82, v83, s[60:61]
v_cndmask_b32_e64 v84, v84, v85, s[60:61]
v_cndmask_b32_e64 v86, v86, v87, s[60:61]
v_cndmask_b32_e64 v88, v88, v89, s[60:61]
v_cndmask_b32_e64 v90, v90, v91, s[60:61]
v_cndmask_b32_e64 v92, v92, v93, s[60:61]
v_cndmask_b32_e64 v94, v94, v95, s[60:61]
v_perm_b32 v152, v82, v80, v8
v_accvgpr_write_b32 a120, v152
v_perm_b32 v153, v86, v84, v8
v_accvgpr_write_b32 a121, v153
v_perm_b32 v152, v90, v88, v8
v_accvgpr_write_b32 a122, v152
v_perm_b32 v153, v94, v92, v8
v_accvgpr_write_b32 a123, v153
s_mov_b32 s39, s16
s_mov_b32 s16, s17
s_mov_b32 s17, s18
s_mov_b32 s18, s19
s_mov_b32 s19, s36
s_mov_b32 s36, s39
s_waitcnt vmcnt(9)
v_add_u32 v1, s16, v6
v_add_u32 v127, 1152, v1
v_add_u32 v128, 2304, v1
ds_read2_b32 v[80:81], v1 offset0:0 offset1:1
ds_read2_b32 v[82:83], v1 offset0:96 offset1:97
ds_read2_b32 v[84:85], v127 offset0:96 offset1:97
ds_read2_b32 v[86:87], v127 offset0:192 offset1:193
ds_read2_b32 v[88:89], v1 offset0:192 offset1:193
ds_read2_b32 v[90:91], v127 offset0:0 offset1:1
ds_read2_b32 v[92:93], v128 offset0:0 offset1:1
ds_read2_b32 v[94:95], v128 offset0:96 offset1:97
s_waitcnt lgkmcnt(8)
s_cmp_lt_u32 s37, 7864320
s_cselect_b32 s10, 7864320, 0
s_cselect_b32 s38, s37, 0
s_add_u32 m0, s36, 0
s_nop 0
buffer_load_dwordx4 v12, s[8:11], s38 offen lds
s_add_u32 m0, s36, 1024
s_nop 0
buffer_load_dwordx4 v13, s[8:11], s38 offen lds
s_add_u32 m0, s36, 2048
s_nop 0
buffer_load_dwordx4 v14, s[8:11], s38 offen lds
s_add_u32 s37, s37, 393216
v_perm_b32 v152, v98, v96, v0
v_accvgpr_write_b32 a116, v152
v_perm_b32 v153, v102, v100, v0
v_accvgpr_write_b32 a117, v153
v_perm_b32 v152, v106, v104, v0
v_accvgpr_write_b32 a118, v152
v_perm_b32 v153, v110, v108, v0
v_accvgpr_write_b32 a119, v153
v_perm_b32 v152, v99, v97, v0
v_accvgpr_write_b32 a60, v152
v_perm_b32 v153, v103, v101, v0
v_accvgpr_write_b32 a61, v153
v_perm_b32 v152, v107, v105, v0
v_accvgpr_write_b32 a62, v152
v_perm_b32 v153, v111, v109, v0
v_accvgpr_write_b32 a63, v153
v_cndmask_b32_e64 v96, v96, v97, s[60:61]
v_cndmask_b32_e64 v98, v98, v99, s[60:61]
v_cndmask_b32_e64 v100, v100, v101, s[60:61]
v_cndmask_b32_e64 v102, v102, v103, s[60:61]
v_cndmask_b32_e64 v104, v104, v105, s[60:61]
v_cndmask_b32_e64 v106, v106, v107, s[60:61]
v_cndmask_b32_e64 v108, v108, v109, s[60:61]
v_cndmask_b32_e64 v110, v110, v111, s[60:61]
v_perm_b32 v152, v98, v96, v8
v_accvgpr_write_b32 a124, v152
v_perm_b32 v153, v102, v100, v8
v_accvgpr_write_b32 a125, v153
v_perm_b32 v152, v106, v104, v8
v_accvgpr_write_b32 a126, v152
v_perm_b32 v153, v110, v108, v8
v_accvgpr_write_b32 a127, v153
s_cmp_eq_u32 s37, 9830400
s_cbranch_scc1 Lcirc_20_end
s_mov_b32 s39, s16
s_mov_b32 s16, s17
s_mov_b32 s17, s18
s_mov_b32 s18, s19
s_mov_b32 s19, s36
s_mov_b32 s36, s39
Lcirc_20_7:
s_waitcnt vmcnt(9)
v_add_u32 v1, s16, v6
v_add_u32 v127, 1152, v1
v_add_u32 v128, 2304, v1
ds_read2_b32 v[96:97], v1 offset0:0 offset1:1
ds_read2_b32 v[98:99], v1 offset0:96 offset1:97
ds_read2_b32 v[100:101], v127 offset0:96 offset1:97
ds_read2_b32 v[102:103], v127 offset0:192 offset1:193
ds_read2_b32 v[104:105], v1 offset0:192 offset1:193
ds_read2_b32 v[106:107], v127 offset0:0 offset1:1
ds_read2_b32 v[108:109], v128 offset0:0 offset1:1
ds_read2_b32 v[110:111], v128 offset0:96 offset1:97
s_waitcnt lgkmcnt(8)
s_cmp_lt_u32 s37, 7864320
s_cselect_b32 s10, 7864320, 0
s_cselect_b32 s38, s37, 0
s_add_u32 m0, s36, 0
s_nop 0
buffer_load_dwordx4 v12, s[8:11], s38 offen lds
s_add_u32 m0, s36, 1024
s_nop 0
buffer_load_dwordx4 v13, s[8:11], s38 offen lds
s_add_u32 m0, s36, 2048
s_nop 0
buffer_load_dwordx4 v14, s[8:11], s38 offen lds
s_add_u32 s37, s37, 393216
v_perm_b32 v152, v82, v80, v0
v_accvgpr_write_b32 a128, v152
v_perm_b32 v153, v86, v84, v0
v_accvgpr_write_b32 a129, v153
v_perm_b32 v152, v90, v88, v0
v_accvgpr_write_b32 a130, v152
v_perm_b32 v153, v94, v92, v0
v_accvgpr_write_b32 a131, v153
v_perm_b32 v152, v83, v81, v0
v_accvgpr_write_b32 a72, v152
v_perm_b32 v153, v87, v85, v0
v_accvgpr_write_b32 a73, v153
v_perm_b32 v152, v91, v89, v0
v_accvgpr_write_b32 a74, v152
v_perm_b32 v153, v95, v93, v0
v_accvgpr_write_b32 a75, v153
v_cndmask_b32_e64 v80, v80, v81, s[60:61]
v_cndmask_b32_e64 v82, v82, v83, s[60:61]
v_cndmask_b32_e64 v84, v84, v85, s[60:61]
v_cndmask_b32_e64 v86, v86, v87, s[60:61]
v_cndmask_b32_e64 v88, v88, v89, s[60:61]
v_cndmask_b32_e64 v90, v90, v91, s[60:61]
v_cndmask_b32_e64 v92, v92, v93, s[60:61]
v_cndmask_b32_e64 v94, v94, v95, s[60:61]
v_perm_b32 v152, v82, v80, v8
v_accvgpr_write_b32 a136, v152
v_perm_b32 v153, v86, v84, v8
v_accvgpr_write_b32 a137, v153
v_perm_b32 v152, v90, v88, v8
v_accvgpr_write_b32 a138, v152
v_perm_b32 v153, v94, v92, v8
v_accvgpr_write_b32 a139, v153
s_mov_b32 s39, s16
s_mov_b32 s16, s17
s_mov_b32 s17, s18
s_mov_b32 s18, s19
s_mov_b32 s19, s36
s_mov_b32 s36, s39
s_waitcnt vmcnt(9)
v_add_u32 v1, s16, v6
v_add_u32 v127, 1152, v1
v_add_u32 v128, 2304, v1
ds_read2_b32 v[80:81], v1 offset0:0 offset1:1
ds_read2_b32 v[82:83], v1 offset0:96 offset1:97
ds_read2_b32 v[84:85], v127 offset0:96 offset1:97
ds_read2_b32 v[86:87], v127 offset0:192 offset1:193
ds_read2_b32 v[88:89], v1 offset0:192 offset1:193
ds_read2_b32 v[90:91], v127 offset0:0 offset1:1
ds_read2_b32 v[92:93], v128 offset0:0 offset1:1
ds_read2_b32 v[94:95], v128 offset0:96 offset1:97
s_waitcnt lgkmcnt(8)
s_cmp_lt_u32 s37, 7864320
s_cselect_b32 s10, 7864320, 0
s_cselect_b32 s38, s37, 0
s_add_u32 m0, s36, 0
s_nop 0
buffer_load_dwordx4 v12, s[8:11], s38 offen lds
s_add_u32 m0, s36, 1024
s_nop 0
buffer_load_dwordx4 v13, s[8:11], s38 offen lds
s_add_u32 m0, s36, 2048
s_nop 0
buffer_load_dwordx4 v14, s[8:11], s38 offen lds
s_add_u32 s37, s37, 393216
v_perm_b32 v152, v98, v96, v0
v_accvgpr_write_b32 a132, v152
v_perm_b32 v153, v102, v100, v0
v_accvgpr_write_b32 a133, v153
v_perm_b32 v152, v106, v104, v0
v_accvgpr_write_b32 a134, v152
v_perm_b32 v153, v110, v108, v0
v_accvgpr_write_b32 a135, v153
v_perm_b32 v152, v99, v97, v0
v_accvgpr_write_b32 a76, v152
v_perm_b32 v153, v103, v101, v0
v_accvgpr_write_b32 a77, v153
v_perm_b32 v152, v107, v105, v0
v_accvgpr_write_b32 a78, v152
v_perm_b32 v153, v111, v109, v0
v_accvgpr_write_b32 a79, v153
v_cndmask_b32_e64 v96, v96, v97, s[60:61]
v_cndmask_b32_e64 v98, v98, v99, s[60:61]
v_cndmask_b32_e64 v100, v100, v101, s[60:61]
v_cndmask_b32_e64 v102, v102, v103, s[60:61]
v_cndmask_b32_e64 v104, v104, v105, s[60:61]
v_cndmask_b32_e64 v106, v106, v107, s[60:61]
v_cndmask_b32_e64 v108, v108, v109, s[60:61]
v_cndmask_b32_e64 v110, v110, v111, s[60:61]
v_perm_b32 v152, v98, v96, v8
v_accvgpr_write_b32 a140, v152
v_perm_b32 v153, v102, v100, v8
v_accvgpr_write_b32 a141, v153
v_perm_b32 v152, v106, v104, v8
v_accvgpr_write_b32 a142, v152
v_perm_b32 v153, v110, v108, v8
v_accvgpr_write_b32 a143, v153
s_cmp_eq_u32 s37, 9830400
s_cbranch_scc1 Lcirc_20_end
s_mov_b32 s39, s16
s_mov_b32 s16, s17
s_mov_b32 s17, s18
s_mov_b32 s18, s19
s_mov_b32 s19, s36
s_mov_b32 s36, s39
Lcirc_20_8:
s_waitcnt vmcnt(9)
v_add_u32 v1, s16, v6
v_add_u32 v127, 1152, v1
v_add_u32 v128, 2304, v1
ds_read2_b32 v[96:97], v1 offset0:0 offset1:1
ds_read2_b32 v[98:99], v1 offset0:96 offset1:97
ds_read2_b32 v[100:101], v127 offset0:96 offset1:97
ds_read2_b32 v[102:103], v127 offset0:192 offset1:193
ds_read2_b32 v[104:105], v1 offset0:192 offset1:193
ds_read2_b32 v[106:107], v127 offset0:0 offset1:1
ds_read2_b32 v[108:109], v128 offset0:0 offset1:1
ds_read2_b32 v[110:111], v128 offset0:96 offset1:97
s_waitcnt lgkmcnt(8)
s_cmp_lt_u32 s37, 7864320
s_cselect_b32 s10, 7864320, 0
s_cselect_b32 s38, s37, 0
s_add_u32 m0, s36, 0
s_nop 0
buffer_load_dwordx4 v12, s[8:11], s38 offen lds
s_add_u32 m0, s36, 1024
s_nop 0
buffer_load_dwordx4 v13, s[8:11], s38 offen lds
s_add_u32 m0, s36, 2048
s_nop 0
buffer_load_dwordx4 v14, s[8:11], s38 offen lds
s_add_u32 s37, s37, 393216
v_perm_b32 v152, v82, v80, v0
v_accvgpr_write_b32 a144, v152
v_perm_b32 v153, v86, v84, v0
v_accvgpr_write_b32 a145, v153
v_perm_b32 v152, v90, v88, v0
v_accvgpr_write_b32 a146, v152
v_perm_b32 v153, v94, v92, v0
v_accvgpr_write_b32 a147, v153
v_perm_b32 v152, v83, v81, v0
v_accvgpr_write_b32 a88, v152
v_perm_b32 v153, v87, v85, v0
v_accvgpr_write_b32 a89, v153
v_perm_b32 v152, v91, v89, v0
v_accvgpr_write_b32 a90, v152
v_perm_b32 v153, v95, v93, v0
v_accvgpr_write_b32 a91, v153
v_cndmask_b32_e64 v80, v80, v81, s[60:61]
v_cndmask_b32_e64 v82, v82, v83, s[60:61]
v_cndmask_b32_e64 v84, v84, v85, s[60:61]
v_cndmask_b32_e64 v86, v86, v87, s[60:61]
v_cndmask_b32_e64 v88, v88, v89, s[60:61]
v_cndmask_b32_e64 v90, v90, v91, s[60:61]
v_cndmask_b32_e64 v92, v92, v93, s[60:61]
v_cndmask_b32_e64 v94, v94, v95, s[60:61]
v_perm_b32 v152, v82, v80, v8
v_accvgpr_write_b32 a152, v152
v_perm_b32 v153, v86, v84, v8
v_accvgpr_write_b32 a153, v153
v_perm_b32 v152, v90, v88, v8
v_accvgpr_write_b32 a154, v152
v_perm_b32 v153, v94, v92, v8
v_accvgpr_write_b32 a155, v153
s_mov_b32 s39, s16
s_mov_b32 s16, s17
s_mov_b32 s17, s18
s_mov_b32 s18, s19
s_mov_b32 s19, s36
s_mov_b32 s36, s39
s_waitcnt vmcnt(9)
v_add_u32 v1, s16, v6
v_add_u32 v127, 1152, v1
v_add_u32 v128, 2304, v1
ds_read2_b32 v[80:81], v1 offset0:0 offset1:1
ds_read2_b32 v[82:83], v1 offset0:96 offset1:97
ds_read2_b32 v[84:85], v127 offset0:96 offset1:97
ds_read2_b32 v[86:87], v127 offset0:192 offset1:193
ds_read2_b32 v[88:89], v1 offset0:192 offset1:193
ds_read2_b32 v[90:91], v127 offset0:0 offset1:1
ds_read2_b32 v[92:93], v128 offset0:0 offset1:1
ds_read2_b32 v[94:95], v128 offset0:96 offset1:97
s_waitcnt lgkmcnt(8)
s_cmp_lt_u32 s37, 7864320
s_cselect_b32 s10, 7864320, 0
s_cselect_b32 s38, s37, 0
s_add_u32 m0, s36, 0
s_nop 0
buffer_load_dwordx4 v12, s[8:11], s38 offen lds
s_add_u32 m0, s36, 1024
s_nop 0
buffer_load_dwordx4 v13, s[8:11], s38 offen lds
s_add_u32 m0, s36, 2048
s_nop 0
buffer_load_dwordx4 v14, s[8:11], s38 offen lds
s_add_u32 s37, s37, 393216
v_perm_b32 v152, v98, v96, v0
v_accvgpr_write_b32 a148, v152
v_perm_b32 v153, v102, v100, v0
v_accvgpr_write_b32 a149, v153
v_perm_b32 v152, v106, v104, v0
v_accvgpr_write_b32 a150, v152
v_perm_b32 v153, v110, v108, v0
v_accvgpr_write_b32 a151, v153
v_perm_b32 v152, v99, v97, v0
v_accvgpr_write_b32 a92, v152
v_perm_b32 v153, v103, v101, v0
v_accvgpr_write_b32 a93, v153
v_perm_b32 v152, v107, v105, v0
v_accvgpr_write_b32 a94, v152
v_perm_b32 v153, v111, v109, v0
v_accvgpr_write_b32 a95, v153
v_cndmask_b32_e64 v96, v96, v97, s[60:61]
v_cndmask_b32_e64 v98, v98, v99, s[60:61]
v_cndmask_b32_e64 v100, v100, v101, s[60:61]
v_cndmask_b32_e64 v102, v102, v103, s[60:61]
v_cndmask_b32_e64 v104, v104, v105, s[60:61]
v_cndmask_b32_e64 v106, v106, v107, s[60:61]
v_cndmask_b32_e64 v108, v108, v109, s[60:61]
v_cndmask_b32_e64 v110, v110, v111, s[60:61]
v_perm_b32 v152, v98, v96, v8
v_accvgpr_write_b32 a156, v152
v_perm_b32 v153, v102, v100, v8
v_accvgpr_write_b32 a157, v153
v_perm_b32 v152, v106, v104, v8
v_accvgpr_write_b32 a158, v152
v_perm_b32 v153, v110, v108, v8
v_accvgpr_write_b32 a159, v153
s_cmp_eq_u32 s37, 9830400
s_cbranch_scc1 Lcirc_20_end
s_mov_b32 s39, s16
s_mov_b32 s16, s17
s_mov_b32 s17, s18
s_mov_b32 s18, s19
s_mov_b32 s19, s36
s_mov_b32 s36, s39
Lcirc_20_9:
s_waitcnt vmcnt(9)
v_add_u32 v1, s16, v6
v_add_u32 v127, 1152, v1
v_add_u32 v128, 2304, v1
ds_read2_b32 v[96:97], v1 offset0:0 offset1:1
ds_read2_b32 v[98:99], v1 offset0:96 offset1:97
ds_read2_b32 v[100:101], v127 offset0:96 offset1:97
ds_read2_b32 v[102:103], v127 offset0:192 offset1:193
ds_read2_b32 v[104:105], v1 offset0:192 offset1:193
ds_read2_b32 v[106:107], v127 offset0:0 offset1:1
ds_read2_b32 v[108:109], v128 offset0:0 offset1:1
ds_read2_b32 v[110:111], v128 offset0:96 offset1:97
s_waitcnt lgkmcnt(8)
s_cmp_lt_u32 s37, 7864320
s_cselect_b32 s10, 7864320, 0
s_cselect_b32 s38, s37, 0
s_add_u32 m0, s36, 0
s_nop 0
buffer_load_dwordx4 v12, s[8:11], s38 offen lds
s_add_u32 m0, s36, 1024
s_nop 0
buffer_load_dwordx4 v13, s[8:11], s38 offen lds
s_add_u32 m0, s36, 2048
s_nop 0
buffer_load_dwordx4 v14, s[8:11], s38 offen lds
s_add_u32 s37, s37, 393216
v_perm_b32 v152, v82, v80, v0
v_accvgpr_write_b32 a160, v152
v_perm_b32 v153, v86, v84, v0
v_accvgpr_write_b32 a161, v153
v_perm_b32 v152, v90, v88, v0
v_accvgpr_write_b32 a162, v152
v_perm_b32 v153, v94, v92, v0
v_accvgpr_write_b32 a163, v153
v_perm_b32 v152, v83, v81, v0
v_accvgpr_write_b32 a104, v152
v_perm_b32 v153, v87, v85, v0
v_accvgpr_write_b32 a105, v153
v_perm_b32 v152, v91, v89, v0
v_accvgpr_write_b32 a106, v152
v_perm_b32 v153, v95, v93, v0
v_accvgpr_write_b32 a107, v153
v_cndmask_b32_e64 v80, v80, v81, s[60:61]
v_cndmask_b32_e64 v82, v82, v83, s[60:61]
v_cndmask_b32_e64 v84, v84, v85, s[60:61]
v_cndmask_b32_e64 v86, v86, v87, s[60:61]
v_cndmask_b32_e64 v88, v88, v89, s[60:61]
v_cndmask_b32_e64 v90, v90, v91, s[60:61]
v_cndmask_b32_e64 v92, v92, v93, s[60:61]
v_cndmask_b32_e64 v94, v94, v95, s[60:61]
v_perm_b32 v152, v82, v80, v8
v_accvgpr_write_b32 a168, v152
v_perm_b32 v153, v86, v84, v8
v_accvgpr_write_b32 a169, v153
v_perm_b32 v152, v90, v88, v8
v_accvgpr_write_b32 a170, v152
v_perm_b32 v153, v94, v92, v8
v_accvgpr_write_b32 a171, v153
s_mov_b32 s39, s16
s_mov_b32 s16, s17
s_mov_b32 s17, s18
s_mov_b32 s18, s19
s_mov_b32 s19, s36
s_mov_b32 s36, s39
s_branch Lcirc_20_top
Lcirc_20_end:
s_waitcnt vmcnt(0)
ds_write_b128 v3, v[16:19] offset:16384
ds_write_b128 v3, v[20:23] offset:17408
ds_write_b128 v3, v[24:27] offset:18432
ds_write_b128 v3, v[28:31] offset:19456
ds_write_b128 v3, v[32:35] offset:20480
ds_write_b128 v3, v[36:39] offset:21504
ds_write_b128 v3, v[40:43] offset:22528
ds_write_b128 v3, v[44:47] offset:23552
ds_write_b128 v3, v[48:51] offset:24576
ds_write_b128 v3, v[52:55] offset:25600
ds_write_b128 v3, v[56:59] offset:26624
ds_write_b128 v3, v[60:63] offset:27648
ds_write_b128 v3, v[64:67] offset:28672
ds_write_b128 v3, v[68:71] offset:29696
ds_write_b128 v3, v[72:75] offset:30720
ds_write_b128 v3, v[76:79] offset:31744
v_mov_b32 v8, -1
v_mov_b32 v9, -1
v_mov_b32 v10, -1
v_mov_b32 v11, -1
v_mov_b32 v12, v159
v_mov_b32 v13, v156
v_mov_b32 v14, v157
v_mov_b32 v0, v155
v_add_u32 v6, 131072, v2
s_and_b32 s46, s27, 15
s_mul_i32 s47, s46, 32
s_lshr_b32 s47, s47, 8
s_mul_i32 s47, s47, 8
s_sub_u32 s46, s46, s47
s_lshl_b32 s46, s46, 2
s_add_u32 s46, s46, s26
s_lshl_b32 s46, s46, 14
s_add_u32 s46, s46, 1048576
s_mov_b32 s35, s46
s_lshl_b32 s34, s34, 6
v_min_u32 v7, 176, v2
v_add_u32 v7, s34, v7
v_subrev_u32 v1, 640, v7
v_min_u32 v7, v1, v7
v_lshl_add_u32 v7, v7, 3, s35
s_cmp_lg_u32 s28, 0
s_cbranch_scc1 Lgwd_22
Lgw_21:
buffer_load_dwordx2 v[18:19], off, s[20:23], 0 sc1
s_waitcnt vmcnt(0)
v_cmp_gt_u32 vcc, 255, v18
v_mov_b32 v18, v19
v_and_b32 v19, 0xffff, v19
v_cmp_gt_u32_e64 s[46:47], 2, v19
s_or_b64 vcc, vcc, s[46:47]
s_cbranch_vccz Lgwe_23
s_cmp_eq_u32 s25, 0
s_cbranch_scc1 Lgwe_23
s_sub_u32 s25, s25, 1
s_sleep 4
s_branch Lgw_21
Lgwe_23:
v_mov_b32 v19, 163836
ds_write_b32 v19, v18
s_waitcnt lgkmcnt(0)
Lgwd_22:
s_barrier
v_mov_b32 v19, 163836
ds_read_b32 v18, v19
s_waitcnt lgkmcnt(0)
v_readfirstlane_b32 s46, v18
s_bfe_u32 s47, s46, 0x10010
s_lshl_b32 s47, s47, 13
s_add_u32 s88, s88, s47
s_bfe_u32 s47, s46, 0x10011
s_lshl_b32 s47, s47, 13
s_add_u32 s89, s89, s47
s_add_u32 s43, s53, s88
s_add_u32 s54, s43, 1310720
s_mov_b32 s53, s54
Lvum_loop:
ds_read_b128 v[96:99], v3 offset:0
ds_read_b128 v[100:103], v3 offset:1024
ds_read_b128 v[104:107], v3 offset:2048
ds_read_b128 v[108:111], v3 offset:3072
ds_read_b128 v[112:115], v3 offset:4096
ds_read_b128 v[116:119], v3 offset:5120
ds_read_b128 v[120:123], v3 offset:6144
ds_read_b128 v[124:127], v3 offset:7168
ds_read_b128 v[128:131], v3 offset:8192
ds_read_b128 v[132:135], v3 offset:9216
ds_read_b128 v[136:139], v3 offset:10240
ds_read_b128 v[140:143], v3 offset:11264
ds_read_b128 v[144:147], v3 offset:12288
ds_read_b128 v[148:151], v3 offset:13312
ds_read_b128 v[152:155], v3 offset:14336
ds_read_b128 v[156:159], v3 offset:15360
s_and_b32 s46, s24, 3
s_mul_i32 s46, s46, 32768
s_add_u32 s46, s46, s89
s_add_u32 s40, s46, s90
s_add_u32 s41, s46, s91
s_add_u32 s42, s46, s92
s_add_u32 s50, s24, 1
Lvum_gate:
buffer_load_dword v1, v7, s[4:7], s89 offen sc1
s_waitcnt vmcnt(0)
v_cmp_gt_u32 vcc, s24, v1
s_cbranch_vccz Lvum_open
s_mov_b64 exec, vcc
s_cmp_eq_u32 s25, 0
s_cbranch_scc1 Lvum_open
s_sub_u32 s25, s25, 1
s_branch Lvum_gate
Lvum_open:
s_mov_b64 exec, -1
buffer_load_dwordx4 v[16:19], v2, s[4:7], s40 offen sc1
buffer_load_dwordx4 v[20:23], v2, s[4:7], s41 offen sc1
buffer_load_dwordx4 v[24:27], v2, s[4:7], s42 offen sc1
v_add_u32 v53, s93, v2
v_add_u32 v54, s94, v2
v_add_u32 v55, s95, v2
v_add_u32 v28, s96, v2
v_add_u32 v32, s97, v2
v_add_u32 v36, s98, v2
v_add_u32 v40, s99, v2
v_add_u32 v44, s100, v2
v_add_u32 v48, s101, v2
v_add_u32 v52, s32, v2
v_mov_b64 v[56:57], 0
v_mov_b64 v[58:59], 0
v_mov_b64 v[60:61], 0
v_mov_b64 v[62:63], 0
v_mov_b64 v[64:65], 0
v_mov_b64 v[66:67], 0
s_waitcnt lgkmcnt(0)
s_waitcnt vmcnt(2)
v_cmp_eq_u32 vcc, -1, v16
s_cbranch_vccnz Lvum_R0
Lvum_G0:
v_smfmac_f32_16x16x64_bf16 v[56:59], v[16:19], v[96:103], v4
ds_write_b128 v53, v[16:19]
s_waitcnt vmcnt(1)
v_cmp_eq_u32 vcc, -1, v20
v_smfmac_f32_16x16x64_bf16 v[60:63], v[16:19], v[104:111], v4
s_cbranch_vccnz Lvum_R1
Lvum_G1:
v_smfmac_f32_16x16x64_bf16 v[64:67], v[16:19], v[112:119], v4
ds_write_b128 v54, v[20:23]
s_waitcnt vmcnt(0)
v_cmp_eq_u32 vcc, -1, v24
v_smfmac_f32_16x16x64_bf16 v[56:59], v[20:23], v[120:127], v4
s_cbranch_vccnz Lvum_R2
Lvum_G2:
v_smfmac_f32_16x16x64_bf16 v[60:63], v[20:23], v[128:135], v4
ds_write_b128 v55, v[24:27]
v_smfmac_f32_16x16x64_bf16 v[64:67], v[20:23], v[136:143], v4
s_waitcnt lgkmcnt(0)
s_barrier
ds_read_b128 v[28:31], v28
ds_read_b128 v[32:35], v32
v_smfmac_f32_16x16x64_bf16 v[56:59], v[24:27], v[144:151], v4
ds_read_b128 v[36:39], v36
ds_read_b128 v[40:43], v40
v_smfmac_f32_16x16x64_bf16 v[60:63], v[24:27], v[152:159], v4
ds_read_b128 v[44:47], v44
ds_read_b128 v[48:51], v48
v_smfmac_f32_16x16x64_bf16 v[64:67], v[24:27], a[0:7], v4
ds_read_b128 v[52:55], v52
s_waitcnt lgkmcnt(6)
v_smfmac_f32_16x16x64_bf16 v[64:67], v[28:31], a[8:15], v4
v_mov_b64 v[16:17], 0
v_smfmac_f32_16x16x64_bf16 v[56:59], v[28:31], a[16:23], v4
s_waitcnt lgkmcnt(5)
v_mov_b64 v[18:19], 0
v_smfmac_f32_16x16x64_bf16 v[64:67], v[32:35], a[24:31], v4
v_mov_b64 v[20:21], 0
v_smfmac_f32_16x16x64_bf16 v[60:63], v[28:31], a[32:39], v4
ds_read_b128 v[96:99], v3 offset:16384
s_waitcnt lgkmcnt(5)
v_mov_b64 v[22:23], 0
v_smfmac_f32_16x16x64_bf16 v[64:67], v[36:39], a[40:47], v4
ds_read_b128 v[100:103], v3 offset:17408
v_mov_b64 v[24:25], 0
v_smfmac_f32_16x16x64_bf16 v[56:59], v[32:35], a[48:55], v4
ds_read_b128 v[104:107], v3 offset:18432
s_waitcnt lgkmcnt(6)
v_mov_b64 v[26:27], 0
v_smfmac_f32_16x16x64_bf16 v[64:67], v[40:43], a[56:63], v4
ds_read_b128 v[108:111], v3 offset:19456
v_smfmac_f32_16x16x64_bf16 v[60:63], v[32:35], a[64:71], v4
ds_read_b128 v[112:115], v3 offset:20480
s_waitcnt lgkmcnt(7)
v_smfmac_f32_16x16x64_bf16 v[64:67], v[44:47], a[72:79], v4
ds_read_b128 v[116:119], v3 offset:21504
v_mov_b64 v[28:29], 0
v_smfmac_f32_16x16x64_bf16 v[56:59], v[36:39], a[80:87], v4
ds_read_b128 v[120:123], v3 offset:22528
s_waitcnt lgkmcnt(8)
v_mov_b64 v[30:31], 0
v_smfmac_f32_16x16x64_bf16 v[64:67], v[48:51], a[88:95], v4
ds_read_b128 v[124:127], v3 offset:23552
v_mov_b64 v[32:33], 0
v_smfmac_f32_16x16x64_bf16 v[60:63], v[36:39], a[96:103], v4
ds_read_b128 v[128:131], v3 offset:24576
s_waitcnt lgkmcnt(9)
v_mov_b64 v[34:35], 0
v_smfmac_f32_16x16x64_bf16 v[64:67], v[52:55], a[104:111], v4
ds_read_b128 v[132:135], v3 offset:25600
v_smfmac_f32_16x16x64_bf16 v[56:59], v[40:43], a[112:119], v4
ds_read_b128 v[136:139], v3 offset:26624
v_smfmac_f32_16x16x64_bf16 v[60:63], v[40:43], a[120:127], v4
ds_read_b128 v[140:143], v3 offset:27648
v_permlane32_swap_b32 v64, v65
v_smfmac_f32_16x16x64_bf16 v[56:59], v[44:47], a[128:135], v4
ds_read_b128 v[144:147], v3 offset:28672
v_permlane32_swap_b32 v66, v67
v_smfmac_f32_16x16x64_bf16 v[60:63], v[44:47], a[136:143], v4
ds_read_b128 v[148:151], v3 offset:29696
v_add_f32 v64, v64, v65
v_smfmac_f32_16x16x64_bf16 v[56:59], v[48:51], a[144:151], v4
ds_read_b128 v[152:155], v3 offset:30720
v_add_f32 v66, v66, v67
v_smfmac_f32_16x16x64_bf16 v[60:63], v[48:51], a[152:159], v4
ds_read_b128 v[156:159], v3 offset:31744
v_cvt_pk_bf16_f32 v65, v64, v66
v_smfmac_f32_16x16x64_bf16 v[56:59], v[52:55], a[160:167], v4
ds_write_b16 v14, v65
v_smfmac_f32_16x16x64_bf16 v[60:63], v[52:55], a[168:175], v4
ds_write_b16_d16_hi v14, v65 offset:32
s_nop 2
v_permlane32_swap_b32 v56, v57
v_permlane32_swap_b32 v58, v59
s_nop 1
v_permlane32_swap_b32 v60, v61
v_permlane32_swap_b32 v62, v63
v_add_f32 v56, v56, v57
v_add_f32 v58, v58, v59
v_add_f32 v60, v60, v61
v_add_f32 v62, v62, v63
v_cvt_pk_bf16_f32 v57, v56, v60
v_cvt_pk_bf16_f32 v59, v58, v62
ds_write2_b32 v13, v57, v59 offset1:8
s_waitcnt lgkmcnt(0)
s_barrier
ds_read_b128 v[68:71], v6 offset:0
ds_read_b128 v[72:75], v6 offset:1024
ds_read_b128 v[76:79], v6 offset:2048
v_mov_b64 v[36:37], 0
v_mov_b64 v[38:39], 0
v_mov_b64 v[40:41], 0
v_mov_b64 v[42:43], 0
v_mov_b64 v[44:45], 0
v_mov_b64 v[46:47], 0
v_mov_b64 v[48:49], 0
v_mov_b64 v[50:51], 0
v_mov_b64 v[52:53], 0
v_mov_b64 v[54:55], 0
s_waitcnt lgkmcnt(2)
v_smfmac_f32_16x16x64_bf16 v[16:19], v[68:71], a[176:183], v4
v_smfmac_f32_16x16x64_bf16 v[20:23], v[68:71], a[184:191], v4
s_waitcnt lgkmcnt(1)
v_smfmac_f32_16x16x64_bf16 v[16:19], v[72:75], a[192:199], v4
v_smfmac_f32_16x16x64_bf16 v[20:23], v[72:75], a[200:207], v4
s_waitcnt lgkmcnt(0)
v_smfmac_f32_16x16x64_bf16 v[16:19], v[76:79], a[208:215], v4
v_smfmac_f32_16x16x64_bf16 v[20:23], v[76:79], a[216:223], v4
v_smfmac_f32_16x16x64_bf16 v[24:27], v[68:71], a[224:231], v4
v_smfmac_f32_16x16x64_bf16 v[28:31], v[68:71], a[232:239], v4
v_permlane32_swap_b32 v16, v20
v_permlane32_swap_b32 v17, v21
v_smfmac_f32_16x16x64_bf16 v[24:27], v[72:75], a[240:247], v4
v_add_f32 v16, v16, v20
v_permlane32_swap_b32 v18, v22
v_smfmac_f32_16x16x64_bf16 v[28:31], v[72:75], a[248:255], v4
v_add_f32 v17, v17, v21
v_smfmac_f32_16x16x64_bf16 v[24:27], v[76:79], v[160:167], v4
v_permlane32_swap_b32 v19, v23
v_smfmac_f32_16x16x64_bf16 v[28:31], v[76:79], v[168:175], v4
v_add_f32 v18, v18, v22
v_smfmac_f32_16x16x64_bf16 v[32:35], v[68:71], v[176:183], v4
v_add_f32 v19, v19, v23
v_smfmac_f32_16x16x64_bf16 v[36:39], v[68:71], v[184:191], v4
v_cvt_pk_bf16_f32 v20, v16, v17
v_cvt_pk_bf16_f32 v21, v18, v19
v_smfmac_f32_16x16x64_bf16 v[32:35], v[72:75], v[192:199], v4
v_permlane32_swap_b32 v24, v28
v_permlane32_swap_b32 v25, v29
v_smfmac_f32_16x16x64_bf16 v[36:39], v[72:75], v[200:207], v4
v_add_f32 v24, v24, v28
v_permlane32_swap_b32 v26, v30
v_smfmac_f32_16x16x64_bf16 v[32:35], v[76:79], v[208:215], v4
v_add_f32 v25, v25, v29
v_permlane32_swap_b32 v27, v31
v_smfmac_f32_16x16x64_bf16 v[36:39], v[76:79], v[216:223], v4
v_add_f32 v26, v26, v30
v_add_f32 v27, v27, v31
v_smfmac_f32_16x16x64_bf16 v[40:43], v[68:71], v[224:231], v4
v_cvt_pk_bf16_f32 v22, v24, v25
v_smfmac_f32_16x16x64_bf16 v[44:47], v[68:71], v[232:239], v4
v_cvt_pk_bf16_f32 v23, v26, v27
v_permlane16_swap_b32 v20, v22
v_smfmac_f32_16x16x64_bf16 v[40:43], v[72:75], v[240:247], v4
v_permlane16_swap_b32 v21, v23
v_smfmac_f32_16x16x64_bf16 v[44:47], v[72:75], v[248:255], v4
s_add_u32 s46, s43, 0
buffer_store_dwordx4 v[20:23], v5, s[4:7], s46 offen sc1
v_permlane32_swap_b32 v32, v36
v_permlane32_swap_b32 v33, v37
v_smfmac_f32_16x16x64_bf16 v[40:43], v[76:79], v[96:103], v4
v_add_f32 v32, v32, v36
v_permlane32_swap_b32 v34, v38
v_smfmac_f32_16x16x64_bf16 v[44:47], v[76:79], v[104:111], v4
v_add_f32 v33, v33, v37
v_smfmac_f32_16x16x64_bf16 v[48:51], v[68:71], v[112:119], v4
v_permlane32_swap_b32 v35, v39
v_smfmac_f32_16x16x64_bf16 v[52:55], v[68:71], v[120:127], v4
v_add_f32 v34, v34, v38
v_add_f32 v35, v35, v39
v_cvt_pk_bf16_f32 v36, v32, v33
v_smfmac_f32_16x16x64_bf16 v[48:51], v[72:75], v[128:135], v4
v_cvt_pk_bf16_f32 v37, v34, v35
v_permlane32_swap_b32 v40, v44
v_smfmac_f32_16x16x64_bf16 v[52:55], v[72:75], v[136:143], v4
v_permlane32_swap_b32 v41, v45
v_add_f32 v40, v40, v44
v_smfmac_f32_16x16x64_bf16 v[48:51], v[76:79], v[144:151], v4
v_permlane32_swap_b32 v42, v46
v_add_f32 v41, v41, v45
v_smfmac_f32_16x16x64_bf16 v[52:55], v[76:79], v[152:159], v4
v_permlane32_swap_b32 v43, v47
v_add_f32 v42, v42, v46
v_add_f32 v43, v43, v47
v_cvt_pk_bf16_f32 v38, v40, v41
v_cvt_pk_bf16_f32 v39, v42, v43
s_nop 0
v_permlane16_swap_b32 v36, v38
v_permlane16_swap_b32 v37, v39
s_add_u32 s46, s43, 65536
buffer_store_dwordx4 v[36:39], v5, s[4:7], s46 offen sc1
v_permlane32_swap_b32 v48, v52
v_permlane32_swap_b32 v49, v53
v_permlane32_swap_b32 v50, v54
v_permlane32_swap_b32 v51, v55
v_add_f32 v48, v48, v52
v_add_f32 v49, v49, v53
v_add_f32 v50, v50, v54
v_add_f32 v51, v51, v55
v_cvt_pk_bf16_f32 v52, v48, v49
v_cvt_pk_bf16_f32 v53, v50, v51
v_cvt_pk_bf16_f32 v54, v48, v49
v_cvt_pk_bf16_f32 v55, v50, v51
s_nop 0
v_permlane16_swap_b32 v52, v54
v_permlane16_swap_b32 v53, v55
s_add_u32 s46, s43, 131072
buffer_store_dwordx4 v[52:55], v12, s[4:7], s46 offen sc1
s_add_u32 s46, s54, 0
buffer_store_dwordx4 v[8:11], v5, s[4:7], s46 offen sc1
s_add_u32 s46, s54, 65536
buffer_store_dwordx4 v[8:11], v5, s[4:7], s46 offen sc1
s_add_u32 s46, s54, 131072
buffer_store_dwordx4 v[8:11], v12, s[4:7], s46 offen sc1
s_mov_b32 s54, s43
s_cmp_eq_u32 s43, s53
s_cselect_b32 s46, 1966080, 0
s_add_u32 s43, s43, 655360
s_sub_u32 s43, s43, s46
s_add_u32 s24, s24, 1
s_cmp_lt_u32 s24, 64
s_cbranch_scc1 Lvum_loop
s_endpgm
Lvum_R0:
s_cmp_eq_u32 s25, 0
s_cbranch_scc1 Lvum_G0
s_sub_u32 s25, s25, 1
buffer_load_dwordx4 v[16:19], v2, s[4:7], s40 offen sc1
buffer_load_dwordx4 v[20:23], v2, s[4:7], s41 offen sc1
buffer_load_dwordx4 v[24:27], v2, s[4:7], s42 offen sc1
s_waitcnt vmcnt(2)
v_cmp_eq_u32 vcc, -1, v16
s_cbranch_vccnz Lvum_R0
s_branch Lvum_G0
Lvum_R1:
s_cmp_eq_u32 s25, 0
s_cbranch_scc1 Lvum_G1
s_sub_u32 s25, s25, 1
buffer_load_dwordx4 v[20:23], v2, s[4:7], s41 offen sc1
buffer_load_dwordx4 v[24:27], v2, s[4:7], s42 offen sc1
s_waitcnt vmcnt(1)
v_cmp_eq_u32 vcc, -1, v20
s_cbranch_vccnz Lvum_R1
s_branch Lvum_G1
Lvum_R2:
s_cmp_eq_u32 s25, 0
s_cbranch_scc1 Lvum_G2
s_sub_u32 s25, s25, 1
buffer_load_dwordx4 v[24:27], v2, s[4:7], s42 offen sc1
s_waitcnt vmcnt(0)
v_cmp_eq_u32 vcc, -1, v24
s_cbranch_vccnz Lvum_R2
s_branch Lvum_G2
Lpu:
s_load_dwordx2 s[8:9], s[0:1], 0
s_mov_b32 s10, 2621440
s_mov_b32 s11, 0x20000
s_load_dwordx2 s[12:13], s[0:1], 88
s_mov_b32 s14, 2621440
s_mov_b32 s15, 0x20000
s_load_dwordx2 s[16:17], s[0:1], 8
s_mov_b32 s18, 10240
s_mov_b32 s19, 0x20000
s_mul_i32 s33, s26, 10
s_add_u32 s33, s33, s27
s_sub_u32 s33, s33, 16
s_cmp_ge_u32 s33, 32
s_cselect_b32 s55, 8192, 0
s_lshl_b32 s46, s33, 8
s_add_u32 s55, s55, s46
v_lshlrev_b32 v2, 4, v0
s_lshl_b32 s46, s28, 15
v_add_u32 v3, s46, v2
v_and_b32 v9, 15, v0
v_lshrrev_b32 v10, 4, v0
v_mov_b32 v4, 0x44444444
v_mov_b32 v1, 0xeeeeeeee
v_cmp_lt_u32 vcc, 7, v9
s_nop 1
v_cndmask_b32 v4, v4, v1, vcc
v_and_b32 v11, 1, v10
v_lshlrev_b32 v8, 2, v11
v_lshrrev_b32 v1, 1, v10
v_add_u32 v11, v8, v1
v_lshl_add_u32 v8, v1, 4, v8
v_mov_b32 v12, -1
v_mov_b32 v13, -1
v_mov_b32 v14, -1
v_mov_b32 v15, -1
v_lshrrev_b32 v18, 3, v0
s_lshl_b32 s46, s28, 3
v_add_u32 v18, s46, v18
v_and_b32 v19, 7, v0
v_mul_u32_u24 v16, 1280, v18
v_lshl_add_u32 v16, v19, 4, v16
v_lshlrev_b32 v17, 4, v18
v_and_b32 v20, 1, v19
v_lshl_add_u32 v17, v20, 9, v17
v_lshrrev_b32 v20, 1, v19
v_lshl_add_u32 v17, v20, 10, v17
v_mul_u32_u24 v5, 640, v10
v_lshl_add_u32 v5, v9, 4, v5
v_mul_u32_u24 v6, 1280, v10
v_lshl_add_u32 v6, v9, 3, v6
v_add_u32 v6, 512, v6
v_lshrrev_b32 v20, 3, v9
v_lshl_add_u32 v11, v20, 1, v11
v_and_b32 v8, 7, v9
v_lshrrev_b32 v20, 1, v10
v_lshlrev_b32 v20, 10, v20
v_and_b32 v21, 1, v10
v_lshl_add_u32 v20, v21, 8, v20
v_lshl_add_u32 v3, v9, 4, v20
s_mov_b32 s34, s33
s_waitcnt lgkmcnt(0)
s_and_b32 s9, s9, 0xffff
s_and_b32 s13, s13, 0xffff
s_and_b32 s17, s17, 0xffff
s_lshl_b32 s46, s33, 7
s_add_u32 s46, s46, 1048576
v_lshl_add_u32 v200, v0, 14, s46
s_cmp_eq_u32 s28, 0
s_cselect_b32 s46, 32, 0
v_mov_b32 v1, 2146435072
v_cmp_gt_u32 vcc, s46, v0
s_nop 1
v_cndmask_b32 v200, v1, v200, vcc
v_mov_b32 v1, 0
s_add_u32 s46, s89, 8192
buffer_store_dword v1, v200, s[4:7], s89 offen sc1
buffer_store_dword v1, v200, s[4:7], s46 offen sc1
s_and_b32 s46, s27, 15
s_mul_i32 s47, s46, 26
s_lshr_b32 s47, s47, 8
s_mul_i32 s47, s47, 10
s_sub_u32 s46, s46, s47
s_lshl_b32 s46, s46, 2
s_add_u32 s46, s46, s26
s_lshl_b32 s46, s46, 14
s_add_u32 s46, s46, 393216
v_min_u32 v201, 31, v0
v_lshl_add_u32 v201, v201, 7, s46
v_add_u32 v202, 4096, v201
v_mov_b32 v203, 2146435072
s_cmp_lg_u32 s28, 0
s_cbranch_scc1 Lm0_24
v_and_b32 v20, 7, v0
v_mul_u32_u24 v20, 1280, v20
v_bfe_u32 v21, v0, 3, 1
v_lshl_add_u32 v20, v21, 4, v20
s_lshl_b32 s46, s33, 5
v_add_u32 v20, s46, v20
v_lshl_add_u32 v21, v9, 4, s55
v_mov_b32 v1, 2146435072
v_lshlrev_b32 v22, 17, v10
v_cmp_gt_u32 vcc, 16, v0
s_nop 1
v_cndmask_b32 v21, v1, v21, vcc
buffer_load_dwordx4 v[24:27], v20, s[16:19], 0 offen
s_lshl_b32 s46, s33, 7
s_add_u32 s46, s46, 98304
v_mov_b32 v203, s46
v_cmp_eq_u32 vcc, 0, v0
s_nop 1
v_cndmask_b32 v203, v1, v203, vcc
v_mov_b32 v204, 0
buffer_store_dword v204, v203, s[4:7], 0 offen sc1
s_add_u32 s46, s89, 32768
s_add_u32 s47, s89, 65536
buffer_store_dwordx4 v[12:15], v21, s[4:7], s46 offen sc1
buffer_store_dwordx4 v[12:15], v21, s[4:7], s47 offen sc1
s_add_u32 s46, s89, 40960
s_add_u32 s47, s89, 73728
s_add_u32 s48, s89, 8192
buffer_store_dwordx4 v[12:15], v21, s[4:7], s46 offen sc1
buffer_store_dwordx4 v[12:15], v21, s[4:7], s47 offen sc1
s_waitcnt vmcnt(5)
buffer_store_dwordx4 v[24:27], v21, s[4:7], s89 offen sc1
buffer_store_dwordx4 v[24:27], v21, s[4:7], s48 offen sc1
Lm0_24:
s_mul_i32 s46, s34, 40960
buffer_load_dwordx4 v[20:23], v16, s[8:11], s46 offen offset:0
buffer_load_dwordx4 v[24:27], v16, s[8:11], s46 offen offset:128
buffer_load_dwordx4 v[28:31], v16, s[8:11], s46 offen offset:256
buffer_load_dwordx4 v[32:35], v16, s[8:11], s46 offen offset:384
buffer_load_dwordx4 v[36:39], v16, s[8:11], s46 offen offset:512
buffer_load_dwordx4 v[40:43], v16, s[8:11], s46 offen offset:640
buffer_load_dwordx4 v[44:47], v16, s[8:11], s46 offen offset:768
buffer_load_dwordx4 v[48:51], v16, s[8:11], s46 offen offset:896
buffer_load_dwordx4 v[52:55], v16, s[8:11], s46 offen offset:1024
buffer_load_dwordx4 v[56:59], v16, s[8:11], s46 offen offset:1152
s_waitcnt vmcnt(9)
v_lshlrev_b32 v64, 16, v20
v_and_b32 v65, 0xffff0000, v20
v_lshlrev_b32 v66, 16, v21
v_and_b32 v67, 0xffff0000, v21
v_lshlrev_b32 v68, 16, v22
v_and_b32 v69, 0xffff0000, v22
v_lshlrev_b32 v70, 16, v23
v_and_b32 v71, 0xffff0000, v23
s_waitcnt vmcnt(8)
v_lshlrev_b32 v72, 16, v24
v_and_b32 v73, 0xffff0000, v24
v_lshlrev_b32 v74, 16, v25
v_and_b32 v75, 0xffff0000, v25
v_lshlrev_b32 v76, 16, v26
v_and_b32 v77, 0xffff0000, v26
v_lshlrev_b32 v78, 16, v27
v_and_b32 v79, 0xffff0000, v27
s_waitcnt vmcnt(7)
v_lshlrev_b32 v80, 16, v28
v_and_b32 v81, 0xffff0000, v28
v_lshlrev_b32 v82, 16, v29
v_and_b32 v83, 0xffff0000, v29
v_lshlrev_b32 v84, 16, v30
v_and_b32 v85, 0xffff0000, v30
v_lshlrev_b32 v86, 16, v31
v_and_b32 v87, 0xffff0000, v31
s_waitcnt vmcnt(6)
v_lshlrev_b32 v88, 16, v32
v_and_b32 v89, 0xffff0000, v32
v_lshlrev_b32 v90, 16, v33
v_and_b32 v91, 0xffff0000, v33
v_lshlrev_b32 v92, 16, v34
v_and_b32 v93, 0xffff0000, v34
v_lshlrev_b32 v94, 16, v35
v_and_b32 v95, 0xffff0000, v35
s_waitcnt vmcnt(5)
v_lshlrev_b32 v96, 16, v36
v_and_b32 v97, 0xffff0000, v36
v_lshlrev_b32 v98, 16, v37
v_and_b32 v99, 0xffff0000, v37
v_lshlrev_b32 v100, 16, v38
v_and_b32 v101, 0xffff0000, v38
v_lshlrev_b32 v102, 16, v39
v_and_b32 v103, 0xffff0000, v39
s_waitcnt vmcnt(4)
v_lshlrev_b32 v104, 16, v40
v_and_b32 v105, 0xffff0000, v40
v_lshlrev_b32 v106, 16, v41
v_and_b32 v107, 0xffff0000, v41
v_lshlrev_b32 v108, 16, v42
v_and_b32 v109, 0xffff0000, v42
v_lshlrev_b32 v110, 16, v43
v_and_b32 v111, 0xffff0000, v43
s_waitcnt vmcnt(3)
v_lshlrev_b32 v112, 16, v44
v_and_b32 v113, 0xffff0000, v44
v_lshlrev_b32 v114, 16, v45
v_and_b32 v115, 0xffff0000, v45
v_lshlrev_b32 v116, 16, v46
v_and_b32 v117, 0xffff0000, v46
v_lshlrev_b32 v118, 16, v47
v_and_b32 v119, 0xffff0000, v47
s_waitcnt vmcnt(2)
v_lshlrev_b32 v120, 16, v48
v_and_b32 v121, 0xffff0000, v48
v_lshlrev_b32 v122, 16, v49
v_and_b32 v123, 0xffff0000, v49
v_lshlrev_b32 v124, 16, v50
v_and_b32 v125, 0xffff0000, v50
v_lshlrev_b32 v126, 16, v51
v_and_b32 v127, 0xffff0000, v51
s_waitcnt vmcnt(1)
v_lshlrev_b32 v128, 16, v52
v_and_b32 v129, 0xffff0000, v52
v_lshlrev_b32 v130, 16, v53
v_and_b32 v131, 0xffff0000, v53
v_lshlrev_b32 v132, 16, v54
v_and_b32 v133, 0xffff0000, v54
v_lshlrev_b32 v134, 16, v55
v_and_b32 v135, 0xffff0000, v55
s_waitcnt vmcnt(0)
v_lshlrev_b32 v136, 16, v56
v_and_b32 v137, 0xffff0000, v56
v_lshlrev_b32 v138, 16, v57
v_and_b32 v139, 0xffff0000, v57
v_lshlrev_b32 v140, 16, v58
v_and_b32 v141, 0xffff0000, v58
v_lshlrev_b32 v142, 16, v59
v_and_b32 v143, 0xffff0000, v59
v_pk_add_f32 v[18:19], v[64:65], v[66:67]
v_pk_add_f32 v[18:19], v[18:19], v[68:69]
v_pk_add_f32 v[18:19], v[18:19], v[70:71]
v_pk_add_f32 v[18:19], v[18:19], v[72:73]
v_pk_add_f32 v[18:19], v[18:19], v[74:75]
v_pk_add_f32 v[18:19], v[18:19], v[76:77]
v_pk_add_f32 v[18:19], v[18:19], v[78:79]
v_pk_add_f32 v[18:19], v[18:19], v[80:81]
v_pk_add_f32 v[18:19], v[18:19], v[82:83]
v_pk_add_f32 v[18:19], v[18:19], v[84:85]
v_pk_add_f32 v[18:19], v[18:19], v[86:87]
v_pk_add_f32 v[18:19], v[18:19], v[88:89]
v_pk_add_f32 v[18:19], v[18:19], v[90:91]
v_pk_add_f32 v[18:19], v[18:19], v[92:93]
v_pk_add_f32 v[18:19], v[18:19], v[94:95]
v_pk_add_f32 v[18:19], v[18:19], v[96:97]
v_pk_add_f32 v[18:19], v[18:19], v[98:99]
v_pk_add_f32 v[18:19], v[18:19], v[100:101]
v_pk_add_f32 v[18:19], v[18:19], v[102:103]
v_pk_add_f32 v[18:19], v[18:19], v[104:105]
v_pk_add_f32 v[18:19], v[18:19], v[106:107]
v_pk_add_f32 v[18:19], v[18:19], v[108:109]
v_pk_add_f32 v[18:19], v[18:19], v[110:111]
v_pk_add_f32 v[18:19], v[18:19], v[112:113]
v_pk_add_f32 v[18:19], v[18:19], v[114:115]
v_pk_add_f32 v[18:19], v[18:19], v[116:117]
v_pk_add_f32 v[18:19], v[18:19], v[118:119]
v_pk_add_f32 v[18:19], v[18:19], v[120:121]
v_pk_add_f32 v[18:19], v[18:19], v[122:123]
v_pk_add_f32 v[18:19], v[18:19], v[124:125]
v_pk_add_f32 v[18:19], v[18:19], v[126:127]
v_pk_add_f32 v[18:19], v[18:19], v[128:129]
v_pk_add_f32 v[18:19], v[18:19], v[130:131]
v_pk_add_f32 v[18:19], v[18:19], v[132:133]
v_pk_add_f32 v[18:19], v[18:19], v[134:135]
v_pk_add_f32 v[18:19], v[18:19], v[136:137]
v_pk_add_f32 v[18:19], v[18:19], v[138:139]
v_pk_add_f32 v[18:19], v[18:19], v[140:141]
v_pk_add_f32 v[18:19], v[18:19], v[142:143]
v_add_f32 v18, v18, v19
s_nop 1
v_add_f32_dpp v18, v18, v18 quad_perm:[1,0,3,2] row_mask:0xf bank_mask:0xf
s_nop 1
v_add_f32_dpp v18, v18, v18 quad_perm:[2,3,0,1] row_mask:0xf bank_mask:0xf
s_nop 1
v_add_f32_dpp v18, v18, v18 row_half_mirror row_mask:0xf bank_mask:0xf
v_mul_f32 v18, 0x3acccccd, v18
v_mov_b32 v60, 0
v_mov_b32 v61, 0
v_sub_f32 v62, v64, v18
v_fmac_f32 v60, v62, v62
v_sub_f32 v63, v65, v18
v_fmac_f32 v61, v63, v63
v_sub_f32 v62, v66, v18
v_fmac_f32 v60, v62, v62
v_sub_f32 v63, v67, v18
v_fmac_f32 v61, v63, v63
v_sub_f32 v62, v68, v18
v_fmac_f32 v60, v62, v62
v_sub_f32 v63, v69, v18
v_fmac_f32 v61, v63, v63
v_sub_f32 v62, v70, v18
v_fmac_f32 v60, v62, v62
v_sub_f32 v63, v71, v18
v_fmac_f32 v61, v63, v63
v_sub_f32 v62, v72, v18
v_fmac_f32 v60, v62, v62
v_sub_f32 v63, v73, v18
v_fmac_f32 v61, v63, v63
v_sub_f32 v62, v74, v18
v_fmac_f32 v60, v62, v62
v_sub_f32 v63, v75, v18
v_fmac_f32 v61, v63, v63
v_sub_f32 v62, v76, v18
v_fmac_f32 v60, v62, v62
v_sub_f32 v63, v77, v18
v_fmac_f32 v61, v63, v63
v_sub_f32 v62, v78, v18
v_fmac_f32 v60, v62, v62
v_sub_f32 v63, v79, v18
v_fmac_f32 v61, v63, v63
v_sub_f32 v62, v80, v18
v_fmac_f32 v60, v62, v62
v_sub_f32 v63, v81, v18
v_fmac_f32 v61, v63, v63
v_sub_f32 v62, v82, v18
v_fmac_f32 v60, v62, v62
v_sub_f32 v63, v83, v18
v_fmac_f32 v61, v63, v63
v_sub_f32 v62, v84, v18
v_fmac_f32 v60, v62, v62
v_sub_f32 v63, v85, v18
v_fmac_f32 v61, v63, v63
v_sub_f32 v62, v86, v18
v_fmac_f32 v60, v62, v62
v_sub_f32 v63, v87, v18
v_fmac_f32 v61, v63, v63
v_sub_f32 v62, v88, v18
v_fmac_f32 v60, v62, v62
v_sub_f32 v63, v89, v18
v_fmac_f32 v61, v63, v63
v_sub_f32 v62, v90, v18
v_fmac_f32 v60, v62, v62
v_sub_f32 v63, v91, v18
v_fmac_f32 v61, v63, v63
v_sub_f32 v62, v92, v18
v_fmac_f32 v60, v62, v62
v_sub_f32 v63, v93, v18
v_fmac_f32 v61, v63, v63
v_sub_f32 v62, v94, v18
v_fmac_f32 v60, v62, v62
v_sub_f32 v63, v95, v18
v_fmac_f32 v61, v63, v63
v_sub_f32 v62, v96, v18
v_fmac_f32 v60, v62, v62
v_sub_f32 v63, v97, v18
v_fmac_f32 v61, v63, v63
v_sub_f32 v62, v98, v18
v_fmac_f32 v60, v62, v62
v_sub_f32 v63, v99, v18
v_fmac_f32 v61, v63, v63
v_sub_f32 v62, v100, v18
v_fmac_f32 v60, v62, v62
v_sub_f32 v63, v101, v18
v_fmac_f32 v61, v63, v63
v_sub_f32 v62, v102, v18
v_fmac_f32 v60, v62, v62
v_sub_f32 v63, v103, v18
v_fmac_f32 v61, v63, v63
v_sub_f32 v62, v104, v18
v_fmac_f32 v60, v62, v62
v_sub_f32 v63, v105, v18
v_fmac_f32 v61, v63, v63
v_sub_f32 v62, v106, v18
v_fmac_f32 v60, v62, v62
v_sub_f32 v63, v107, v18
v_fmac_f32 v61, v63, v63
v_sub_f32 v62, v108, v18
v_fmac_f32 v60, v62, v62
v_sub_f32 v63, v109, v18
v_fmac_f32 v61, v63, v63
v_sub_f32 v62, v110, v18
v_fmac_f32 v60, v62, v62
v_sub_f32 v63, v111, v18
v_fmac_f32 v61, v63, v63
v_sub_f32 v62, v112, v18
v_fmac_f32 v60, v62, v62
v_sub_f32 v63, v113, v18
v_fmac_f32 v61, v63, v63
v_sub_f32 v62, v114, v18
v_fmac_f32 v60, v62, v62
v_sub_f32 v63, v115, v18
v_fmac_f32 v61, v63, v63
v_sub_f32 v62, v116, v18
v_fmac_f32 v60, v62, v62
v_sub_f32 v63, v117, v18
v_fmac_f32 v61, v63, v63
v_sub_f32 v62, v118, v18
v_fmac_f32 v60, v62, v62
v_sub_f32 v63, v119, v18
v_fmac_f32 v61, v63, v63
v_sub_f32 v62, v120, v18
v_fmac_f32 v60, v62, v62
v_sub_f32 v63, v121, v18
v_fmac_f32 v61, v63, v63
v_sub_f32 v62, v122, v18
v_fmac_f32 v60, v62, v62
v_sub_f32 v63, v123, v18
v_fmac_f32 v61, v63, v63
v_sub_f32 v62, v124, v18
v_fmac_f32 v60, v62, v62
v_sub_f32 v63, v125, v18
v_fmac_f32 v61, v63, v63
v_sub_f32 v62, v126, v18
v_fmac_f32 v60, v62, v62
v_sub_f32 v63, v127, v18
v_fmac_f32 v61, v63, v63
v_sub_f32 v62, v128, v18
v_fmac_f32 v60, v62, v62
v_sub_f32 v63, v129, v18
v_fmac_f32 v61, v63, v63
v_sub_f32 v62, v130, v18
v_fmac_f32 v60, v62, v62
v_sub_f32 v63, v131, v18
v_fmac_f32 v61, v63, v63
v_sub_f32 v62, v132, v18
v_fmac_f32 v60, v62, v62
v_sub_f32 v63, v133, v18
v_fmac_f32 v61, v63, v63
v_sub_f32 v62, v134, v18
v_fmac_f32 v60, v62, v62
v_sub_f32 v63, v135, v18
v_fmac_f32 v61, v63, v63
v_sub_f32 v62, v136, v18
v_fmac_f32 v60, v62, v62
v_sub_f32 v63, v137, v18
v_fmac_f32 v61, v63, v63
v_sub_f32 v62, v138, v18
v_fmac_f32 v60, v62, v62
v_sub_f32 v63, v139, v18
v_fmac_f32 v61, v63, v63
v_sub_f32 v62, v140, v18
v_fmac_f32 v60, v62, v62
v_sub_f32 v63, v141, v18
v_fmac_f32 v61, v63, v63
v_sub_f32 v62, v142, v18
v_fmac_f32 v60, v62, v62
v_sub_f32 v63, v143, v18
v_fmac_f32 v61, v63, v63
v_add_f32 v60, v60, v61
s_nop 1
v_add_f32_dpp v60, v60, v60 quad_perm:[1,0,3,2] row_mask:0xf bank_mask:0xf
s_nop 1
v_add_f32_dpp v60, v60, v60 quad_perm:[2,3,0,1] row_mask:0xf bank_mask:0xf
s_nop 1
v_add_f32_dpp v60, v60, v60 row_half_mirror row_mask:0xf bank_mask:0xf
v_mul_f32 v60, 0x3acccccd, v60
v_cvt_pk_bf16_f32 v18, v18, v18
v_and_b32 v18, 0xffff0000, v18
v_cvt_pk_bf16_f32 v60, v60, v60
v_and_b32 v60, 0xffff0000, v60
v_add_f32 v60, 0x3727c5ac, v60
v_cvt_pk_bf16_f32 v60, v60, v60
v_and_b32 v60, 0xffff0000, v60
v_sqrt_f32 v60, v60
s_nop 0
v_cvt_pk_bf16_f32 v60, v60, v60
v_and_b32 v60, 0xffff0000, v60
v_rcp_f32 v60, v60
s_add_u32 s46, s46, 7340032
v_sub_f32 v64, v64, v18
v_sub_f32 v65, v65, v18
v_cvt_pk_bf16_f32 v64, v64, v65
v_and_b32 v65, 0xffff0000, v64
v_lshlrev_b32 v64, 16, v64
v_mul_f32 v64, v64, v60
v_mul_f32 v65, v65, v60
v_cvt_pk_bf16_f32 v20, v64, v65
v_sub_f32 v66, v66, v18
v_sub_f32 v67, v67, v18
v_cvt_pk_bf16_f32 v66, v66, v67
v_and_b32 v67, 0xffff0000, v66
v_lshlrev_b32 v66, 16, v66
v_mul_f32 v66, v66, v60
v_mul_f32 v67, v67, v60
v_cvt_pk_bf16_f32 v21, v66, v67
v_sub_f32 v68, v68, v18
v_sub_f32 v69, v69, v18
v_cvt_pk_bf16_f32 v68, v68, v69
v_and_b32 v69, 0xffff0000, v68
v_lshlrev_b32 v68, 16, v68
v_mul_f32 v68, v68, v60
v_mul_f32 v69, v69, v60
v_cvt_pk_bf16_f32 v22, v68, v69
v_sub_f32 v70, v70, v18
v_sub_f32 v71, v71, v18
v_cvt_pk_bf16_f32 v70, v70, v71
v_and_b32 v71, 0xffff0000, v70
v_lshlrev_b32 v70, 16, v70
v_mul_f32 v70, v70, v60
v_mul_f32 v71, v71, v60
v_cvt_pk_bf16_f32 v23, v70, v71
buffer_store_dwordx4 v[20:23], v17, s[4:7], s46 offen sc1
s_add_u32 s46, s46, 4096
v_sub_f32 v72, v72, v18
v_sub_f32 v73, v73, v18
v_cvt_pk_bf16_f32 v72, v72, v73
v_and_b32 v73, 0xffff0000, v72
v_lshlrev_b32 v72, 16, v72
v_mul_f32 v72, v72, v60
v_mul_f32 v73, v73, v60
v_cvt_pk_bf16_f32 v24, v72, v73
v_sub_f32 v74, v74, v18
v_sub_f32 v75, v75, v18
v_cvt_pk_bf16_f32 v74, v74, v75
v_and_b32 v75, 0xffff0000, v74
v_lshlrev_b32 v74, 16, v74
v_mul_f32 v74, v74, v60
v_mul_f32 v75, v75, v60
v_cvt_pk_bf16_f32 v25, v74, v75
v_sub_f32 v76, v76, v18
v_sub_f32 v77, v77, v18
v_cvt_pk_bf16_f32 v76, v76, v77
v_and_b32 v77, 0xffff0000, v76
v_lshlrev_b32 v76, 16, v76
v_mul_f32 v76, v76, v60
v_mul_f32 v77, v77, v60
v_cvt_pk_bf16_f32 v26, v76, v77
v_sub_f32 v78, v78, v18
v_sub_f32 v79, v79, v18
v_cvt_pk_bf16_f32 v78, v78, v79
v_and_b32 v79, 0xffff0000, v78
v_lshlrev_b32 v78, 16, v78
v_mul_f32 v78, v78, v60
v_mul_f32 v79, v79, v60
v_cvt_pk_bf16_f32 v27, v78, v79
buffer_store_dwordx4 v[24:27], v17, s[4:7], s46 offen sc1
s_add_u32 s46, s46, 4096
v_sub_f32 v80, v80, v18
v_sub_f32 v81, v81, v18
v_cvt_pk_bf16_f32 v80, v80, v81
v_and_b32 v81, 0xffff0000, v80
v_lshlrev_b32 v80, 16, v80
v_mul_f32 v80, v80, v60
v_mul_f32 v81, v81, v60
v_cvt_pk_bf16_f32 v28, v80, v81
v_sub_f32 v82, v82, v18
v_sub_f32 v83, v83, v18
v_cvt_pk_bf16_f32 v82, v82, v83
v_and_b32 v83, 0xffff0000, v82
v_lshlrev_b32 v82, 16, v82
v_mul_f32 v82, v82, v60
v_mul_f32 v83, v83, v60
v_cvt_pk_bf16_f32 v29, v82, v83
v_sub_f32 v84, v84, v18
v_sub_f32 v85, v85, v18
v_cvt_pk_bf16_f32 v84, v84, v85
v_and_b32 v85, 0xffff0000, v84
v_lshlrev_b32 v84, 16, v84
v_mul_f32 v84, v84, v60
v_mul_f32 v85, v85, v60
v_cvt_pk_bf16_f32 v30, v84, v85
v_sub_f32 v86, v86, v18
v_sub_f32 v87, v87, v18
v_cvt_pk_bf16_f32 v86, v86, v87
v_and_b32 v87, 0xffff0000, v86
v_lshlrev_b32 v86, 16, v86
v_mul_f32 v86, v86, v60
v_mul_f32 v87, v87, v60
v_cvt_pk_bf16_f32 v31, v86, v87
buffer_store_dwordx4 v[28:31], v17, s[4:7], s46 offen sc1
s_add_u32 s46, s46, 4096
v_sub_f32 v88, v88, v18
v_sub_f32 v89, v89, v18
v_cvt_pk_bf16_f32 v88, v88, v89
v_and_b32 v89, 0xffff0000, v88
v_lshlrev_b32 v88, 16, v88
v_mul_f32 v88, v88, v60
v_mul_f32 v89, v89, v60
v_cvt_pk_bf16_f32 v32, v88, v89
v_sub_f32 v90, v90, v18
v_sub_f32 v91, v91, v18
v_cvt_pk_bf16_f32 v90, v90, v91
v_and_b32 v91, 0xffff0000, v90
v_lshlrev_b32 v90, 16, v90
v_mul_f32 v90, v90, v60
v_mul_f32 v91, v91, v60
v_cvt_pk_bf16_f32 v33, v90, v91
v_sub_f32 v92, v92, v18
v_sub_f32 v93, v93, v18
v_cvt_pk_bf16_f32 v92, v92, v93
v_and_b32 v93, 0xffff0000, v92
v_lshlrev_b32 v92, 16, v92
v_mul_f32 v92, v92, v60
v_mul_f32 v93, v93, v60
v_cvt_pk_bf16_f32 v34, v92, v93
v_sub_f32 v94, v94, v18
v_sub_f32 v95, v95, v18
v_cvt_pk_bf16_f32 v94, v94, v95
v_and_b32 v95, 0xffff0000, v94
v_lshlrev_b32 v94, 16, v94
v_mul_f32 v94, v94, v60
v_mul_f32 v95, v95, v60
v_cvt_pk_bf16_f32 v35, v94, v95
buffer_store_dwordx4 v[32:35], v17, s[4:7], s46 offen sc1
s_add_u32 s46, s46, 4096
v_sub_f32 v96, v96, v18
v_sub_f32 v97, v97, v18
v_cvt_pk_bf16_f32 v96, v96, v97
v_and_b32 v97, 0xffff0000, v96
v_lshlrev_b32 v96, 16, v96
v_mul_f32 v96, v96, v60
v_mul_f32 v97, v97, v60
v_cvt_pk_bf16_f32 v36, v96, v97
v_sub_f32 v98, v98, v18
v_sub_f32 v99, v99, v18
v_cvt_pk_bf16_f32 v98, v98, v99
v_and_b32 v99, 0xffff0000, v98
v_lshlrev_b32 v98, 16, v98
v_mul_f32 v98, v98, v60
v_mul_f32 v99, v99, v60
v_cvt_pk_bf16_f32 v37, v98, v99
v_sub_f32 v100, v100, v18
v_sub_f32 v101, v101, v18
v_cvt_pk_bf16_f32 v100, v100, v101
v_and_b32 v101, 0xffff0000, v100
v_lshlrev_b32 v100, 16, v100
v_mul_f32 v100, v100, v60
v_mul_f32 v101, v101, v60
v_cvt_pk_bf16_f32 v38, v100, v101
v_sub_f32 v102, v102, v18
v_sub_f32 v103, v103, v18
v_cvt_pk_bf16_f32 v102, v102, v103
v_and_b32 v103, 0xffff0000, v102
v_lshlrev_b32 v102, 16, v102
v_mul_f32 v102, v102, v60
v_mul_f32 v103, v103, v60
v_cvt_pk_bf16_f32 v39, v102, v103
buffer_store_dwordx4 v[36:39], v17, s[4:7], s46 offen sc1
s_add_u32 s46, s46, 4096
v_sub_f32 v104, v104, v18
v_sub_f32 v105, v105, v18
v_cvt_pk_bf16_f32 v104, v104, v105
v_and_b32 v105, 0xffff0000, v104
v_lshlrev_b32 v104, 16, v104
v_mul_f32 v104, v104, v60
v_mul_f32 v105, v105, v60
v_cvt_pk_bf16_f32 v40, v104, v105
v_sub_f32 v106, v106, v18
v_sub_f32 v107, v107, v18
v_cvt_pk_bf16_f32 v106, v106, v107
v_and_b32 v107, 0xffff0000, v106
v_lshlrev_b32 v106, 16, v106
v_mul_f32 v106, v106, v60
v_mul_f32 v107, v107, v60
v_cvt_pk_bf16_f32 v41, v106, v107
v_sub_f32 v108, v108, v18
v_sub_f32 v109, v109, v18
v_cvt_pk_bf16_f32 v108, v108, v109
v_and_b32 v109, 0xffff0000, v108
v_lshlrev_b32 v108, 16, v108
v_mul_f32 v108, v108, v60
v_mul_f32 v109, v109, v60
v_cvt_pk_bf16_f32 v42, v108, v109
v_sub_f32 v110, v110, v18
v_sub_f32 v111, v111, v18
v_cvt_pk_bf16_f32 v110, v110, v111
v_and_b32 v111, 0xffff0000, v110
v_lshlrev_b32 v110, 16, v110
v_mul_f32 v110, v110, v60
v_mul_f32 v111, v111, v60
v_cvt_pk_bf16_f32 v43, v110, v111
buffer_store_dwordx4 v[40:43], v17, s[4:7], s46 offen sc1
s_add_u32 s46, s46, 4096
v_sub_f32 v112, v112, v18
v_sub_f32 v113, v113, v18
v_cvt_pk_bf16_f32 v112, v112, v113
v_and_b32 v113, 0xffff0000, v112
v_lshlrev_b32 v112, 16, v112
v_mul_f32 v112, v112, v60
v_mul_f32 v113, v113, v60
v_cvt_pk_bf16_f32 v44, v112, v113
v_sub_f32 v114, v114, v18
v_sub_f32 v115, v115, v18
v_cvt_pk_bf16_f32 v114, v114, v115
v_and_b32 v115, 0xffff0000, v114
v_lshlrev_b32 v114, 16, v114
v_mul_f32 v114, v114, v60
v_mul_f32 v115, v115, v60
v_cvt_pk_bf16_f32 v45, v114, v115
v_sub_f32 v116, v116, v18
v_sub_f32 v117, v117, v18
v_cvt_pk_bf16_f32 v116, v116, v117
v_and_b32 v117, 0xffff0000, v116
v_lshlrev_b32 v116, 16, v116
v_mul_f32 v116, v116, v60
v_mul_f32 v117, v117, v60
v_cvt_pk_bf16_f32 v46, v116, v117
v_sub_f32 v118, v118, v18
v_sub_f32 v119, v119, v18
v_cvt_pk_bf16_f32 v118, v118, v119
v_and_b32 v119, 0xffff0000, v118
v_lshlrev_b32 v118, 16, v118
v_mul_f32 v118, v118, v60
v_mul_f32 v119, v119, v60
v_cvt_pk_bf16_f32 v47, v118, v119
buffer_store_dwordx4 v[44:47], v17, s[4:7], s46 offen sc1
s_add_u32 s46, s46, 4096
v_sub_f32 v120, v120, v18
v_sub_f32 v121, v121, v18
v_cvt_pk_bf16_f32 v120, v120, v121
v_and_b32 v121, 0xffff0000, v120
v_lshlrev_b32 v120, 16, v120
v_mul_f32 v120, v120, v60
v_mul_f32 v121, v121, v60
v_cvt_pk_bf16_f32 v48, v120, v121
v_sub_f32 v122, v122, v18
v_sub_f32 v123, v123, v18
v_cvt_pk_bf16_f32 v122, v122, v123
v_and_b32 v123, 0xffff0000, v122
v_lshlrev_b32 v122, 16, v122
v_mul_f32 v122, v122, v60
v_mul_f32 v123, v123, v60
v_cvt_pk_bf16_f32 v49, v122, v123
v_sub_f32 v124, v124, v18
v_sub_f32 v125, v125, v18
v_cvt_pk_bf16_f32 v124, v124, v125
v_and_b32 v125, 0xffff0000, v124
v_lshlrev_b32 v124, 16, v124
v_mul_f32 v124, v124, v60
v_mul_f32 v125, v125, v60
v_cvt_pk_bf16_f32 v50, v124, v125
v_sub_f32 v126, v126, v18
v_sub_f32 v127, v127, v18
v_cvt_pk_bf16_f32 v126, v126, v127
v_and_b32 v127, 0xffff0000, v126
v_lshlrev_b32 v126, 16, v126
v_mul_f32 v126, v126, v60
v_mul_f32 v127, v127, v60
v_cvt_pk_bf16_f32 v51, v126, v127
buffer_store_dwordx4 v[48:51], v17, s[4:7], s46 offen sc1
s_add_u32 s46, s46, 4096
v_sub_f32 v128, v128, v18
v_sub_f32 v129, v129, v18
v_cvt_pk_bf16_f32 v128, v128, v129
v_and_b32 v129, 0xffff0000, v128
v_lshlrev_b32 v128, 16, v128
v_mul_f32 v128, v128, v60
v_mul_f32 v129, v129, v60
v_cvt_pk_bf16_f32 v52, v128, v129
v_sub_f32 v130, v130, v18
v_sub_f32 v131, v131, v18
v_cvt_pk_bf16_f32 v130, v130, v131
v_and_b32 v131, 0xffff0000, v130
v_lshlrev_b32 v130, 16, v130
v_mul_f32 v130, v130, v60
v_mul_f32 v131, v131, v60
v_cvt_pk_bf16_f32 v53, v130, v131
v_sub_f32 v132, v132, v18
v_sub_f32 v133, v133, v18
v_cvt_pk_bf16_f32 v132, v132, v133
v_and_b32 v133, 0xffff0000, v132
v_lshlrev_b32 v132, 16, v132
v_mul_f32 v132, v132, v60
v_mul_f32 v133, v133, v60
v_cvt_pk_bf16_f32 v54, v132, v133
v_sub_f32 v134, v134, v18
v_sub_f32 v135, v135, v18
v_cvt_pk_bf16_f32 v134, v134, v135
v_and_b32 v135, 0xffff0000, v134
v_lshlrev_b32 v134, 16, v134
v_mul_f32 v134, v134, v60
v_mul_f32 v135, v135, v60
v_cvt_pk_bf16_f32 v55, v134, v135
buffer_store_dwordx4 v[52:55], v17, s[4:7], s46 offen sc1
s_add_u32 s46, s46, 4096
v_sub_f32 v136, v136, v18
v_sub_f32 v137, v137, v18
v_cvt_pk_bf16_f32 v136, v136, v137
v_and_b32 v137, 0xffff0000, v136
v_lshlrev_b32 v136, 16, v136
v_mul_f32 v136, v136, v60
v_mul_f32 v137, v137, v60
v_cvt_pk_bf16_f32 v56, v136, v137
v_sub_f32 v138, v138, v18
v_sub_f32 v139, v139, v18
v_cvt_pk_bf16_f32 v138, v138, v139
v_and_b32 v139, 0xffff0000, v138
v_lshlrev_b32 v138, 16, v138
v_mul_f32 v138, v138, v60
v_mul_f32 v139, v139, v60
v_cvt_pk_bf16_f32 v57, v138, v139
v_sub_f32 v140, v140, v18
v_sub_f32 v141, v141, v18
v_cvt_pk_bf16_f32 v140, v140, v141
v_and_b32 v141, 0xffff0000, v140
v_lshlrev_b32 v140, 16, v140
v_mul_f32 v140, v140, v60
v_mul_f32 v141, v141, v60
v_cvt_pk_bf16_f32 v58, v140, v141
v_sub_f32 v142, v142, v18
v_sub_f32 v143, v143, v18
v_cvt_pk_bf16_f32 v142, v142, v143
v_and_b32 v143, 0xffff0000, v142
v_lshlrev_b32 v142, 16, v142
v_mul_f32 v142, v142, v60
v_mul_f32 v143, v143, v60
v_cvt_pk_bf16_f32 v59, v142, v143
buffer_store_dwordx4 v[56:59], v17, s[4:7], s46 offen sc1
s_add_u32 s46, s46, 4096
s_waitcnt vmcnt(0)
s_barrier
s_cmp_lg_u32 s28, 0
s_cbranch_scc1 Larr_25
v_mov_b32 v1, 1
s_mov_b64 exec, 1
buffer_atomic_add v1, off, s[20:23], 0 sc1
s_mov_b64 exec, -1
Larr_25:
s_lshl_b32 s34, s33, 2
s_add_u32 s34, s34, s28
s_cmp_lg_u32 s28, 0
s_cbranch_scc1 Lgwd_27
Lgw_26:
buffer_load_dwordx2 v[18:19], off, s[20:23], 0 sc1
s_waitcnt vmcnt(0)
v_cmp_gt_u32 vcc, 255, v18
v_mov_b32 v18, v19
v_and_b32 v19, 0xffff, v19
v_cmp_gt_u32_e64 s[46:47], 2, v19
s_or_b64 vcc, vcc, s[46:47]
s_cbranch_vccz Lgwe_28
s_cmp_eq_u32 s25, 0
s_cbranch_scc1 Lgwe_28
s_sub_u32 s25, s25, 1
s_sleep 4
s_branch Lgw_26
Lgwe_28:
v_mov_b32 v19, 163836
ds_write_b32 v19, v18
s_waitcnt lgkmcnt(0)
Lgwd_27:
s_barrier
v_mov_b32 v19, 163836
ds_read_b32 v18, v19
s_waitcnt lgkmcnt(0)
v_readfirstlane_b32 s46, v18
s_bfe_u32 s47, s46, 0x10010
s_lshl_b32 s47, s47, 13
s_add_u32 s88, s88, s47
s_bfe_u32 s47, s46, 0x10011
s_lshl_b32 s47, s47, 13
s_add_u32 s89, s89, s47
s_cmp_lg_u32 s28, 0
s_cbranch_scc1 Lpux
v_lshrrev_b32 v16, 2, v8
v_lshlrev_b32 v16, 7, v16
v_lshl_add_u32 v16, v11, 4, v16
v_and_b32 v17, 3, v9
v_add_u32 v7, s55, v16
v_mov_b32 v1, 2146435072
v_cmp_eq_u32 vcc, 0, v17
s_nop 1
v_cndmask_b32 v7, v1, v7, vcc
v_and_b32 v16, 7, v0
v_bfe_u32 v17, v0, 3, 2
v_lshlrev_b32 v17, 14, v17
v_mul_u32_u24 v0, 640, v16
v_add_u32 v0, v0, v17
v_mov_b32 v136, -1
v_mov_b32 v137, -1
v_mov_b32 v138, -1
v_mov_b32 v139, -1
v_mov_b32 v132, v3
v_add_u32 v133, 32768, v2
s_add_u32 s53, s89, 131072
s_mov_b32 s40, s53
s_lshl_b32 s44, s33, 14
s_add_u32 s44, s44, s88
s_add_u32 s54, s44, 1310720
s_mov_b32 s48, 0
s_lshl_b32 s56, s33, 13
s_add_u32 s56, s56, 184426496
s_barrier
Lpu0_loop:
v_add_u32 v3, s48, v132
v_add_u32 v131, s48, v133
ds_read_b128 a[0:3], v3 offset:0
ds_read_b128 a[4:7], v3 offset:2048
ds_read_b128 a[8:11], v3 offset:512
ds_read_b128 a[12:15], v3 offset:2560
ds_read_b128 a[16:19], v3 offset:4096
ds_read_b128 a[20:23], v3 offset:6144
ds_read_b128 a[24:27], v3 offset:4608
ds_read_b128 a[28:31], v3 offset:6656
ds_read_b128 a[32:35], v3 offset:8192
ds_read_b128 a[36:39], v3 offset:10240
ds_read_b128 a[40:43], v3 offset:8704
ds_read_b128 a[44:47], v3 offset:10752
ds_read_b128 a[48:51], v3 offset:12288
ds_read_b128 a[52:55], v3 offset:14336
ds_read_b128 a[56:59], v3 offset:12800
ds_read_b128 a[60:63], v3 offset:14848
ds_read_b128 a[64:67], v3 offset:16384
ds_read_b128 a[68:71], v3 offset:18432
ds_read_b128 a[72:75], v3 offset:16896
ds_read_b128 a[76:79], v3 offset:18944
ds_read_b128 a[80:83], v3 offset:20480
ds_read_b128 a[84:87], v3 offset:22528
ds_read_b128 a[88:91], v3 offset:20992
ds_read_b128 a[92:95], v3 offset:23040
ds_read_b128 a[96:99], v3 offset:24576
ds_read_b128 a[100:103], v3 offset:26624
ds_read_b128 a[104:107], v3 offset:25088
ds_read_b128 a[108:111], v3 offset:27136
ds_read_b128 a[112:115], v3 offset:28672
ds_read_b128 a[116:119], v3 offset:30720
ds_read_b128 a[120:123], v3 offset:29184
ds_read_b128 a[124:127], v3 offset:31232
s_add_u32 s41, s40, 16384
s_add_u32 s42, s40, 32768
s_add_u32 s43, s40, 49152
s_add_u32 s45, s44, 4096
s_add_u32 s52, s24, 1
v_mov_b32 v135, s52
s_add_u32 s46, s24, 1
s_and_b32 s46, s46, 3
s_mul_i32 s46, s46, 32768
s_add_u32 s46, s46, s89
s_add_u32 s47, s24, 3
s_and_b32 s47, s47, 3
s_mul_i32 s47, s47, 32768
s_add_u32 s47, s47, s89
buffer_load_dword v1, v201, s[4:7], s89 offen sc1
s_waitcnt vmcnt(0)
v_cmp_gt_u32 vcc, s52, v1
s_cbranch_vccz Lpu0_open
s_mov_b64 exec, vcc
buffer_load_dword v1, v201, s[4:7], s89 offen sc1
s_sleep 4
buffer_load_dword v134, v201, s[4:7], s89 offen sc1
s_sleep 4
Lpu0_gate:
buffer_load_dword v130, v201, s[4:7], s89 offen sc1
s_waitcnt vmcnt(2)
v_cmp_gt_u32 vcc, s52, v1
s_cbranch_vccz Lpu0_open
s_mov_b64 exec, vcc
buffer_load_dword v1, v201, s[4:7], s89 offen sc1
s_waitcnt vmcnt(2)
v_cmp_gt_u32 vcc, s52, v134
s_cbranch_vccz Lpu0_open
s_mov_b64 exec, vcc
buffer_load_dword v134, v201, s[4:7], s89 offen sc1
s_waitcnt vmcnt(2)
v_cmp_gt_u32 vcc, s52, v130
s_cbranch_vccz Lpu0_open
s_mov_b64 exec, vcc
s_cmp_eq_u32 s25, 0
s_cbranch_scc1 Lpu0_open
s_sub_u32 s25, s25, 1
s_branch Lpu0_gate
Lpu0_open:
s_mov_b64 exec, -1
buffer_load_dwordx4 v[96:99], v2, s[4:7], s44 offen offset:0 sc1
buffer_load_dwordx4 v[100:103], v2, s[4:7], s44 offen offset:1024 sc1
buffer_load_dwordx4 v[104:107], v2, s[4:7], s44 offen offset:2048 sc1
buffer_load_dwordx4 v[108:111], v2, s[4:7], s44 offen offset:3072 sc1
buffer_load_dwordx4 v[112:115], v2, s[4:7], s45 offen offset:0 sc1
buffer_load_dwordx4 v[116:119], v2, s[4:7], s45 offen offset:1024 sc1
buffer_load_dwordx4 v[120:123], v2, s[4:7], s45 offen offset:2048 sc1
buffer_load_dwordx4 v[124:127], v2, s[4:7], s45 offen offset:3072 sc1
Lpu0_try:
buffer_load_dwordx2 v[80:81], v6, s[4:7], s40 offen offset:0 sc1
buffer_load_dwordx2 v[82:83], v6, s[4:7], s40 offen offset:640 sc1
buffer_load_dwordx2 v[84:85], v6, s[4:7], s41 offen offset:0 sc1
buffer_load_dwordx2 v[86:87], v6, s[4:7], s41 offen offset:640 sc1
buffer_load_dwordx2 v[88:89], v6, s[4:7], s42 offen offset:0 sc1
buffer_load_dwordx2 v[90:91], v6, s[4:7], s42 offen offset:640 sc1
buffer_load_dwordx2 v[92:93], v6, s[4:7], s43 offen offset:0 sc1
buffer_load_dwordx2 v[94:95], v6, s[4:7], s43 offen offset:640 sc1
buffer_load_dwordx4 v[16:19], v5, s[4:7], s40 offen offset:0 sc1
buffer_load_dwordx4 v[20:23], v5, s[4:7], s40 offen offset:256 sc1
buffer_load_dwordx4 v[24:27], v5, s[4:7], s40 offen offset:2560 sc1
buffer_load_dwordx4 v[28:31], v5, s[4:7], s40 offen offset:2816 sc1
buffer_load_dwordx4 v[32:35], v5, s[4:7], s41 offen offset:0 sc1
buffer_load_dwordx4 v[36:39], v5, s[4:7], s41 offen offset:256 sc1
buffer_load_dwordx4 v[40:43], v5, s[4:7], s41 offen offset:2560 sc1
buffer_load_dwordx4 v[44:47], v5, s[4:7], s41 offen offset:2816 sc1
buffer_load_dwordx4 v[48:51], v5, s[4:7], s42 offen offset:0 sc1
buffer_load_dwordx4 v[52:55], v5, s[4:7], s42 offen offset:256 sc1
buffer_load_dwordx4 v[56:59], v5, s[4:7], s42 offen offset:2560 sc1
buffer_load_dwordx4 v[60:63], v5, s[4:7], s42 offen offset:2816 sc1
buffer_load_dwordx4 v[64:67], v5, s[4:7], s43 offen offset:0 sc1
buffer_load_dwordx4 v[68:71], v5, s[4:7], s43 offen offset:256 sc1
buffer_load_dwordx4 v[72:75], v5, s[4:7], s43 offen offset:2560 sc1
buffer_load_dwordx4 v[76:79], v5, s[4:7], s43 offen offset:2816 sc1
v_mov_b32 v8, 0
v_mov_b32 v9, 0
v_mov_b32 v10, 0
v_mov_b32 v11, 0
v_mov_b32 v128, 0
v_mov_b32 v129, 0
s_waitcnt lgkmcnt(0)
s_waitcnt vmcnt(22)
buffer_store_dword v135, v200, s[4:7], s89 offen sc1
v_smfmac_f32_16x16x64_bf16 v[8:11], v[80:83], v[96:103], v4
v_or3_b32 v128, v128, v80, v81
v_or3_b32 v128, v128, v82, v83
s_waitcnt vmcnt(21)
v_smfmac_f32_16x16x64_bf16 v[8:11], v[84:87], v[104:111], v4
v_or3_b32 v128, v128, v84, v85
v_or3_b32 v128, v128, v86, v87
s_waitcnt vmcnt(19)
v_smfmac_f32_16x16x64_bf16 v[8:11], v[88:91], v[112:119], v4
v_or3_b32 v128, v128, v88, v89
v_or3_b32 v128, v128, v90, v91
s_waitcnt vmcnt(17)
v_smfmac_f32_16x16x64_bf16 v[8:11], v[92:95], v[120:127], v4
v_or3_b32 v128, v128, v92, v93
v_or3_b32 v128, v128, v94, v95
s_waitcnt vmcnt(16)
v_smfmac_f32_16x16x64_bf16 v[8:11], v[16:19], a[0:7], v4
v_or3_b32 v128, v128, v16, v17
v_or3_b32 v128, v128, v18, v19
v_max3_u32 v129, v129, v96, v98
s_waitcnt vmcnt(15)
v_smfmac_f32_16x16x64_bf16 v[8:11], v[20:23], a[8:15], v4
v_or3_b32 v128, v128, v20, v21
v_or3_b32 v128, v128, v22, v23
v_max3_u32 v129, v129, v100, v102
s_waitcnt vmcnt(14)
v_smfmac_f32_16x16x64_bf16 v[8:11], v[24:27], a[16:23], v4
v_or3_b32 v128, v128, v24, v25
v_or3_b32 v128, v128, v26, v27
v_max3_u32 v129, v129, v104, v106
s_waitcnt vmcnt(13)
v_smfmac_f32_16x16x64_bf16 v[8:11], v[28:31], a[24:31], v4
v_or3_b32 v128, v128, v28, v29
v_or3_b32 v128, v128, v30, v31
v_max3_u32 v129, v129, v108, v110
s_waitcnt vmcnt(12)
v_smfmac_f32_16x16x64_bf16 v[8:11], v[32:35], a[32:39], v4
v_or3_b32 v128, v128, v32, v33
v_or3_b32 v128, v128, v34, v35
v_max3_u32 v129, v129, v112, v114
s_waitcnt vmcnt(11)
v_smfmac_f32_16x16x64_bf16 v[8:11], v[36:39], a[40:47], v4
v_or3_b32 v128, v128, v36, v37
v_or3_b32 v128, v128, v38, v39
v_max3_u32 v129, v129, v116, v118
s_waitcnt vmcnt(10)
v_smfmac_f32_16x16x64_bf16 v[8:11], v[40:43], a[48:55], v4
v_or3_b32 v128, v128, v40, v41
v_or3_b32 v128, v128, v42, v43
v_max3_u32 v129, v129, v120, v122
s_waitcnt vmcnt(9)
v_smfmac_f32_16x16x64_bf16 v[8:11], v[44:47], a[56:63], v4
v_or3_b32 v128, v128, v44, v45
v_or3_b32 v128, v128, v46, v47
v_max3_u32 v129, v129, v124, v126
s_waitcnt vmcnt(8)
v_smfmac_f32_16x16x64_bf16 v[8:11], v[48:51], a[64:71], v4
v_or3_b32 v128, v128, v48, v49
v_or3_b32 v128, v128, v50, v51
v_cmp_eq_u32_e64 s[50:51], -1, v129
s_waitcnt vmcnt(7)
v_smfmac_f32_16x16x64_bf16 v[8:11], v[52:55], a[72:79], v4
v_or3_b32 v128, v128, v52, v53
v_or3_b32 v128, v128, v54, v55
s_waitcnt vmcnt(6)
v_smfmac_f32_16x16x64_bf16 v[8:11], v[56:59], a[80:87], v4
v_or3_b32 v128, v128, v56, v57
v_or3_b32 v128, v128, v58, v59
s_waitcnt vmcnt(5)
v_smfmac_f32_16x16x64_bf16 v[8:11], v[60:63], a[88:95], v4
v_or3_b32 v128, v128, v60, v61
v_or3_b32 v128, v128, v62, v63
s_waitcnt vmcnt(4)
v_smfmac_f32_16x16x64_bf16 v[8:11], v[64:67], a[96:103], v4
v_or3_b32 v128, v128, v64, v65
v_or3_b32 v128, v128, v66, v67
s_waitcnt vmcnt(3)
v_smfmac_f32_16x16x64_bf16 v[8:11], v[68:71], a[104:111], v4
v_or3_b32 v128, v128, v68, v69
v_or3_b32 v128, v128, v70, v71
s_waitcnt vmcnt(2)
v_smfmac_f32_16x16x64_bf16 v[8:11], v[72:75], a[112:119], v4
v_or3_b32 v128, v128, v72, v73
v_or3_b32 v128, v128, v74, v75
s_waitcnt vmcnt(1)
v_smfmac_f32_16x16x64_bf16 v[8:11], v[76:79], a[120:127], v4
v_or3_b32 v128, v128, v76, v77
v_or3_b32 v128, v128, v78, v79
v_and_b32 v128, 0x80008000, v128
v_cmp_ne_u32 vcc, 0, v128
s_or_b64 vcc, vcc, s[50:51]
s_cbranch_scc1 Lpu0_retry
Lpu0_ok:
s_nop 1
v_permlane32_swap_b32 v8, v9
v_permlane32_swap_b32 v10, v11
v_add_f32 v8, v8, v9
v_add_f32 v10, v10, v11
v_mov_b32 v12, v8
s_nop 0
v_mov_b32_dpp v8, v10 row_ror:8 row_mask:0xf bank_mask:0xc
v_mov_b32_dpp v10, v12 row_ror:8 row_mask:0xf bank_mask:0x3
v_cvt_pk_bf16_f32 v8, v8, v10
s_nop 1
v_mov_b32_dpp v9, v8 quad_perm:[1,1,1,1] row_mask:0xf bank_mask:0xf
v_mov_b32_dpp v10, v8 quad_perm:[2,2,2,2] row_mask:0xf bank_mask:0xf
v_mov_b32_dpp v11, v8 quad_perm:[3,3,3,3] row_mask:0xf bank_mask:0xf
buffer_store_dwordx4 v[8:11], v7, s[4:7], s46 offen sc1
s_barrier
buffer_store_dwordx4 v[136:139], v7, s[4:7], s47 offen sc1
ds_write_b128 v131, v[96:99] offset:0
ds_write_b128 v131, v[100:103] offset:1024
ds_write_b128 v131, v[104:107] offset:2048
ds_write_b128 v131, v[108:111] offset:3072
ds_write_b128 v131, v[112:115] offset:4096
ds_write_b128 v131, v[116:119] offset:5120
ds_write_b128 v131, v[120:123] offset:6144
ds_write_b128 v131, v[124:127] offset:7168
s_cmp_eq_u32 s24, 57
s_cbranch_scc1 Lpu0_fl
s_cmp_eq_u32 s24, 62
s_cbranch_scc1 Lpu0_fl
Lpu0_fr:
s_cmp_eq_u32 s44, s54
s_cselect_b32 s46, 1966080, 0
s_add_u32 s44, s44, 655360
s_sub_u32 s44, s44, s46
s_add_u32 s48, s48, 40960
s_cmp_eq_u32 s48, 163840
s_cselect_b32 s48, 0, s48
s_add_u32 s24, s24, 1
s_and_b32 s40, s24, 3
s_mul_i32 s40, s40, 65536
s_add_u32 s40, s40, s53
s_cmp_lt_u32 s24, 63
s_cbranch_scc1 Lpu0_loop
s_mov_b32 s52, 64
s_waitcnt lgkmcnt(0)
Lpu0l_gate:
buffer_load_dword v1, v201, s[4:7], s89 offen sc1
s_waitcnt vmcnt(0)
v_cmp_gt_u32 vcc, s52, v1
s_cbranch_vccz Lpu0l_open
s_mov_b64 exec, vcc
s_cmp_eq_u32 s25, 0
s_cbranch_scc1 Lpu0l_open
s_sub_u32 s25, s25, 1
s_branch Lpu0l_gate
Lpu0l_open:
s_mov_b64 exec, -1
s_barrier
s_endpgm
Lpu0_fl:
v_mov_b32 v204, s24
buffer_store_dword v204, v203, s[4:7], 0 offen sc1
s_branch Lpu0_fr
s_cmp_lt_u32 s24, 64
s_cbranch_scc1 Lpu0_loop
Lpu0_fin:
buffer_load_dword v1, v0, s[4:7], s40 offen offset:512 sc1
s_waitcnt vmcnt(0)
v_and_b32 v1, 0x80008000, v1
v_cmp_ne_u32 vcc, 0, v1
s_cbranch_vccz Lpu0_end
s_cmp_eq_u32 s25, 0
s_cbranch_scc1 Lpu0_end
s_sub_u32 s25, s25, 1
s_branch Lpu0_fin
Lpu0_end:
s_barrier
s_endpgm
Lpu0_retry:
s_cmp_eq_u32 s25, 0
s_cbranch_scc1 Lpu0_ok
s_sub_u32 s25, s25, 1
buffer_load_dwordx4 v[96:99], v2, s[4:7], s44 offen offset:0 sc1
buffer_load_dwordx4 v[100:103], v2, s[4:7], s44 offen offset:1024 sc1
buffer_load_dwordx4 v[104:107], v2, s[4:7], s44 offen offset:2048 sc1
buffer_load_dwordx4 v[108:111], v2, s[4:7], s44 offen offset:3072 sc1
buffer_load_dwordx4 v[112:115], v2, s[4:7], s45 offen offset:0 sc1
buffer_load_dwordx4 v[116:119], v2, s[4:7], s45 offen offset:1024 sc1
buffer_load_dwordx4 v[120:123], v2, s[4:7], s45 offen offset:2048 sc1
buffer_load_dwordx4 v[124:127], v2, s[4:7], s45 offen offset:3072 sc1
s_branch Lpu0_try
Lpux:
s_lshr_b32 s46, s33, 3
s_sub_u32 s47, s33, 32
s_lshr_b32 s47, s47, 2
s_lshl_b32 s47, s47, 1
s_add_u32 s48, s47, 1
s_cmp_lt_u32 s33, 32
s_cselect_b32 s47, s46, s47
s_cselect_b32 s48, s46, s48
s_lshl_b32 s47, s47, 12
s_lshl_b32 s48, s48, 12
v_mov_b32 v16, s47
v_mov_b32 v17, s48
v_cmp_gt_u32 vcc, 32, v0
s_nop 1
v_cndmask_b32 v16, v17, v16, vcc
v_and_b32 v17, 31, v0
v_lshl_add_u32 v16, v17, 7, v16
v_add_u32 v160, 65536, v16
s_lshl_b32 s46, s33, 7
s_add_u32 s46, s46, 90112
v_mov_b32 v161, s46
v_mul_u32_u24 v7, 1280, v11
v_lshl_add_u32 v7, v8, 2, v7
s_lshl_b32 s46, s33, 5
v_add_u32 v7, s46, v7
v_lshlrev_b32 v162, 5, v11
v_lshl_add_u32 v162, v8, 2, v162
v_mov_b32 v163, v3
v_add_u32 v164, 32768, v2
s_cmp_eq_u32 s28, 1
s_cselect_b32 s35, 0, s28
s_mul_i32 s40, s35, 20480
s_add_u32 s40, s40, 179183616
s_mul_i32 s49, s35, 10240
s_lshl_b32 s51, s35, 8
s_lshl_b32 s46, s33, 10
s_add_u32 s51, s51, s46
s_add_u32 s51, s51, 176562176
s_cmp_eq_u32 s28, 2
s_cselect_b32 s36, 10240, 0
s_cmp_eq_u32 s28, 3
s_cselect_b32 s36, 21504, s36
s_lshl_b32 s44, s33, 15
s_add_u32 s44, s44, s36
s_add_u32 s44, s44, 86286336
s_mov_b32 s45, 0
s_mov_b32 s48, 0
s_mov_b32 s50, 1
Lpux_pro:
Lpl_29:
buffer_load_dword v1, v160, s[4:7], 0 offen sc1
s_waitcnt vmcnt(0)
v_cmp_gt_u32 vcc, s50, v1
s_cbranch_vccz Lpld_30
s_cmp_eq_u32 s25, 0
s_cbranch_scc1 Lpld_30
s_sub_u32 s25, s25, 1
s_sleep 1
s_branch Lpl_29
Lpld_30:
s_add_u32 s46, s45, s36
s_add_u32 m0, s46, 0
s_add_u32 s47, s44, 0
buffer_load_dwordx4 v2, s[4:7], s47 offen offset:0 sc1 lds
buffer_load_dwordx4 v2, s[4:7], s47 offen offset:1024 sc1 lds
buffer_load_dwordx4 v2, s[4:7], s47 offen offset:2048 sc1 lds
buffer_load_dwordx4 v2, s[4:7], s47 offen offset:3072 sc1 lds
s_add_u32 m0, s46, 4096
s_add_u32 s47, s44, 4096
buffer_load_dwordx4 v2, s[4:7], s47 offen offset:0 sc1 lds
buffer_load_dwordx4 v2, s[4:7], s47 offen offset:1024 sc1 lds
buffer_load_dwordx4 v2, s[4:7], s47 offen offset:2048 sc1 lds
buffer_load_dwordx4 v2, s[4:7], s47 offen offset:3072 sc1 lds
s_add_u32 m0, s46, 8192
s_add_u32 s47, s44, 8192
buffer_load_dwordx4 v2, s[4:7], s47 offen offset:0 sc1 lds
buffer_load_dwordx4 v2, s[4:7], s47 offen offset:1024 sc1 lds
buffer_load_dwordx4 v2, s[4:7], s47 offen offset:2048 sc1 lds
s_add_u32 s44, s44, 1310720
s_add_u32 s45, s45, 40960
s_cmp_eq_u32 s45, 163840
s_cselect_b32 s45, 0, s45
s_add_u32 s50, s50, 1
s_waitcnt vmcnt(0)
s_barrier
s_cmp_lt_u32 s50, 4
s_cbranch_scc1 Lpux_pro
v_mov_b32 v176, 0
v_mov_b32 v177, 0
s_mov_b32 s50, 1
Lpl_31:
buffer_load_dword v1, v161, s[4:7], 0 offen sc1
s_waitcnt vmcnt(0)
v_cmp_gt_u32 vcc, s50, v1
s_cbranch_vccz Lpld_32
s_cmp_eq_u32 s25, 0
s_cbranch_scc1 Lpld_32
s_sub_u32 s25, s25, 1
s_sleep 1
s_branch Lpl_31
Lpld_32:
s_cmp_eq_u32 s28, 1
s_cbranch_scc1 Lpux1_in
Lpux2_in:
s_add_u32 s41, s40, 5120
s_add_u32 s42, s40, 10240
s_add_u32 s43, s40, 15360
v_add_u32 v3, s48, v163
v_add_u32 v0, s48, v164
s_branch Lpux2_go
Lpux2_loop:
s_add_u32 s41, s40, 5120
s_add_u32 s42, s40, 10240
s_add_u32 s43, s40, 15360
v_add_u32 v3, s48, v163
v_add_u32 v0, s48, v164
s_barrier
Lpux2_go:
buffer_load_dwordx2 v[80:81], v6, s[4:7], s40 offen offset:0 sc1
buffer_load_dwordx2 v[82:83], v6, s[4:7], s40 offen offset:640 sc1
buffer_load_dwordx2 v[84:85], v6, s[4:7], s41 offen offset:0 sc1
buffer_load_dwordx2 v[86:87], v6, s[4:7], s41 offen offset:640 sc1
buffer_load_dwordx2 v[88:89], v6, s[4:7], s42 offen offset:0 sc1
buffer_load_dwordx2 v[90:91], v6, s[4:7], s42 offen offset:640 sc1
buffer_load_dwordx2 v[92:93], v6, s[4:7], s43 offen offset:0 sc1
buffer_load_dwordx2 v[94:95], v6, s[4:7], s43 offen offset:640 sc1
buffer_load_dwordx4 v[16:19], v5, s[4:7], s40 offen offset:0 sc1
buffer_load_dwordx4 v[20:23], v5, s[4:7], s40 offen offset:256 sc1
buffer_load_dwordx4 v[24:27], v5, s[4:7], s40 offen offset:2560 sc1
buffer_load_dwordx4 v[28:31], v5, s[4:7], s40 offen offset:2816 sc1
buffer_load_dwordx4 v[32:35], v5, s[4:7], s41 offen offset:0 sc1
buffer_load_dwordx4 v[36:39], v5, s[4:7], s41 offen offset:256 sc1
buffer_load_dwordx4 v[40:43], v5, s[4:7], s41 offen offset:2560 sc1
buffer_load_dwordx4 v[44:47], v5, s[4:7], s41 offen offset:2816 sc1
buffer_load_dwordx4 v[48:51], v5, s[4:7], s42 offen offset:0 sc1
buffer_load_dwordx4 v[52:55], v5, s[4:7], s42 offen offset:256 sc1
buffer_load_dwordx4 v[56:59], v5, s[4:7], s42 offen offset:2560 sc1
buffer_load_dwordx4 v[60:63], v5, s[4:7], s42 offen offset:2816 sc1
buffer_load_dwordx4 v[64:67], v5, s[4:7], s43 offen offset:0 sc1
buffer_load_dwordx4 v[68:71], v5, s[4:7], s43 offen offset:256 sc1
buffer_load_dwordx4 v[72:75], v5, s[4:7], s43 offen offset:2560 sc1
buffer_load_dwordx4 v[76:79], v5, s[4:7], s43 offen offset:2816 sc1
s_add_u32 s46, s49, 0
buffer_load_dword v166, v7, s[8:11], s46 offen
buffer_load_dword v168, v162, s[4:7], s51 offen offset:0 sc1
s_cmp_lt_u32 s24, 2
s_cbranch_scc1 Lpux2_e0
s_add_u32 s46, s45, s36
s_add_u32 m0, s46, 0
s_add_u32 s47, s44, 0
buffer_load_dwordx4 v2, s[4:7], s47 offen offset:0 sc1 lds
buffer_load_dwordx4 v2, s[4:7], s47 offen offset:1024 sc1 lds
buffer_load_dwordx4 v2, s[4:7], s47 offen offset:2048 sc1 lds
buffer_load_dwordx4 v2, s[4:7], s47 offen offset:3072 sc1 lds
s_add_u32 m0, s46, 4096
s_add_u32 s47, s44, 4096
buffer_load_dwordx4 v2, s[4:7], s47 offen offset:0 sc1 lds
buffer_load_dwordx4 v2, s[4:7], s47 offen offset:1024 sc1 lds
buffer_load_dwordx4 v2, s[4:7], s47 offen offset:2048 sc1 lds
buffer_load_dwordx4 v2, s[4:7], s47 offen offset:3072 sc1 lds
s_add_u32 m0, s46, 8192
s_add_u32 s47, s44, 8192
buffer_load_dwordx4 v2, s[4:7], s47 offen offset:0 sc1 lds
buffer_load_dwordx4 v2, s[4:7], s47 offen offset:1024 sc1 lds
buffer_load_dwordx4 v2, s[4:7], s47 offen offset:2048 sc1 lds
s_add_u32 s44, s44, 1310720
s_add_u32 s45, s45, 40960
s_cmp_eq_u32 s45, 163840
s_cselect_b32 s45, 0, s45
Lpux2_e1:
ds_read_b128 v[112:115], v0 offset:0
ds_read_b128 v[116:119], v0 offset:1024
ds_read_b128 v[120:123], v0 offset:2048
ds_read_b128 v[124:127], v0 offset:3072
ds_read_b128 v[128:131], v0 offset:4096
ds_read_b128 v[132:135], v0 offset:5120
ds_read_b128 v[136:139], v0 offset:6144
ds_read_b128 v[140:143], v0 offset:7168
ds_read_b128 v[144:147], v3 offset:0
ds_read_b128 v[148:151], v3 offset:2048
ds_read_b128 v[152:155], v3 offset:512
ds_read_b128 v[156:159], v3 offset:2560
v_mov_b32 v8, 0
v_mov_b32 v9, 0
v_mov_b32 v10, 0
v_mov_b32 v11, 0
v_mov_b32 v12, 0
v_mov_b32 v13, 0
v_mov_b32 v14, 0
v_mov_b32 v15, 0
s_waitcnt vmcnt(11)
s_waitcnt lgkmcnt(10)
v_smfmac_f32_16x16x64_bf16 v[8:11], v[80:83], v[112:119], v4
ds_read_b128 v[112:115], v3 offset:4096
ds_read_b128 v[116:119], v3 offset:6144
s_waitcnt lgkmcnt(10)
v_smfmac_f32_16x16x64_bf16 v[12:15], v[84:87], v[120:127], v4
ds_read_b128 v[120:123], v3 offset:4608
ds_read_b128 v[124:127], v3 offset:6656
s_waitcnt lgkmcnt(10)
v_smfmac_f32_16x16x64_bf16 v[8:11], v[88:91], v[128:135], v4
ds_read_b128 v[128:131], v3 offset:8192
ds_read_b128 v[132:135], v3 offset:10240
s_waitcnt lgkmcnt(10)
v_smfmac_f32_16x16x64_bf16 v[12:15], v[92:95], v[136:143], v4
ds_read_b128 v[136:139], v3 offset:8704
ds_read_b128 v[140:143], v3 offset:10752
s_waitcnt lgkmcnt(10)
v_smfmac_f32_16x16x64_bf16 v[8:11], v[16:19], v[144:151], v4
ds_read_b128 v[144:147], v3 offset:12288
ds_read_b128 v[148:151], v3 offset:14336
s_waitcnt lgkmcnt(10)
v_smfmac_f32_16x16x64_bf16 v[12:15], v[20:23], v[152:159], v4
ds_read_b128 v[152:155], v3 offset:12800
ds_read_b128 v[156:159], v3 offset:14848
s_waitcnt lgkmcnt(10)
v_smfmac_f32_16x16x64_bf16 v[8:11], v[24:27], v[112:119], v4
ds_read_b128 v[112:115], v3 offset:16384
ds_read_b128 v[116:119], v3 offset:18432
s_waitcnt lgkmcnt(10)
v_smfmac_f32_16x16x64_bf16 v[12:15], v[28:31], v[120:127], v4
ds_read_b128 v[120:123], v3 offset:16896
ds_read_b128 v[124:127], v3 offset:18944
s_waitcnt lgkmcnt(10)
v_smfmac_f32_16x16x64_bf16 v[8:11], v[32:35], v[128:135], v4
ds_read_b128 v[128:131], v3 offset:20480
ds_read_b128 v[132:135], v3 offset:22528
s_waitcnt lgkmcnt(10)
v_smfmac_f32_16x16x64_bf16 v[12:15], v[36:39], v[136:143], v4
ds_read_b128 v[136:139], v3 offset:20992
ds_read_b128 v[140:143], v3 offset:23040
s_waitcnt lgkmcnt(10)
v_smfmac_f32_16x16x64_bf16 v[8:11], v[40:43], v[144:151], v4
ds_read_b128 v[144:147], v3 offset:24576
ds_read_b128 v[148:151], v3 offset:26624
s_waitcnt lgkmcnt(10)
v_smfmac_f32_16x16x64_bf16 v[12:15], v[44:47], v[152:159], v4
ds_read_b128 v[152:155], v3 offset:25088
ds_read_b128 v[156:159], v3 offset:27136
s_waitcnt lgkmcnt(10)
v_smfmac_f32_16x16x64_bf16 v[8:11], v[48:51], v[112:119], v4
ds_read_b128 v[112:115], v3 offset:28672
ds_read_b128 v[116:119], v3 offset:30720
s_waitcnt lgkmcnt(10)
v_smfmac_f32_16x16x64_bf16 v[12:15], v[52:55], v[120:127], v4
ds_read_b128 v[120:123], v3 offset:29184
ds_read_b128 v[124:127], v3 offset:31232
s_waitcnt lgkmcnt(10)
v_smfmac_f32_16x16x64_bf16 v[8:11], v[56:59], v[128:135], v4
s_waitcnt lgkmcnt(8)
v_smfmac_f32_16x16x64_bf16 v[12:15], v[60:63], v[136:143], v4
s_waitcnt lgkmcnt(6)
v_smfmac_f32_16x16x64_bf16 v[8:11], v[64:67], v[144:151], v4
s_waitcnt lgkmcnt(4)
v_smfmac_f32_16x16x64_bf16 v[12:15], v[68:71], v[152:159], v4
s_waitcnt lgkmcnt(2)
v_smfmac_f32_16x16x64_bf16 v[8:11], v[72:75], v[112:119], v4
s_waitcnt lgkmcnt(0)
v_smfmac_f32_16x16x64_bf16 v[12:15], v[76:79], v[120:127], v4
s_nop 7
v_pk_add_f32 v[8:9], v[8:9], v[12:13]
v_pk_add_f32 v[10:11], v[10:11], v[14:15]
s_nop 0
v_permlane32_swap_b32 v8, v9
v_permlane32_swap_b32 v10, v11
v_add_f32 v8, v8, v9
v_add_f32 v10, v10, v11
v_mov_b32 v170, v8
s_nop 0
v_mov_b32_dpp v8, v10 row_ror:8 row_mask:0xf bank_mask:0xc
v_mov_b32_dpp v10, v170 row_ror:8 row_mask:0xf bank_mask:0x3
v_cvt_pk_bf16_f32 v170, v8, v10
v_lshlrev_b32 v171, 16, v170
v_and_b32 v170, 0xffff0000, v170
v_lshlrev_b32 v172, 16, v168
v_and_b32 v173, 0xffff0000, v168
v_mul_f32 v171, v171, v172
v_mul_f32 v170, v170, v173
v_cvt_pk_bf16_f32 v170, v171, v170
v_lshlrev_b32 v171, 16, v170
v_and_b32 v170, 0xffff0000, v170
v_lshlrev_b32 v172, 16, v166
v_and_b32 v173, 0xffff0000, v166
v_add_f32 v171, v171, v172
v_add_f32 v170, v170, v173
v_cvt_pk_bf16_f32 v174, v171, v170
s_add_u32 s46, s49, 0
buffer_store_dword v174, v7, s[12:15], s46 offen
s_add_u32 s40, s40, 81920
s_add_u32 s49, s49, 40960
s_add_u32 s51, s51, 40960
s_add_u32 s48, s48, 40960
s_cmp_eq_u32 s48, 163840
s_cselect_b32 s48, 0, s48
s_add_u32 s24, s24, 1
s_cmp_eq_u32 s24, 63
s_cbranch_scc1 Lxe_33
s_cmp_le_u32 s24, 2
s_cbranch_scc1 Lpux2_e2
s_waitcnt vmcnt(1)
Lpux2_e3:
s_branch Lpux2_loop
Lxe_33:
s_waitcnt vmcnt(0)
s_endpgm
Lpux2_e0:
s_waitcnt vmcnt(0)
s_branch Lpux2_e1
Lpux2_e2:
s_add_u32 s50, s24, 3
Lpl_34:
buffer_load_dword v1, v160, s[4:7], 0 offen sc1
s_waitcnt vmcnt(0)
v_cmp_gt_u32 vcc, s50, v1
s_cbranch_vccz Lpld_35
s_cmp_eq_u32 s25, 0
s_cbranch_scc1 Lpld_35
s_sub_u32 s25, s25, 1
s_sleep 1
s_branch Lpl_34
Lpld_35:
s_add_u32 s46, s45, s36
s_add_u32 m0, s46, 0
s_add_u32 s47, s44, 0
buffer_load_dwordx4 v2, s[4:7], s47 offen offset:0 sc1 lds
buffer_load_dwordx4 v2, s[4:7], s47 offen offset:1024 sc1 lds
buffer_load_dwordx4 v2, s[4:7], s47 offen offset:2048 sc1 lds
buffer_load_dwordx4 v2, s[4:7], s47 offen offset:3072 sc1 lds
s_add_u32 m0, s46, 4096
s_add_u32 s47, s44, 4096
buffer_load_dwordx4 v2, s[4:7], s47 offen offset:0 sc1 lds
buffer_load_dwordx4 v2, s[4:7], s47 offen offset:1024 sc1 lds
buffer_load_dwordx4 v2, s[4:7], s47 offen offset:2048 sc1 lds
buffer_load_dwordx4 v2, s[4:7], s47 offen offset:3072 sc1 lds
s_add_u32 m0, s46, 8192
s_add_u32 s47, s44, 8192
buffer_load_dwordx4 v2, s[4:7], s47 offen offset:0 sc1 lds
buffer_load_dwordx4 v2, s[4:7], s47 offen offset:1024 sc1 lds
buffer_load_dwordx4 v2, s[4:7], s47 offen offset:2048 sc1 lds
s_add_u32 s44, s44, 1310720
s_add_u32 s45, s45, 40960
s_cmp_eq_u32 s45, 163840
s_cselect_b32 s45, 0, s45
s_waitcnt vmcnt(0)
s_branch Lpux2_e3
Lpux1_in:
s_add_u32 s41, s40, 5120
s_add_u32 s42, s40, 10240
s_add_u32 s43, s40, 15360
v_add_u32 v3, s48, v163
v_add_u32 v0, s48, v164
s_add_u32 s52, s40, 20480
s_add_u32 s53, s41, 20480
s_add_u32 s54, s42, 20480
s_add_u32 s55, s43, 20480
s_branch Lpux1_go
Lpux1_loop:
s_add_u32 s41, s40, 5120
s_add_u32 s42, s40, 10240
s_add_u32 s43, s40, 15360
v_add_u32 v3, s48, v163
v_add_u32 v0, s48, v164
s_add_u32 s52, s40, 20480
s_add_u32 s53, s41, 20480
s_add_u32 s54, s42, 20480
s_add_u32 s55, s43, 20480
s_barrier
Lpux1_go:
buffer_load_dwordx2 v[80:81], v6, s[4:7], s40 offen offset:0 sc1
buffer_load_dwordx2 v[82:83], v6, s[4:7], s40 offen offset:640 sc1
buffer_load_dwordx2 v[84:85], v6, s[4:7], s41 offen offset:0 sc1
buffer_load_dwordx2 v[86:87], v6, s[4:7], s41 offen offset:640 sc1
buffer_load_dwordx2 v[88:89], v6, s[4:7], s42 offen offset:0 sc1
buffer_load_dwordx2 v[90:91], v6, s[4:7], s42 offen offset:640 sc1
buffer_load_dwordx2 v[92:93], v6, s[4:7], s43 offen offset:0 sc1
buffer_load_dwordx2 v[94:95], v6, s[4:7], s43 offen offset:640 sc1
buffer_load_dwordx4 v[16:19], v5, s[4:7], s40 offen offset:0 sc1
buffer_load_dwordx4 v[20:23], v5, s[4:7], s40 offen offset:2560 sc1
buffer_load_dwordx4 v[24:27], v5, s[4:7], s41 offen offset:0 sc1
buffer_load_dwordx4 v[28:31], v5, s[4:7], s41 offen offset:2560 sc1
buffer_load_dwordx4 v[32:35], v5, s[4:7], s42 offen offset:0 sc1
buffer_load_dwordx4 v[36:39], v5, s[4:7], s42 offen offset:2560 sc1
buffer_load_dwordx4 v[40:43], v5, s[4:7], s43 offen offset:0 sc1
buffer_load_dwordx4 v[44:47], v5, s[4:7], s43 offen offset:2560 sc1
buffer_load_dwordx2 v[96:97], v6, s[4:7], s52 offen offset:0 sc1
buffer_load_dwordx2 v[98:99], v6, s[4:7], s52 offen offset:640 sc1
buffer_load_dwordx2 v[100:101], v6, s[4:7], s53 offen offset:0 sc1
buffer_load_dwordx2 v[102:103], v6, s[4:7], s53 offen offset:640 sc1
buffer_load_dwordx2 v[104:105], v6, s[4:7], s54 offen offset:0 sc1
buffer_load_dwordx2 v[106:107], v6, s[4:7], s54 offen offset:640 sc1
buffer_load_dwordx2 v[108:109], v6, s[4:7], s55 offen offset:0 sc1
buffer_load_dwordx2 v[110:111], v6, s[4:7], s55 offen offset:640 sc1
buffer_load_dwordx4 v[48:51], v5, s[4:7], s52 offen offset:0 sc1
buffer_load_dwordx4 v[52:55], v5, s[4:7], s52 offen offset:2560 sc1
buffer_load_dwordx4 v[56:59], v5, s[4:7], s53 offen offset:0 sc1
buffer_load_dwordx4 v[60:63], v5, s[4:7], s53 offen offset:2560 sc1
buffer_load_dwordx4 v[64:67], v5, s[4:7], s54 offen offset:0 sc1
buffer_load_dwordx4 v[68:71], v5, s[4:7], s54 offen offset:2560 sc1
buffer_load_dwordx4 v[72:75], v5, s[4:7], s55 offen offset:0 sc1
buffer_load_dwordx4 v[76:79], v5, s[4:7], s55 offen offset:2560 sc1
s_add_u32 s46, s49, 0
buffer_load_dword v166, v7, s[8:11], s46 offen
buffer_load_dword v168, v162, s[4:7], s51 offen offset:0 sc1
s_add_u32 s46, s49, 10240
buffer_load_dword v167, v7, s[8:11], s46 offen
buffer_load_dword v169, v162, s[4:7], s51 offen offset:256 sc1
s_cmp_lt_u32 s24, 2
s_cbranch_scc1 Lpux1_e0
s_add_u32 s46, s45, s36
s_add_u32 m0, s46, 0
s_add_u32 s47, s44, 0
buffer_load_dwordx4 v2, s[4:7], s47 offen offset:0 sc1 lds
buffer_load_dwordx4 v2, s[4:7], s47 offen offset:1024 sc1 lds
buffer_load_dwordx4 v2, s[4:7], s47 offen offset:2048 sc1 lds
buffer_load_dwordx4 v2, s[4:7], s47 offen offset:3072 sc1 lds
s_add_u32 m0, s46, 4096
s_add_u32 s47, s44, 4096
buffer_load_dwordx4 v2, s[4:7], s47 offen offset:0 sc1 lds
buffer_load_dwordx4 v2, s[4:7], s47 offen offset:1024 sc1 lds
buffer_load_dwordx4 v2, s[4:7], s47 offen offset:2048 sc1 lds
buffer_load_dwordx4 v2, s[4:7], s47 offen offset:3072 sc1 lds
s_add_u32 m0, s46, 8192
s_add_u32 s47, s44, 8192
buffer_load_dwordx4 v2, s[4:7], s47 offen offset:0 sc1 lds
buffer_load_dwordx4 v2, s[4:7], s47 offen offset:1024 sc1 lds
buffer_load_dwordx4 v2, s[4:7], s47 offen offset:2048 sc1 lds
s_add_u32 s44, s44, 1310720
s_add_u32 s45, s45, 40960
s_cmp_eq_u32 s45, 163840
s_cselect_b32 s45, 0, s45
Lpux1_e1:
ds_read_b128 v[112:115], v0 offset:0
ds_read_b128 v[116:119], v0 offset:1024
ds_read_b128 v[120:123], v0 offset:2048
ds_read_b128 v[124:127], v0 offset:3072
ds_read_b128 v[128:131], v0 offset:4096
ds_read_b128 v[132:135], v0 offset:5120
ds_read_b128 v[136:139], v0 offset:6144
ds_read_b128 v[140:143], v0 offset:7168
ds_read_b128 v[144:147], v3 offset:0
ds_read_b128 v[148:151], v3 offset:2048
ds_read_b128 v[152:155], v3 offset:4096
ds_read_b128 v[156:159], v3 offset:6144
v_mov_b32 v8, 0
v_mov_b32 v9, 0
v_mov_b32 v10, 0
v_mov_b32 v11, 0
v_mov_b32 v12, 0
v_mov_b32 v13, 0
v_mov_b32 v14, 0
v_mov_b32 v15, 0
s_waitcnt vmcnt(11)
s_add_u32 s46, s24, 2
s_min_u32 s46, s46, 64
v_cmp_gt_u32 vcc, s46, v176
s_cbranch_vccz Lrf_36
buffer_load_dword v176, v161, s[4:7], 0 offen sc1
Lrf_36:
s_add_u32 s46, s24, 5
s_min_u32 s46, s46, 64
v_cmp_gt_u32 vcc, s46, v177
s_cbranch_vccz Lrf_37
buffer_load_dword v177, v160, s[4:7], 0 offen sc1
Lrf_37:
s_waitcnt lgkmcnt(10)
v_smfmac_f32_16x16x64_bf16 v[8:11], v[80:83], v[112:119], v4
v_smfmac_f32_16x16x64_bf16 v[12:15], v[96:99], v[112:119], v4
ds_read_b128 v[112:115], v3 offset:8192
ds_read_b128 v[116:119], v3 offset:10240
s_waitcnt lgkmcnt(10)
v_smfmac_f32_16x16x64_bf16 v[8:11], v[84:87], v[120:127], v4
v_smfmac_f32_16x16x64_bf16 v[12:15], v[100:103], v[120:127], v4
ds_read_b128 v[120:123], v3 offset:12288
ds_read_b128 v[124:127], v3 offset:14336
s_waitcnt lgkmcnt(10)
v_smfmac_f32_16x16x64_bf16 v[8:11], v[88:91], v[128:135], v4
v_smfmac_f32_16x16x64_bf16 v[12:15], v[104:107], v[128:135], v4
ds_read_b128 v[128:131], v3 offset:16384
ds_read_b128 v[132:135], v3 offset:18432
s_waitcnt lgkmcnt(10)
v_smfmac_f32_16x16x64_bf16 v[8:11], v[92:95], v[136:143], v4
v_smfmac_f32_16x16x64_bf16 v[12:15], v[108:111], v[136:143], v4
ds_read_b128 v[136:139], v3 offset:20480
ds_read_b128 v[140:143], v3 offset:22528
s_waitcnt lgkmcnt(10)
v_smfmac_f32_16x16x64_bf16 v[8:11], v[16:19], v[144:151], v4
v_smfmac_f32_16x16x64_bf16 v[12:15], v[48:51], v[144:151], v4
ds_read_b128 v[144:147], v3 offset:24576
ds_read_b128 v[148:151], v3 offset:26624
s_waitcnt lgkmcnt(10)
v_smfmac_f32_16x16x64_bf16 v[8:11], v[20:23], v[152:159], v4
v_smfmac_f32_16x16x64_bf16 v[12:15], v[52:55], v[152:159], v4
ds_read_b128 v[152:155], v3 offset:28672
ds_read_b128 v[156:159], v3 offset:30720
s_waitcnt lgkmcnt(10)
v_smfmac_f32_16x16x64_bf16 v[8:11], v[24:27], v[112:119], v4
v_smfmac_f32_16x16x64_bf16 v[12:15], v[56:59], v[112:119], v4
s_waitcnt lgkmcnt(8)
v_smfmac_f32_16x16x64_bf16 v[8:11], v[28:31], v[120:127], v4
v_smfmac_f32_16x16x64_bf16 v[12:15], v[60:63], v[120:127], v4
s_waitcnt lgkmcnt(6)
v_smfmac_f32_16x16x64_bf16 v[8:11], v[32:35], v[128:135], v4
v_smfmac_f32_16x16x64_bf16 v[12:15], v[64:67], v[128:135], v4
s_waitcnt lgkmcnt(4)
v_smfmac_f32_16x16x64_bf16 v[8:11], v[36:39], v[136:143], v4
v_smfmac_f32_16x16x64_bf16 v[12:15], v[68:71], v[136:143], v4
s_waitcnt lgkmcnt(2)
v_smfmac_f32_16x16x64_bf16 v[8:11], v[40:43], v[144:151], v4
v_smfmac_f32_16x16x64_bf16 v[12:15], v[72:75], v[144:151], v4
s_waitcnt lgkmcnt(0)
v_smfmac_f32_16x16x64_bf16 v[8:11], v[44:47], v[152:159], v4
v_smfmac_f32_16x16x64_bf16 v[12:15], v[76:79], v[152:159], v4
s_nop 3
v_permlane32_swap_b32 v8, v9
v_permlane32_swap_b32 v10, v11
v_add_f32 v8, v8, v9
v_add_f32 v10, v10, v11
v_mov_b32 v170, v8
s_nop 0
v_mov_b32_dpp v8, v10 row_ror:8 row_mask:0xf bank_mask:0xc
v_mov_b32_dpp v10, v170 row_ror:8 row_mask:0xf bank_mask:0x3
v_cvt_pk_bf16_f32 v170, v8, v10
v_lshlrev_b32 v171, 16, v170
v_and_b32 v170, 0xffff0000, v170
v_lshlrev_b32 v172, 16, v168
v_and_b32 v173, 0xffff0000, v168
v_mul_f32 v171, v171, v172
v_mul_f32 v170, v170, v173
v_cvt_pk_bf16_f32 v170, v171, v170
v_lshlrev_b32 v171, 16, v170
v_and_b32 v170, 0xffff0000, v170
v_lshlrev_b32 v172, 16, v166
v_and_b32 v173, 0xffff0000, v166
v_add_f32 v171, v171, v172
v_add_f32 v170, v170, v173
v_cvt_pk_bf16_f32 v174, v171, v170
s_add_u32 s46, s49, 0
buffer_store_dword v174, v7, s[12:15], s46 offen
v_permlane32_swap_b32 v12, v13
v_permlane32_swap_b32 v14, v15
v_add_f32 v12, v12, v13
v_add_f32 v14, v14, v15
v_mov_b32 v170, v12
s_nop 0
v_mov_b32_dpp v12, v14 row_ror:8 row_mask:0xf bank_mask:0xc
v_mov_b32_dpp v14, v170 row_ror:8 row_mask:0xf bank_mask:0x3
v_cvt_pk_bf16_f32 v170, v12, v14
v_lshlrev_b32 v171, 16, v170
v_and_b32 v170, 0xffff0000, v170
v_lshlrev_b32 v172, 16, v169
v_and_b32 v173, 0xffff0000, v169
v_mul_f32 v171, v171, v172
v_mul_f32 v170, v170, v173
v_cvt_pk_bf16_f32 v170, v171, v170
v_lshlrev_b32 v171, 16, v170
v_and_b32 v170, 0xffff0000, v170
v_lshlrev_b32 v172, 16, v167
v_and_b32 v173, 0xffff0000, v167
v_add_f32 v171, v171, v172
v_add_f32 v170, v170, v173
v_cvt_pk_bf16_f32 v175, v171, v170
s_add_u32 s46, s49, 10240
buffer_store_dword v175, v7, s[12:15], s46 offen
s_add_u32 s40, s40, 81920
s_add_u32 s49, s49, 40960
s_add_u32 s51, s51, 40960
s_add_u32 s48, s48, 40960
s_cmp_eq_u32 s48, 163840
s_cselect_b32 s48, 0, s48
s_add_u32 s24, s24, 1
s_cmp_eq_u32 s24, 63
s_cbranch_scc1 Lxe_38
s_cmp_le_u32 s24, 2
s_cbranch_scc1 Lpux1_e2
s_waitcnt vmcnt(2)
Lpux1_e3:
s_add_u32 s50, s24, 1
v_cmp_gt_u32 vcc, s50, v176
s_cbranch_vccz Lfa_39
Lpl_41:
buffer_load_dword v1, v161, s[4:7], 0 offen sc1
s_waitcnt vmcnt(0)
v_cmp_gt_u32 vcc, s50, v1
s_cbranch_vccz Lpld_42
s_cmp_eq_u32 s25, 0
s_cbranch_scc1 Lpld_42
s_sub_u32 s25, s25, 1
s_sleep 1
s_branch Lpl_41
Lpld_42:
Lfa_39:
s_add_u32 s50, s24, 4
s_min_u32 s50, s50, 64
s_cmp_lt_u32 s24, 2
s_cbranch_scc1 Lfb_40
v_cmp_gt_u32 vcc, s50, v177
s_cbranch_vccz Lfb_40
Lpl_43:
buffer_load_dword v1, v160, s[4:7], 0 offen sc1
s_waitcnt vmcnt(0)
v_cmp_gt_u32 vcc, s50, v1
s_cbranch_vccz Lpld_44
s_cmp_eq_u32 s25, 0
s_cbranch_scc1 Lpld_44
s_sub_u32 s25, s25, 1
s_sleep 1
s_branch Lpl_43
Lpld_44:
Lfb_40:
s_branch Lpux1_loop
Lxe_38:
s_waitcnt vmcnt(0)
s_endpgm
Lpux1_e0:
s_waitcnt vmcnt(0)
s_branch Lpux1_e1
Lpux1_e2:
s_add_u32 s50, s24, 3
Lpl_45:
buffer_load_dword v1, v160, s[4:7], 0 offen sc1
s_waitcnt vmcnt(0)
v_cmp_gt_u32 vcc, s50, v1
s_cbranch_vccz Lpld_46
s_cmp_eq_u32 s25, 0
s_cbranch_scc1 Lpld_46
s_sub_u32 s25, s25, 1
s_sleep 1
s_branch Lpl_45
Lpld_46:
s_add_u32 s46, s45, s36
s_add_u32 m0, s46, 0
s_add_u32 s47, s44, 0
buffer_load_dwordx4 v2, s[4:7], s47 offen offset:0 sc1 lds
buffer_load_dwordx4 v2, s[4:7], s47 offen offset:1024 sc1 lds
buffer_load_dwordx4 v2, s[4:7], s47 offen offset:2048 sc1 lds
buffer_load_dwordx4 v2, s[4:7], s47 offen offset:3072 sc1 lds
s_add_u32 m0, s46, 4096
s_add_u32 s47, s44, 4096
buffer_load_dwordx4 v2, s[4:7], s47 offen offset:0 sc1 lds
buffer_load_dwordx4 v2, s[4:7], s47 offen offset:1024 sc1 lds
buffer_load_dwordx4 v2, s[4:7], s47 offen offset:2048 sc1 lds
buffer_load_dwordx4 v2, s[4:7], s47 offen offset:3072 sc1 lds
s_add_u32 m0, s46, 8192
s_add_u32 s47, s44, 8192
buffer_load_dwordx4 v2, s[4:7], s47 offen offset:0 sc1 lds
buffer_load_dwordx4 v2, s[4:7], s47 offen offset:1024 sc1 lds
buffer_load_dwordx4 v2, s[4:7], s47 offen offset:2048 sc1 lds
s_add_u32 s44, s44, 1310720
s_add_u32 s45, s45, 40960
s_cmp_eq_u32 s45, 163840
s_cselect_b32 s45, 0, s45
s_waitcnt vmcnt(0)
s_branch Lpux1_e3
Lpx:
s_load_dwordx2 s[8:9], s[0:1], 0
s_mov_b32 s10, 2621440
s_mov_b32 s11, 0x20000
s_load_dwordx2 s[12:13], s[0:1], 88
s_mov_b32 s14, 2621440
s_mov_b32 s15, 0x20000
s_add_u32 s46, s26, 3
s_and_b32 s46, s46, 3
s_mul_i32 s33, s46, 6
s_add_u32 s33, s33, s27
s_sub_u32 s33, s33, 26
s_add_u32 s34, s33, 40
s_mov_b32 s35, s28
s_cmp_lg_u32 s33, 23
s_cbranch_scc1 Lpx_a
s_cmp_lt_u32 s28, 2
s_cbranch_scc1 Lcal
s_lshl_b32 s35, s28, 1
s_sub_u32 s35, s35, 4
Lpx_a:
v_lshlrev_b32 v2, 4, v0
s_lshl_b32 s46, s28, 15
v_add_u32 v3, s46, v2
v_and_b32 v9, 15, v0
v_lshrrev_b32 v10, 4, v0
v_mov_b32 v4, 0x44444444
v_mov_b32 v1, 0xeeeeeeee
v_cmp_lt_u32 vcc, 7, v9
s_nop 1
v_cndmask_b32 v4, v4, v1, vcc
v_and_b32 v11, 1, v10
v_lshlrev_b32 v8, 2, v11
v_lshrrev_b32 v1, 1, v10
v_add_u32 v11, v8, v1
v_lshl_add_u32 v8, v1, 4, v8
v_mov_b32 v12, -1
v_mov_b32 v13, -1
v_mov_b32 v14, -1
v_mov_b32 v15, -1
v_lshrrev_b32 v18, 3, v0
s_lshl_b32 s46, s35, 3
v_add_u32 v18, s46, v18
v_and_b32 v19, 7, v0
v_mul_u32_u24 v16, 1280, v18
v_lshl_add_u32 v16, v19, 4, v16
v_lshlrev_b32 v17, 4, v18
v_and_b32 v20, 1, v19
v_lshl_add_u32 v17, v20, 9, v17
v_lshrrev_b32 v20, 1, v19
v_lshl_add_u32 v17, v20, 10, v17
v_mul_u32_u24 v5, 640, v10
v_lshl_add_u32 v5, v9, 4, v5
v_mul_u32_u24 v6, 1280, v10
v_lshl_add_u32 v6, v9, 3, v6
v_add_u32 v6, 512, v6
v_lshrrev_b32 v20, 3, v9
v_lshl_add_u32 v11, v20, 1, v11
v_and_b32 v8, 7, v9
v_lshrrev_b32 v20, 1, v10
v_lshlrev_b32 v20, 10, v20
v_and_b32 v21, 1, v10
v_lshl_add_u32 v20, v21, 8, v20
v_lshl_add_u32 v3, v9, 4, v20
s_waitcnt lgkmcnt(0)
s_and_b32 s9, s9, 0xffff
s_and_b32 s13, s13, 0xffff
Lpx_ln:
s_mul_i32 s46, s34, 40960
buffer_load_dwordx4 v[20:23], v16, s[8:11], s46 offen offset:0
buffer_load_dwordx4 v[24:27], v16, s[8:11], s46 offen offset:128
buffer_load_dwordx4 v[28:31], v16, s[8:11], s46 offen offset:256
buffer_load_dwordx4 v[32:35], v16, s[8:11], s46 offen offset:384
buffer_load_dwordx4 v[36:39], v16, s[8:11], s46 offen offset:512
buffer_load_dwordx4 v[40:43], v16, s[8:11], s46 offen offset:640
buffer_load_dwordx4 v[44:47], v16, s[8:11], s46 offen offset:768
buffer_load_dwordx4 v[48:51], v16, s[8:11], s46 offen offset:896
buffer_load_dwordx4 v[52:55], v16, s[8:11], s46 offen offset:1024
buffer_load_dwordx4 v[56:59], v16, s[8:11], s46 offen offset:1152
s_waitcnt vmcnt(9)
v_lshlrev_b32 v64, 16, v20
v_and_b32 v65, 0xffff0000, v20
v_lshlrev_b32 v66, 16, v21
v_and_b32 v67, 0xffff0000, v21
v_lshlrev_b32 v68, 16, v22
v_and_b32 v69, 0xffff0000, v22
v_lshlrev_b32 v70, 16, v23
v_and_b32 v71, 0xffff0000, v23
s_waitcnt vmcnt(8)
v_lshlrev_b32 v72, 16, v24
v_and_b32 v73, 0xffff0000, v24
v_lshlrev_b32 v74, 16, v25
v_and_b32 v75, 0xffff0000, v25
v_lshlrev_b32 v76, 16, v26
v_and_b32 v77, 0xffff0000, v26
v_lshlrev_b32 v78, 16, v27
v_and_b32 v79, 0xffff0000, v27
s_waitcnt vmcnt(7)
v_lshlrev_b32 v80, 16, v28
v_and_b32 v81, 0xffff0000, v28
v_lshlrev_b32 v82, 16, v29
v_and_b32 v83, 0xffff0000, v29
v_lshlrev_b32 v84, 16, v30
v_and_b32 v85, 0xffff0000, v30
v_lshlrev_b32 v86, 16, v31
v_and_b32 v87, 0xffff0000, v31
s_waitcnt vmcnt(6)
v_lshlrev_b32 v88, 16, v32
v_and_b32 v89, 0xffff0000, v32
v_lshlrev_b32 v90, 16, v33
v_and_b32 v91, 0xffff0000, v33
v_lshlrev_b32 v92, 16, v34
v_and_b32 v93, 0xffff0000, v34
v_lshlrev_b32 v94, 16, v35
v_and_b32 v95, 0xffff0000, v35
s_waitcnt vmcnt(5)
v_lshlrev_b32 v96, 16, v36
v_and_b32 v97, 0xffff0000, v36
v_lshlrev_b32 v98, 16, v37
v_and_b32 v99, 0xffff0000, v37
v_lshlrev_b32 v100, 16, v38
v_and_b32 v101, 0xffff0000, v38
v_lshlrev_b32 v102, 16, v39
v_and_b32 v103, 0xffff0000, v39
s_waitcnt vmcnt(4)
v_lshlrev_b32 v104, 16, v40
v_and_b32 v105, 0xffff0000, v40
v_lshlrev_b32 v106, 16, v41
v_and_b32 v107, 0xffff0000, v41
v_lshlrev_b32 v108, 16, v42
v_and_b32 v109, 0xffff0000, v42
v_lshlrev_b32 v110, 16, v43
v_and_b32 v111, 0xffff0000, v43
s_waitcnt vmcnt(3)
v_lshlrev_b32 v112, 16, v44
v_and_b32 v113, 0xffff0000, v44
v_lshlrev_b32 v114, 16, v45
v_and_b32 v115, 0xffff0000, v45
v_lshlrev_b32 v116, 16, v46
v_and_b32 v117, 0xffff0000, v46
v_lshlrev_b32 v118, 16, v47
v_and_b32 v119, 0xffff0000, v47
s_waitcnt vmcnt(2)
v_lshlrev_b32 v120, 16, v48
v_and_b32 v121, 0xffff0000, v48
v_lshlrev_b32 v122, 16, v49
v_and_b32 v123, 0xffff0000, v49
v_lshlrev_b32 v124, 16, v50
v_and_b32 v125, 0xffff0000, v50
v_lshlrev_b32 v126, 16, v51
v_and_b32 v127, 0xffff0000, v51
s_waitcnt vmcnt(1)
v_lshlrev_b32 v128, 16, v52
v_and_b32 v129, 0xffff0000, v52
v_lshlrev_b32 v130, 16, v53
v_and_b32 v131, 0xffff0000, v53
v_lshlrev_b32 v132, 16, v54
v_and_b32 v133, 0xffff0000, v54
v_lshlrev_b32 v134, 16, v55
v_and_b32 v135, 0xffff0000, v55
s_waitcnt vmcnt(0)
v_lshlrev_b32 v136, 16, v56
v_and_b32 v137, 0xffff0000, v56
v_lshlrev_b32 v138, 16, v57
v_and_b32 v139, 0xffff0000, v57
v_lshlrev_b32 v140, 16, v58
v_and_b32 v141, 0xffff0000, v58
v_lshlrev_b32 v142, 16, v59
v_and_b32 v143, 0xffff0000, v59
v_pk_add_f32 v[18:19], v[64:65], v[66:67]
v_pk_add_f32 v[18:19], v[18:19], v[68:69]
v_pk_add_f32 v[18:19], v[18:19], v[70:71]
v_pk_add_f32 v[18:19], v[18:19], v[72:73]
v_pk_add_f32 v[18:19], v[18:19], v[74:75]
v_pk_add_f32 v[18:19], v[18:19], v[76:77]
v_pk_add_f32 v[18:19], v[18:19], v[78:79]
v_pk_add_f32 v[18:19], v[18:19], v[80:81]
v_pk_add_f32 v[18:19], v[18:19], v[82:83]
v_pk_add_f32 v[18:19], v[18:19], v[84:85]
v_pk_add_f32 v[18:19], v[18:19], v[86:87]
v_pk_add_f32 v[18:19], v[18:19], v[88:89]
v_pk_add_f32 v[18:19], v[18:19], v[90:91]
v_pk_add_f32 v[18:19], v[18:19], v[92:93]
v_pk_add_f32 v[18:19], v[18:19], v[94:95]
v_pk_add_f32 v[18:19], v[18:19], v[96:97]
v_pk_add_f32 v[18:19], v[18:19], v[98:99]
v_pk_add_f32 v[18:19], v[18:19], v[100:101]
v_pk_add_f32 v[18:19], v[18:19], v[102:103]
v_pk_add_f32 v[18:19], v[18:19], v[104:105]
v_pk_add_f32 v[18:19], v[18:19], v[106:107]
v_pk_add_f32 v[18:19], v[18:19], v[108:109]
v_pk_add_f32 v[18:19], v[18:19], v[110:111]
v_pk_add_f32 v[18:19], v[18:19], v[112:113]
v_pk_add_f32 v[18:19], v[18:19], v[114:115]
v_pk_add_f32 v[18:19], v[18:19], v[116:117]
v_pk_add_f32 v[18:19], v[18:19], v[118:119]
v_pk_add_f32 v[18:19], v[18:19], v[120:121]
v_pk_add_f32 v[18:19], v[18:19], v[122:123]
v_pk_add_f32 v[18:19], v[18:19], v[124:125]
v_pk_add_f32 v[18:19], v[18:19], v[126:127]
v_pk_add_f32 v[18:19], v[18:19], v[128:129]
v_pk_add_f32 v[18:19], v[18:19], v[130:131]
v_pk_add_f32 v[18:19], v[18:19], v[132:133]
v_pk_add_f32 v[18:19], v[18:19], v[134:135]
v_pk_add_f32 v[18:19], v[18:19], v[136:137]
v_pk_add_f32 v[18:19], v[18:19], v[138:139]
v_pk_add_f32 v[18:19], v[18:19], v[140:141]
v_pk_add_f32 v[18:19], v[18:19], v[142:143]
v_add_f32 v18, v18, v19
s_nop 1
v_add_f32_dpp v18, v18, v18 quad_perm:[1,0,3,2] row_mask:0xf bank_mask:0xf
s_nop 1
v_add_f32_dpp v18, v18, v18 quad_perm:[2,3,0,1] row_mask:0xf bank_mask:0xf
s_nop 1
v_add_f32_dpp v18, v18, v18 row_half_mirror row_mask:0xf bank_mask:0xf
v_mul_f32 v18, 0x3acccccd, v18
v_mov_b32 v60, 0
v_mov_b32 v61, 0
v_sub_f32 v62, v64, v18
v_fmac_f32 v60, v62, v62
v_sub_f32 v63, v65, v18
v_fmac_f32 v61, v63, v63
v_sub_f32 v62, v66, v18
v_fmac_f32 v60, v62, v62
v_sub_f32 v63, v67, v18
v_fmac_f32 v61, v63, v63
v_sub_f32 v62, v68, v18
v_fmac_f32 v60, v62, v62
v_sub_f32 v63, v69, v18
v_fmac_f32 v61, v63, v63
v_sub_f32 v62, v70, v18
v_fmac_f32 v60, v62, v62
v_sub_f32 v63, v71, v18
v_fmac_f32 v61, v63, v63
v_sub_f32 v62, v72, v18
v_fmac_f32 v60, v62, v62
v_sub_f32 v63, v73, v18
v_fmac_f32 v61, v63, v63
v_sub_f32 v62, v74, v18
v_fmac_f32 v60, v62, v62
v_sub_f32 v63, v75, v18
v_fmac_f32 v61, v63, v63
v_sub_f32 v62, v76, v18
v_fmac_f32 v60, v62, v62
v_sub_f32 v63, v77, v18
v_fmac_f32 v61, v63, v63
v_sub_f32 v62, v78, v18
v_fmac_f32 v60, v62, v62
v_sub_f32 v63, v79, v18
v_fmac_f32 v61, v63, v63
v_sub_f32 v62, v80, v18
v_fmac_f32 v60, v62, v62
v_sub_f32 v63, v81, v18
v_fmac_f32 v61, v63, v63
v_sub_f32 v62, v82, v18
v_fmac_f32 v60, v62, v62
v_sub_f32 v63, v83, v18
v_fmac_f32 v61, v63, v63
v_sub_f32 v62, v84, v18
v_fmac_f32 v60, v62, v62
v_sub_f32 v63, v85, v18
v_fmac_f32 v61, v63, v63
v_sub_f32 v62, v86, v18
v_fmac_f32 v60, v62, v62
v_sub_f32 v63, v87, v18
v_fmac_f32 v61, v63, v63
v_sub_f32 v62, v88, v18
v_fmac_f32 v60, v62, v62
v_sub_f32 v63, v89, v18
v_fmac_f32 v61, v63, v63
v_sub_f32 v62, v90, v18
v_fmac_f32 v60, v62, v62
v_sub_f32 v63, v91, v18
v_fmac_f32 v61, v63, v63
v_sub_f32 v62, v92, v18
v_fmac_f32 v60, v62, v62
v_sub_f32 v63, v93, v18
v_fmac_f32 v61, v63, v63
v_sub_f32 v62, v94, v18
v_fmac_f32 v60, v62, v62
v_sub_f32 v63, v95, v18
v_fmac_f32 v61, v63, v63
v_sub_f32 v62, v96, v18
v_fmac_f32 v60, v62, v62
v_sub_f32 v63, v97, v18
v_fmac_f32 v61, v63, v63
v_sub_f32 v62, v98, v18
v_fmac_f32 v60, v62, v62
v_sub_f32 v63, v99, v18
v_fmac_f32 v61, v63, v63
v_sub_f32 v62, v100, v18
v_fmac_f32 v60, v62, v62
v_sub_f32 v63, v101, v18
v_fmac_f32 v61, v63, v63
v_sub_f32 v62, v102, v18
v_fmac_f32 v60, v62, v62
v_sub_f32 v63, v103, v18
v_fmac_f32 v61, v63, v63
v_sub_f32 v62, v104, v18
v_fmac_f32 v60, v62, v62
v_sub_f32 v63, v105, v18
v_fmac_f32 v61, v63, v63
v_sub_f32 v62, v106, v18
v_fmac_f32 v60, v62, v62
v_sub_f32 v63, v107, v18
v_fmac_f32 v61, v63, v63
v_sub_f32 v62, v108, v18
v_fmac_f32 v60, v62, v62
v_sub_f32 v63, v109, v18
v_fmac_f32 v61, v63, v63
v_sub_f32 v62, v110, v18
v_fmac_f32 v60, v62, v62
v_sub_f32 v63, v111, v18
v_fmac_f32 v61, v63, v63
v_sub_f32 v62, v112, v18
v_fmac_f32 v60, v62, v62
v_sub_f32 v63, v113, v18
v_fmac_f32 v61, v63, v63
v_sub_f32 v62, v114, v18
v_fmac_f32 v60, v62, v62
v_sub_f32 v63, v115, v18
v_fmac_f32 v61, v63, v63
v_sub_f32 v62, v116, v18
v_fmac_f32 v60, v62, v62
v_sub_f32 v63, v117, v18
v_fmac_f32 v61, v63, v63
v_sub_f32 v62, v118, v18
v_fmac_f32 v60, v62, v62
v_sub_f32 v63, v119, v18
v_fmac_f32 v61, v63, v63
v_sub_f32 v62, v120, v18
v_fmac_f32 v60, v62, v62
v_sub_f32 v63, v121, v18
v_fmac_f32 v61, v63, v63
v_sub_f32 v62, v122, v18
v_fmac_f32 v60, v62, v62
v_sub_f32 v63, v123, v18
v_fmac_f32 v61, v63, v63
v_sub_f32 v62, v124, v18
v_fmac_f32 v60, v62, v62
v_sub_f32 v63, v125, v18
v_fmac_f32 v61, v63, v63
v_sub_f32 v62, v126, v18
v_fmac_f32 v60, v62, v62
v_sub_f32 v63, v127, v18
v_fmac_f32 v61, v63, v63
v_sub_f32 v62, v128, v18
v_fmac_f32 v60, v62, v62
v_sub_f32 v63, v129, v18
v_fmac_f32 v61, v63, v63
v_sub_f32 v62, v130, v18
v_fmac_f32 v60, v62, v62
v_sub_f32 v63, v131, v18
v_fmac_f32 v61, v63, v63
v_sub_f32 v62, v132, v18
v_fmac_f32 v60, v62, v62
v_sub_f32 v63, v133, v18
v_fmac_f32 v61, v63, v63
v_sub_f32 v62, v134, v18
v_fmac_f32 v60, v62, v62
v_sub_f32 v63, v135, v18
v_fmac_f32 v61, v63, v63
v_sub_f32 v62, v136, v18
v_fmac_f32 v60, v62, v62
v_sub_f32 v63, v137, v18
v_fmac_f32 v61, v63, v63
v_sub_f32 v62, v138, v18
v_fmac_f32 v60, v62, v62
v_sub_f32 v63, v139, v18
v_fmac_f32 v61, v63, v63
v_sub_f32 v62, v140, v18
v_fmac_f32 v60, v62, v62
v_sub_f32 v63, v141, v18
v_fmac_f32 v61, v63, v63
v_sub_f32 v62, v142, v18
v_fmac_f32 v60, v62, v62
v_sub_f32 v63, v143, v18
v_fmac_f32 v61, v63, v63
v_add_f32 v60, v60, v61
s_nop 1
v_add_f32_dpp v60, v60, v60 quad_perm:[1,0,3,2] row_mask:0xf bank_mask:0xf
s_nop 1
v_add_f32_dpp v60, v60, v60 quad_perm:[2,3,0,1] row_mask:0xf bank_mask:0xf
s_nop 1
v_add_f32_dpp v60, v60, v60 row_half_mirror row_mask:0xf bank_mask:0xf
v_mul_f32 v60, 0x3acccccd, v60
v_cvt_pk_bf16_f32 v18, v18, v18
v_and_b32 v18, 0xffff0000, v18
v_cvt_pk_bf16_f32 v60, v60, v60
v_and_b32 v60, 0xffff0000, v60
v_add_f32 v60, 0x3727c5ac, v60
v_cvt_pk_bf16_f32 v60, v60, v60
v_and_b32 v60, 0xffff0000, v60
v_sqrt_f32 v60, v60
s_nop 0
v_cvt_pk_bf16_f32 v60, v60, v60
v_and_b32 v60, 0xffff0000, v60
v_rcp_f32 v60, v60
s_add_u32 s46, s46, 7340032
v_sub_f32 v64, v64, v18
v_sub_f32 v65, v65, v18
v_cvt_pk_bf16_f32 v64, v64, v65
v_and_b32 v65, 0xffff0000, v64
v_lshlrev_b32 v64, 16, v64
v_mul_f32 v64, v64, v60
v_mul_f32 v65, v65, v60
v_cvt_pk_bf16_f32 v20, v64, v65
v_sub_f32 v66, v66, v18
v_sub_f32 v67, v67, v18
v_cvt_pk_bf16_f32 v66, v66, v67
v_and_b32 v67, 0xffff0000, v66
v_lshlrev_b32 v66, 16, v66
v_mul_f32 v66, v66, v60
v_mul_f32 v67, v67, v60
v_cvt_pk_bf16_f32 v21, v66, v67
v_sub_f32 v68, v68, v18
v_sub_f32 v69, v69, v18
v_cvt_pk_bf16_f32 v68, v68, v69
v_and_b32 v69, 0xffff0000, v68
v_lshlrev_b32 v68, 16, v68
v_mul_f32 v68, v68, v60
v_mul_f32 v69, v69, v60
v_cvt_pk_bf16_f32 v22, v68, v69
v_sub_f32 v70, v70, v18
v_sub_f32 v71, v71, v18
v_cvt_pk_bf16_f32 v70, v70, v71
v_and_b32 v71, 0xffff0000, v70
v_lshlrev_b32 v70, 16, v70
v_mul_f32 v70, v70, v60
v_mul_f32 v71, v71, v60
v_cvt_pk_bf16_f32 v23, v70, v71
buffer_store_dwordx4 v[20:23], v17, s[4:7], s46 offen sc1
s_add_u32 s46, s46, 4096
v_sub_f32 v72, v72, v18
v_sub_f32 v73, v73, v18
v_cvt_pk_bf16_f32 v72, v72, v73
v_and_b32 v73, 0xffff0000, v72
v_lshlrev_b32 v72, 16, v72
v_mul_f32 v72, v72, v60
v_mul_f32 v73, v73, v60
v_cvt_pk_bf16_f32 v24, v72, v73
v_sub_f32 v74, v74, v18
v_sub_f32 v75, v75, v18
v_cvt_pk_bf16_f32 v74, v74, v75
v_and_b32 v75, 0xffff0000, v74
v_lshlrev_b32 v74, 16, v74
v_mul_f32 v74, v74, v60
v_mul_f32 v75, v75, v60
v_cvt_pk_bf16_f32 v25, v74, v75
v_sub_f32 v76, v76, v18
v_sub_f32 v77, v77, v18
v_cvt_pk_bf16_f32 v76, v76, v77
v_and_b32 v77, 0xffff0000, v76
v_lshlrev_b32 v76, 16, v76
v_mul_f32 v76, v76, v60
v_mul_f32 v77, v77, v60
v_cvt_pk_bf16_f32 v26, v76, v77
v_sub_f32 v78, v78, v18
v_sub_f32 v79, v79, v18
v_cvt_pk_bf16_f32 v78, v78, v79
v_and_b32 v79, 0xffff0000, v78
v_lshlrev_b32 v78, 16, v78
v_mul_f32 v78, v78, v60
v_mul_f32 v79, v79, v60
v_cvt_pk_bf16_f32 v27, v78, v79
buffer_store_dwordx4 v[24:27], v17, s[4:7], s46 offen sc1
s_add_u32 s46, s46, 4096
v_sub_f32 v80, v80, v18
v_sub_f32 v81, v81, v18
v_cvt_pk_bf16_f32 v80, v80, v81
v_and_b32 v81, 0xffff0000, v80
v_lshlrev_b32 v80, 16, v80
v_mul_f32 v80, v80, v60
v_mul_f32 v81, v81, v60
v_cvt_pk_bf16_f32 v28, v80, v81
v_sub_f32 v82, v82, v18
v_sub_f32 v83, v83, v18
v_cvt_pk_bf16_f32 v82, v82, v83
v_and_b32 v83, 0xffff0000, v82
v_lshlrev_b32 v82, 16, v82
v_mul_f32 v82, v82, v60
v_mul_f32 v83, v83, v60
v_cvt_pk_bf16_f32 v29, v82, v83
v_sub_f32 v84, v84, v18
v_sub_f32 v85, v85, v18
v_cvt_pk_bf16_f32 v84, v84, v85
v_and_b32 v85, 0xffff0000, v84
v_lshlrev_b32 v84, 16, v84
v_mul_f32 v84, v84, v60
v_mul_f32 v85, v85, v60
v_cvt_pk_bf16_f32 v30, v84, v85
v_sub_f32 v86, v86, v18
v_sub_f32 v87, v87, v18
v_cvt_pk_bf16_f32 v86, v86, v87
v_and_b32 v87, 0xffff0000, v86
v_lshlrev_b32 v86, 16, v86
v_mul_f32 v86, v86, v60
v_mul_f32 v87, v87, v60
v_cvt_pk_bf16_f32 v31, v86, v87
buffer_store_dwordx4 v[28:31], v17, s[4:7], s46 offen sc1
s_add_u32 s46, s46, 4096
v_sub_f32 v88, v88, v18
v_sub_f32 v89, v89, v18
v_cvt_pk_bf16_f32 v88, v88, v89
v_and_b32 v89, 0xffff0000, v88
v_lshlrev_b32 v88, 16, v88
v_mul_f32 v88, v88, v60
v_mul_f32 v89, v89, v60
v_cvt_pk_bf16_f32 v32, v88, v89
v_sub_f32 v90, v90, v18
v_sub_f32 v91, v91, v18
v_cvt_pk_bf16_f32 v90, v90, v91
v_and_b32 v91, 0xffff0000, v90
v_lshlrev_b32 v90, 16, v90
v_mul_f32 v90, v90, v60
v_mul_f32 v91, v91, v60
v_cvt_pk_bf16_f32 v33, v90, v91
v_sub_f32 v92, v92, v18
v_sub_f32 v93, v93, v18
v_cvt_pk_bf16_f32 v92, v92, v93
v_and_b32 v93, 0xffff0000, v92
v_lshlrev_b32 v92, 16, v92
v_mul_f32 v92, v92, v60
v_mul_f32 v93, v93, v60
v_cvt_pk_bf16_f32 v34, v92, v93
v_sub_f32 v94, v94, v18
v_sub_f32 v95, v95, v18
v_cvt_pk_bf16_f32 v94, v94, v95
v_and_b32 v95, 0xffff0000, v94
v_lshlrev_b32 v94, 16, v94
v_mul_f32 v94, v94, v60
v_mul_f32 v95, v95, v60
v_cvt_pk_bf16_f32 v35, v94, v95
buffer_store_dwordx4 v[32:35], v17, s[4:7], s46 offen sc1
s_add_u32 s46, s46, 4096
v_sub_f32 v96, v96, v18
v_sub_f32 v97, v97, v18
v_cvt_pk_bf16_f32 v96, v96, v97
v_and_b32 v97, 0xffff0000, v96
v_lshlrev_b32 v96, 16, v96
v_mul_f32 v96, v96, v60
v_mul_f32 v97, v97, v60
v_cvt_pk_bf16_f32 v36, v96, v97
v_sub_f32 v98, v98, v18
v_sub_f32 v99, v99, v18
v_cvt_pk_bf16_f32 v98, v98, v99
v_and_b32 v99, 0xffff0000, v98
v_lshlrev_b32 v98, 16, v98
v_mul_f32 v98, v98, v60
v_mul_f32 v99, v99, v60
v_cvt_pk_bf16_f32 v37, v98, v99
v_sub_f32 v100, v100, v18
v_sub_f32 v101, v101, v18
v_cvt_pk_bf16_f32 v100, v100, v101
v_and_b32 v101, 0xffff0000, v100
v_lshlrev_b32 v100, 16, v100
v_mul_f32 v100, v100, v60
v_mul_f32 v101, v101, v60
v_cvt_pk_bf16_f32 v38, v100, v101
v_sub_f32 v102, v102, v18
v_sub_f32 v103, v103, v18
v_cvt_pk_bf16_f32 v102, v102, v103
v_and_b32 v103, 0xffff0000, v102
v_lshlrev_b32 v102, 16, v102
v_mul_f32 v102, v102, v60
v_mul_f32 v103, v103, v60
v_cvt_pk_bf16_f32 v39, v102, v103
buffer_store_dwordx4 v[36:39], v17, s[4:7], s46 offen sc1
s_add_u32 s46, s46, 4096
v_sub_f32 v104, v104, v18
v_sub_f32 v105, v105, v18
v_cvt_pk_bf16_f32 v104, v104, v105
v_and_b32 v105, 0xffff0000, v104
v_lshlrev_b32 v104, 16, v104
v_mul_f32 v104, v104, v60
v_mul_f32 v105, v105, v60
v_cvt_pk_bf16_f32 v40, v104, v105
v_sub_f32 v106, v106, v18
v_sub_f32 v107, v107, v18
v_cvt_pk_bf16_f32 v106, v106, v107
v_and_b32 v107, 0xffff0000, v106
v_lshlrev_b32 v106, 16, v106
v_mul_f32 v106, v106, v60
v_mul_f32 v107, v107, v60
v_cvt_pk_bf16_f32 v41, v106, v107
v_sub_f32 v108, v108, v18
v_sub_f32 v109, v109, v18
v_cvt_pk_bf16_f32 v108, v108, v109
v_and_b32 v109, 0xffff0000, v108
v_lshlrev_b32 v108, 16, v108
v_mul_f32 v108, v108, v60
v_mul_f32 v109, v109, v60
v_cvt_pk_bf16_f32 v42, v108, v109
v_sub_f32 v110, v110, v18
v_sub_f32 v111, v111, v18
v_cvt_pk_bf16_f32 v110, v110, v111
v_and_b32 v111, 0xffff0000, v110
v_lshlrev_b32 v110, 16, v110
v_mul_f32 v110, v110, v60
v_mul_f32 v111, v111, v60
v_cvt_pk_bf16_f32 v43, v110, v111
buffer_store_dwordx4 v[40:43], v17, s[4:7], s46 offen sc1
s_add_u32 s46, s46, 4096
v_sub_f32 v112, v112, v18
v_sub_f32 v113, v113, v18
v_cvt_pk_bf16_f32 v112, v112, v113
v_and_b32 v113, 0xffff0000, v112
v_lshlrev_b32 v112, 16, v112
v_mul_f32 v112, v112, v60
v_mul_f32 v113, v113, v60
v_cvt_pk_bf16_f32 v44, v112, v113
v_sub_f32 v114, v114, v18
v_sub_f32 v115, v115, v18
v_cvt_pk_bf16_f32 v114, v114, v115
v_and_b32 v115, 0xffff0000, v114
v_lshlrev_b32 v114, 16, v114
v_mul_f32 v114, v114, v60
v_mul_f32 v115, v115, v60
v_cvt_pk_bf16_f32 v45, v114, v115
v_sub_f32 v116, v116, v18
v_sub_f32 v117, v117, v18
v_cvt_pk_bf16_f32 v116, v116, v117
v_and_b32 v117, 0xffff0000, v116
v_lshlrev_b32 v116, 16, v116
v_mul_f32 v116, v116, v60
v_mul_f32 v117, v117, v60
v_cvt_pk_bf16_f32 v46, v116, v117
v_sub_f32 v118, v118, v18
v_sub_f32 v119, v119, v18
v_cvt_pk_bf16_f32 v118, v118, v119
v_and_b32 v119, 0xffff0000, v118
v_lshlrev_b32 v118, 16, v118
v_mul_f32 v118, v118, v60
v_mul_f32 v119, v119, v60
v_cvt_pk_bf16_f32 v47, v118, v119
buffer_store_dwordx4 v[44:47], v17, s[4:7], s46 offen sc1
s_add_u32 s46, s46, 4096
v_sub_f32 v120, v120, v18
v_sub_f32 v121, v121, v18
v_cvt_pk_bf16_f32 v120, v120, v121
v_and_b32 v121, 0xffff0000, v120
v_lshlrev_b32 v120, 16, v120
v_mul_f32 v120, v120, v60
v_mul_f32 v121, v121, v60
v_cvt_pk_bf16_f32 v48, v120, v121
v_sub_f32 v122, v122, v18
v_sub_f32 v123, v123, v18
v_cvt_pk_bf16_f32 v122, v122, v123
v_and_b32 v123, 0xffff0000, v122
v_lshlrev_b32 v122, 16, v122
v_mul_f32 v122, v122, v60
v_mul_f32 v123, v123, v60
v_cvt_pk_bf16_f32 v49, v122, v123
v_sub_f32 v124, v124, v18
v_sub_f32 v125, v125, v18
v_cvt_pk_bf16_f32 v124, v124, v125
v_and_b32 v125, 0xffff0000, v124
v_lshlrev_b32 v124, 16, v124
v_mul_f32 v124, v124, v60
v_mul_f32 v125, v125, v60
v_cvt_pk_bf16_f32 v50, v124, v125
v_sub_f32 v126, v126, v18
v_sub_f32 v127, v127, v18
v_cvt_pk_bf16_f32 v126, v126, v127
v_and_b32 v127, 0xffff0000, v126
v_lshlrev_b32 v126, 16, v126
v_mul_f32 v126, v126, v60
v_mul_f32 v127, v127, v60
v_cvt_pk_bf16_f32 v51, v126, v127
buffer_store_dwordx4 v[48:51], v17, s[4:7], s46 offen sc1
s_add_u32 s46, s46, 4096
v_sub_f32 v128, v128, v18
v_sub_f32 v129, v129, v18
v_cvt_pk_bf16_f32 v128, v128, v129
v_and_b32 v129, 0xffff0000, v128
v_lshlrev_b32 v128, 16, v128
v_mul_f32 v128, v128, v60
v_mul_f32 v129, v129, v60
v_cvt_pk_bf16_f32 v52, v128, v129
v_sub_f32 v130, v130, v18
v_sub_f32 v131, v131, v18
v_cvt_pk_bf16_f32 v130, v130, v131
v_and_b32 v131, 0xffff0000, v130
v_lshlrev_b32 v130, 16, v130
v_mul_f32 v130, v130, v60
v_mul_f32 v131, v131, v60
v_cvt_pk_bf16_f32 v53, v130, v131
v_sub_f32 v132, v132, v18
v_sub_f32 v133, v133, v18
v_cvt_pk_bf16_f32 v132, v132, v133
v_and_b32 v133, 0xffff0000, v132
v_lshlrev_b32 v132, 16, v132
v_mul_f32 v132, v132, v60
v_mul_f32 v133, v133, v60
v_cvt_pk_bf16_f32 v54, v132, v133
v_sub_f32 v134, v134, v18
v_sub_f32 v135, v135, v18
v_cvt_pk_bf16_f32 v134, v134, v135
v_and_b32 v135, 0xffff0000, v134
v_lshlrev_b32 v134, 16, v134
v_mul_f32 v134, v134, v60
v_mul_f32 v135, v135, v60
v_cvt_pk_bf16_f32 v55, v134, v135
buffer_store_dwordx4 v[52:55], v17, s[4:7], s46 offen sc1
s_add_u32 s46, s46, 4096
v_sub_f32 v136, v136, v18
v_sub_f32 v137, v137, v18
v_cvt_pk_bf16_f32 v136, v136, v137
v_and_b32 v137, 0xffff0000, v136
v_lshlrev_b32 v136, 16, v136
v_mul_f32 v136, v136, v60
v_mul_f32 v137, v137, v60
v_cvt_pk_bf16_f32 v56, v136, v137
v_sub_f32 v138, v138, v18
v_sub_f32 v139, v139, v18
v_cvt_pk_bf16_f32 v138, v138, v139
v_and_b32 v139, 0xffff0000, v138
v_lshlrev_b32 v138, 16, v138
v_mul_f32 v138, v138, v60
v_mul_f32 v139, v139, v60
v_cvt_pk_bf16_f32 v57, v138, v139
v_sub_f32 v140, v140, v18
v_sub_f32 v141, v141, v18
v_cvt_pk_bf16_f32 v140, v140, v141
v_and_b32 v141, 0xffff0000, v140
v_lshlrev_b32 v140, 16, v140
v_mul_f32 v140, v140, v60
v_mul_f32 v141, v141, v60
v_cvt_pk_bf16_f32 v58, v140, v141
v_sub_f32 v142, v142, v18
v_sub_f32 v143, v143, v18
v_cvt_pk_bf16_f32 v142, v142, v143
v_and_b32 v143, 0xffff0000, v142
v_lshlrev_b32 v142, 16, v142
v_mul_f32 v142, v142, v60
v_mul_f32 v143, v143, v60
v_cvt_pk_bf16_f32 v59, v142, v143
buffer_store_dwordx4 v[56:59], v17, s[4:7], s46 offen sc1
s_add_u32 s46, s46, 4096
s_cmp_lg_u32 s33, 23
s_cbranch_scc1 Lpx_b
v_add_u32 v16, 10240, v16
v_add_u32 v17, 128, v17
s_xor_b32 s35, s35, 1
s_bitcmp1_b32 s35, 0
s_cbranch_scc1 Lpx_ln
s_waitcnt vmcnt(0)
v_mov_b32 v1, 1
s_mov_b64 exec, 1
buffer_atomic_add v1, off, s[20:23], 0 sc1
s_endpgm
Lpx_b:
s_waitcnt vmcnt(0)
s_barrier
s_cmp_lg_u32 s28, 0
s_cbranch_scc1 Larr_47
v_mov_b32 v1, 1
s_mov_b64 exec, 1
buffer_atomic_add v1, off, s[20:23], 0 sc1
s_mov_b64 exec, -1
Larr_47:
s_cmp_lt_u32 s27, 31
s_cbranch_scc1 Lxw
s_endpgm
Lxw:
s_mul_i32 s33, s26, 5
s_add_u32 s33, s33, s27
s_sub_u32 s33, s33, 26
s_lshl_b32 s33, s33, 1
s_lshr_b32 s46, s33, 3
s_sub_u32 s47, s33, 32
s_lshr_b32 s47, s47, 2
s_lshl_b32 s47, s47, 1
s_add_u32 s48, s47, 1
s_cmp_lt_u32 s33, 32
s_cselect_b32 s47, s46, s47
s_cselect_b32 s48, s46, s48
s_lshl_b32 s47, s47, 12
s_lshl_b32 s48, s48, 12
v_mov_b32 v16, s47
v_mov_b32 v17, s48
v_cmp_gt_u32 vcc, 32, v0
s_nop 1
v_cndmask_b32 v16, v17, v16, vcc
v_and_b32 v17, 31, v0
v_lshl_add_u32 v16, v17, 7, v16
v_add_u32 v160, 65536, v16
v_and_b32 v16, 1, v0
v_add_u32 v16, s33, v16
v_lshlrev_b32 v17, 7, v16
v_add_u32 v165, 98304, v17
v_add_u32 v161, 90112, v17
v_min_u32 v16, 31, v0
s_lshl_b32 s46, s33, 14
s_add_u32 s46, s46, 397312
v_lshl_add_u32 v164, v16, 7, s46
v_mul_u32_u24 v7, 1280, v11
v_lshl_add_u32 v7, v8, 2, v7
s_lshl_b32 s46, s33, 5
v_add_u32 v7, s46, v7
v_lshlrev_b32 v162, 5, v11
v_lshl_add_u32 v162, v8, 2, v162
s_mul_i32 s40, s28, 20480
s_add_u32 s40, s40, 184344576
s_add_u32 s41, s40, 5120
s_add_u32 s42, s40, 10240
s_add_u32 s43, s40, 15360
s_mul_i32 s49, s28, 10240
s_add_u32 s49, s49, 2580480
s_lshl_b32 s51, s28, 8
s_lshl_b32 s46, s33, 10
s_add_u32 s51, s51, s46
s_add_u32 s51, s51, 179142656
s_lshl_b32 s44, s33, 15
s_lshl_b32 s46, s28, 14
s_add_u32 s44, s44, s46
s_add_u32 s44, s44, 168861696
s_lshr_b32 s46, s28, 1
s_mul_i32 s46, s46, 40960
s_and_b32 s47, s28, 1
s_lshl_b32 s36, s47, 14
s_add_u32 s36, s36, s46
s_xor_b32 s47, s47, 1
s_add_u32 s52, s33, s47
s_lshl_b32 s52, s52, 14
s_mul_i32 s37, s47, 40960
v_add_u32 v0, 32768, v2
v_add_u32 v163, s37, v0
v_add_u32 v130, 40960, v3
v_add_u32 v131, 40960, v0
s_cmp_lg_u32 s28, 0
s_cbranch_scc1 Lgwd_49
Lgw_48:
buffer_load_dwordx2 v[18:19], off, s[20:23], 0 sc1
s_waitcnt vmcnt(0)
v_cmp_gt_u32 vcc, 255, v18
v_mov_b32 v18, v19
v_and_b32 v19, 0xffff, v19
v_cmp_gt_u32_e64 s[46:47], 2, v19
s_or_b64 vcc, vcc, s[46:47]
s_cbranch_vccz Lgwe_50
s_cmp_eq_u32 s25, 0
s_cbranch_scc1 Lgwe_50
s_sub_u32 s25, s25, 1
s_sleep 4
s_branch Lgw_48
Lgwe_50:
v_mov_b32 v19, 163836
ds_write_b32 v19, v18
s_waitcnt lgkmcnt(0)
Lgwd_49:
s_barrier
v_mov_b32 v19, 163836
ds_read_b32 v18, v19
s_waitcnt lgkmcnt(0)
v_readfirstlane_b32 s46, v18
s_bfe_u32 s47, s46, 0x10010
s_lshl_b32 s47, s47, 13
s_add_u32 s88, s88, s47
s_bfe_u32 s47, s46, 0x10011
s_lshl_b32 s47, s47, 13
s_add_u32 s89, s89, s47
s_add_u32 s52, s52, s88
s_add_u32 s52, s52, 0
s_add_u32 s53, s52, 4096
s_cmp_lg_u32 s28, 0
s_cbranch_scc1 Ltw_a
s_mov_b32 s50, 57
Lpl_51:
buffer_load_dword v1, v165, s[4:7], 0 offen sc1
s_waitcnt vmcnt(0)
v_cmp_gt_u32 vcc, s50, v1
s_cbranch_vccz Lpld_52
s_cmp_eq_u32 s25, 0
s_cbranch_scc1 Lpld_52
s_sub_u32 s25, s25, 1
s_sleep 32
s_branch Lpl_51
Lpld_52:
s_cmp_lg_u32 s28, 0
s_cbranch_scc1 Ltw_a
s_mov_b32 s50, 64
Lpl_53:
buffer_load_dword v1, v160, s[4:7], 0 offen sc1
s_waitcnt vmcnt(0)
v_cmp_gt_u32 vcc, s50, v1
s_cbranch_vccz Lpld_54
s_cmp_eq_u32 s25, 0
s_cbranch_scc1 Lpld_54
s_sub_u32 s25, s25, 1
s_sleep 8
s_branch Lpl_53
Lpld_54:
Lpl_55:
buffer_load_dword v1, v161, s[4:7], 0 offen sc1
s_waitcnt vmcnt(0)
v_cmp_gt_u32 vcc, s50, v1
s_cbranch_vccz Lpld_56
s_cmp_eq_u32 s25, 0
s_cbranch_scc1 Lpld_56
s_sub_u32 s25, s25, 1
s_sleep 8
s_branch Lpl_55
Lpld_56:
Ltw_a:
s_barrier
s_add_u32 m0, s36, 0
s_add_u32 s47, s44, 0
buffer_load_dwordx4 v2, s[4:7], s47 offen offset:0 sc1 lds
buffer_load_dwordx4 v2, s[4:7], s47 offen offset:1024 sc1 lds
buffer_load_dwordx4 v2, s[4:7], s47 offen offset:2048 sc1 lds
buffer_load_dwordx4 v2, s[4:7], s47 offen offset:3072 sc1 lds
s_add_u32 m0, s36, 4096
s_add_u32 s47, s44, 4096
buffer_load_dwordx4 v2, s[4:7], s47 offen offset:0 sc1 lds
buffer_load_dwordx4 v2, s[4:7], s47 offen offset:1024 sc1 lds
buffer_load_dwordx4 v2, s[4:7], s47 offen offset:2048 sc1 lds
buffer_load_dwordx4 v2, s[4:7], s47 offen offset:3072 sc1 lds
s_add_u32 m0, s36, 8192
s_add_u32 s47, s44, 8192
buffer_load_dwordx4 v2, s[4:7], s47 offen offset:0 sc1 lds
buffer_load_dwordx4 v2, s[4:7], s47 offen offset:1024 sc1 lds
buffer_load_dwordx4 v2, s[4:7], s47 offen offset:2048 sc1 lds
buffer_load_dwordx4 v2, s[4:7], s47 offen offset:3072 sc1 lds
s_add_u32 m0, s36, 12288
s_add_u32 s47, s44, 12288
buffer_load_dwordx4 v2, s[4:7], s47 offen offset:0 sc1 lds
buffer_load_dwordx4 v2, s[4:7], s47 offen offset:1024 sc1 lds
buffer_load_dwordx4 v2, s[4:7], s47 offen offset:2048 sc1 lds
buffer_load_dwordx4 v2, s[4:7], s47 offen offset:3072 sc1 lds
buffer_load_dword v166, v7, s[8:11], s49 offen offset:0
buffer_load_dword v168, v162, s[4:7], s51 offen offset:0 sc1
buffer_load_dword v167, v7, s[8:11], s49 offen offset:32
buffer_load_dword v169, v162, s[4:7], s51 offen offset:1024 sc1
s_waitcnt vmcnt(0)
s_barrier
ds_read_b128 a[0:3], v3 offset:0
ds_read_b128 a[4:7], v3 offset:2048
ds_read_b128 a[8:11], v130 offset:0
ds_read_b128 a[12:15], v130 offset:2048
s_waitcnt lgkmcnt(4)
ds_read_b128 a[16:19], v3 offset:512
ds_read_b128 a[20:23], v3 offset:2560
ds_read_b128 a[24:27], v130 offset:512
ds_read_b128 a[28:31], v130 offset:2560
s_waitcnt lgkmcnt(4)
ds_read_b128 a[32:35], v3 offset:4096
ds_read_b128 a[36:39], v3 offset:6144
ds_read_b128 a[40:43], v130 offset:4096
ds_read_b128 a[44:47], v130 offset:6144
s_waitcnt lgkmcnt(4)
ds_read_b128 a[48:51], v3 offset:4608
ds_read_b128 a[52:55], v3 offset:6656
ds_read_b128 a[56:59], v130 offset:4608
ds_read_b128 a[60:63], v130 offset:6656
s_waitcnt lgkmcnt(4)
ds_read_b128 a[64:67], v3 offset:8192
ds_read_b128 a[68:71], v3 offset:10240
ds_read_b128 a[72:75], v130 offset:8192
ds_read_b128 a[76:79], v130 offset:10240
s_waitcnt lgkmcnt(4)
ds_read_b128 a[80:83], v3 offset:8704
ds_read_b128 a[84:87], v3 offset:10752
ds_read_b128 a[88:91], v130 offset:8704
ds_read_b128 a[92:95], v130 offset:10752
s_waitcnt lgkmcnt(4)
ds_read_b128 a[96:99], v3 offset:12288
ds_read_b128 a[100:103], v3 offset:14336
ds_read_b128 a[104:107], v130 offset:12288
ds_read_b128 a[108:111], v130 offset:14336
s_waitcnt lgkmcnt(4)
ds_read_b128 a[112:115], v3 offset:12800
ds_read_b128 a[116:119], v3 offset:14848
ds_read_b128 a[120:123], v130 offset:12800
ds_read_b128 a[124:127], v130 offset:14848
s_waitcnt lgkmcnt(4)
ds_read_b128 a[128:131], v3 offset:16384
ds_read_b128 a[132:135], v3 offset:18432
ds_read_b128 a[136:139], v130 offset:16384
ds_read_b128 a[140:143], v130 offset:18432
s_waitcnt lgkmcnt(4)
ds_read_b128 a[144:147], v3 offset:16896
ds_read_b128 a[148:151], v3 offset:18944
ds_read_b128 a[152:155], v130 offset:16896
ds_read_b128 a[156:159], v130 offset:18944
s_waitcnt lgkmcnt(4)
ds_read_b128 a[160:163], v3 offset:20480
ds_read_b128 a[164:167], v3 offset:22528
ds_read_b128 a[168:171], v130 offset:20480
ds_read_b128 a[172:175], v130 offset:22528
s_waitcnt lgkmcnt(4)
ds_read_b128 a[176:179], v3 offset:20992
ds_read_b128 a[180:183], v3 offset:23040
ds_read_b128 a[184:187], v130 offset:20992
ds_read_b128 a[188:191], v130 offset:23040
s_waitcnt lgkmcnt(4)
ds_read_b128 a[192:195], v3 offset:24576
ds_read_b128 a[196:199], v3 offset:26624
ds_read_b128 a[200:203], v130 offset:24576
ds_read_b128 a[204:207], v130 offset:26624
s_waitcnt lgkmcnt(4)
ds_read_b128 a[208:211], v3 offset:25088
ds_read_b128 a[212:215], v3 offset:27136
ds_read_b128 a[216:219], v130 offset:25088
ds_read_b128 a[220:223], v130 offset:27136
s_waitcnt lgkmcnt(4)
ds_read_b128 a[224:227], v3 offset:28672
ds_read_b128 a[228:231], v3 offset:30720
ds_read_b128 a[232:235], v130 offset:28672
ds_read_b128 a[236:239], v130 offset:30720
s_waitcnt lgkmcnt(4)
ds_read_b128 a[240:243], v3 offset:29184
ds_read_b128 a[244:247], v3 offset:31232
ds_read_b128 a[248:251], v130 offset:29184
ds_read_b128 a[252:255], v130 offset:31232
s_waitcnt lgkmcnt(4)
s_cmp_lg_u32 s28, 0
s_cbranch_scc1 Ltw_b
s_mov_b32 s50, 62
Lpl_57:
buffer_load_dword v1, v165, s[4:7], 0 offen sc1
s_waitcnt vmcnt(0)
v_cmp_gt_u32 vcc, s50, v1
s_cbranch_vccz Lpld_58
s_cmp_eq_u32 s25, 0
s_cbranch_scc1 Lpld_58
s_sub_u32 s25, s25, 1
s_sleep 12
s_branch Lpl_57
Lpld_58:
Ltw_b:
s_barrier
s_cmp_eq_u32 s28, 0
s_cbranch_scc1 Ltw_c
s_cmp_eq_u32 s28, 3
s_cbranch_scc1 Ltw_d
Ltw_um:
buffer_load_dwordx4 v[96:99], v2, s[4:7], s52 offen offset:0 sc1
buffer_load_dwordx4 v[100:103], v2, s[4:7], s52 offen offset:1024 sc1
buffer_load_dwordx4 v[104:107], v2, s[4:7], s52 offen offset:2048 sc1
buffer_load_dwordx4 v[108:111], v2, s[4:7], s52 offen offset:3072 sc1
buffer_load_dwordx4 v[112:115], v2, s[4:7], s53 offen offset:0 sc1
buffer_load_dwordx4 v[116:119], v2, s[4:7], s53 offen offset:1024 sc1
buffer_load_dwordx4 v[120:123], v2, s[4:7], s53 offen offset:2048 sc1
buffer_load_dwordx4 v[124:127], v2, s[4:7], s53 offen offset:3072 sc1
v_mov_b32 v129, 0
s_waitcnt vmcnt(0)
v_max3_u32 v129, v129, v96, v98
v_max3_u32 v129, v129, v100, v102
v_max3_u32 v129, v129, v104, v106
v_max3_u32 v129, v129, v108, v110
v_max3_u32 v129, v129, v112, v114
v_max3_u32 v129, v129, v116, v118
v_max3_u32 v129, v129, v120, v122
v_max3_u32 v129, v129, v124, v126
v_cmp_eq_u32 vcc, -1, v129
s_cbranch_vccz Ltw_uok
s_cmp_eq_u32 s25, 0
s_cbranch_scc1 Ltw_uok
s_sub_u32 s25, s25, 1
s_sleep 8
s_branch Ltw_um
Ltw_uok:
ds_write_b128 v163, v[96:99] offset:0
ds_write_b128 v163, v[100:103] offset:1024
ds_write_b128 v163, v[104:107] offset:2048
ds_write_b128 v163, v[108:111] offset:3072
ds_write_b128 v163, v[112:115] offset:4096
ds_write_b128 v163, v[116:119] offset:5120
ds_write_b128 v163, v[120:123] offset:6144
ds_write_b128 v163, v[124:127] offset:7168
s_waitcnt lgkmcnt(0)
s_branch Ltw_d
Ltw_c:
s_mov_b32 s50, 1
Ltw5_gate:
buffer_load_dword v1, v164, s[4:7], s89 offen sc1
s_waitcnt vmcnt(0)
v_cmp_gt_u32 vcc, s50, v1
s_cbranch_vccz Ltw5_open
s_mov_b64 exec, vcc
s_cmp_eq_u32 s25, 0
s_cbranch_scc1 Ltw5_open
s_sub_u32 s25, s25, 1
s_branch Ltw5_gate
Ltw5_open:
s_mov_b64 exec, -1
Ltw_d:
s_barrier
s_cmp_lt_u32 s28, 2
s_cbranch_scc1 Ltw1
Ltw2:
buffer_load_dwordx2 v[80:81], v6, s[4:7], s40 offen offset:0 sc1
buffer_load_dwordx2 v[82:83], v6, s[4:7], s40 offen offset:640 sc1
buffer_load_dwordx2 v[84:85], v6, s[4:7], s41 offen offset:0 sc1
buffer_load_dwordx2 v[86:87], v6, s[4:7], s41 offen offset:640 sc1
buffer_load_dwordx2 v[88:89], v6, s[4:7], s42 offen offset:0 sc1
buffer_load_dwordx2 v[90:91], v6, s[4:7], s42 offen offset:640 sc1
buffer_load_dwordx2 v[92:93], v6, s[4:7], s43 offen offset:0 sc1
buffer_load_dwordx2 v[94:95], v6, s[4:7], s43 offen offset:640 sc1
buffer_load_dwordx4 v[16:19], v5, s[4:7], s40 offen offset:0 sc1
buffer_load_dwordx4 v[20:23], v5, s[4:7], s40 offen offset:256 sc1
buffer_load_dwordx4 v[24:27], v5, s[4:7], s40 offen offset:2560 sc1
buffer_load_dwordx4 v[28:31], v5, s[4:7], s40 offen offset:2816 sc1
buffer_load_dwordx4 v[32:35], v5, s[4:7], s41 offen offset:0 sc1
buffer_load_dwordx4 v[36:39], v5, s[4:7], s41 offen offset:256 sc1
buffer_load_dwordx4 v[40:43], v5, s[4:7], s41 offen offset:2560 sc1
buffer_load_dwordx4 v[44:47], v5, s[4:7], s41 offen offset:2816 sc1
buffer_load_dwordx4 v[48:51], v5, s[4:7], s42 offen offset:0 sc1
buffer_load_dwordx4 v[52:55], v5, s[4:7], s42 offen offset:256 sc1
buffer_load_dwordx4 v[56:59], v5, s[4:7], s42 offen offset:2560 sc1
buffer_load_dwordx4 v[60:63], v5, s[4:7], s42 offen offset:2816 sc1
buffer_load_dwordx4 v[64:67], v5, s[4:7], s43 offen offset:0 sc1
buffer_load_dwordx4 v[68:71], v5, s[4:7], s43 offen offset:256 sc1
buffer_load_dwordx4 v[72:75], v5, s[4:7], s43 offen offset:2560 sc1
buffer_load_dwordx4 v[76:79], v5, s[4:7], s43 offen offset:2816 sc1
ds_read_b128 v[176:179], v0 offset:0
ds_read_b128 v[180:183], v0 offset:1024
ds_read_b128 v[184:187], v131 offset:0
ds_read_b128 v[188:191], v131 offset:1024
ds_read_b128 v[192:195], v0 offset:2048
ds_read_b128 v[196:199], v0 offset:3072
ds_read_b128 v[200:203], v131 offset:2048
ds_read_b128 v[204:207], v131 offset:3072
ds_read_b128 v[208:211], v0 offset:4096
ds_read_b128 v[212:215], v0 offset:5120
ds_read_b128 v[216:219], v131 offset:4096
ds_read_b128 v[220:223], v131 offset:5120
ds_read_b128 v[224:227], v0 offset:6144
ds_read_b128 v[228:231], v0 offset:7168
ds_read_b128 v[232:235], v131 offset:6144
ds_read_b128 v[236:239], v131 offset:7168
v_mov_b32 v8, 0
v_mov_b32 v9, 0
v_mov_b32 v10, 0
v_mov_b32 v11, 0
v_mov_b32 v12, 0
v_mov_b32 v13, 0
v_mov_b32 v14, 0
v_mov_b32 v15, 0
v_mov_b32 v128, 0
s_waitcnt lgkmcnt(0)
s_waitcnt vmcnt(22)
v_smfmac_f32_16x16x64_bf16 v[8:11], v[80:83], v[176:183], v4
v_smfmac_f32_16x16x64_bf16 v[12:15], v[80:83], v[184:191], v4
v_or3_b32 v128, v128, v80, v81
v_or3_b32 v128, v128, v82, v83
s_waitcnt vmcnt(20)
v_smfmac_f32_16x16x64_bf16 v[8:11], v[84:87], v[192:199], v4
v_smfmac_f32_16x16x64_bf16 v[12:15], v[84:87], v[200:207], v4
v_or3_b32 v128, v128, v84, v85
v_or3_b32 v128, v128, v86, v87
s_waitcnt vmcnt(18)
v_smfmac_f32_16x16x64_bf16 v[8:11], v[88:91], v[208:215], v4
v_smfmac_f32_16x16x64_bf16 v[12:15], v[88:91], v[216:223], v4
v_or3_b32 v128, v128, v88, v89
v_or3_b32 v128, v128, v90, v91
s_waitcnt vmcnt(16)
v_smfmac_f32_16x16x64_bf16 v[8:11], v[92:95], v[224:231], v4
v_smfmac_f32_16x16x64_bf16 v[12:15], v[92:95], v[232:239], v4
v_or3_b32 v128, v128, v92, v93
v_or3_b32 v128, v128, v94, v95
s_waitcnt vmcnt(15)
v_smfmac_f32_16x16x64_bf16 v[8:11], v[16:19], a[0:7], v4
v_smfmac_f32_16x16x64_bf16 v[12:15], v[16:19], a[8:15], v4
v_or3_b32 v128, v128, v16, v17
v_or3_b32 v128, v128, v18, v19
s_waitcnt vmcnt(14)
v_smfmac_f32_16x16x64_bf16 v[8:11], v[20:23], a[16:23], v4
v_smfmac_f32_16x16x64_bf16 v[12:15], v[20:23], a[24:31], v4
v_or3_b32 v128, v128, v20, v21
v_or3_b32 v128, v128, v22, v23
s_waitcnt vmcnt(13)
v_smfmac_f32_16x16x64_bf16 v[8:11], v[24:27], a[32:39], v4
v_smfmac_f32_16x16x64_bf16 v[12:15], v[24:27], a[40:47], v4
v_or3_b32 v128, v128, v24, v25
v_or3_b32 v128, v128, v26, v27
s_waitcnt vmcnt(12)
v_smfmac_f32_16x16x64_bf16 v[8:11], v[28:31], a[48:55], v4
v_smfmac_f32_16x16x64_bf16 v[12:15], v[28:31], a[56:63], v4
v_or3_b32 v128, v128, v28, v29
v_or3_b32 v128, v128, v30, v31
s_waitcnt vmcnt(11)
v_smfmac_f32_16x16x64_bf16 v[8:11], v[32:35], a[64:71], v4
v_smfmac_f32_16x16x64_bf16 v[12:15], v[32:35], a[72:79], v4
v_or3_b32 v128, v128, v32, v33
v_or3_b32 v128, v128, v34, v35
s_waitcnt vmcnt(10)
v_smfmac_f32_16x16x64_bf16 v[8:11], v[36:39], a[80:87], v4
v_smfmac_f32_16x16x64_bf16 v[12:15], v[36:39], a[88:95], v4
v_or3_b32 v128, v128, v36, v37
v_or3_b32 v128, v128, v38, v39
s_waitcnt vmcnt(9)
v_smfmac_f32_16x16x64_bf16 v[8:11], v[40:43], a[96:103], v4
v_smfmac_f32_16x16x64_bf16 v[12:15], v[40:43], a[104:111], v4
v_or3_b32 v128, v128, v40, v41
v_or3_b32 v128, v128, v42, v43
s_waitcnt vmcnt(8)
v_smfmac_f32_16x16x64_bf16 v[8:11], v[44:47], a[112:119], v4
v_smfmac_f32_16x16x64_bf16 v[12:15], v[44:47], a[120:127], v4
v_or3_b32 v128, v128, v44, v45
v_or3_b32 v128, v128, v46, v47
s_waitcnt vmcnt(7)
v_smfmac_f32_16x16x64_bf16 v[8:11], v[48:51], a[128:135], v4
v_smfmac_f32_16x16x64_bf16 v[12:15], v[48:51], a[136:143], v4
v_or3_b32 v128, v128, v48, v49
v_or3_b32 v128, v128, v50, v51
s_waitcnt vmcnt(6)
v_smfmac_f32_16x16x64_bf16 v[8:11], v[52:55], a[144:151], v4
v_smfmac_f32_16x16x64_bf16 v[12:15], v[52:55], a[152:159], v4
v_or3_b32 v128, v128, v52, v53
v_or3_b32 v128, v128, v54, v55
s_waitcnt vmcnt(5)
v_smfmac_f32_16x16x64_bf16 v[8:11], v[56:59], a[160:167], v4
v_smfmac_f32_16x16x64_bf16 v[12:15], v[56:59], a[168:175], v4
v_or3_b32 v128, v128, v56, v57
v_or3_b32 v128, v128, v58, v59
s_waitcnt vmcnt(4)
v_smfmac_f32_16x16x64_bf16 v[8:11], v[60:63], a[176:183], v4
v_smfmac_f32_16x16x64_bf16 v[12:15], v[60:63], a[184:191], v4
v_or3_b32 v128, v128, v60, v61
v_or3_b32 v128, v128, v62, v63
s_waitcnt vmcnt(3)
v_smfmac_f32_16x16x64_bf16 v[8:11], v[64:67], a[192:199], v4
v_smfmac_f32_16x16x64_bf16 v[12:15], v[64:67], a[200:207], v4
v_or3_b32 v128, v128, v64, v65
v_or3_b32 v128, v128, v66, v67
s_waitcnt vmcnt(2)
v_smfmac_f32_16x16x64_bf16 v[8:11], v[68:71], a[208:215], v4
v_smfmac_f32_16x16x64_bf16 v[12:15], v[68:71], a[216:223], v4
v_or3_b32 v128, v128, v68, v69
v_or3_b32 v128, v128, v70, v71
s_waitcnt vmcnt(1)
v_smfmac_f32_16x16x64_bf16 v[8:11], v[72:75], a[224:231], v4
v_smfmac_f32_16x16x64_bf16 v[12:15], v[72:75], a[232:239], v4
v_or3_b32 v128, v128, v72, v73
v_or3_b32 v128, v128, v74, v75
s_waitcnt vmcnt(0)
v_smfmac_f32_16x16x64_bf16 v[8:11], v[76:79], a[240:247], v4
v_smfmac_f32_16x16x64_bf16 v[12:15], v[76:79], a[248:255], v4
v_or3_b32 v128, v128, v76, v77
v_or3_b32 v128, v128, v78, v79
v_and_b32 v128, 0x80008000, v128
v_cmp_ne_u32 vcc, 0, v128
s_cbranch_vccnz Ltw2_re
Ltw2_ok:
s_nop 3
v_permlane32_swap_b32 v8, v9
v_permlane32_swap_b32 v10, v11
v_add_f32 v8, v8, v9
v_add_f32 v10, v10, v11
v_mov_b32 v170, v8
s_nop 0
v_mov_b32_dpp v8, v10 row_ror:8 row_mask:0xf bank_mask:0xc
v_mov_b32_dpp v10, v170 row_ror:8 row_mask:0xf bank_mask:0x3
v_cvt_pk_bf16_f32 v170, v8, v10
v_lshlrev_b32 v171, 16, v170
v_and_b32 v170, 0xffff0000, v170
v_lshlrev_b32 v172, 16, v168
v_and_b32 v173, 0xffff0000, v168
v_mul_f32 v171, v171, v172
v_mul_f32 v170, v170, v173
v_cvt_pk_bf16_f32 v170, v171, v170
v_lshlrev_b32 v171, 16, v170
v_and_b32 v170, 0xffff0000, v170
v_lshlrev_b32 v172, 16, v166
v_and_b32 v173, 0xffff0000, v166
v_add_f32 v171, v171, v172
v_add_f32 v170, v170, v173
v_cvt_pk_bf16_f32 v174, v171, v170
buffer_store_dword v174, v7, s[12:15], s49 offen offset:0
v_permlane32_swap_b32 v12, v13
v_permlane32_swap_b32 v14, v15
v_add_f32 v12, v12, v13
v_add_f32 v14, v14, v15
v_mov_b32 v170, v12
s_nop 0
v_mov_b32_dpp v12, v14 row_ror:8 row_mask:0xf bank_mask:0xc
v_mov_b32_dpp v14, v170 row_ror:8 row_mask:0xf bank_mask:0x3
v_cvt_pk_bf16_f32 v170, v12, v14
v_lshlrev_b32 v171, 16, v170
v_and_b32 v170, 0xffff0000, v170
v_lshlrev_b32 v172, 16, v169
v_and_b32 v173, 0xffff0000, v169
v_mul_f32 v171, v171, v172
v_mul_f32 v170, v170, v173
v_cvt_pk_bf16_f32 v170, v171, v170
v_lshlrev_b32 v171, 16, v170
v_and_b32 v170, 0xffff0000, v170
v_lshlrev_b32 v172, 16, v167
v_and_b32 v173, 0xffff0000, v167
v_add_f32 v171, v171, v172
v_add_f32 v170, v170, v173
v_cvt_pk_bf16_f32 v175, v171, v170
buffer_store_dword v175, v7, s[12:15], s49 offen offset:32
s_endpgm
Ltw2_re:
s_cmp_eq_u32 s25, 0
s_cbranch_scc1 Ltw2_ok
s_sub_u32 s25, s25, 1
s_branch Ltw2
Ltw1:
buffer_load_dwordx2 v[80:81], v6, s[4:7], s40 offen offset:0 sc1
buffer_load_dwordx2 v[82:83], v6, s[4:7], s40 offen offset:640 sc1
buffer_load_dwordx2 v[84:85], v6, s[4:7], s41 offen offset:0 sc1
buffer_load_dwordx2 v[86:87], v6, s[4:7], s41 offen offset:640 sc1
buffer_load_dwordx2 v[88:89], v6, s[4:7], s42 offen offset:0 sc1
buffer_load_dwordx2 v[90:91], v6, s[4:7], s42 offen offset:640 sc1
buffer_load_dwordx2 v[92:93], v6, s[4:7], s43 offen offset:0 sc1
buffer_load_dwordx2 v[94:95], v6, s[4:7], s43 offen offset:640 sc1
buffer_load_dwordx4 v[16:19], v5, s[4:7], s40 offen offset:0 sc1
buffer_load_dwordx4 v[20:23], v5, s[4:7], s40 offen offset:2560 sc1
buffer_load_dwordx4 v[24:27], v5, s[4:7], s41 offen offset:0 sc1
buffer_load_dwordx4 v[28:31], v5, s[4:7], s41 offen offset:2560 sc1
buffer_load_dwordx4 v[32:35], v5, s[4:7], s42 offen offset:0 sc1
buffer_load_dwordx4 v[36:39], v5, s[4:7], s42 offen offset:2560 sc1
buffer_load_dwordx4 v[40:43], v5, s[4:7], s43 offen offset:0 sc1
buffer_load_dwordx4 v[44:47], v5, s[4:7], s43 offen offset:2560 sc1
ds_read_b128 v[176:179], v0 offset:0
ds_read_b128 v[180:183], v0 offset:1024
ds_read_b128 v[184:187], v131 offset:0
ds_read_b128 v[188:191], v131 offset:1024
ds_read_b128 v[192:195], v0 offset:2048
ds_read_b128 v[196:199], v0 offset:3072
ds_read_b128 v[200:203], v131 offset:2048
ds_read_b128 v[204:207], v131 offset:3072
ds_read_b128 v[208:211], v0 offset:4096
ds_read_b128 v[212:215], v0 offset:5120
ds_read_b128 v[216:219], v131 offset:4096
ds_read_b128 v[220:223], v131 offset:5120
ds_read_b128 v[224:227], v0 offset:6144
ds_read_b128 v[228:231], v0 offset:7168
ds_read_b128 v[232:235], v131 offset:6144
ds_read_b128 v[236:239], v131 offset:7168
v_mov_b32 v8, 0
v_mov_b32 v9, 0
v_mov_b32 v10, 0
v_mov_b32 v11, 0
v_mov_b32 v12, 0
v_mov_b32 v13, 0
v_mov_b32 v14, 0
v_mov_b32 v15, 0
v_mov_b32 v128, 0
s_waitcnt lgkmcnt(0)
s_waitcnt vmcnt(14)
v_smfmac_f32_16x16x64_bf16 v[8:11], v[80:83], v[176:183], v4
v_smfmac_f32_16x16x64_bf16 v[12:15], v[80:83], v[184:191], v4
v_or3_b32 v128, v128, v80, v81
v_or3_b32 v128, v128, v82, v83
s_waitcnt vmcnt(12)
v_smfmac_f32_16x16x64_bf16 v[8:11], v[84:87], v[192:199], v4
v_smfmac_f32_16x16x64_bf16 v[12:15], v[84:87], v[200:207], v4
v_or3_b32 v128, v128, v84, v85
v_or3_b32 v128, v128, v86, v87
s_waitcnt vmcnt(10)
v_smfmac_f32_16x16x64_bf16 v[8:11], v[88:91], v[208:215], v4
v_smfmac_f32_16x16x64_bf16 v[12:15], v[88:91], v[216:223], v4
v_or3_b32 v128, v128, v88, v89
v_or3_b32 v128, v128, v90, v91
s_waitcnt vmcnt(8)
v_smfmac_f32_16x16x64_bf16 v[8:11], v[92:95], v[224:231], v4
v_smfmac_f32_16x16x64_bf16 v[12:15], v[92:95], v[232:239], v4
v_or3_b32 v128, v128, v92, v93
v_or3_b32 v128, v128, v94, v95
s_waitcnt vmcnt(7)
v_smfmac_f32_16x16x64_bf16 v[8:11], v[16:19], a[0:7], v4
v_smfmac_f32_16x16x64_bf16 v[12:15], v[16:19], a[8:15], v4
v_or3_b32 v128, v128, v16, v17
v_or3_b32 v128, v128, v18, v19
s_waitcnt vmcnt(6)
v_smfmac_f32_16x16x64_bf16 v[8:11], v[20:23], a[32:39], v4
v_smfmac_f32_16x16x64_bf16 v[12:15], v[20:23], a[40:47], v4
v_or3_b32 v128, v128, v20, v21
v_or3_b32 v128, v128, v22, v23
s_waitcnt vmcnt(5)
v_smfmac_f32_16x16x64_bf16 v[8:11], v[24:27], a[64:71], v4
v_smfmac_f32_16x16x64_bf16 v[12:15], v[24:27], a[72:79], v4
v_or3_b32 v128, v128, v24, v25
v_or3_b32 v128, v128, v26, v27
s_waitcnt vmcnt(4)
v_smfmac_f32_16x16x64_bf16 v[8:11], v[28:31], a[96:103], v4
v_smfmac_f32_16x16x64_bf16 v[12:15], v[28:31], a[104:111], v4
v_or3_b32 v128, v128, v28, v29
v_or3_b32 v128, v128, v30, v31
s_waitcnt vmcnt(3)
v_smfmac_f32_16x16x64_bf16 v[8:11], v[32:35], a[128:135], v4
v_smfmac_f32_16x16x64_bf16 v[12:15], v[32:35], a[136:143], v4
v_or3_b32 v128, v128, v32, v33
v_or3_b32 v128, v128, v34, v35
s_waitcnt vmcnt(2)
v_smfmac_f32_16x16x64_bf16 v[8:11], v[36:39], a[160:167], v4
v_smfmac_f32_16x16x64_bf16 v[12:15], v[36:39], a[168:175], v4
v_or3_b32 v128, v128, v36, v37
v_or3_b32 v128, v128, v38, v39
s_waitcnt vmcnt(1)
v_smfmac_f32_16x16x64_bf16 v[8:11], v[40:43], a[192:199], v4
v_smfmac_f32_16x16x64_bf16 v[12:15], v[40:43], a[200:207], v4
v_or3_b32 v128, v128, v40, v41
v_or3_b32 v128, v128, v42, v43
s_waitcnt vmcnt(0)
v_smfmac_f32_16x16x64_bf16 v[8:11], v[44:47], a[224:231], v4
v_smfmac_f32_16x16x64_bf16 v[12:15], v[44:47], a[232:239], v4
v_or3_b32 v128, v128, v44, v45
v_or3_b32 v128, v128, v46, v47
v_and_b32 v128, 0x80008000, v128
v_cmp_ne_u32 vcc, 0, v128
s_cbranch_vccnz Ltw1_re
Ltw1_ok:
s_nop 3
v_permlane32_swap_b32 v8, v9
v_permlane32_swap_b32 v10, v11
v_add_f32 v8, v8, v9
v_add_f32 v10, v10, v11
v_mov_b32 v170, v8
s_nop 0
v_mov_b32_dpp v8, v10 row_ror:8 row_mask:0xf bank_mask:0xc
v_mov_b32_dpp v10, v170 row_ror:8 row_mask:0xf bank_mask:0x3
v_cvt_pk_bf16_f32 v170, v8, v10
v_lshlrev_b32 v171, 16, v170
v_and_b32 v170, 0xffff0000, v170
v_lshlrev_b32 v172, 16, v168
v_and_b32 v173, 0xffff0000, v168
v_mul_f32 v171, v171, v172
v_mul_f32 v170, v170, v173
v_cvt_pk_bf16_f32 v170, v171, v170
v_lshlrev_b32 v171, 16, v170
v_and_b32 v170, 0xffff0000, v170
v_lshlrev_b32 v172, 16, v166
v_and_b32 v173, 0xffff0000, v166
v_add_f32 v171, v171, v172
v_add_f32 v170, v170, v173
v_cvt_pk_bf16_f32 v174, v171, v170
buffer_store_dword v174, v7, s[12:15], s49 offen offset:0
v_permlane32_swap_b32 v12, v13
v_permlane32_swap_b32 v14, v15
v_add_f32 v12, v12, v13
v_add_f32 v14, v14, v15
v_mov_b32 v170, v12
s_nop 0
v_mov_b32_dpp v12, v14 row_ror:8 row_mask:0xf bank_mask:0xc
v_mov_b32_dpp v14, v170 row_ror:8 row_mask:0xf bank_mask:0x3
v_cvt_pk_bf16_f32 v170, v12, v14
v_lshlrev_b32 v171, 16, v170
v_and_b32 v170, 0xffff0000, v170
v_lshlrev_b32 v172, 16, v169
v_and_b32 v173, 0xffff0000, v169
v_mul_f32 v171, v171, v172
v_mul_f32 v170, v170, v173
v_cvt_pk_bf16_f32 v170, v171, v170
v_lshlrev_b32 v171, 16, v170
v_and_b32 v170, 0xffff0000, v170
v_lshlrev_b32 v172, 16, v167
v_and_b32 v173, 0xffff0000, v167
v_add_f32 v171, v171, v172
v_add_f32 v170, v170, v173
v_cvt_pk_bf16_f32 v175, v171, v170
buffer_store_dword v175, v7, s[12:15], s49 offen offset:32
s_endpgm
Ltw1_re:
s_cmp_eq_u32 s25, 0
s_cbranch_scc1 Ltw1_ok
s_sub_u32 s25, s25, 1
s_branch Ltw1
Lg1:
v_and_b32 v9, 31, v0
v_lshrrev_b32 v10, 5, v0
v_lshlrev_b32 v6, 4, v0
s_load_dwordx2 s[8:9], s[0:1], 16
s_load_dwordx2 s[12:13], s[0:1], 24
s_load_dwordx2 s[14:15], s[0:1], 32
s_lshl_b32 s32, s27, 2
s_add_u32 s32, s32, s28
s_mul_i32 s33, s32, 57
s_lshr_b32 s33, s33, 9
s_mul_i32 s34, s33, 9
s_sub_u32 s34, s32, s34
s_lshl_b32 s35, s26, 3
s_add_u32 s33, s33, s35
s_mul_i32 s35, s34, 11
s_lshr_b32 s35, s35, 5
s_mul_i32 s36, s35, 3
s_sub_u32 s36, s34, s36
s_mov_b32 s10, 7864320
s_mov_b32 s11, 0x20000
s_waitcnt lgkmcnt(0)
s_cmp_eq_u32 s35, 1
s_cselect_b32 s8, s12, s8
s_cselect_b32 s9, s13, s9
s_cmp_eq_u32 s35, 2
s_cselect_b32 s8, s14, s8
s_cselect_b32 s9, s15, s9
s_and_b32 s9, s9, 0xffff
s_lshl_b32 s46, s33, 11
s_lshl_b32 s47, s34, 7
s_add_u32 s46, s46, s47
s_add_u32 s46, s46, 0
v_mov_b32 v5, s46
v_mov_b32 v1, 2146435072
v_cmp_eq_u32 vcc, 0, v0
s_nop 1
v_cndmask_b32 v5, v1, v5, vcc
v_and_b32 v11, 24, v9
v_bfe_u32 v12, v9, 2, 1
v_and_b32 v13, 3, v9
v_lshl_add_u32 v12, v13, 1, v12
v_add_u32 v11, v11, v12
s_cmp_eq_u32 s35, 0
s_cselect_b64 vcc, -1, 0
v_cndmask_b32 v11, v9, v11, vcc
s_mul_i32 s46, s33, 384
s_lshl_b32 s47, s36, 7
s_add_u32 s46, s46, s47
v_lshlrev_b32 v14, 2, v11
v_lshl_add_u32 v14, v10, 10, v14
v_lshrrev_b32 v12, 3, v0
v_mul_u32_u24 v12, 12288, v12
v_and_b32 v13, 7, v0
v_lshl_add_u32 v2, v13, 4, s46
v_add_u32 v2, v2, v12
s_mul_i32 s37, s33, 12288
s_cmp_eq_u32 s35, 0
s_cbranch_scc1 Lgq_59
s_cmp_eq_u32 s35, 1
s_cbranch_scc1 Lgk_60
v_and_b32 v11, 19, v9
v_bfe_u32 v12, v9, 2, 1
v_lshl_add_u32 v11, v12, 3, v11
v_bfe_u32 v12, v9, 3, 1
v_lshl_add_u32 v11, v12, 2, v11
v_lshlrev_b32 v11, 4, v11
v_lshl_add_u32 v4, v10, 9, v11
s_movk_i32 s38, 1024
s_lshl_b32 s46, s36, 12
s_add_u32 s37, s37, 60727296
s_branch Lgd_61
Lgq_59:
v_lshrrev_b32 v11, 3, v9
v_mul_u32_u24 v11, 3072, v11
v_and_b32 v12, 7, v9
v_lshl_add_u32 v11, v12, 4, v11
v_lshl_add_u32 v4, v10, 7, v11
s_movk_i32 s38, 256
s_lshl_b32 s46, s36, 10
s_add_u32 s37, s37, 10002432
s_branch Lgd_61
Lgk_60:
v_and_b32 v11, 1, v9
v_mul_u32_u24 v11, 6144, v11
v_lshrrev_b32 v12, 1, v9
v_lshl_add_u32 v11, v12, 4, v11
v_lshl_add_u32 v4, v10, 8, v11
s_movk_i32 s38, 512
s_lshl_b32 s46, s36, 11
s_add_u32 s37, s37, 35168256
Lgd_61:
s_add_u32 s37, s37, s46
s_mov_b32 s42, 393216
v_mov_b32 v8, 0
buffer_store_dword v8, v5, s[4:7], 0 offen sc1
s_load_dwordx2 s[16:17], s[0:1], 0
s_mov_b32 s18, 2621440
s_mov_b32 s19, 0x20000
v_lshrrev_b32 v18, 3, v0
s_lshl_b32 s46, s28, 3
v_add_u32 v18, s46, v18
v_and_b32 v19, 7, v0
v_mul_u32_u24 v16, 1280, v18
v_lshl_add_u32 v16, v19, 4, v16
v_lshlrev_b32 v17, 4, v18
v_and_b32 v20, 1, v19
v_lshl_add_u32 v17, v20, 9, v17
v_lshrrev_b32 v20, 1, v19
v_lshl_add_u32 v17, v20, 10, v17
s_waitcnt lgkmcnt(0)
s_and_b32 s17, s17, 0xffff
s_mul_i32 s53, s28, 30720
s_add_u32 s53, s53, 40960
v_add_u32 v14, s53, v14
s_add_u32 m0, s53, 0
s_mov_b32 s31, 0
buffer_load_dwordx4 v2, s[8:11], s31 offen lds
s_add_u32 m0, s53, 1024
s_mov_b32 s31, 98304
buffer_load_dwordx4 v2, s[8:11], s31 offen lds
s_add_u32 m0, s53, 2048
s_mov_b32 s31, 196608
buffer_load_dwordx4 v2, s[8:11], s31 offen lds
s_add_u32 m0, s53, 3072
s_mov_b32 s31, 294912
buffer_load_dwordx4 v2, s[8:11], s31 offen lds
s_add_u32 m0, s53, 4096
s_mov_b32 s31, 393216
buffer_load_dwordx4 v2, s[8:11], s31 offen lds
s_add_u32 m0, s53, 5120
s_mov_b32 s31, 491520
buffer_load_dwordx4 v2, s[8:11], s31 offen lds
s_waitcnt vmcnt(6)
s_barrier
s_cmp_lg_u32 s28, 0
s_cbranch_scc1 Larr_62
v_mov_b32 v8, 1
s_mov_b64 exec, 1
buffer_atomic_add v8, off, s[20:23], 0 sc1
s_mov_b64 exec, -1
Larr_62:
buffer_load_dwordx4 v[20:23], v16, s[16:19], 0 offen offset:0
buffer_load_dwordx4 v[24:27], v16, s[16:19], 0 offen offset:128
buffer_load_dwordx4 v[28:31], v16, s[16:19], 0 offen offset:256
buffer_load_dwordx4 v[32:35], v16, s[16:19], 0 offen offset:384
buffer_load_dwordx4 v[36:39], v16, s[16:19], 0 offen offset:512
buffer_load_dwordx4 v[40:43], v16, s[16:19], 0 offen offset:640
buffer_load_dwordx4 v[44:47], v16, s[16:19], 0 offen offset:768
buffer_load_dwordx4 v[48:51], v16, s[16:19], 0 offen offset:896
buffer_load_dwordx4 v[52:55], v16, s[16:19], 0 offen offset:1024
buffer_load_dwordx4 v[56:59], v16, s[16:19], 0 offen offset:1152
s_add_u32 m0, s53, 6144
s_mov_b32 s31, 589824
buffer_load_dwordx4 v2, s[8:11], s31 offen lds
s_add_u32 m0, s53, 7168
s_mov_b32 s31, 688128
buffer_load_dwordx4 v2, s[8:11], s31 offen lds
s_add_u32 m0, s53, 8192
s_mov_b32 s31, 786432
buffer_load_dwordx4 v2, s[8:11], s31 offen lds
s_add_u32 m0, s53, 9216
s_mov_b32 s31, 884736
buffer_load_dwordx4 v2, s[8:11], s31 offen lds
s_add_u32 m0, s53, 10240
s_mov_b32 s31, 983040
buffer_load_dwordx4 v2, s[8:11], s31 offen lds
s_add_u32 m0, s53, 11264
s_mov_b32 s31, 1081344
buffer_load_dwordx4 v2, s[8:11], s31 offen lds
s_add_u32 m0, s53, 12288
s_mov_b32 s31, 1179648
buffer_load_dwordx4 v2, s[8:11], s31 offen lds
s_add_u32 m0, s53, 13312
s_mov_b32 s31, 1277952
buffer_load_dwordx4 v2, s[8:11], s31 offen lds
s_add_u32 m0, s53, 14336
s_mov_b32 s31, 1376256
buffer_load_dwordx4 v2, s[8:11], s31 offen lds
s_add_u32 m0, s53, 15360
s_mov_b32 s31, 1474560
buffer_load_dwordx4 v2, s[8:11], s31 offen lds
s_add_u32 m0, s53, 16384
s_mov_b32 s31, 1572864
buffer_load_dwordx4 v2, s[8:11], s31 offen lds
s_add_u32 m0, s53, 17408
s_mov_b32 s31, 1671168
buffer_load_dwordx4 v2, s[8:11], s31 offen lds
s_add_u32 m0, s53, 18432
s_mov_b32 s31, 1769472
buffer_load_dwordx4 v2, s[8:11], s31 offen lds
s_add_u32 m0, s53, 19456
s_mov_b32 s31, 1867776
buffer_load_dwordx4 v2, s[8:11], s31 offen lds
s_add_u32 m0, s53, 20480
s_mov_b32 s31, 1966080
buffer_load_dwordx4 v2, s[8:11], s31 offen lds
s_add_u32 m0, s53, 21504
s_mov_b32 s31, 2064384
buffer_load_dwordx4 v2, s[8:11], s31 offen lds
s_add_u32 m0, s53, 22528
s_mov_b32 s31, 2162688
buffer_load_dwordx4 v2, s[8:11], s31 offen lds
s_add_u32 m0, s53, 23552
s_mov_b32 s31, 2260992
buffer_load_dwordx4 v2, s[8:11], s31 offen lds
s_add_u32 m0, s53, 24576
s_mov_b32 s31, 2359296
buffer_load_dwordx4 v2, s[8:11], s31 offen lds
s_add_u32 m0, s53, 25600
s_mov_b32 s31, 2457600
buffer_load_dwordx4 v2, s[8:11], s31 offen lds
s_add_u32 m0, s53, 26624
s_mov_b32 s31, 2555904
buffer_load_dwordx4 v2, s[8:11], s31 offen lds
s_add_u32 m0, s53, 27648
s_mov_b32 s31, 2654208
buffer_load_dwordx4 v2, s[8:11], s31 offen lds
s_add_u32 m0, s53, 28672
s_mov_b32 s31, 2752512
buffer_load_dwordx4 v2, s[8:11], s31 offen lds
s_add_u32 m0, s53, 29696
s_mov_b32 s31, 2850816
buffer_load_dwordx4 v2, s[8:11], s31 offen lds
s_waitcnt vmcnt(28)
v_add_u32 v146, 0, v14
ds_read2_b32 v[148:149], v146 offset0:0 offset1:32
ds_read2_b32 v[150:151], v146 offset0:64 offset1:96
ds_read2_b32 v[152:153], v146 offset0:128 offset1:160
ds_read2_b32 v[154:155], v146 offset0:192 offset1:224
s_waitcnt vmcnt(26)
v_add_u32 v146, 2048, v14
ds_read2_b32 v[156:157], v146 offset0:0 offset1:32
ds_read2_b32 v[158:159], v146 offset0:64 offset1:96
ds_read2_b32 v[160:161], v146 offset0:128 offset1:160
ds_read2_b32 v[162:163], v146 offset0:192 offset1:224
s_waitcnt lgkmcnt(4)
s_add_u32 m0, s53, 0
s_mov_b32 s31, 2949120
buffer_load_dwordx4 v2, s[8:11], s31 offen lds
s_add_u32 m0, s53, 1024
s_mov_b32 s31, 3047424
buffer_load_dwordx4 v2, s[8:11], s31 offen lds
v_perm_b32 v144, v149, v148, s29
v_accvgpr_write_b32 a0, v144
v_perm_b32 v145, v151, v150, s29
v_accvgpr_write_b32 a1, v145
v_perm_b32 v144, v153, v152, s29
v_accvgpr_write_b32 a2, v144
v_perm_b32 v145, v155, v154, s29
v_accvgpr_write_b32 a3, v145
v_perm_b32 v144, v149, v148, s30
v_accvgpr_write_b32 a4, v144
v_perm_b32 v145, v151, v150, s30
v_accvgpr_write_b32 a5, v145
v_perm_b32 v144, v153, v152, s30
v_accvgpr_write_b32 a6, v144
v_perm_b32 v145, v155, v154, s30
v_accvgpr_write_b32 a7, v145
s_waitcnt vmcnt(26)
v_add_u32 v146, 4096, v14
ds_read2_b32 v[148:149], v146 offset0:0 offset1:32
ds_read2_b32 v[150:151], v146 offset0:64 offset1:96
ds_read2_b32 v[152:153], v146 offset0:128 offset1:160
ds_read2_b32 v[154:155], v146 offset0:192 offset1:224
s_waitcnt lgkmcnt(4)
s_add_u32 m0, s53, 2048
s_mov_b32 s31, 3145728
buffer_load_dwordx4 v2, s[8:11], s31 offen lds
s_add_u32 m0, s53, 3072
s_mov_b32 s31, 3244032
buffer_load_dwordx4 v2, s[8:11], s31 offen lds
v_perm_b32 v144, v157, v156, s29
v_accvgpr_write_b32 a8, v144
v_perm_b32 v145, v159, v158, s29
v_accvgpr_write_b32 a9, v145
v_perm_b32 v144, v161, v160, s29
v_accvgpr_write_b32 a10, v144
v_perm_b32 v145, v163, v162, s29
v_accvgpr_write_b32 a11, v145
v_perm_b32 v144, v157, v156, s30
v_accvgpr_write_b32 a12, v144
v_perm_b32 v145, v159, v158, s30
v_accvgpr_write_b32 a13, v145
v_perm_b32 v144, v161, v160, s30
v_accvgpr_write_b32 a14, v144
v_perm_b32 v145, v163, v162, s30
v_accvgpr_write_b32 a15, v145
s_waitcnt vmcnt(26)
v_add_u32 v146, 6144, v14
ds_read2_b32 v[156:157], v146 offset0:0 offset1:32
ds_read2_b32 v[158:159], v146 offset0:64 offset1:96
ds_read2_b32 v[160:161], v146 offset0:128 offset1:160
ds_read2_b32 v[162:163], v146 offset0:192 offset1:224
s_waitcnt lgkmcnt(4)
s_add_u32 m0, s53, 4096
s_mov_b32 s31, 3342336
buffer_load_dwordx4 v2, s[8:11], s31 offen lds
s_add_u32 m0, s53, 5120
s_mov_b32 s31, 3440640
buffer_load_dwordx4 v2, s[8:11], s31 offen lds
v_perm_b32 v144, v149, v148, s29
v_accvgpr_write_b32 a16, v144
v_perm_b32 v145, v151, v150, s29
v_accvgpr_write_b32 a17, v145
v_perm_b32 v144, v153, v152, s29
v_accvgpr_write_b32 a18, v144
v_perm_b32 v145, v155, v154, s29
v_accvgpr_write_b32 a19, v145
v_perm_b32 v144, v149, v148, s30
v_accvgpr_write_b32 a20, v144
v_perm_b32 v145, v151, v150, s30
v_accvgpr_write_b32 a21, v145
v_perm_b32 v144, v153, v152, s30
v_accvgpr_write_b32 a22, v144
v_perm_b32 v145, v155, v154, s30
v_accvgpr_write_b32 a23, v145
s_waitcnt vmcnt(26)
v_add_u32 v146, 8192, v14
ds_read2_b32 v[148:149], v146 offset0:0 offset1:32
ds_read2_b32 v[150:151], v146 offset0:64 offset1:96
ds_read2_b32 v[152:153], v146 offset0:128 offset1:160
ds_read2_b32 v[154:155], v146 offset0:192 offset1:224
s_waitcnt lgkmcnt(4)
s_add_u32 m0, s53, 6144
s_mov_b32 s31, 3538944
buffer_load_dwordx4 v2, s[8:11], s31 offen lds
s_add_u32 m0, s53, 7168
s_mov_b32 s31, 3637248
buffer_load_dwordx4 v2, s[8:11], s31 offen lds
v_perm_b32 v144, v157, v156, s29
v_accvgpr_write_b32 a24, v144
v_perm_b32 v145, v159, v158, s29
v_accvgpr_write_b32 a25, v145
v_perm_b32 v144, v161, v160, s29
v_accvgpr_write_b32 a26, v144
v_perm_b32 v145, v163, v162, s29
v_accvgpr_write_b32 a27, v145
v_perm_b32 v144, v157, v156, s30
v_accvgpr_write_b32 a28, v144
v_perm_b32 v145, v159, v158, s30
v_accvgpr_write_b32 a29, v145
v_perm_b32 v144, v161, v160, s30
v_accvgpr_write_b32 a30, v144
v_perm_b32 v145, v163, v162, s30
v_accvgpr_write_b32 a31, v145
v_lshlrev_b32 v64, 16, v20
v_and_b32 v65, 0xffff0000, v20
v_lshlrev_b32 v66, 16, v21
v_and_b32 v67, 0xffff0000, v21
v_lshlrev_b32 v68, 16, v22
v_and_b32 v69, 0xffff0000, v22
v_lshlrev_b32 v70, 16, v23
v_and_b32 v71, 0xffff0000, v23
v_lshlrev_b32 v72, 16, v24
v_and_b32 v73, 0xffff0000, v24
v_lshlrev_b32 v74, 16, v25
v_and_b32 v75, 0xffff0000, v25
v_lshlrev_b32 v76, 16, v26
v_and_b32 v77, 0xffff0000, v26
v_lshlrev_b32 v78, 16, v27
v_and_b32 v79, 0xffff0000, v27
v_lshlrev_b32 v80, 16, v28
v_and_b32 v81, 0xffff0000, v28
v_lshlrev_b32 v82, 16, v29
v_and_b32 v83, 0xffff0000, v29
v_lshlrev_b32 v84, 16, v30
v_and_b32 v85, 0xffff0000, v30
v_lshlrev_b32 v86, 16, v31
v_and_b32 v87, 0xffff0000, v31
v_lshlrev_b32 v88, 16, v32
v_and_b32 v89, 0xffff0000, v32
v_lshlrev_b32 v90, 16, v33
v_and_b32 v91, 0xffff0000, v33
v_lshlrev_b32 v92, 16, v34
v_and_b32 v93, 0xffff0000, v34
v_lshlrev_b32 v94, 16, v35
v_and_b32 v95, 0xffff0000, v35
v_lshlrev_b32 v96, 16, v36
v_and_b32 v97, 0xffff0000, v36
v_lshlrev_b32 v98, 16, v37
v_and_b32 v99, 0xffff0000, v37
v_lshlrev_b32 v100, 16, v38
v_and_b32 v101, 0xffff0000, v38
v_lshlrev_b32 v102, 16, v39
v_and_b32 v103, 0xffff0000, v39
v_lshlrev_b32 v104, 16, v40
v_and_b32 v105, 0xffff0000, v40
v_lshlrev_b32 v106, 16, v41
v_and_b32 v107, 0xffff0000, v41
v_lshlrev_b32 v108, 16, v42
v_and_b32 v109, 0xffff0000, v42
v_lshlrev_b32 v110, 16, v43
v_and_b32 v111, 0xffff0000, v43
v_lshlrev_b32 v112, 16, v44
v_and_b32 v113, 0xffff0000, v44
v_lshlrev_b32 v114, 16, v45
v_and_b32 v115, 0xffff0000, v45
v_lshlrev_b32 v116, 16, v46
v_and_b32 v117, 0xffff0000, v46
v_lshlrev_b32 v118, 16, v47
v_and_b32 v119, 0xffff0000, v47
v_lshlrev_b32 v120, 16, v48
v_and_b32 v121, 0xffff0000, v48
v_lshlrev_b32 v122, 16, v49
v_and_b32 v123, 0xffff0000, v49
v_lshlrev_b32 v124, 16, v50
v_and_b32 v125, 0xffff0000, v50
v_lshlrev_b32 v126, 16, v51
v_and_b32 v127, 0xffff0000, v51
v_lshlrev_b32 v128, 16, v52
v_and_b32 v129, 0xffff0000, v52
v_lshlrev_b32 v130, 16, v53
v_and_b32 v131, 0xffff0000, v53
v_lshlrev_b32 v132, 16, v54
v_and_b32 v133, 0xffff0000, v54
v_lshlrev_b32 v134, 16, v55
v_and_b32 v135, 0xffff0000, v55
v_lshlrev_b32 v136, 16, v56
v_and_b32 v137, 0xffff0000, v56
v_lshlrev_b32 v138, 16, v57
v_and_b32 v139, 0xffff0000, v57
v_lshlrev_b32 v140, 16, v58
v_and_b32 v141, 0xffff0000, v58
v_lshlrev_b32 v142, 16, v59
v_and_b32 v143, 0xffff0000, v59
v_pk_add_f32 v[18:19], v[64:65], v[66:67]
v_pk_add_f32 v[18:19], v[18:19], v[68:69]
v_pk_add_f32 v[18:19], v[18:19], v[70:71]
v_pk_add_f32 v[18:19], v[18:19], v[72:73]
v_pk_add_f32 v[18:19], v[18:19], v[74:75]
v_pk_add_f32 v[18:19], v[18:19], v[76:77]
v_pk_add_f32 v[18:19], v[18:19], v[78:79]
v_pk_add_f32 v[18:19], v[18:19], v[80:81]
v_pk_add_f32 v[18:19], v[18:19], v[82:83]
v_pk_add_f32 v[18:19], v[18:19], v[84:85]
v_pk_add_f32 v[18:19], v[18:19], v[86:87]
v_pk_add_f32 v[18:19], v[18:19], v[88:89]
v_pk_add_f32 v[18:19], v[18:19], v[90:91]
v_pk_add_f32 v[18:19], v[18:19], v[92:93]
v_pk_add_f32 v[18:19], v[18:19], v[94:95]
v_pk_add_f32 v[18:19], v[18:19], v[96:97]
v_pk_add_f32 v[18:19], v[18:19], v[98:99]
v_pk_add_f32 v[18:19], v[18:19], v[100:101]
v_pk_add_f32 v[18:19], v[18:19], v[102:103]
v_pk_add_f32 v[18:19], v[18:19], v[104:105]
v_pk_add_f32 v[18:19], v[18:19], v[106:107]
v_pk_add_f32 v[18:19], v[18:19], v[108:109]
v_pk_add_f32 v[18:19], v[18:19], v[110:111]
v_pk_add_f32 v[18:19], v[18:19], v[112:113]
v_pk_add_f32 v[18:19], v[18:19], v[114:115]
v_pk_add_f32 v[18:19], v[18:19], v[116:117]
v_pk_add_f32 v[18:19], v[18:19], v[118:119]
v_pk_add_f32 v[18:19], v[18:19], v[120:121]
v_pk_add_f32 v[18:19], v[18:19], v[122:123]
v_pk_add_f32 v[18:19], v[18:19], v[124:125]
v_pk_add_f32 v[18:19], v[18:19], v[126:127]
v_pk_add_f32 v[18:19], v[18:19], v[128:129]
v_pk_add_f32 v[18:19], v[18:19], v[130:131]
v_pk_add_f32 v[18:19], v[18:19], v[132:133]
v_pk_add_f32 v[18:19], v[18:19], v[134:135]
v_pk_add_f32 v[18:19], v[18:19], v[136:137]
v_pk_add_f32 v[18:19], v[18:19], v[138:139]
v_pk_add_f32 v[18:19], v[18:19], v[140:141]
v_pk_add_f32 v[18:19], v[18:19], v[142:143]
v_add_f32 v18, v18, v19
s_nop 1
v_add_f32_dpp v18, v18, v18 quad_perm:[1,0,3,2] row_mask:0xf bank_mask:0xf
s_nop 1
v_add_f32_dpp v18, v18, v18 quad_perm:[2,3,0,1] row_mask:0xf bank_mask:0xf
s_nop 1
v_add_f32_dpp v18, v18, v18 row_half_mirror row_mask:0xf bank_mask:0xf
v_mul_f32 v18, 0x3acccccd, v18
v_mov_b32 v60, 0
v_mov_b32 v61, 0
v_sub_f32 v62, v64, v18
v_fmac_f32 v60, v62, v62
v_sub_f32 v63, v65, v18
v_fmac_f32 v61, v63, v63
v_sub_f32 v62, v66, v18
v_fmac_f32 v60, v62, v62
v_sub_f32 v63, v67, v18
v_fmac_f32 v61, v63, v63
v_sub_f32 v62, v68, v18
v_fmac_f32 v60, v62, v62
v_sub_f32 v63, v69, v18
v_fmac_f32 v61, v63, v63
v_sub_f32 v62, v70, v18
v_fmac_f32 v60, v62, v62
v_sub_f32 v63, v71, v18
v_fmac_f32 v61, v63, v63
v_sub_f32 v62, v72, v18
v_fmac_f32 v60, v62, v62
v_sub_f32 v63, v73, v18
v_fmac_f32 v61, v63, v63
v_sub_f32 v62, v74, v18
v_fmac_f32 v60, v62, v62
v_sub_f32 v63, v75, v18
v_fmac_f32 v61, v63, v63
v_sub_f32 v62, v76, v18
v_fmac_f32 v60, v62, v62
v_sub_f32 v63, v77, v18
v_fmac_f32 v61, v63, v63
v_sub_f32 v62, v78, v18
v_fmac_f32 v60, v62, v62
v_sub_f32 v63, v79, v18
v_fmac_f32 v61, v63, v63
v_sub_f32 v62, v80, v18
v_fmac_f32 v60, v62, v62
v_sub_f32 v63, v81, v18
v_fmac_f32 v61, v63, v63
v_sub_f32 v62, v82, v18
v_fmac_f32 v60, v62, v62
v_sub_f32 v63, v83, v18
v_fmac_f32 v61, v63, v63
v_sub_f32 v62, v84, v18
v_fmac_f32 v60, v62, v62
v_sub_f32 v63, v85, v18
v_fmac_f32 v61, v63, v63
v_sub_f32 v62, v86, v18
v_fmac_f32 v60, v62, v62
v_sub_f32 v63, v87, v18
v_fmac_f32 v61, v63, v63
v_sub_f32 v62, v88, v18
v_fmac_f32 v60, v62, v62
v_sub_f32 v63, v89, v18
v_fmac_f32 v61, v63, v63
v_sub_f32 v62, v90, v18
v_fmac_f32 v60, v62, v62
v_sub_f32 v63, v91, v18
v_fmac_f32 v61, v63, v63
v_sub_f32 v62, v92, v18
v_fmac_f32 v60, v62, v62
v_sub_f32 v63, v93, v18
v_fmac_f32 v61, v63, v63
v_sub_f32 v62, v94, v18
v_fmac_f32 v60, v62, v62
v_sub_f32 v63, v95, v18
v_fmac_f32 v61, v63, v63
v_sub_f32 v62, v96, v18
v_fmac_f32 v60, v62, v62
v_sub_f32 v63, v97, v18
v_fmac_f32 v61, v63, v63
v_sub_f32 v62, v98, v18
v_fmac_f32 v60, v62, v62
v_sub_f32 v63, v99, v18
v_fmac_f32 v61, v63, v63
v_sub_f32 v62, v100, v18
v_fmac_f32 v60, v62, v62
v_sub_f32 v63, v101, v18
v_fmac_f32 v61, v63, v63
v_sub_f32 v62, v102, v18
v_fmac_f32 v60, v62, v62
v_sub_f32 v63, v103, v18
v_fmac_f32 v61, v63, v63
v_sub_f32 v62, v104, v18
v_fmac_f32 v60, v62, v62
v_sub_f32 v63, v105, v18
v_fmac_f32 v61, v63, v63
v_sub_f32 v62, v106, v18
v_fmac_f32 v60, v62, v62
v_sub_f32 v63, v107, v18
v_fmac_f32 v61, v63, v63
v_sub_f32 v62, v108, v18
v_fmac_f32 v60, v62, v62
v_sub_f32 v63, v109, v18
v_fmac_f32 v61, v63, v63
v_sub_f32 v62, v110, v18
v_fmac_f32 v60, v62, v62
v_sub_f32 v63, v111, v18
v_fmac_f32 v61, v63, v63
v_sub_f32 v62, v112, v18
v_fmac_f32 v60, v62, v62
v_sub_f32 v63, v113, v18
v_fmac_f32 v61, v63, v63
v_sub_f32 v62, v114, v18
v_fmac_f32 v60, v62, v62
v_sub_f32 v63, v115, v18
v_fmac_f32 v61, v63, v63
v_sub_f32 v62, v116, v18
v_fmac_f32 v60, v62, v62
v_sub_f32 v63, v117, v18
v_fmac_f32 v61, v63, v63
v_sub_f32 v62, v118, v18
v_fmac_f32 v60, v62, v62
v_sub_f32 v63, v119, v18
v_fmac_f32 v61, v63, v63
v_sub_f32 v62, v120, v18
v_fmac_f32 v60, v62, v62
v_sub_f32 v63, v121, v18
v_fmac_f32 v61, v63, v63
v_sub_f32 v62, v122, v18
v_fmac_f32 v60, v62, v62
v_sub_f32 v63, v123, v18
v_fmac_f32 v61, v63, v63
v_sub_f32 v62, v124, v18
v_fmac_f32 v60, v62, v62
v_sub_f32 v63, v125, v18
v_fmac_f32 v61, v63, v63
v_sub_f32 v62, v126, v18
v_fmac_f32 v60, v62, v62
v_sub_f32 v63, v127, v18
v_fmac_f32 v61, v63, v63
v_sub_f32 v62, v128, v18
v_fmac_f32 v60, v62, v62
v_sub_f32 v63, v129, v18
v_fmac_f32 v61, v63, v63
v_sub_f32 v62, v130, v18
v_fmac_f32 v60, v62, v62
v_sub_f32 v63, v131, v18
v_fmac_f32 v61, v63, v63
v_sub_f32 v62, v132, v18
v_fmac_f32 v60, v62, v62
v_sub_f32 v63, v133, v18
v_fmac_f32 v61, v63, v63
v_sub_f32 v62, v134, v18
v_fmac_f32 v60, v62, v62
v_sub_f32 v63, v135, v18
v_fmac_f32 v61, v63, v63
v_sub_f32 v62, v136, v18
v_fmac_f32 v60, v62, v62
v_sub_f32 v63, v137, v18
v_fmac_f32 v61, v63, v63
v_sub_f32 v62, v138, v18
v_fmac_f32 v60, v62, v62
v_sub_f32 v63, v139, v18
v_fmac_f32 v61, v63, v63
v_sub_f32 v62, v140, v18
v_fmac_f32 v60, v62, v62
v_sub_f32 v63, v141, v18
v_fmac_f32 v61, v63, v63
v_sub_f32 v62, v142, v18
v_fmac_f32 v60, v62, v62
v_sub_f32 v63, v143, v18
v_fmac_f32 v61, v63, v63
v_add_f32 v60, v60, v61
s_nop 1
v_add_f32_dpp v60, v60, v60 quad_perm:[1,0,3,2] row_mask:0xf bank_mask:0xf
s_nop 1
v_add_f32_dpp v60, v60, v60 quad_perm:[2,3,0,1] row_mask:0xf bank_mask:0xf
s_nop 1
v_add_f32_dpp v60, v60, v60 row_half_mirror row_mask:0xf bank_mask:0xf
v_mul_f32 v60, 0x3acccccd, v60
v_cvt_pk_bf16_f32 v18, v18, v18
v_and_b32 v18, 0xffff0000, v18
v_cvt_pk_bf16_f32 v60, v60, v60
v_and_b32 v60, 0xffff0000, v60
v_add_f32 v60, 0x3727c5ac, v60
v_cvt_pk_bf16_f32 v60, v60, v60
v_and_b32 v60, 0xffff0000, v60
v_sqrt_f32 v60, v60
s_nop 0
v_cvt_pk_bf16_f32 v60, v60, v60
v_and_b32 v60, 0xffff0000, v60
v_rcp_f32 v60, v60
v_sub_f32 v64, v64, v18
v_sub_f32 v65, v65, v18
v_cvt_pk_bf16_f32 v64, v64, v65
v_and_b32 v65, 0xffff0000, v64
v_lshlrev_b32 v64, 16, v64
v_mul_f32 v64, v64, v60
v_mul_f32 v65, v65, v60
v_cvt_pk_bf16_f32 v20, v64, v65
v_sub_f32 v66, v66, v18
v_sub_f32 v67, v67, v18
v_cvt_pk_bf16_f32 v66, v66, v67
v_and_b32 v67, 0xffff0000, v66
v_lshlrev_b32 v66, 16, v66
v_mul_f32 v66, v66, v60
v_mul_f32 v67, v67, v60
v_cvt_pk_bf16_f32 v21, v66, v67
v_sub_f32 v68, v68, v18
v_sub_f32 v69, v69, v18
v_cvt_pk_bf16_f32 v68, v68, v69
v_and_b32 v69, 0xffff0000, v68
v_lshlrev_b32 v68, 16, v68
v_mul_f32 v68, v68, v60
v_mul_f32 v69, v69, v60
v_cvt_pk_bf16_f32 v22, v68, v69
v_sub_f32 v70, v70, v18
v_sub_f32 v71, v71, v18
v_cvt_pk_bf16_f32 v70, v70, v71
v_and_b32 v71, 0xffff0000, v70
v_lshlrev_b32 v70, 16, v70
v_mul_f32 v70, v70, v60
v_mul_f32 v71, v71, v60
v_cvt_pk_bf16_f32 v23, v70, v71
ds_write_b128 v17, v[20:23] offset:0
v_sub_f32 v72, v72, v18
v_sub_f32 v73, v73, v18
v_cvt_pk_bf16_f32 v72, v72, v73
v_and_b32 v73, 0xffff0000, v72
v_lshlrev_b32 v72, 16, v72
v_mul_f32 v72, v72, v60
v_mul_f32 v73, v73, v60
v_cvt_pk_bf16_f32 v24, v72, v73
v_sub_f32 v74, v74, v18
v_sub_f32 v75, v75, v18
v_cvt_pk_bf16_f32 v74, v74, v75
v_and_b32 v75, 0xffff0000, v74
v_lshlrev_b32 v74, 16, v74
v_mul_f32 v74, v74, v60
v_mul_f32 v75, v75, v60
v_cvt_pk_bf16_f32 v25, v74, v75
v_sub_f32 v76, v76, v18
v_sub_f32 v77, v77, v18
v_cvt_pk_bf16_f32 v76, v76, v77
v_and_b32 v77, 0xffff0000, v76
v_lshlrev_b32 v76, 16, v76
v_mul_f32 v76, v76, v60
v_mul_f32 v77, v77, v60
v_cvt_pk_bf16_f32 v26, v76, v77
v_sub_f32 v78, v78, v18
v_sub_f32 v79, v79, v18
v_cvt_pk_bf16_f32 v78, v78, v79
v_and_b32 v79, 0xffff0000, v78
v_lshlrev_b32 v78, 16, v78
v_mul_f32 v78, v78, v60
v_mul_f32 v79, v79, v60
v_cvt_pk_bf16_f32 v27, v78, v79
ds_write_b128 v17, v[24:27] offset:4096
v_sub_f32 v80, v80, v18
v_sub_f32 v81, v81, v18
v_cvt_pk_bf16_f32 v80, v80, v81
v_and_b32 v81, 0xffff0000, v80
v_lshlrev_b32 v80, 16, v80
v_mul_f32 v80, v80, v60
v_mul_f32 v81, v81, v60
v_cvt_pk_bf16_f32 v28, v80, v81
v_sub_f32 v82, v82, v18
v_sub_f32 v83, v83, v18
v_cvt_pk_bf16_f32 v82, v82, v83
v_and_b32 v83, 0xffff0000, v82
v_lshlrev_b32 v82, 16, v82
v_mul_f32 v82, v82, v60
v_mul_f32 v83, v83, v60
v_cvt_pk_bf16_f32 v29, v82, v83
v_sub_f32 v84, v84, v18
v_sub_f32 v85, v85, v18
v_cvt_pk_bf16_f32 v84, v84, v85
v_and_b32 v85, 0xffff0000, v84
v_lshlrev_b32 v84, 16, v84
v_mul_f32 v84, v84, v60
v_mul_f32 v85, v85, v60
v_cvt_pk_bf16_f32 v30, v84, v85
v_sub_f32 v86, v86, v18
v_sub_f32 v87, v87, v18
v_cvt_pk_bf16_f32 v86, v86, v87
v_and_b32 v87, 0xffff0000, v86
v_lshlrev_b32 v86, 16, v86
v_mul_f32 v86, v86, v60
v_mul_f32 v87, v87, v60
v_cvt_pk_bf16_f32 v31, v86, v87
ds_write_b128 v17, v[28:31] offset:8192
v_sub_f32 v88, v88, v18
v_sub_f32 v89, v89, v18
v_cvt_pk_bf16_f32 v88, v88, v89
v_and_b32 v89, 0xffff0000, v88
v_lshlrev_b32 v88, 16, v88
v_mul_f32 v88, v88, v60
v_mul_f32 v89, v89, v60
v_cvt_pk_bf16_f32 v32, v88, v89
v_sub_f32 v90, v90, v18
v_sub_f32 v91, v91, v18
v_cvt_pk_bf16_f32 v90, v90, v91
v_and_b32 v91, 0xffff0000, v90
v_lshlrev_b32 v90, 16, v90
v_mul_f32 v90, v90, v60
v_mul_f32 v91, v91, v60
v_cvt_pk_bf16_f32 v33, v90, v91
v_sub_f32 v92, v92, v18
v_sub_f32 v93, v93, v18
v_cvt_pk_bf16_f32 v92, v92, v93
v_and_b32 v93, 0xffff0000, v92
v_lshlrev_b32 v92, 16, v92
v_mul_f32 v92, v92, v60
v_mul_f32 v93, v93, v60
v_cvt_pk_bf16_f32 v34, v92, v93
v_sub_f32 v94, v94, v18
v_sub_f32 v95, v95, v18
v_cvt_pk_bf16_f32 v94, v94, v95
v_and_b32 v95, 0xffff0000, v94
v_lshlrev_b32 v94, 16, v94
v_mul_f32 v94, v94, v60
v_mul_f32 v95, v95, v60
v_cvt_pk_bf16_f32 v35, v94, v95
ds_write_b128 v17, v[32:35] offset:12288
v_sub_f32 v96, v96, v18
v_sub_f32 v97, v97, v18
v_cvt_pk_bf16_f32 v96, v96, v97
v_and_b32 v97, 0xffff0000, v96
v_lshlrev_b32 v96, 16, v96
v_mul_f32 v96, v96, v60
v_mul_f32 v97, v97, v60
v_cvt_pk_bf16_f32 v36, v96, v97
v_sub_f32 v98, v98, v18
v_sub_f32 v99, v99, v18
v_cvt_pk_bf16_f32 v98, v98, v99
v_and_b32 v99, 0xffff0000, v98
v_lshlrev_b32 v98, 16, v98
v_mul_f32 v98, v98, v60
v_mul_f32 v99, v99, v60
v_cvt_pk_bf16_f32 v37, v98, v99
v_sub_f32 v100, v100, v18
v_sub_f32 v101, v101, v18
v_cvt_pk_bf16_f32 v100, v100, v101
v_and_b32 v101, 0xffff0000, v100
v_lshlrev_b32 v100, 16, v100
v_mul_f32 v100, v100, v60
v_mul_f32 v101, v101, v60
v_cvt_pk_bf16_f32 v38, v100, v101
v_sub_f32 v102, v102, v18
v_sub_f32 v103, v103, v18
v_cvt_pk_bf16_f32 v102, v102, v103
v_and_b32 v103, 0xffff0000, v102
v_lshlrev_b32 v102, 16, v102
v_mul_f32 v102, v102, v60
v_mul_f32 v103, v103, v60
v_cvt_pk_bf16_f32 v39, v102, v103
ds_write_b128 v17, v[36:39] offset:16384
v_sub_f32 v104, v104, v18
v_sub_f32 v105, v105, v18
v_cvt_pk_bf16_f32 v104, v104, v105
v_and_b32 v105, 0xffff0000, v104
v_lshlrev_b32 v104, 16, v104
v_mul_f32 v104, v104, v60
v_mul_f32 v105, v105, v60
v_cvt_pk_bf16_f32 v40, v104, v105
v_sub_f32 v106, v106, v18
v_sub_f32 v107, v107, v18
v_cvt_pk_bf16_f32 v106, v106, v107
v_and_b32 v107, 0xffff0000, v106
v_lshlrev_b32 v106, 16, v106
v_mul_f32 v106, v106, v60
v_mul_f32 v107, v107, v60
v_cvt_pk_bf16_f32 v41, v106, v107
v_sub_f32 v108, v108, v18
v_sub_f32 v109, v109, v18
v_cvt_pk_bf16_f32 v108, v108, v109
v_and_b32 v109, 0xffff0000, v108
v_lshlrev_b32 v108, 16, v108
v_mul_f32 v108, v108, v60
v_mul_f32 v109, v109, v60
v_cvt_pk_bf16_f32 v42, v108, v109
v_sub_f32 v110, v110, v18
v_sub_f32 v111, v111, v18
v_cvt_pk_bf16_f32 v110, v110, v111
v_and_b32 v111, 0xffff0000, v110
v_lshlrev_b32 v110, 16, v110
v_mul_f32 v110, v110, v60
v_mul_f32 v111, v111, v60
v_cvt_pk_bf16_f32 v43, v110, v111
ds_write_b128 v17, v[40:43] offset:20480
v_sub_f32 v112, v112, v18
v_sub_f32 v113, v113, v18
v_cvt_pk_bf16_f32 v112, v112, v113
v_and_b32 v113, 0xffff0000, v112
v_lshlrev_b32 v112, 16, v112
v_mul_f32 v112, v112, v60
v_mul_f32 v113, v113, v60
v_cvt_pk_bf16_f32 v44, v112, v113
v_sub_f32 v114, v114, v18
v_sub_f32 v115, v115, v18
v_cvt_pk_bf16_f32 v114, v114, v115
v_and_b32 v115, 0xffff0000, v114
v_lshlrev_b32 v114, 16, v114
v_mul_f32 v114, v114, v60
v_mul_f32 v115, v115, v60
v_cvt_pk_bf16_f32 v45, v114, v115
v_sub_f32 v116, v116, v18
v_sub_f32 v117, v117, v18
v_cvt_pk_bf16_f32 v116, v116, v117
v_and_b32 v117, 0xffff0000, v116
v_lshlrev_b32 v116, 16, v116
v_mul_f32 v116, v116, v60
v_mul_f32 v117, v117, v60
v_cvt_pk_bf16_f32 v46, v116, v117
v_sub_f32 v118, v118, v18
v_sub_f32 v119, v119, v18
v_cvt_pk_bf16_f32 v118, v118, v119
v_and_b32 v119, 0xffff0000, v118
v_lshlrev_b32 v118, 16, v118
v_mul_f32 v118, v118, v60
v_mul_f32 v119, v119, v60
v_cvt_pk_bf16_f32 v47, v118, v119
ds_write_b128 v17, v[44:47] offset:24576
v_sub_f32 v120, v120, v18
v_sub_f32 v121, v121, v18
v_cvt_pk_bf16_f32 v120, v120, v121
v_and_b32 v121, 0xffff0000, v120
v_lshlrev_b32 v120, 16, v120
v_mul_f32 v120, v120, v60
v_mul_f32 v121, v121, v60
v_cvt_pk_bf16_f32 v48, v120, v121
v_sub_f32 v122, v122, v18
v_sub_f32 v123, v123, v18
v_cvt_pk_bf16_f32 v122, v122, v123
v_and_b32 v123, 0xffff0000, v122
v_lshlrev_b32 v122, 16, v122
v_mul_f32 v122, v122, v60
v_mul_f32 v123, v123, v60
v_cvt_pk_bf16_f32 v49, v122, v123
v_sub_f32 v124, v124, v18
v_sub_f32 v125, v125, v18
v_cvt_pk_bf16_f32 v124, v124, v125
v_and_b32 v125, 0xffff0000, v124
v_lshlrev_b32 v124, 16, v124
v_mul_f32 v124, v124, v60
v_mul_f32 v125, v125, v60
v_cvt_pk_bf16_f32 v50, v124, v125
v_sub_f32 v126, v126, v18
v_sub_f32 v127, v127, v18
v_cvt_pk_bf16_f32 v126, v126, v127
v_and_b32 v127, 0xffff0000, v126
v_lshlrev_b32 v126, 16, v126
v_mul_f32 v126, v126, v60
v_mul_f32 v127, v127, v60
v_cvt_pk_bf16_f32 v51, v126, v127
ds_write_b128 v17, v[48:51] offset:28672
v_sub_f32 v128, v128, v18
v_sub_f32 v129, v129, v18
v_cvt_pk_bf16_f32 v128, v128, v129
v_and_b32 v129, 0xffff0000, v128
v_lshlrev_b32 v128, 16, v128
v_mul_f32 v128, v128, v60
v_mul_f32 v129, v129, v60
v_cvt_pk_bf16_f32 v52, v128, v129
v_sub_f32 v130, v130, v18
v_sub_f32 v131, v131, v18
v_cvt_pk_bf16_f32 v130, v130, v131
v_and_b32 v131, 0xffff0000, v130
v_lshlrev_b32 v130, 16, v130
v_mul_f32 v130, v130, v60
v_mul_f32 v131, v131, v60
v_cvt_pk_bf16_f32 v53, v130, v131
v_sub_f32 v132, v132, v18
v_sub_f32 v133, v133, v18
v_cvt_pk_bf16_f32 v132, v132, v133
v_and_b32 v133, 0xffff0000, v132
v_lshlrev_b32 v132, 16, v132
v_mul_f32 v132, v132, v60
v_mul_f32 v133, v133, v60
v_cvt_pk_bf16_f32 v54, v132, v133
v_sub_f32 v134, v134, v18
v_sub_f32 v135, v135, v18
v_cvt_pk_bf16_f32 v134, v134, v135
v_and_b32 v135, 0xffff0000, v134
v_lshlrev_b32 v134, 16, v134
v_mul_f32 v134, v134, v60
v_mul_f32 v135, v135, v60
v_cvt_pk_bf16_f32 v55, v134, v135
ds_write_b128 v17, v[52:55] offset:32768
v_sub_f32 v136, v136, v18
v_sub_f32 v137, v137, v18
v_cvt_pk_bf16_f32 v136, v136, v137
v_and_b32 v137, 0xffff0000, v136
v_lshlrev_b32 v136, 16, v136
v_mul_f32 v136, v136, v60
v_mul_f32 v137, v137, v60
v_cvt_pk_bf16_f32 v56, v136, v137
v_sub_f32 v138, v138, v18
v_sub_f32 v139, v139, v18
v_cvt_pk_bf16_f32 v138, v138, v139
v_and_b32 v139, 0xffff0000, v138
v_lshlrev_b32 v138, 16, v138
v_mul_f32 v138, v138, v60
v_mul_f32 v139, v139, v60
v_cvt_pk_bf16_f32 v57, v138, v139
v_sub_f32 v140, v140, v18
v_sub_f32 v141, v141, v18
v_cvt_pk_bf16_f32 v140, v140, v141
v_and_b32 v141, 0xffff0000, v140
v_lshlrev_b32 v140, 16, v140
v_mul_f32 v140, v140, v60
v_mul_f32 v141, v141, v60
v_cvt_pk_bf16_f32 v58, v140, v141
v_sub_f32 v142, v142, v18
v_sub_f32 v143, v143, v18
v_cvt_pk_bf16_f32 v142, v142, v143
v_and_b32 v143, 0xffff0000, v142
v_lshlrev_b32 v142, 16, v142
v_mul_f32 v142, v142, v60
v_mul_f32 v143, v143, v60
v_cvt_pk_bf16_f32 v59, v142, v143
ds_write_b128 v17, v[56:59] offset:36864
s_waitcnt lgkmcnt(0)
s_barrier
ds_read_b128 v[64:67], v6 offset:0
ds_read_b128 v[68:71], v6 offset:1024
ds_read_b128 v[72:75], v6 offset:2048
ds_read_b128 v[76:79], v6 offset:3072
s_waitcnt lgkmcnt(3)
v_mfma_f32_32x32x16_bf16 v[16:31], a[0:3], v[64:67], 0
v_mfma_f32_32x32x16_bf16 v[32:47], a[4:7], v[64:67], 0
s_waitcnt lgkmcnt(2)
v_mfma_f32_32x32x16_bf16 v[16:31], a[8:11], v[68:71], v[16:31]
v_mfma_f32_32x32x16_bf16 v[32:47], a[12:15], v[68:71], v[32:47]
s_waitcnt lgkmcnt(1)
v_mfma_f32_32x32x16_bf16 v[16:31], a[16:19], v[72:75], v[16:31]
v_mfma_f32_32x32x16_bf16 v[32:47], a[20:23], v[72:75], v[32:47]
s_waitcnt lgkmcnt(0)
v_mfma_f32_32x32x16_bf16 v[16:31], a[24:27], v[76:79], v[16:31]
v_mfma_f32_32x32x16_bf16 v[32:47], a[28:31], v[76:79], v[32:47]
s_waitcnt vmcnt(26)
ds_read_b128 v[48:51], v6 offset:4096
v_add_u32 v146, 10240, v14
ds_read2_b32 v[156:157], v146 offset0:0 offset1:32
ds_read2_b32 v[158:159], v146 offset0:64 offset1:96
ds_read2_b32 v[160:161], v146 offset0:128 offset1:160
ds_read2_b32 v[162:163], v146 offset0:192 offset1:224
s_waitcnt lgkmcnt(4)
s_add_u32 m0, s53, 8192
s_mov_b32 s31, 3735552
buffer_load_dwordx4 v2, s[8:11], s31 offen lds
s_add_u32 m0, s53, 9216
s_mov_b32 s31, 3833856
buffer_load_dwordx4 v2, s[8:11], s31 offen lds
v_perm_b32 v144, v149, v148, s29
v_accvgpr_write_b32 a32, v144
v_perm_b32 v145, v151, v150, s29
v_accvgpr_write_b32 a33, v145
v_perm_b32 v144, v153, v152, s29
v_accvgpr_write_b32 a34, v144
v_perm_b32 v145, v155, v154, s29
v_accvgpr_write_b32 a35, v145
v_perm_b32 v144, v149, v148, s30
v_accvgpr_write_b32 a36, v144
v_perm_b32 v145, v151, v150, s30
v_accvgpr_write_b32 a37, v145
v_perm_b32 v144, v153, v152, s30
v_accvgpr_write_b32 a38, v144
v_perm_b32 v145, v155, v154, s30
v_accvgpr_write_b32 a39, v145
v_mfma_f32_32x32x16_bf16 v[16:31], a[32:35], v[48:51], v[16:31]
s_nop 0
v_mfma_f32_32x32x16_bf16 v[32:47], a[36:39], v[48:51], v[32:47]
s_waitcnt vmcnt(26)
ds_read_b128 v[52:55], v6 offset:5120
v_add_u32 v146, 12288, v14
ds_read2_b32 v[148:149], v146 offset0:0 offset1:32
ds_read2_b32 v[150:151], v146 offset0:64 offset1:96
ds_read2_b32 v[152:153], v146 offset0:128 offset1:160
ds_read2_b32 v[154:155], v146 offset0:192 offset1:224
s_waitcnt lgkmcnt(4)
s_add_u32 m0, s53, 10240
s_mov_b32 s31, 3932160
buffer_load_dwordx4 v2, s[8:11], s31 offen lds
s_add_u32 m0, s53, 11264
s_mov_b32 s31, 4030464
buffer_load_dwordx4 v2, s[8:11], s31 offen lds
v_perm_b32 v144, v157, v156, s29
v_accvgpr_write_b32 a40, v144
v_perm_b32 v145, v159, v158, s29
v_accvgpr_write_b32 a41, v145
v_perm_b32 v144, v161, v160, s29
v_accvgpr_write_b32 a42, v144
v_perm_b32 v145, v163, v162, s29
v_accvgpr_write_b32 a43, v145
v_perm_b32 v144, v157, v156, s30
v_accvgpr_write_b32 a44, v144
v_perm_b32 v145, v159, v158, s30
v_accvgpr_write_b32 a45, v145
v_perm_b32 v144, v161, v160, s30
v_accvgpr_write_b32 a46, v144
v_perm_b32 v145, v163, v162, s30
v_accvgpr_write_b32 a47, v145
v_mfma_f32_32x32x16_bf16 v[16:31], a[40:43], v[52:55], v[16:31]
s_nop 0
v_mfma_f32_32x32x16_bf16 v[32:47], a[44:47], v[52:55], v[32:47]
s_waitcnt vmcnt(26)
ds_read_b128 v[48:51], v6 offset:6144
v_add_u32 v146, 14336, v14
ds_read2_b32 v[156:157], v146 offset0:0 offset1:32
ds_read2_b32 v[158:159], v146 offset0:64 offset1:96
ds_read2_b32 v[160:161], v146 offset0:128 offset1:160
ds_read2_b32 v[162:163], v146 offset0:192 offset1:224
s_waitcnt lgkmcnt(4)
s_add_u32 m0, s53, 12288
s_mov_b32 s31, 4128768
buffer_load_dwordx4 v2, s[8:11], s31 offen lds
s_add_u32 m0, s53, 13312
s_mov_b32 s31, 4227072
buffer_load_dwordx4 v2, s[8:11], s31 offen lds
v_perm_b32 v144, v149, v148, s29
v_accvgpr_write_b32 a48, v144
v_perm_b32 v145, v151, v150, s29
v_accvgpr_write_b32 a49, v145
v_perm_b32 v144, v153, v152, s29
v_accvgpr_write_b32 a50, v144
v_perm_b32 v145, v155, v154, s29
v_accvgpr_write_b32 a51, v145
v_perm_b32 v144, v149, v148, s30
v_accvgpr_write_b32 a52, v144
v_perm_b32 v145, v151, v150, s30
v_accvgpr_write_b32 a53, v145
v_perm_b32 v144, v153, v152, s30
v_accvgpr_write_b32 a54, v144
v_perm_b32 v145, v155, v154, s30
v_accvgpr_write_b32 a55, v145
v_mfma_f32_32x32x16_bf16 v[16:31], a[48:51], v[48:51], v[16:31]
s_nop 0
v_mfma_f32_32x32x16_bf16 v[32:47], a[52:55], v[48:51], v[32:47]
s_waitcnt vmcnt(26)
ds_read_b128 v[52:55], v6 offset:7168
v_add_u32 v146, 16384, v14
ds_read2_b32 v[148:149], v146 offset0:0 offset1:32
ds_read2_b32 v[150:151], v146 offset0:64 offset1:96
ds_read2_b32 v[152:153], v146 offset0:128 offset1:160
ds_read2_b32 v[154:155], v146 offset0:192 offset1:224
s_waitcnt lgkmcnt(4)
s_add_u32 m0, s53, 14336
s_mov_b32 s31, 4325376
buffer_load_dwordx4 v2, s[8:11], s31 offen lds
s_add_u32 m0, s53, 15360
s_mov_b32 s31, 4423680
buffer_load_dwordx4 v2, s[8:11], s31 offen lds
v_perm_b32 v144, v157, v156, s29
v_accvgpr_write_b32 a56, v144
v_perm_b32 v145, v159, v158, s29
v_accvgpr_write_b32 a57, v145
v_perm_b32 v144, v161, v160, s29
v_accvgpr_write_b32 a58, v144
v_perm_b32 v145, v163, v162, s29
v_accvgpr_write_b32 a59, v145
v_perm_b32 v144, v157, v156, s30
v_accvgpr_write_b32 a60, v144
v_perm_b32 v145, v159, v158, s30
v_accvgpr_write_b32 a61, v145
v_perm_b32 v144, v161, v160, s30
v_accvgpr_write_b32 a62, v144
v_perm_b32 v145, v163, v162, s30
v_accvgpr_write_b32 a63, v145
v_mfma_f32_32x32x16_bf16 v[16:31], a[56:59], v[52:55], v[16:31]
s_nop 0
v_mfma_f32_32x32x16_bf16 v[32:47], a[60:63], v[52:55], v[32:47]
s_waitcnt vmcnt(26)
ds_read_b128 v[48:51], v6 offset:8192
v_add_u32 v146, 18432, v14
ds_read2_b32 v[156:157], v146 offset0:0 offset1:32
ds_read2_b32 v[158:159], v146 offset0:64 offset1:96
ds_read2_b32 v[160:161], v146 offset0:128 offset1:160
ds_read2_b32 v[162:163], v146 offset0:192 offset1:224
s_waitcnt lgkmcnt(4)
s_add_u32 m0, s53, 16384
s_mov_b32 s31, 4521984
buffer_load_dwordx4 v2, s[8:11], s31 offen lds
s_add_u32 m0, s53, 17408
s_mov_b32 s31, 4620288
buffer_load_dwordx4 v2, s[8:11], s31 offen lds
v_perm_b32 v144, v149, v148, s29
v_accvgpr_write_b32 a64, v144
v_perm_b32 v145, v151, v150, s29
v_accvgpr_write_b32 a65, v145
v_perm_b32 v144, v153, v152, s29
v_accvgpr_write_b32 a66, v144
v_perm_b32 v145, v155, v154, s29
v_accvgpr_write_b32 a67, v145
v_perm_b32 v144, v149, v148, s30
v_accvgpr_write_b32 a68, v144
v_perm_b32 v145, v151, v150, s30
v_accvgpr_write_b32 a69, v145
v_perm_b32 v144, v153, v152, s30
v_accvgpr_write_b32 a70, v144
v_perm_b32 v145, v155, v154, s30
v_accvgpr_write_b32 a71, v145
v_mfma_f32_32x32x16_bf16 v[16:31], a[64:67], v[48:51], v[16:31]
s_nop 0
v_mfma_f32_32x32x16_bf16 v[32:47], a[68:71], v[48:51], v[32:47]
s_waitcnt vmcnt(26)
ds_read_b128 v[52:55], v6 offset:9216
v_add_u32 v146, 20480, v14
ds_read2_b32 v[148:149], v146 offset0:0 offset1:32
ds_read2_b32 v[150:151], v146 offset0:64 offset1:96
ds_read2_b32 v[152:153], v146 offset0:128 offset1:160
ds_read2_b32 v[154:155], v146 offset0:192 offset1:224
s_waitcnt lgkmcnt(4)
s_add_u32 m0, s53, 18432
s_mov_b32 s31, 4718592
buffer_load_dwordx4 v2, s[8:11], s31 offen lds
s_add_u32 m0, s53, 19456
s_mov_b32 s31, 4816896
buffer_load_dwordx4 v2, s[8:11], s31 offen lds
v_perm_b32 v144, v157, v156, s29
v_accvgpr_write_b32 a72, v144
v_perm_b32 v145, v159, v158, s29
v_accvgpr_write_b32 a73, v145
v_perm_b32 v144, v161, v160, s29
v_accvgpr_write_b32 a74, v144
v_perm_b32 v145, v163, v162, s29
v_accvgpr_write_b32 a75, v145
v_perm_b32 v144, v157, v156, s30
v_accvgpr_write_b32 a76, v144
v_perm_b32 v145, v159, v158, s30
v_accvgpr_write_b32 a77, v145
v_perm_b32 v144, v161, v160, s30
v_accvgpr_write_b32 a78, v144
v_perm_b32 v145, v163, v162, s30
v_accvgpr_write_b32 a79, v145
v_mfma_f32_32x32x16_bf16 v[16:31], a[72:75], v[52:55], v[16:31]
s_nop 0
v_mfma_f32_32x32x16_bf16 v[32:47], a[76:79], v[52:55], v[32:47]
s_waitcnt vmcnt(26)
ds_read_b128 v[48:51], v6 offset:10240
v_add_u32 v146, 22528, v14
ds_read2_b32 v[156:157], v146 offset0:0 offset1:32
ds_read2_b32 v[158:159], v146 offset0:64 offset1:96
ds_read2_b32 v[160:161], v146 offset0:128 offset1:160
ds_read2_b32 v[162:163], v146 offset0:192 offset1:224
s_waitcnt lgkmcnt(4)
s_add_u32 m0, s53, 20480
s_mov_b32 s31, 4915200
buffer_load_dwordx4 v2, s[8:11], s31 offen lds
s_add_u32 m0, s53, 21504
s_mov_b32 s31, 5013504
buffer_load_dwordx4 v2, s[8:11], s31 offen lds
v_perm_b32 v144, v149, v148, s29
v_accvgpr_write_b32 a80, v144
v_perm_b32 v145, v151, v150, s29
v_accvgpr_write_b32 a81, v145
v_perm_b32 v144, v153, v152, s29
v_accvgpr_write_b32 a82, v144
v_perm_b32 v145, v155, v154, s29
v_accvgpr_write_b32 a83, v145
v_perm_b32 v144, v149, v148, s30
v_accvgpr_write_b32 a84, v144
v_perm_b32 v145, v151, v150, s30
v_accvgpr_write_b32 a85, v145
v_perm_b32 v144, v153, v152, s30
v_accvgpr_write_b32 a86, v144
v_perm_b32 v145, v155, v154, s30
v_accvgpr_write_b32 a87, v145
v_mfma_f32_32x32x16_bf16 v[16:31], a[80:83], v[48:51], v[16:31]
s_nop 0
v_mfma_f32_32x32x16_bf16 v[32:47], a[84:87], v[48:51], v[32:47]
s_waitcnt vmcnt(26)
ds_read_b128 v[52:55], v6 offset:11264
v_add_u32 v146, 24576, v14
ds_read2_b32 v[148:149], v146 offset0:0 offset1:32
ds_read2_b32 v[150:151], v146 offset0:64 offset1:96
ds_read2_b32 v[152:153], v146 offset0:128 offset1:160
ds_read2_b32 v[154:155], v146 offset0:192 offset1:224
s_waitcnt lgkmcnt(4)
s_add_u32 m0, s53, 22528
s_mov_b32 s31, 5111808
buffer_load_dwordx4 v2, s[8:11], s31 offen lds
s_add_u32 m0, s53, 23552
s_mov_b32 s31, 5210112
buffer_load_dwordx4 v2, s[8:11], s31 offen lds
v_perm_b32 v144, v157, v156, s29
v_accvgpr_write_b32 a88, v144
v_perm_b32 v145, v159, v158, s29
v_accvgpr_write_b32 a89, v145
v_perm_b32 v144, v161, v160, s29
v_accvgpr_write_b32 a90, v144
v_perm_b32 v145, v163, v162, s29
v_accvgpr_write_b32 a91, v145
v_perm_b32 v144, v157, v156, s30
v_accvgpr_write_b32 a92, v144
v_perm_b32 v145, v159, v158, s30
v_accvgpr_write_b32 a93, v145
v_perm_b32 v144, v161, v160, s30
v_accvgpr_write_b32 a94, v144
v_perm_b32 v145, v163, v162, s30
v_accvgpr_write_b32 a95, v145
v_mfma_f32_32x32x16_bf16 v[16:31], a[88:91], v[52:55], v[16:31]
s_nop 0
v_mfma_f32_32x32x16_bf16 v[32:47], a[92:95], v[52:55], v[32:47]
s_waitcnt vmcnt(26)
ds_read_b128 v[48:51], v6 offset:12288
v_add_u32 v146, 26624, v14
ds_read2_b32 v[156:157], v146 offset0:0 offset1:32
ds_read2_b32 v[158:159], v146 offset0:64 offset1:96
ds_read2_b32 v[160:161], v146 offset0:128 offset1:160
ds_read2_b32 v[162:163], v146 offset0:192 offset1:224
s_waitcnt lgkmcnt(4)
s_add_u32 m0, s53, 24576
s_mov_b32 s31, 5308416
buffer_load_dwordx4 v2, s[8:11], s31 offen lds
s_add_u32 m0, s53, 25600
s_mov_b32 s31, 5406720
buffer_load_dwordx4 v2, s[8:11], s31 offen lds
v_perm_b32 v144, v149, v148, s29
v_accvgpr_write_b32 a96, v144
v_perm_b32 v145, v151, v150, s29
v_accvgpr_write_b32 a97, v145
v_perm_b32 v144, v153, v152, s29
v_accvgpr_write_b32 a98, v144
v_perm_b32 v145, v155, v154, s29
v_accvgpr_write_b32 a99, v145
v_perm_b32 v144, v149, v148, s30
v_accvgpr_write_b32 a100, v144
v_perm_b32 v145, v151, v150, s30
v_accvgpr_write_b32 a101, v145
v_perm_b32 v144, v153, v152, s30
v_accvgpr_write_b32 a102, v144
v_perm_b32 v145, v155, v154, s30
v_accvgpr_write_b32 a103, v145
v_mfma_f32_32x32x16_bf16 v[16:31], a[96:99], v[48:51], v[16:31]
s_nop 0
v_mfma_f32_32x32x16_bf16 v[32:47], a[100:103], v[48:51], v[32:47]
s_waitcnt vmcnt(26)
ds_read_b128 v[52:55], v6 offset:13312
v_add_u32 v146, 28672, v14
ds_read2_b32 v[148:149], v146 offset0:0 offset1:32
ds_read2_b32 v[150:151], v146 offset0:64 offset1:96
ds_read2_b32 v[152:153], v146 offset0:128 offset1:160
ds_read2_b32 v[154:155], v146 offset0:192 offset1:224
s_waitcnt lgkmcnt(4)
s_add_u32 m0, s53, 26624
s_mov_b32 s31, 5505024
buffer_load_dwordx4 v2, s[8:11], s31 offen lds
s_add_u32 m0, s53, 27648
s_mov_b32 s31, 5603328
buffer_load_dwordx4 v2, s[8:11], s31 offen lds
v_perm_b32 v144, v157, v156, s29
v_accvgpr_write_b32 a104, v144
v_perm_b32 v145, v159, v158, s29
v_accvgpr_write_b32 a105, v145
v_perm_b32 v144, v161, v160, s29
v_accvgpr_write_b32 a106, v144
v_perm_b32 v145, v163, v162, s29
v_accvgpr_write_b32 a107, v145
v_perm_b32 v144, v157, v156, s30
v_accvgpr_write_b32 a108, v144
v_perm_b32 v145, v159, v158, s30
v_accvgpr_write_b32 a109, v145
v_perm_b32 v144, v161, v160, s30
v_accvgpr_write_b32 a110, v144
v_perm_b32 v145, v163, v162, s30
v_accvgpr_write_b32 a111, v145
v_mfma_f32_32x32x16_bf16 v[16:31], a[104:107], v[52:55], v[16:31]
s_nop 0
v_mfma_f32_32x32x16_bf16 v[32:47], a[108:111], v[52:55], v[32:47]
s_waitcnt vmcnt(26)
ds_read_b128 v[48:51], v6 offset:14336
v_add_u32 v146, 0, v14
ds_read2_b32 v[156:157], v146 offset0:0 offset1:32
ds_read2_b32 v[158:159], v146 offset0:64 offset1:96
ds_read2_b32 v[160:161], v146 offset0:128 offset1:160
ds_read2_b32 v[162:163], v146 offset0:192 offset1:224
s_waitcnt lgkmcnt(4)
s_add_u32 m0, s53, 28672
s_mov_b32 s31, 5701632
buffer_load_dwordx4 v2, s[8:11], s31 offen lds
s_add_u32 m0, s53, 29696
s_mov_b32 s31, 5799936
buffer_load_dwordx4 v2, s[8:11], s31 offen lds
v_perm_b32 v144, v149, v148, s29
v_accvgpr_write_b32 a112, v144
v_perm_b32 v145, v151, v150, s29
v_accvgpr_write_b32 a113, v145
v_perm_b32 v144, v153, v152, s29
v_accvgpr_write_b32 a114, v144
v_perm_b32 v145, v155, v154, s29
v_accvgpr_write_b32 a115, v145
v_perm_b32 v144, v149, v148, s30
v_accvgpr_write_b32 a116, v144
v_perm_b32 v145, v151, v150, s30
v_accvgpr_write_b32 a117, v145
v_perm_b32 v144, v153, v152, s30
v_accvgpr_write_b32 a118, v144
v_perm_b32 v145, v155, v154, s30
v_accvgpr_write_b32 a119, v145
v_mfma_f32_32x32x16_bf16 v[16:31], a[112:115], v[48:51], v[16:31]
s_nop 0
v_mfma_f32_32x32x16_bf16 v[32:47], a[116:119], v[48:51], v[32:47]
s_waitcnt vmcnt(26)
ds_read_b128 v[52:55], v6 offset:15360
v_add_u32 v146, 2048, v14
ds_read2_b32 v[148:149], v146 offset0:0 offset1:32
ds_read2_b32 v[150:151], v146 offset0:64 offset1:96
ds_read2_b32 v[152:153], v146 offset0:128 offset1:160
ds_read2_b32 v[154:155], v146 offset0:192 offset1:224
s_waitcnt lgkmcnt(4)
s_add_u32 m0, s53, 0
s_mov_b32 s31, 5898240
buffer_load_dwordx4 v2, s[8:11], s31 offen lds
s_add_u32 m0, s53, 1024
s_mov_b32 s31, 5996544
buffer_load_dwordx4 v2, s[8:11], s31 offen lds
v_perm_b32 v144, v157, v156, s29
v_accvgpr_write_b32 a120, v144
v_perm_b32 v145, v159, v158, s29
v_accvgpr_write_b32 a121, v145
v_perm_b32 v144, v161, v160, s29
v_accvgpr_write_b32 a122, v144
v_perm_b32 v145, v163, v162, s29
v_accvgpr_write_b32 a123, v145
v_perm_b32 v144, v157, v156, s30
v_accvgpr_write_b32 a124, v144
v_perm_b32 v145, v159, v158, s30
v_accvgpr_write_b32 a125, v145
v_perm_b32 v144, v161, v160, s30
v_accvgpr_write_b32 a126, v144
v_perm_b32 v145, v163, v162, s30
v_accvgpr_write_b32 a127, v145
v_mfma_f32_32x32x16_bf16 v[16:31], a[120:123], v[52:55], v[16:31]
s_nop 0
v_mfma_f32_32x32x16_bf16 v[32:47], a[124:127], v[52:55], v[32:47]
s_waitcnt vmcnt(26)
ds_read_b128 v[48:51], v6 offset:16384
v_add_u32 v146, 4096, v14
ds_read2_b32 v[156:157], v146 offset0:0 offset1:32
ds_read2_b32 v[158:159], v146 offset0:64 offset1:96
ds_read2_b32 v[160:161], v146 offset0:128 offset1:160
ds_read2_b32 v[162:163], v146 offset0:192 offset1:224
s_waitcnt lgkmcnt(4)
s_add_u32 m0, s53, 2048
s_mov_b32 s31, 6094848
buffer_load_dwordx4 v2, s[8:11], s31 offen lds
s_add_u32 m0, s53, 3072
s_mov_b32 s31, 6193152
buffer_load_dwordx4 v2, s[8:11], s31 offen lds
v_perm_b32 v144, v149, v148, s29
v_accvgpr_write_b32 a128, v144
v_perm_b32 v145, v151, v150, s29
v_accvgpr_write_b32 a129, v145
v_perm_b32 v144, v153, v152, s29
v_accvgpr_write_b32 a130, v144
v_perm_b32 v145, v155, v154, s29
v_accvgpr_write_b32 a131, v145
v_perm_b32 v144, v149, v148, s30
v_accvgpr_write_b32 a132, v144
v_perm_b32 v145, v151, v150, s30
v_accvgpr_write_b32 a133, v145
v_perm_b32 v144, v153, v152, s30
v_accvgpr_write_b32 a134, v144
v_perm_b32 v145, v155, v154, s30
v_accvgpr_write_b32 a135, v145
v_mfma_f32_32x32x16_bf16 v[16:31], a[128:131], v[48:51], v[16:31]
s_nop 0
v_mfma_f32_32x32x16_bf16 v[32:47], a[132:135], v[48:51], v[32:47]
s_waitcnt vmcnt(26)
ds_read_b128 v[52:55], v6 offset:17408
v_add_u32 v146, 6144, v14
ds_read2_b32 v[148:149], v146 offset0:0 offset1:32
ds_read2_b32 v[150:151], v146 offset0:64 offset1:96
ds_read2_b32 v[152:153], v146 offset0:128 offset1:160
ds_read2_b32 v[154:155], v146 offset0:192 offset1:224
s_waitcnt lgkmcnt(4)
s_add_u32 m0, s53, 4096
s_mov_b32 s31, 6291456
buffer_load_dwordx4 v2, s[8:11], s31 offen lds
s_add_u32 m0, s53, 5120
s_mov_b32 s31, 6389760
buffer_load_dwordx4 v2, s[8:11], s31 offen lds
v_perm_b32 v144, v157, v156, s29
v_accvgpr_write_b32 a136, v144
v_perm_b32 v145, v159, v158, s29
v_accvgpr_write_b32 a137, v145
v_perm_b32 v144, v161, v160, s29
v_accvgpr_write_b32 a138, v144
v_perm_b32 v145, v163, v162, s29
v_accvgpr_write_b32 a139, v145
v_perm_b32 v144, v157, v156, s30
v_accvgpr_write_b32 a140, v144
v_perm_b32 v145, v159, v158, s30
v_accvgpr_write_b32 a141, v145
v_perm_b32 v144, v161, v160, s30
v_accvgpr_write_b32 a142, v144
v_perm_b32 v145, v163, v162, s30
v_accvgpr_write_b32 a143, v145
v_mfma_f32_32x32x16_bf16 v[16:31], a[136:139], v[52:55], v[16:31]
s_nop 0
v_mfma_f32_32x32x16_bf16 v[32:47], a[140:143], v[52:55], v[32:47]
s_waitcnt vmcnt(26)
ds_read_b128 v[48:51], v6 offset:18432
v_add_u32 v146, 8192, v14
ds_read2_b32 v[156:157], v146 offset0:0 offset1:32
ds_read2_b32 v[158:159], v146 offset0:64 offset1:96
ds_read2_b32 v[160:161], v146 offset0:128 offset1:160
ds_read2_b32 v[162:163], v146 offset0:192 offset1:224
s_waitcnt lgkmcnt(4)
s_add_u32 m0, s53, 6144
s_mov_b32 s31, 6488064
buffer_load_dwordx4 v2, s[8:11], s31 offen lds
s_add_u32 m0, s53, 7168
s_mov_b32 s31, 6586368
buffer_load_dwordx4 v2, s[8:11], s31 offen lds
v_perm_b32 v144, v149, v148, s29
v_accvgpr_write_b32 a144, v144
v_perm_b32 v145, v151, v150, s29
v_accvgpr_write_b32 a145, v145
v_perm_b32 v144, v153, v152, s29
v_accvgpr_write_b32 a146, v144
v_perm_b32 v145, v155, v154, s29
v_accvgpr_write_b32 a147, v145
v_perm_b32 v144, v149, v148, s30
v_accvgpr_write_b32 a148, v144
v_perm_b32 v145, v151, v150, s30
v_accvgpr_write_b32 a149, v145
v_perm_b32 v144, v153, v152, s30
v_accvgpr_write_b32 a150, v144
v_perm_b32 v145, v155, v154, s30
v_accvgpr_write_b32 a151, v145
v_mfma_f32_32x32x16_bf16 v[16:31], a[144:147], v[48:51], v[16:31]
s_nop 0
v_mfma_f32_32x32x16_bf16 v[32:47], a[148:151], v[48:51], v[32:47]
s_waitcnt vmcnt(26)
ds_read_b128 v[52:55], v6 offset:19456
v_add_u32 v146, 10240, v14
ds_read2_b32 v[148:149], v146 offset0:0 offset1:32
ds_read2_b32 v[150:151], v146 offset0:64 offset1:96
ds_read2_b32 v[152:153], v146 offset0:128 offset1:160
ds_read2_b32 v[154:155], v146 offset0:192 offset1:224
s_waitcnt lgkmcnt(4)
s_add_u32 m0, s53, 8192
s_mov_b32 s31, 6684672
buffer_load_dwordx4 v2, s[8:11], s31 offen lds
s_add_u32 m0, s53, 9216
s_mov_b32 s31, 6782976
buffer_load_dwordx4 v2, s[8:11], s31 offen lds
v_perm_b32 v144, v157, v156, s29
v_accvgpr_write_b32 a152, v144
v_perm_b32 v145, v159, v158, s29
v_accvgpr_write_b32 a153, v145
v_perm_b32 v144, v161, v160, s29
v_accvgpr_write_b32 a154, v144
v_perm_b32 v145, v163, v162, s29
v_accvgpr_write_b32 a155, v145
v_perm_b32 v144, v157, v156, s30
v_accvgpr_write_b32 a156, v144
v_perm_b32 v145, v159, v158, s30
v_accvgpr_write_b32 a157, v145
v_perm_b32 v144, v161, v160, s30
v_accvgpr_write_b32 a158, v144
v_perm_b32 v145, v163, v162, s30
v_accvgpr_write_b32 a159, v145
v_mfma_f32_32x32x16_bf16 v[16:31], a[152:155], v[52:55], v[16:31]
s_nop 0
v_mfma_f32_32x32x16_bf16 v[32:47], a[156:159], v[52:55], v[32:47]
s_waitcnt vmcnt(26)
ds_read_b128 v[48:51], v6 offset:20480
v_add_u32 v146, 12288, v14
ds_read2_b32 v[156:157], v146 offset0:0 offset1:32
ds_read2_b32 v[158:159], v146 offset0:64 offset1:96
ds_read2_b32 v[160:161], v146 offset0:128 offset1:160
ds_read2_b32 v[162:163], v146 offset0:192 offset1:224
s_waitcnt lgkmcnt(4)
s_add_u32 m0, s53, 10240
s_mov_b32 s31, 6881280
buffer_load_dwordx4 v2, s[8:11], s31 offen lds
s_add_u32 m0, s53, 11264
s_mov_b32 s31, 6979584
buffer_load_dwordx4 v2, s[8:11], s31 offen lds
v_perm_b32 v144, v149, v148, s29
v_accvgpr_write_b32 a160, v144
v_perm_b32 v145, v151, v150, s29
v_accvgpr_write_b32 a161, v145
v_perm_b32 v144, v153, v152, s29
v_accvgpr_write_b32 a162, v144
v_perm_b32 v145, v155, v154, s29
v_accvgpr_write_b32 a163, v145
v_perm_b32 v144, v149, v148, s30
v_accvgpr_write_b32 a164, v144
v_perm_b32 v145, v151, v150, s30
v_accvgpr_write_b32 a165, v145
v_perm_b32 v144, v153, v152, s30
v_accvgpr_write_b32 a166, v144
v_perm_b32 v145, v155, v154, s30
v_accvgpr_write_b32 a167, v145
v_mfma_f32_32x32x16_bf16 v[16:31], a[160:163], v[48:51], v[16:31]
s_nop 0
v_mfma_f32_32x32x16_bf16 v[32:47], a[164:167], v[48:51], v[32:47]
s_waitcnt vmcnt(26)
ds_read_b128 v[52:55], v6 offset:21504
v_add_u32 v146, 14336, v14
ds_read2_b32 v[148:149], v146 offset0:0 offset1:32
ds_read2_b32 v[150:151], v146 offset0:64 offset1:96
ds_read2_b32 v[152:153], v146 offset0:128 offset1:160
ds_read2_b32 v[154:155], v146 offset0:192 offset1:224
s_waitcnt lgkmcnt(4)
s_add_u32 m0, s53, 12288
s_mov_b32 s31, 7077888
buffer_load_dwordx4 v2, s[8:11], s31 offen lds
s_add_u32 m0, s53, 13312
s_mov_b32 s31, 7176192
buffer_load_dwordx4 v2, s[8:11], s31 offen lds
v_perm_b32 v144, v157, v156, s29
v_accvgpr_write_b32 a168, v144
v_perm_b32 v145, v159, v158, s29
v_accvgpr_write_b32 a169, v145
v_perm_b32 v144, v161, v160, s29
v_accvgpr_write_b32 a170, v144
v_perm_b32 v145, v163, v162, s29
v_accvgpr_write_b32 a171, v145
v_perm_b32 v144, v157, v156, s30
v_accvgpr_write_b32 a172, v144
v_perm_b32 v145, v159, v158, s30
v_accvgpr_write_b32 a173, v145
v_perm_b32 v144, v161, v160, s30
v_accvgpr_write_b32 a174, v144
v_perm_b32 v145, v163, v162, s30
v_accvgpr_write_b32 a175, v145
v_mfma_f32_32x32x16_bf16 v[16:31], a[168:171], v[52:55], v[16:31]
s_nop 0
v_mfma_f32_32x32x16_bf16 v[32:47], a[172:175], v[52:55], v[32:47]
s_waitcnt vmcnt(26)
ds_read_b128 v[48:51], v6 offset:22528
v_add_u32 v146, 16384, v14
ds_read2_b32 v[156:157], v146 offset0:0 offset1:32
ds_read2_b32 v[158:159], v146 offset0:64 offset1:96
ds_read2_b32 v[160:161], v146 offset0:128 offset1:160
ds_read2_b32 v[162:163], v146 offset0:192 offset1:224
s_waitcnt lgkmcnt(4)
s_add_u32 m0, s53, 14336
s_mov_b32 s31, 7274496
buffer_load_dwordx4 v2, s[8:11], s31 offen lds
s_add_u32 m0, s53, 15360
s_mov_b32 s31, 7372800
buffer_load_dwordx4 v2, s[8:11], s31 offen lds
v_perm_b32 v144, v149, v148, s29
v_accvgpr_write_b32 a176, v144
v_perm_b32 v145, v151, v150, s29
v_accvgpr_write_b32 a177, v145
v_perm_b32 v144, v153, v152, s29
v_accvgpr_write_b32 a178, v144
v_perm_b32 v145, v155, v154, s29
v_accvgpr_write_b32 a179, v145
v_perm_b32 v144, v149, v148, s30
v_accvgpr_write_b32 a180, v144
v_perm_b32 v145, v151, v150, s30
v_accvgpr_write_b32 a181, v145
v_perm_b32 v144, v153, v152, s30
v_accvgpr_write_b32 a182, v144
v_perm_b32 v145, v155, v154, s30
v_accvgpr_write_b32 a183, v145
v_mfma_f32_32x32x16_bf16 v[16:31], a[176:179], v[48:51], v[16:31]
s_nop 0
v_mfma_f32_32x32x16_bf16 v[32:47], a[180:183], v[48:51], v[32:47]
s_waitcnt vmcnt(26)
ds_read_b128 v[52:55], v6 offset:23552
v_add_u32 v146, 18432, v14
ds_read2_b32 v[148:149], v146 offset0:0 offset1:32
ds_read2_b32 v[150:151], v146 offset0:64 offset1:96
ds_read2_b32 v[152:153], v146 offset0:128 offset1:160
ds_read2_b32 v[154:155], v146 offset0:192 offset1:224
s_waitcnt lgkmcnt(4)
s_add_u32 m0, s53, 16384
s_mov_b32 s31, 7471104
buffer_load_dwordx4 v2, s[8:11], s31 offen lds
s_add_u32 m0, s53, 17408
s_mov_b32 s31, 7569408
buffer_load_dwordx4 v2, s[8:11], s31 offen lds
v_perm_b32 v144, v157, v156, s29
v_accvgpr_write_b32 a184, v144
v_perm_b32 v145, v159, v158, s29
v_accvgpr_write_b32 a185, v145
v_perm_b32 v144, v161, v160, s29
v_accvgpr_write_b32 a186, v144
v_perm_b32 v145, v163, v162, s29
v_accvgpr_write_b32 a187, v145
v_perm_b32 v144, v157, v156, s30
v_accvgpr_write_b32 a188, v144
v_perm_b32 v145, v159, v158, s30
v_accvgpr_write_b32 a189, v145
v_perm_b32 v144, v161, v160, s30
v_accvgpr_write_b32 a190, v144
v_perm_b32 v145, v163, v162, s30
v_accvgpr_write_b32 a191, v145
v_mfma_f32_32x32x16_bf16 v[16:31], a[184:187], v[52:55], v[16:31]
s_nop 0
v_mfma_f32_32x32x16_bf16 v[32:47], a[188:191], v[52:55], v[32:47]
s_waitcnt vmcnt(26)
ds_read_b128 v[48:51], v6 offset:24576
v_add_u32 v146, 20480, v14
ds_read2_b32 v[156:157], v146 offset0:0 offset1:32
ds_read2_b32 v[158:159], v146 offset0:64 offset1:96
ds_read2_b32 v[160:161], v146 offset0:128 offset1:160
ds_read2_b32 v[162:163], v146 offset0:192 offset1:224
s_waitcnt lgkmcnt(4)
s_add_u32 m0, s53, 18432
s_mov_b32 s31, 7667712
buffer_load_dwordx4 v2, s[8:11], s31 offen lds
s_add_u32 m0, s53, 19456
s_mov_b32 s31, 7766016
buffer_load_dwordx4 v2, s[8:11], s31 offen lds
v_perm_b32 v144, v149, v148, s29
v_accvgpr_write_b32 a192, v144
v_perm_b32 v145, v151, v150, s29
v_accvgpr_write_b32 a193, v145
v_perm_b32 v144, v153, v152, s29
v_accvgpr_write_b32 a194, v144
v_perm_b32 v145, v155, v154, s29
v_accvgpr_write_b32 a195, v145
v_perm_b32 v144, v149, v148, s30
v_accvgpr_write_b32 a196, v144
v_perm_b32 v145, v151, v150, s30
v_accvgpr_write_b32 a197, v145
v_perm_b32 v144, v153, v152, s30
v_accvgpr_write_b32 a198, v144
v_perm_b32 v145, v155, v154, s30
v_accvgpr_write_b32 a199, v145
v_mfma_f32_32x32x16_bf16 v[16:31], a[192:195], v[48:51], v[16:31]
s_nop 0
v_mfma_f32_32x32x16_bf16 v[32:47], a[196:199], v[48:51], v[32:47]
s_waitcnt vmcnt(26)
ds_read_b128 v[52:55], v6 offset:25600
v_add_u32 v146, 22528, v14
ds_read2_b32 v[148:149], v146 offset0:0 offset1:32
ds_read2_b32 v[150:151], v146 offset0:64 offset1:96
ds_read2_b32 v[152:153], v146 offset0:128 offset1:160
ds_read2_b32 v[154:155], v146 offset0:192 offset1:224
s_waitcnt lgkmcnt(4)
v_perm_b32 v144, v157, v156, s29
v_accvgpr_write_b32 a200, v144
v_perm_b32 v145, v159, v158, s29
v_accvgpr_write_b32 a201, v145
v_perm_b32 v144, v161, v160, s29
v_accvgpr_write_b32 a202, v144
v_perm_b32 v145, v163, v162, s29
v_accvgpr_write_b32 a203, v145
v_perm_b32 v144, v157, v156, s30
v_accvgpr_write_b32 a204, v144
v_perm_b32 v145, v159, v158, s30
v_accvgpr_write_b32 a205, v145
v_perm_b32 v144, v161, v160, s30
v_accvgpr_write_b32 a206, v144
v_perm_b32 v145, v163, v162, s30
v_accvgpr_write_b32 a207, v145
v_mfma_f32_32x32x16_bf16 v[16:31], a[200:203], v[52:55], v[16:31]
s_nop 0
v_mfma_f32_32x32x16_bf16 v[32:47], a[204:207], v[52:55], v[32:47]
s_waitcnt vmcnt(24)
ds_read_b128 v[48:51], v6 offset:26624
v_add_u32 v146, 24576, v14
ds_read2_b32 v[156:157], v146 offset0:0 offset1:32
ds_read2_b32 v[158:159], v146 offset0:64 offset1:96
ds_read2_b32 v[160:161], v146 offset0:128 offset1:160
ds_read2_b32 v[162:163], v146 offset0:192 offset1:224
s_waitcnt lgkmcnt(4)
v_perm_b32 v144, v149, v148, s29
v_accvgpr_write_b32 a208, v144
v_perm_b32 v145, v151, v150, s29
v_accvgpr_write_b32 a209, v145
v_perm_b32 v144, v153, v152, s29
v_accvgpr_write_b32 a210, v144
v_perm_b32 v145, v155, v154, s29
v_accvgpr_write_b32 a211, v145
v_perm_b32 v144, v149, v148, s30
v_accvgpr_write_b32 a212, v144
v_perm_b32 v145, v151, v150, s30
v_accvgpr_write_b32 a213, v145
v_perm_b32 v144, v153, v152, s30
v_accvgpr_write_b32 a214, v144
v_perm_b32 v145, v155, v154, s30
v_accvgpr_write_b32 a215, v145
v_mfma_f32_32x32x16_bf16 v[16:31], a[208:211], v[48:51], v[16:31]
s_nop 0
v_mfma_f32_32x32x16_bf16 v[32:47], a[212:215], v[48:51], v[32:47]
s_waitcnt vmcnt(22)
ds_read_b128 v[52:55], v6 offset:27648
v_add_u32 v146, 26624, v14
ds_read2_b32 v[148:149], v146 offset0:0 offset1:32
ds_read2_b32 v[150:151], v146 offset0:64 offset1:96
ds_read2_b32 v[152:153], v146 offset0:128 offset1:160
ds_read2_b32 v[154:155], v146 offset0:192 offset1:224
s_waitcnt lgkmcnt(4)
v_perm_b32 v144, v157, v156, s29
v_accvgpr_write_b32 a216, v144
v_perm_b32 v145, v159, v158, s29
v_accvgpr_write_b32 a217, v145
v_perm_b32 v144, v161, v160, s29
v_accvgpr_write_b32 a218, v144
v_perm_b32 v145, v163, v162, s29
v_accvgpr_write_b32 a219, v145
v_perm_b32 v144, v157, v156, s30
v_accvgpr_write_b32 a220, v144
v_perm_b32 v145, v159, v158, s30
v_accvgpr_write_b32 a221, v145
v_perm_b32 v144, v161, v160, s30
v_accvgpr_write_b32 a222, v144
v_perm_b32 v145, v163, v162, s30
v_accvgpr_write_b32 a223, v145
v_mfma_f32_32x32x16_bf16 v[16:31], a[216:219], v[52:55], v[16:31]
s_nop 0
v_mfma_f32_32x32x16_bf16 v[32:47], a[220:223], v[52:55], v[32:47]
s_waitcnt vmcnt(20)
ds_read_b128 v[48:51], v6 offset:28672
v_add_u32 v146, 28672, v14
ds_read2_b32 v[156:157], v146 offset0:0 offset1:32
ds_read2_b32 v[158:159], v146 offset0:64 offset1:96
ds_read2_b32 v[160:161], v146 offset0:128 offset1:160
ds_read2_b32 v[162:163], v146 offset0:192 offset1:224
s_waitcnt lgkmcnt(4)
v_perm_b32 v144, v149, v148, s29
v_accvgpr_write_b32 a224, v144
v_perm_b32 v145, v151, v150, s29
v_accvgpr_write_b32 a225, v145
v_perm_b32 v144, v153, v152, s29
v_accvgpr_write_b32 a226, v144
v_perm_b32 v145, v155, v154, s29
v_accvgpr_write_b32 a227, v145
v_perm_b32 v144, v149, v148, s30
v_accvgpr_write_b32 a228, v144
v_perm_b32 v145, v151, v150, s30
v_accvgpr_write_b32 a229, v145
v_perm_b32 v144, v153, v152, s30
v_accvgpr_write_b32 a230, v144
v_perm_b32 v145, v155, v154, s30
v_accvgpr_write_b32 a231, v145
v_mfma_f32_32x32x16_bf16 v[16:31], a[224:227], v[48:51], v[16:31]
s_nop 0
v_mfma_f32_32x32x16_bf16 v[32:47], a[228:231], v[48:51], v[32:47]
s_waitcnt vmcnt(18)
ds_read_b128 v[52:55], v6 offset:29696
v_add_u32 v146, 0, v14
ds_read2_b32 v[148:149], v146 offset0:0 offset1:32
ds_read2_b32 v[150:151], v146 offset0:64 offset1:96
ds_read2_b32 v[152:153], v146 offset0:128 offset1:160
ds_read2_b32 v[154:155], v146 offset0:192 offset1:224
s_waitcnt lgkmcnt(4)
v_perm_b32 v144, v157, v156, s29
v_accvgpr_write_b32 a232, v144
v_perm_b32 v145, v159, v158, s29
v_accvgpr_write_b32 a233, v145
v_perm_b32 v144, v161, v160, s29
v_accvgpr_write_b32 a234, v144
v_perm_b32 v145, v163, v162, s29
v_accvgpr_write_b32 a235, v145
v_perm_b32 v144, v157, v156, s30
v_accvgpr_write_b32 a236, v144
v_perm_b32 v145, v159, v158, s30
v_accvgpr_write_b32 a237, v145
v_perm_b32 v144, v161, v160, s30
v_accvgpr_write_b32 a238, v144
v_perm_b32 v145, v163, v162, s30
v_accvgpr_write_b32 a239, v145
v_mfma_f32_32x32x16_bf16 v[16:31], a[232:235], v[52:55], v[16:31]
s_nop 0
v_mfma_f32_32x32x16_bf16 v[32:47], a[236:239], v[52:55], v[32:47]
s_waitcnt vmcnt(16)
ds_read_b128 v[48:51], v6 offset:30720
v_add_u32 v146, 2048, v14
ds_read2_b32 v[156:157], v146 offset0:0 offset1:32
ds_read2_b32 v[158:159], v146 offset0:64 offset1:96
ds_read2_b32 v[160:161], v146 offset0:128 offset1:160
ds_read2_b32 v[162:163], v146 offset0:192 offset1:224
s_waitcnt lgkmcnt(4)
v_perm_b32 v144, v149, v148, s29
v_accvgpr_write_b32 a240, v144
v_perm_b32 v145, v151, v150, s29
v_accvgpr_write_b32 a241, v145
v_perm_b32 v144, v153, v152, s29
v_accvgpr_write_b32 a242, v144
v_perm_b32 v145, v155, v154, s29
v_accvgpr_write_b32 a243, v145
v_perm_b32 v144, v149, v148, s30
v_accvgpr_write_b32 a244, v144
v_perm_b32 v145, v151, v150, s30
v_accvgpr_write_b32 a245, v145
v_perm_b32 v144, v153, v152, s30
v_accvgpr_write_b32 a246, v144
v_perm_b32 v145, v155, v154, s30
v_accvgpr_write_b32 a247, v145
v_mfma_f32_32x32x16_bf16 v[16:31], a[240:243], v[48:51], v[16:31]
s_nop 0
v_mfma_f32_32x32x16_bf16 v[32:47], a[244:247], v[48:51], v[32:47]
s_waitcnt vmcnt(14)
ds_read_b128 v[52:55], v6 offset:31744
v_add_u32 v146, 4096, v14
ds_read2_b32 v[148:149], v146 offset0:0 offset1:32
ds_read2_b32 v[150:151], v146 offset0:64 offset1:96
ds_read2_b32 v[152:153], v146 offset0:128 offset1:160
ds_read2_b32 v[154:155], v146 offset0:192 offset1:224
s_waitcnt lgkmcnt(4)
v_perm_b32 v144, v157, v156, s29
v_accvgpr_write_b32 a248, v144
v_perm_b32 v145, v159, v158, s29
v_accvgpr_write_b32 a249, v145
v_perm_b32 v144, v161, v160, s29
v_accvgpr_write_b32 a250, v144
v_perm_b32 v145, v163, v162, s29
v_accvgpr_write_b32 a251, v145
v_perm_b32 v144, v157, v156, s30
v_accvgpr_write_b32 a252, v144
v_perm_b32 v145, v159, v158, s30
v_accvgpr_write_b32 a253, v145
v_perm_b32 v144, v161, v160, s30
v_accvgpr_write_b32 a254, v144
v_perm_b32 v145, v163, v162, s30
v_accvgpr_write_b32 a255, v145
v_mfma_f32_32x32x16_bf16 v[16:31], a[248:251], v[52:55], v[16:31]
s_nop 0
v_mfma_f32_32x32x16_bf16 v[32:47], a[252:255], v[52:55], v[32:47]
s_waitcnt vmcnt(12)
ds_read_b128 v[48:51], v6 offset:32768
v_add_u32 v146, 6144, v14
ds_read2_b32 v[156:157], v146 offset0:0 offset1:32
ds_read2_b32 v[158:159], v146 offset0:64 offset1:96
ds_read2_b32 v[160:161], v146 offset0:128 offset1:160
ds_read2_b32 v[162:163], v146 offset0:192 offset1:224
s_waitcnt lgkmcnt(4)
v_perm_b32 v192, v149, v148, s29
v_perm_b32 v193, v151, v150, s29
v_perm_b32 v194, v153, v152, s29
v_perm_b32 v195, v155, v154, s29
v_perm_b32 v196, v149, v148, s30
v_perm_b32 v197, v151, v150, s30
v_perm_b32 v198, v153, v152, s30
v_perm_b32 v199, v155, v154, s30
v_mfma_f32_32x32x16_bf16 v[16:31], v[192:195], v[48:51], v[16:31]
s_nop 0
v_mfma_f32_32x32x16_bf16 v[32:47], v[196:199], v[48:51], v[32:47]
s_waitcnt vmcnt(10)
ds_read_b128 v[52:55], v6 offset:33792
v_add_u32 v146, 8192, v14
ds_read2_b32 v[148:149], v146 offset0:0 offset1:32
ds_read2_b32 v[150:151], v146 offset0:64 offset1:96
ds_read2_b32 v[152:153], v146 offset0:128 offset1:160
ds_read2_b32 v[154:155], v146 offset0:192 offset1:224
s_waitcnt lgkmcnt(4)
v_perm_b32 v200, v157, v156, s29
v_perm_b32 v201, v159, v158, s29
v_perm_b32 v202, v161, v160, s29
v_perm_b32 v203, v163, v162, s29
v_perm_b32 v204, v157, v156, s30
v_perm_b32 v205, v159, v158, s30
v_perm_b32 v206, v161, v160, s30
v_perm_b32 v207, v163, v162, s30
v_mfma_f32_32x32x16_bf16 v[16:31], v[200:203], v[52:55], v[16:31]
s_nop 0
v_mfma_f32_32x32x16_bf16 v[32:47], v[204:207], v[52:55], v[32:47]
s_waitcnt vmcnt(8)
ds_read_b128 v[48:51], v6 offset:34816
v_add_u32 v146, 10240, v14
ds_read2_b32 v[156:157], v146 offset0:0 offset1:32
ds_read2_b32 v[158:159], v146 offset0:64 offset1:96
ds_read2_b32 v[160:161], v146 offset0:128 offset1:160
ds_read2_b32 v[162:163], v146 offset0:192 offset1:224
s_waitcnt lgkmcnt(4)
v_perm_b32 v208, v149, v148, s29
v_perm_b32 v209, v151, v150, s29
v_perm_b32 v210, v153, v152, s29
v_perm_b32 v211, v155, v154, s29
v_perm_b32 v212, v149, v148, s30
v_perm_b32 v213, v151, v150, s30
v_perm_b32 v214, v153, v152, s30
v_perm_b32 v215, v155, v154, s30
v_mfma_f32_32x32x16_bf16 v[16:31], v[208:211], v[48:51], v[16:31]
s_nop 0
v_mfma_f32_32x32x16_bf16 v[32:47], v[212:215], v[48:51], v[32:47]
s_waitcnt vmcnt(6)
ds_read_b128 v[52:55], v6 offset:35840
v_add_u32 v146, 12288, v14
ds_read2_b32 v[148:149], v146 offset0:0 offset1:32
ds_read2_b32 v[150:151], v146 offset0:64 offset1:96
ds_read2_b32 v[152:153], v146 offset0:128 offset1:160
ds_read2_b32 v[154:155], v146 offset0:192 offset1:224
s_waitcnt lgkmcnt(4)
v_perm_b32 v216, v157, v156, s29
v_perm_b32 v217, v159, v158, s29
v_perm_b32 v218, v161, v160, s29
v_perm_b32 v219, v163, v162, s29
v_perm_b32 v220, v157, v156, s30
v_perm_b32 v221, v159, v158, s30
v_perm_b32 v222, v161, v160, s30
v_perm_b32 v223, v163, v162, s30
v_mfma_f32_32x32x16_bf16 v[16:31], v[216:219], v[52:55], v[16:31]
s_nop 0
v_mfma_f32_32x32x16_bf16 v[32:47], v[220:223], v[52:55], v[32:47]
s_waitcnt vmcnt(4)
ds_read_b128 v[48:51], v6 offset:36864
v_add_u32 v146, 14336, v14
ds_read2_b32 v[156:157], v146 offset0:0 offset1:32
ds_read2_b32 v[158:159], v146 offset0:64 offset1:96
ds_read2_b32 v[160:161], v146 offset0:128 offset1:160
ds_read2_b32 v[162:163], v146 offset0:192 offset1:224
s_waitcnt lgkmcnt(4)
v_perm_b32 v224, v149, v148, s29
v_perm_b32 v225, v151, v150, s29
v_perm_b32 v226, v153, v152, s29
v_perm_b32 v227, v155, v154, s29
v_perm_b32 v228, v149, v148, s30
v_perm_b32 v229, v151, v150, s30
v_perm_b32 v230, v153, v152, s30
v_perm_b32 v231, v155, v154, s30
v_mfma_f32_32x32x16_bf16 v[16:31], v[224:227], v[48:51], v[16:31]
s_nop 0
v_mfma_f32_32x32x16_bf16 v[32:47], v[228:231], v[48:51], v[32:47]
s_waitcnt vmcnt(2)
ds_read_b128 v[52:55], v6 offset:37888
v_add_u32 v146, 16384, v14
ds_read2_b32 v[148:149], v146 offset0:0 offset1:32
ds_read2_b32 v[150:151], v146 offset0:64 offset1:96
ds_read2_b32 v[152:153], v146 offset0:128 offset1:160
ds_read2_b32 v[154:155], v146 offset0:192 offset1:224
s_waitcnt lgkmcnt(4)
v_perm_b32 v232, v157, v156, s29
v_perm_b32 v233, v159, v158, s29
v_perm_b32 v234, v161, v160, s29
v_perm_b32 v235, v163, v162, s29
v_perm_b32 v236, v157, v156, s30
v_perm_b32 v237, v159, v158, s30
v_perm_b32 v238, v161, v160, s30
v_perm_b32 v239, v163, v162, s30
v_mfma_f32_32x32x16_bf16 v[16:31], v[232:235], v[52:55], v[16:31]
s_nop 0
v_mfma_f32_32x32x16_bf16 v[32:47], v[236:239], v[52:55], v[32:47]
s_waitcnt vmcnt(0)
ds_read_b128 v[48:51], v6 offset:38912
v_add_u32 v146, 18432, v14
ds_read2_b32 v[156:157], v146 offset0:0 offset1:32
ds_read2_b32 v[158:159], v146 offset0:64 offset1:96
ds_read2_b32 v[160:161], v146 offset0:128 offset1:160
ds_read2_b32 v[162:163], v146 offset0:192 offset1:224
s_waitcnt lgkmcnt(4)
v_perm_b32 v240, v149, v148, s29
v_perm_b32 v241, v151, v150, s29
v_perm_b32 v242, v153, v152, s29
v_perm_b32 v243, v155, v154, s29
v_perm_b32 v244, v149, v148, s30
v_perm_b32 v245, v151, v150, s30
v_perm_b32 v246, v153, v152, s30
v_perm_b32 v247, v155, v154, s30
v_mfma_f32_32x32x16_bf16 v[16:31], v[240:243], v[48:51], v[16:31]
s_nop 0
v_mfma_f32_32x32x16_bf16 v[32:47], v[244:247], v[48:51], v[32:47]
ds_read_b128 v[52:55], v6 offset:39936
s_waitcnt lgkmcnt(0)
v_perm_b32 v248, v157, v156, s29
v_perm_b32 v249, v159, v158, s29
v_perm_b32 v250, v161, v160, s29
v_perm_b32 v251, v163, v162, s29
v_perm_b32 v252, v157, v156, s30
v_perm_b32 v253, v159, v158, s30
v_perm_b32 v254, v161, v160, s30
v_perm_b32 v255, v163, v162, s30
v_mfma_f32_32x32x16_bf16 v[16:31], v[248:251], v[52:55], v[16:31]
s_nop 0
v_mfma_f32_32x32x16_bf16 v[32:47], v[252:255], v[52:55], v[32:47]
s_cmp_lg_u32 s28, 0
s_cbranch_scc1 Lgwd_64
Lgw_63:
buffer_load_dwordx2 v[8:9], off, s[20:23], 0 sc1
s_waitcnt vmcnt(0)
v_cmp_gt_u32 vcc, 255, v8
s_cbranch_vccz Lgwe_65
s_cmp_eq_u32 s25, 0
s_cbranch_scc1 Lgwe_65
s_sub_u32 s25, s25, 1
s_sleep 4
s_branch Lgw_63
Lgwe_65:
Lgwd_64:
s_barrier
s_add_u32 s39, s37, s38
s_add_u32 s40, s39, s38
s_add_u32 s41, s40, s38
s_nop 5
v_cvt_pk_bf16_f32 v64, v16, v32
v_cvt_pk_bf16_f32 v65, v17, v33
v_cvt_pk_bf16_f32 v66, v18, v34
v_cvt_pk_bf16_f32 v67, v19, v35
buffer_store_dwordx4 v[64:67], v4, s[4:7], s37 offen sc1
v_cvt_pk_bf16_f32 v68, v20, v36
v_cvt_pk_bf16_f32 v69, v21, v37
v_cvt_pk_bf16_f32 v70, v22, v38
v_cvt_pk_bf16_f32 v71, v23, v39
buffer_store_dwordx4 v[68:71], v4, s[4:7], s39 offen sc1
v_cvt_pk_bf16_f32 v72, v24, v40
v_cvt_pk_bf16_f32 v73, v25, v41
v_cvt_pk_bf16_f32 v74, v26, v42
v_cvt_pk_bf16_f32 v75, v27, v43
buffer_store_dwordx4 v[72:75], v4, s[4:7], s40 offen sc1
v_cvt_pk_bf16_f32 v76, v28, v44
v_cvt_pk_bf16_f32 v77, v29, v45
v_cvt_pk_bf16_f32 v78, v30, v46
v_cvt_pk_bf16_f32 v79, v31, v47
buffer_store_dwordx4 v[76:79], v4, s[4:7], s41 offen sc1
s_mul_i32 s44, s28, 10240
s_add_u32 s44, s44, 40960
s_add_u32 s43, s44, 7340032
s_add_u32 m0, s44, 0
s_add_u32 s46, s43, 0
buffer_load_dwordx4 v6, s[4:7], s46 offen offset:0 sc1 lds
buffer_load_dwordx4 v6, s[4:7], s46 offen offset:1024 sc1 lds
buffer_load_dwordx4 v6, s[4:7], s46 offen offset:2048 sc1 lds
buffer_load_dwordx4 v6, s[4:7], s46 offen offset:3072 sc1 lds
s_add_u32 m0, s44, 4096
s_add_u32 s46, s43, 4096
buffer_load_dwordx4 v6, s[4:7], s46 offen offset:0 sc1 lds
buffer_load_dwordx4 v6, s[4:7], s46 offen offset:1024 sc1 lds
buffer_load_dwordx4 v6, s[4:7], s46 offen offset:2048 sc1 lds
buffer_load_dwordx4 v6, s[4:7], s46 offen offset:3072 sc1 lds
s_add_u32 m0, s44, 8192
s_add_u32 s46, s43, 8192
buffer_load_dwordx4 v6, s[4:7], s46 offen offset:0 sc1 lds
buffer_load_dwordx4 v6, s[4:7], s46 offen offset:1024 sc1 lds
s_add_u32 s37, s37, s42
s_mov_b32 s24, 1
v_mov_b32 v8, 1
s_mov_b32 s45, 40960
s_waitcnt vmcnt(10)
buffer_store_dword v8, v5, s[4:7], 0 offen sc1
s_waitcnt vmcnt(1)
Lg1_loop:
s_waitcnt vmcnt(5)
s_barrier
v_add_u32 v7, s45, v6
s_xor_b32 s45, s45, 40960
s_mul_i32 s44, s28, 10240
s_add_u32 s44, s44, s45
s_add_u32 s43, s43, 40960
ds_read_b128 v[48:51], v7 offset:0
ds_read_b128 v[52:55], v7 offset:1024
ds_read_b128 v[56:59], v7 offset:2048
v_mov_b32 v8, s24
ds_read_b128 v[60:63], v7 offset:3072
s_waitcnt lgkmcnt(3)
v_mfma_f32_32x32x16_bf16 v[16:31], a[0:3], v[48:51], 0
v_mfma_f32_32x32x16_bf16 v[32:47], a[4:7], v[48:51], 0
s_add_u32 m0, s44, 0
s_add_u32 s46, s43, 0
buffer_load_dwordx4 v6, s[4:7], s46 offen offset:0 sc1 lds
ds_read_b128 v[48:51], v7 offset:4096
s_waitcnt lgkmcnt(3)
v_mfma_f32_32x32x16_bf16 v[16:31], a[8:11], v[52:55], v[16:31]
v_mfma_f32_32x32x16_bf16 v[32:47], a[12:15], v[52:55], v[32:47]
buffer_load_dwordx4 v6, s[4:7], s46 offen offset:1024 sc1 lds
ds_read_b128 v[52:55], v7 offset:5120
s_waitcnt lgkmcnt(3)
v_mfma_f32_32x32x16_bf16 v[16:31], a[16:19], v[56:59], v[16:31]
v_mfma_f32_32x32x16_bf16 v[32:47], a[20:23], v[56:59], v[32:47]
buffer_load_dwordx4 v6, s[4:7], s46 offen offset:2048 sc1 lds
ds_read_b128 v[56:59], v7 offset:6144
s_waitcnt lgkmcnt(3)
v_mfma_f32_32x32x16_bf16 v[16:31], a[24:27], v[60:63], v[16:31]
v_mfma_f32_32x32x16_bf16 v[32:47], a[28:31], v[60:63], v[32:47]
buffer_load_dwordx4 v6, s[4:7], s46 offen offset:3072 sc1 lds
ds_read_b128 v[60:63], v7 offset:7168
s_waitcnt lgkmcnt(3)
v_mfma_f32_32x32x16_bf16 v[16:31], a[32:35], v[48:51], v[16:31]
v_mfma_f32_32x32x16_bf16 v[32:47], a[36:39], v[48:51], v[32:47]
s_add_u32 m0, s44, 4096
s_add_u32 s46, s43, 4096
buffer_load_dwordx4 v6, s[4:7], s46 offen offset:0 sc1 lds
ds_read_b128 v[48:51], v7 offset:8192
s_waitcnt lgkmcnt(3)
v_mfma_f32_32x32x16_bf16 v[16:31], a[40:43], v[52:55], v[16:31]
v_mfma_f32_32x32x16_bf16 v[32:47], a[44:47], v[52:55], v[32:47]
buffer_load_dwordx4 v6, s[4:7], s46 offen offset:1024 sc1 lds
ds_read_b128 v[52:55], v7 offset:9216
s_waitcnt lgkmcnt(3)
v_mfma_f32_32x32x16_bf16 v[16:31], a[48:51], v[56:59], v[16:31]
v_mfma_f32_32x32x16_bf16 v[32:47], a[52:55], v[56:59], v[32:47]
buffer_load_dwordx4 v6, s[4:7], s46 offen offset:2048 sc1 lds
ds_read_b128 v[56:59], v7 offset:10240
s_waitcnt lgkmcnt(3)
v_mfma_f32_32x32x16_bf16 v[16:31], a[56:59], v[60:63], v[16:31]
v_mfma_f32_32x32x16_bf16 v[32:47], a[60:63], v[60:63], v[32:47]
buffer_load_dwordx4 v6, s[4:7], s46 offen offset:3072 sc1 lds
ds_read_b128 v[60:63], v7 offset:11264
s_waitcnt lgkmcnt(3)
v_mfma_f32_32x32x16_bf16 v[16:31], a[64:67], v[48:51], v[16:31]
v_mfma_f32_32x32x16_bf16 v[32:47], a[68:71], v[48:51], v[32:47]
s_add_u32 m0, s44, 8192
s_add_u32 s46, s43, 8192
buffer_load_dwordx4 v6, s[4:7], s46 offen offset:0 sc1 lds
ds_read_b128 v[48:51], v7 offset:12288
s_waitcnt lgkmcnt(3)
v_mfma_f32_32x32x16_bf16 v[16:31], a[72:75], v[52:55], v[16:31]
v_mfma_f32_32x32x16_bf16 v[32:47], a[76:79], v[52:55], v[32:47]
buffer_load_dwordx4 v6, s[4:7], s46 offen offset:1024 sc1 lds
ds_read_b128 v[52:55], v7 offset:13312
s_waitcnt lgkmcnt(3)
v_mfma_f32_32x32x16_bf16 v[16:31], a[80:83], v[56:59], v[16:31]
v_mfma_f32_32x32x16_bf16 v[32:47], a[84:87], v[56:59], v[32:47]
s_cmp_gt_i32 s24, 4
s_cbranch_scc1 Lef_66
s_waitcnt vmcnt(10)
buffer_store_dword v8, v5, s[4:7], 0 offen sc1
Lef_66:
ds_read_b128 v[56:59], v7 offset:14336
s_waitcnt lgkmcnt(3)
v_mfma_f32_32x32x16_bf16 v[16:31], a[88:91], v[60:63], v[16:31]
v_mfma_f32_32x32x16_bf16 v[32:47], a[92:95], v[60:63], v[32:47]
ds_read_b128 v[60:63], v7 offset:15360
s_waitcnt lgkmcnt(3)
v_mfma_f32_32x32x16_bf16 v[16:31], a[96:99], v[48:51], v[16:31]
v_mfma_f32_32x32x16_bf16 v[32:47], a[100:103], v[48:51], v[32:47]
ds_read_b128 v[48:51], v7 offset:16384
s_waitcnt lgkmcnt(3)
v_mfma_f32_32x32x16_bf16 v[16:31], a[104:107], v[52:55], v[16:31]
v_mfma_f32_32x32x16_bf16 v[32:47], a[108:111], v[52:55], v[32:47]
ds_read_b128 v[52:55], v7 offset:17408
s_waitcnt lgkmcnt(3)
v_mfma_f32_32x32x16_bf16 v[16:31], a[112:115], v[56:59], v[16:31]
v_mfma_f32_32x32x16_bf16 v[32:47], a[116:119], v[56:59], v[32:47]
ds_read_b128 v[56:59], v7 offset:18432
s_waitcnt lgkmcnt(3)
v_mfma_f32_32x32x16_bf16 v[16:31], a[120:123], v[60:63], v[16:31]
v_mfma_f32_32x32x16_bf16 v[32:47], a[124:127], v[60:63], v[32:47]
ds_read_b128 v[60:63], v7 offset:19456
s_waitcnt lgkmcnt(3)
v_mfma_f32_32x32x16_bf16 v[16:31], a[128:131], v[48:51], v[16:31]
v_mfma_f32_32x32x16_bf16 v[32:47], a[132:135], v[48:51], v[32:47]
ds_read_b128 v[48:51], v7 offset:20480
s_waitcnt lgkmcnt(3)
v_mfma_f32_32x32x16_bf16 v[16:31], a[136:139], v[52:55], v[16:31]
v_mfma_f32_32x32x16_bf16 v[32:47], a[140:143], v[52:55], v[32:47]
ds_read_b128 v[52:55], v7 offset:21504
s_waitcnt lgkmcnt(3)
v_mfma_f32_32x32x16_bf16 v[16:31], a[144:147], v[56:59], v[16:31]
v_mfma_f32_32x32x16_bf16 v[32:47], a[148:151], v[56:59], v[32:47]
ds_read_b128 v[56:59], v7 offset:22528
s_waitcnt lgkmcnt(3)
v_mfma_f32_32x32x16_bf16 v[16:31], a[152:155], v[60:63], v[16:31]
v_mfma_f32_32x32x16_bf16 v[32:47], a[156:159], v[60:63], v[32:47]
ds_read_b128 v[60:63], v7 offset:23552
s_waitcnt lgkmcnt(3)
v_mfma_f32_32x32x16_bf16 v[16:31], a[160:163], v[48:51], v[16:31]
v_mfma_f32_32x32x16_bf16 v[32:47], a[164:167], v[48:51], v[32:47]
ds_read_b128 v[48:51], v7 offset:24576
s_waitcnt lgkmcnt(3)
v_mfma_f32_32x32x16_bf16 v[16:31], a[168:171], v[52:55], v[16:31]
v_mfma_f32_32x32x16_bf16 v[32:47], a[172:175], v[52:55], v[32:47]
ds_read_b128 v[52:55], v7 offset:25600
s_waitcnt lgkmcnt(3)
v_mfma_f32_32x32x16_bf16 v[16:31], a[176:179], v[56:59], v[16:31]
v_mfma_f32_32x32x16_bf16 v[32:47], a[180:183], v[56:59], v[32:47]
ds_read_b128 v[56:59], v7 offset:26624
s_waitcnt lgkmcnt(3)
v_mfma_f32_32x32x16_bf16 v[16:31], a[184:187], v[60:63], v[16:31]
v_mfma_f32_32x32x16_bf16 v[32:47], a[188:191], v[60:63], v[32:47]
ds_read_b128 v[60:63], v7 offset:27648
s_waitcnt lgkmcnt(3)
v_mfma_f32_32x32x16_bf16 v[16:31], a[192:195], v[48:51], v[16:31]
v_mfma_f32_32x32x16_bf16 v[32:47], a[196:199], v[48:51], v[32:47]
ds_read_b128 v[48:51], v7 offset:28672
s_waitcnt lgkmcnt(3)
v_mfma_f32_32x32x16_bf16 v[16:31], a[200:203], v[52:55], v[16:31]
v_mfma_f32_32x32x16_bf16 v[32:47], a[204:207], v[52:55], v[32:47]
ds_read_b128 v[52:55], v7 offset:29696
s_waitcnt lgkmcnt(3)
v_mfma_f32_32x32x16_bf16 v[16:31], a[208:211], v[56:59], v[16:31]
v_mfma_f32_32x32x16_bf16 v[32:47], a[212:215], v[56:59], v[32:47]
ds_read_b128 v[56:59], v7 offset:30720
s_waitcnt lgkmcnt(3)
v_mfma_f32_32x32x16_bf16 v[16:31], a[216:219], v[60:63], v[16:31]
v_mfma_f32_32x32x16_bf16 v[32:47], a[220:223], v[60:63], v[32:47]
ds_read_b128 v[60:63], v7 offset:31744
s_waitcnt lgkmcnt(3)
v_mfma_f32_32x32x16_bf16 v[16:31], a[224:227], v[48:51], v[16:31]
v_mfma_f32_32x32x16_bf16 v[32:47], a[228:231], v[48:51], v[32:47]
s_cmp_gt_i32 s24, 4
s_cbranch_scc0 Lef_67
s_waitcnt vmcnt(10)
buffer_store_dword v8, v5, s[4:7], 0 offen sc1
Lef_67:
ds_read_b128 v[48:51], v7 offset:32768
s_waitcnt lgkmcnt(3)
v_mfma_f32_32x32x16_bf16 v[16:31], a[232:235], v[52:55], v[16:31]
v_mfma_f32_32x32x16_bf16 v[32:47], a[236:239], v[52:55], v[32:47]
ds_read_b128 v[52:55], v7 offset:33792
s_waitcnt lgkmcnt(3)
v_mfma_f32_32x32x16_bf16 v[16:31], a[240:243], v[56:59], v[16:31]
v_mfma_f32_32x32x16_bf16 v[32:47], a[244:247], v[56:59], v[32:47]
ds_read_b128 v[56:59], v7 offset:34816
s_waitcnt lgkmcnt(3)
v_mfma_f32_32x32x16_bf16 v[16:31], a[248:251], v[60:63], v[16:31]
v_mfma_f32_32x32x16_bf16 v[32:47], a[252:255], v[60:63], v[32:47]
ds_read_b128 v[60:63], v7 offset:35840
s_waitcnt lgkmcnt(3)
v_mfma_f32_32x32x16_bf16 v[16:31], v[192:195], v[48:51], v[16:31]
v_mfma_f32_32x32x16_bf16 v[32:47], v[196:199], v[48:51], v[32:47]
ds_read_b128 v[48:51], v7 offset:36864
s_waitcnt lgkmcnt(3)
v_mfma_f32_32x32x16_bf16 v[16:31], v[200:203], v[52:55], v[16:31]
v_mfma_f32_32x32x16_bf16 v[32:47], v[204:207], v[52:55], v[32:47]
ds_read_b128 v[52:55], v7 offset:37888
s_waitcnt lgkmcnt(3)
v_mfma_f32_32x32x16_bf16 v[16:31], v[208:211], v[56:59], v[16:31]
v_mfma_f32_32x32x16_bf16 v[32:47], v[212:215], v[56:59], v[32:47]
ds_read_b128 v[56:59], v7 offset:38912
s_waitcnt lgkmcnt(3)
v_mfma_f32_32x32x16_bf16 v[16:31], v[216:219], v[60:63], v[16:31]
v_mfma_f32_32x32x16_bf16 v[32:47], v[220:223], v[60:63], v[32:47]
ds_read_b128 v[60:63], v7 offset:39936
s_waitcnt lgkmcnt(3)
v_mfma_f32_32x32x16_bf16 v[16:31], v[224:227], v[48:51], v[16:31]
v_mfma_f32_32x32x16_bf16 v[32:47], v[228:231], v[48:51], v[32:47]
s_waitcnt lgkmcnt(2)
v_mfma_f32_32x32x16_bf16 v[16:31], v[232:235], v[52:55], v[16:31]
v_mfma_f32_32x32x16_bf16 v[32:47], v[236:239], v[52:55], v[32:47]
s_waitcnt lgkmcnt(1)
v_mfma_f32_32x32x16_bf16 v[16:31], v[240:243], v[56:59], v[16:31]
v_mfma_f32_32x32x16_bf16 v[32:47], v[244:247], v[56:59], v[32:47]
s_waitcnt lgkmcnt(0)
v_mfma_f32_32x32x16_bf16 v[16:31], v[248:251], v[60:63], v[16:31]
v_mfma_f32_32x32x16_bf16 v[32:47], v[252:255], v[60:63], v[32:47]
s_add_u32 s39, s37, s38
s_add_u32 s40, s39, s38
s_add_u32 s41, s40, s38
s_nop 8
v_cvt_pk_bf16_f32 v64, v16, v32
v_cvt_pk_bf16_f32 v65, v17, v33
v_cvt_pk_bf16_f32 v66, v18, v34
v_cvt_pk_bf16_f32 v67, v19, v35
buffer_store_dwordx4 v[64:67], v4, s[4:7], s37 offen sc1
v_cvt_pk_bf16_f32 v68, v20, v36
v_cvt_pk_bf16_f32 v69, v21, v37
v_cvt_pk_bf16_f32 v70, v22, v38
v_cvt_pk_bf16_f32 v71, v23, v39
buffer_store_dwordx4 v[68:71], v4, s[4:7], s39 offen sc1
v_cvt_pk_bf16_f32 v72, v24, v40
v_cvt_pk_bf16_f32 v73, v25, v41
v_cvt_pk_bf16_f32 v74, v26, v42
v_cvt_pk_bf16_f32 v75, v27, v43
buffer_store_dwordx4 v[72:75], v4, s[4:7], s40 offen sc1
v_cvt_pk_bf16_f32 v76, v28, v44
v_cvt_pk_bf16_f32 v77, v29, v45
v_cvt_pk_bf16_f32 v78, v30, v46
v_cvt_pk_bf16_f32 v79, v31, v47
buffer_store_dwordx4 v[76:79], v4, s[4:7], s41 offen sc1
s_add_u32 s37, s37, s42
s_add_u32 s24, s24, 1
s_cmp_lt_u32 s24, 64
s_cbranch_scc1 Lg1_loop
v_mov_b32 v8, 64
s_waitcnt vmcnt(0)
buffer_store_dword v8, v5, s[4:7], 0 offen sc1
s_endpgm
Lu:
s_load_dwordx2 s[8:9], s[0:1], 40
s_mov_b32 s10, 7864320
s_mov_b32 s11, 0x20000
s_sub_u32 s33, s27, 18
s_lshl_b32 s46, s26, 3
s_add_u32 s33, s33, s46
v_and_b32 v9, 31, v0
v_lshrrev_b32 v10, 5, v0
v_lshlrev_b32 v6, 4, v0
s_lshl_b32 s46, s28, 12
s_lshl_b32 s47, s33, 7
s_add_u32 s46, s46, s47
s_add_u32 s46, s46, 65536
v_mov_b32 v5, s46
v_mov_b32 v1, 2146435072
v_cmp_eq_u32 vcc, 0, v0
s_nop 1
v_cndmask_b32 v5, v1, v5, vcc
v_and_b32 v11, 3, v0
v_min_u32 v11, 2, v11
s_lshl_b32 s46, s33, 11
s_add_u32 s46, s46, 768
v_lshl_add_u32 v7, v11, 7, s46
s_mul_i32 s46, s33, 245760
v_lshrrev_b32 v11, 3, v0
v_mul_u32_u24 v11, 1280, v11
v_and_b32 v12, 7, v0
v_lshl_add_u32 v11, v12, 4, v11
v_add_u32 v11, s46, v11
v_lshlrev_b32 v14, 2, v9
v_lshl_add_u32 v14, v10, 10, v14
s_lshl_b32 s47, s28, 8
v_add_u32 v2, s47, v11
s_lshr_b32 s47, s28, 1
s_lshl_b32 s47, s47, 7
s_add_u32 s47, s47, 1024
v_add_u32 v3, s47, v11
s_bitcmp1_b32 s28, 0
s_cselect_b32 s52, s30, s29
v_lshrrev_b32 v11, 3, v9
v_lshlrev_b32 v11, 15, v11
v_and_b32 v12, 7, v9
v_lshl_add_u32 v11, v12, 4, v11
v_lshl_add_u32 v4, v10, 8, v11
s_lshl_b32 s37, s33, 10
s_add_u32 s37, s37, 86286336
s_lshl_b32 s46, s28, 18
s_lshr_b32 s47, s28, 1
s_add_u32 s47, s47, 8
s_lshl_b32 s47, s47, 17
s_and_b32 s48, s28, 1
s_lshl_b32 s48, s48, 7
s_add_u32 s47, s47, s48
s_add_u32 s39, s37, s47
s_add_u32 s37, s37, s46
s_mul_i32 s43, s33, 12288
s_add_u32 s43, s43, 60727296
v_mov_b32 v8, 0
buffer_store_dword v8, v5, s[4:7], 0 offen sc1
s_waitcnt lgkmcnt(0)
s_and_b32 s9, s9, 0xffff
s_mul_i32 s53, s28, 40960
v_add_u32 v14, s53, v14
s_add_u32 m0, s53, 0
s_mov_b32 s31, 0
buffer_load_dwordx4 v2, s[8:11], s31 offen lds
s_add_u32 m0, s53, 1024
s_mov_b32 s31, 10240
buffer_load_dwordx4 v2, s[8:11], s31 offen lds
s_add_u32 m0, s53, 2048
s_mov_b32 s31, 128
buffer_load_dwordx4 v2, s[8:11], s31 offen lds
s_add_u32 m0, s53, 3072
s_mov_b32 s31, 10368
buffer_load_dwordx4 v2, s[8:11], s31 offen lds
s_add_u32 m0, s53, 4096
s_mov_b32 s31, 0
buffer_load_dwordx4 v3, s[8:11], s31 offen lds
s_add_u32 m0, s53, 5120
s_mov_b32 s31, 10240
buffer_load_dwordx4 v3, s[8:11], s31 offen lds
s_waitcnt vmcnt(6)
s_barrier
s_cmp_lg_u32 s28, 0
s_cbranch_scc1 Larr_68
v_mov_b32 v8, 1
s_mov_b64 exec, 1
buffer_atomic_add v8, off, s[20:23], 0 sc1
s_mov_b64 exec, -1
Larr_68:
s_add_u32 m0, s53, 6144
s_mov_b32 s31, 20480
buffer_load_dwordx4 v2, s[8:11], s31 offen lds
s_add_u32 m0, s53, 7168
s_mov_b32 s31, 30720
buffer_load_dwordx4 v2, s[8:11], s31 offen lds
s_add_u32 m0, s53, 8192
s_mov_b32 s31, 20608
buffer_load_dwordx4 v2, s[8:11], s31 offen lds
s_add_u32 m0, s53, 9216
s_mov_b32 s31, 30848
buffer_load_dwordx4 v2, s[8:11], s31 offen lds
s_add_u32 m0, s53, 10240
s_mov_b32 s31, 20480
buffer_load_dwordx4 v3, s[8:11], s31 offen lds
s_add_u32 m0, s53, 11264
s_mov_b32 s31, 30720
buffer_load_dwordx4 v3, s[8:11], s31 offen lds
s_add_u32 m0, s53, 12288
s_mov_b32 s31, 40960
buffer_load_dwordx4 v2, s[8:11], s31 offen lds
s_add_u32 m0, s53, 13312
s_mov_b32 s31, 51200
buffer_load_dwordx4 v2, s[8:11], s31 offen lds
s_add_u32 m0, s53, 14336
s_mov_b32 s31, 41088
buffer_load_dwordx4 v2, s[8:11], s31 offen lds
s_add_u32 m0, s53, 15360
s_mov_b32 s31, 51328
buffer_load_dwordx4 v2, s[8:11], s31 offen lds
s_add_u32 m0, s53, 16384
s_mov_b32 s31, 40960
buffer_load_dwordx4 v3, s[8:11], s31 offen lds
s_add_u32 m0, s53, 17408
s_mov_b32 s31, 51200
buffer_load_dwordx4 v3, s[8:11], s31 offen lds
s_add_u32 m0, s53, 18432
s_mov_b32 s31, 61440
buffer_load_dwordx4 v2, s[8:11], s31 offen lds
s_add_u32 m0, s53, 19456
s_mov_b32 s31, 71680
buffer_load_dwordx4 v2, s[8:11], s31 offen lds
s_add_u32 m0, s53, 20480
s_mov_b32 s31, 61568
buffer_load_dwordx4 v2, s[8:11], s31 offen lds
s_add_u32 m0, s53, 21504
s_mov_b32 s31, 71808
buffer_load_dwordx4 v2, s[8:11], s31 offen lds
s_add_u32 m0, s53, 22528
s_mov_b32 s31, 61440
buffer_load_dwordx4 v3, s[8:11], s31 offen lds
s_add_u32 m0, s53, 23552
s_mov_b32 s31, 71680
buffer_load_dwordx4 v3, s[8:11], s31 offen lds
s_add_u32 m0, s53, 24576
s_mov_b32 s31, 81920
buffer_load_dwordx4 v2, s[8:11], s31 offen lds
s_add_u32 m0, s53, 25600
s_mov_b32 s31, 92160
buffer_load_dwordx4 v2, s[8:11], s31 offen lds
s_add_u32 m0, s53, 26624
s_mov_b32 s31, 82048
buffer_load_dwordx4 v2, s[8:11], s31 offen lds
s_add_u32 m0, s53, 27648
s_mov_b32 s31, 92288
buffer_load_dwordx4 v2, s[8:11], s31 offen lds
s_add_u32 m0, s53, 28672
s_mov_b32 s31, 81920
buffer_load_dwordx4 v3, s[8:11], s31 offen lds
s_add_u32 m0, s53, 29696
s_mov_b32 s31, 92160
buffer_load_dwordx4 v3, s[8:11], s31 offen lds
s_add_u32 m0, s53, 30720
s_mov_b32 s31, 102400
buffer_load_dwordx4 v2, s[8:11], s31 offen lds
s_add_u32 m0, s53, 31744
s_mov_b32 s31, 112640
buffer_load_dwordx4 v2, s[8:11], s31 offen lds
s_add_u32 m0, s53, 32768
s_mov_b32 s31, 102528
buffer_load_dwordx4 v2, s[8:11], s31 offen lds
s_add_u32 m0, s53, 33792
s_mov_b32 s31, 112768
buffer_load_dwordx4 v2, s[8:11], s31 offen lds
s_add_u32 m0, s53, 34816
s_mov_b32 s31, 102400
buffer_load_dwordx4 v3, s[8:11], s31 offen lds
s_add_u32 m0, s53, 35840
s_mov_b32 s31, 112640
buffer_load_dwordx4 v3, s[8:11], s31 offen lds
s_add_u32 m0, s53, 36864
s_mov_b32 s31, 122880
buffer_load_dwordx4 v2, s[8:11], s31 offen lds
s_add_u32 m0, s53, 37888
s_mov_b32 s31, 133120
buffer_load_dwordx4 v2, s[8:11], s31 offen lds
s_add_u32 m0, s53, 38912
s_mov_b32 s31, 123008
buffer_load_dwordx4 v2, s[8:11], s31 offen lds
s_add_u32 m0, s53, 39936
s_mov_b32 s31, 133248
buffer_load_dwordx4 v2, s[8:11], s31 offen lds
s_waitcnt vmcnt(38)
v_add_u32 v146, 0, v14
ds_read2_b32 v[80:81], v146 offset0:0 offset1:32
ds_read2_b32 v[82:83], v146 offset0:64 offset1:96
ds_read2_b32 v[84:85], v146 offset0:128 offset1:160
ds_read2_b32 v[86:87], v146 offset0:192 offset1:224
s_waitcnt vmcnt(36)
v_add_u32 v146, 2048, v14
ds_read2_b32 v[88:89], v146 offset0:0 offset1:32
ds_read2_b32 v[90:91], v146 offset0:64 offset1:96
ds_read2_b32 v[92:93], v146 offset0:128 offset1:160
ds_read2_b32 v[94:95], v146 offset0:192 offset1:224
s_waitcnt lgkmcnt(4)
s_add_u32 m0, s53, 0
s_mov_b32 s31, 122880
buffer_load_dwordx4 v3, s[8:11], s31 offen lds
s_add_u32 m0, s53, 1024
s_mov_b32 s31, 133120
buffer_load_dwordx4 v3, s[8:11], s31 offen lds
v_perm_b32 v144, v81, v80, s29
v_accvgpr_write_b32 a0, v144
v_perm_b32 v145, v83, v82, s29
v_accvgpr_write_b32 a1, v145
v_perm_b32 v144, v85, v84, s29
v_accvgpr_write_b32 a2, v144
v_perm_b32 v145, v87, v86, s29
v_accvgpr_write_b32 a3, v145
v_perm_b32 v144, v81, v80, s30
v_accvgpr_write_b32 a48, v144
v_perm_b32 v145, v83, v82, s30
v_accvgpr_write_b32 a49, v145
v_perm_b32 v144, v85, v84, s30
v_accvgpr_write_b32 a50, v144
v_perm_b32 v145, v87, v86, s30
v_accvgpr_write_b32 a51, v145
s_waitcnt vmcnt(36)
v_add_u32 v146, 4096, v14
ds_read2_b32 v[80:81], v146 offset0:0 offset1:32
ds_read2_b32 v[82:83], v146 offset0:64 offset1:96
ds_read2_b32 v[84:85], v146 offset0:128 offset1:160
ds_read2_b32 v[86:87], v146 offset0:192 offset1:224
s_waitcnt lgkmcnt(4)
s_add_u32 m0, s53, 2048
s_mov_b32 s31, 143360
buffer_load_dwordx4 v2, s[8:11], s31 offen lds
s_add_u32 m0, s53, 3072
s_mov_b32 s31, 153600
buffer_load_dwordx4 v2, s[8:11], s31 offen lds
v_perm_b32 v144, v89, v88, s29
v_accvgpr_write_b32 a96, v144
v_perm_b32 v145, v91, v90, s29
v_accvgpr_write_b32 a97, v145
v_perm_b32 v144, v93, v92, s29
v_accvgpr_write_b32 a98, v144
v_perm_b32 v145, v95, v94, s29
v_accvgpr_write_b32 a99, v145
v_perm_b32 v144, v89, v88, s30
v_accvgpr_write_b32 a144, v144
v_perm_b32 v145, v91, v90, s30
v_accvgpr_write_b32 a145, v145
v_perm_b32 v144, v93, v92, s30
v_accvgpr_write_b32 a146, v144
v_perm_b32 v145, v95, v94, s30
v_accvgpr_write_b32 a147, v145
s_waitcnt vmcnt(36)
v_add_u32 v146, 6144, v14
ds_read2_b32 v[88:89], v146 offset0:0 offset1:32
ds_read2_b32 v[90:91], v146 offset0:64 offset1:96
ds_read2_b32 v[92:93], v146 offset0:128 offset1:160
ds_read2_b32 v[94:95], v146 offset0:192 offset1:224
s_waitcnt lgkmcnt(4)
s_add_u32 m0, s53, 4096
s_mov_b32 s31, 143488
buffer_load_dwordx4 v2, s[8:11], s31 offen lds
s_add_u32 m0, s53, 5120
s_mov_b32 s31, 153728
buffer_load_dwordx4 v2, s[8:11], s31 offen lds
v_perm_b32 v144, v81, v80, s52
v_accvgpr_write_b32 a192, v144
v_perm_b32 v145, v83, v82, s52
v_accvgpr_write_b32 a193, v145
v_perm_b32 v144, v85, v84, s52
v_accvgpr_write_b32 a194, v144
v_perm_b32 v145, v87, v86, s52
v_accvgpr_write_b32 a195, v145
s_waitcnt vmcnt(36)
v_add_u32 v146, 8192, v14
ds_read2_b32 v[80:81], v146 offset0:0 offset1:32
ds_read2_b32 v[82:83], v146 offset0:64 offset1:96
ds_read2_b32 v[84:85], v146 offset0:128 offset1:160
ds_read2_b32 v[86:87], v146 offset0:192 offset1:224
s_waitcnt lgkmcnt(4)
s_add_u32 m0, s53, 6144
s_mov_b32 s31, 143360
buffer_load_dwordx4 v3, s[8:11], s31 offen lds
s_add_u32 m0, s53, 7168
s_mov_b32 s31, 153600
buffer_load_dwordx4 v3, s[8:11], s31 offen lds
v_perm_b32 v144, v89, v88, s29
v_accvgpr_write_b32 a4, v144
v_perm_b32 v145, v91, v90, s29
v_accvgpr_write_b32 a5, v145
v_perm_b32 v144, v93, v92, s29
v_accvgpr_write_b32 a6, v144
v_perm_b32 v145, v95, v94, s29
v_accvgpr_write_b32 a7, v145
v_perm_b32 v144, v89, v88, s30
v_accvgpr_write_b32 a52, v144
v_perm_b32 v145, v91, v90, s30
v_accvgpr_write_b32 a53, v145
v_perm_b32 v144, v93, v92, s30
v_accvgpr_write_b32 a54, v144
v_perm_b32 v145, v95, v94, s30
v_accvgpr_write_b32 a55, v145
s_waitcnt vmcnt(36)
v_add_u32 v146, 10240, v14
ds_read2_b32 v[88:89], v146 offset0:0 offset1:32
ds_read2_b32 v[90:91], v146 offset0:64 offset1:96
ds_read2_b32 v[92:93], v146 offset0:128 offset1:160
ds_read2_b32 v[94:95], v146 offset0:192 offset1:224
s_waitcnt lgkmcnt(4)
s_add_u32 m0, s53, 8192
s_mov_b32 s31, 163840
buffer_load_dwordx4 v2, s[8:11], s31 offen lds
s_add_u32 m0, s53, 9216
s_mov_b32 s31, 174080
buffer_load_dwordx4 v2, s[8:11], s31 offen lds
v_perm_b32 v144, v81, v80, s29
v_accvgpr_write_b32 a100, v144
v_perm_b32 v145, v83, v82, s29
v_accvgpr_write_b32 a101, v145
v_perm_b32 v144, v85, v84, s29
v_accvgpr_write_b32 a102, v144
v_perm_b32 v145, v87, v86, s29
v_accvgpr_write_b32 a103, v145
v_perm_b32 v144, v81, v80, s30
v_accvgpr_write_b32 a148, v144
v_perm_b32 v145, v83, v82, s30
v_accvgpr_write_b32 a149, v145
v_perm_b32 v144, v85, v84, s30
v_accvgpr_write_b32 a150, v144
v_perm_b32 v145, v87, v86, s30
v_accvgpr_write_b32 a151, v145
s_waitcnt vmcnt(36)
v_add_u32 v146, 12288, v14
ds_read2_b32 v[80:81], v146 offset0:0 offset1:32
ds_read2_b32 v[82:83], v146 offset0:64 offset1:96
ds_read2_b32 v[84:85], v146 offset0:128 offset1:160
ds_read2_b32 v[86:87], v146 offset0:192 offset1:224
s_waitcnt lgkmcnt(4)
s_add_u32 m0, s53, 10240
s_mov_b32 s31, 163968
buffer_load_dwordx4 v2, s[8:11], s31 offen lds
s_add_u32 m0, s53, 11264
s_mov_b32 s31, 174208
buffer_load_dwordx4 v2, s[8:11], s31 offen lds
v_perm_b32 v144, v89, v88, s52
v_accvgpr_write_b32 a196, v144
v_perm_b32 v145, v91, v90, s52
v_accvgpr_write_b32 a197, v145
v_perm_b32 v144, v93, v92, s52
v_accvgpr_write_b32 a198, v144
v_perm_b32 v145, v95, v94, s52
v_accvgpr_write_b32 a199, v145
s_waitcnt vmcnt(36)
v_add_u32 v146, 14336, v14
ds_read2_b32 v[88:89], v146 offset0:0 offset1:32
ds_read2_b32 v[90:91], v146 offset0:64 offset1:96
ds_read2_b32 v[92:93], v146 offset0:128 offset1:160
ds_read2_b32 v[94:95], v146 offset0:192 offset1:224
s_waitcnt lgkmcnt(4)
s_add_u32 m0, s53, 12288
s_mov_b32 s31, 163840
buffer_load_dwordx4 v3, s[8:11], s31 offen lds
s_add_u32 m0, s53, 13312
s_mov_b32 s31, 174080
buffer_load_dwordx4 v3, s[8:11], s31 offen lds
v_perm_b32 v144, v81, v80, s29
v_accvgpr_write_b32 a8, v144
v_perm_b32 v145, v83, v82, s29
v_accvgpr_write_b32 a9, v145
v_perm_b32 v144, v85, v84, s29
v_accvgpr_write_b32 a10, v144
v_perm_b32 v145, v87, v86, s29
v_accvgpr_write_b32 a11, v145
v_perm_b32 v144, v81, v80, s30
v_accvgpr_write_b32 a56, v144
v_perm_b32 v145, v83, v82, s30
v_accvgpr_write_b32 a57, v145
v_perm_b32 v144, v85, v84, s30
v_accvgpr_write_b32 a58, v144
v_perm_b32 v145, v87, v86, s30
v_accvgpr_write_b32 a59, v145
s_waitcnt vmcnt(36)
v_add_u32 v146, 16384, v14
ds_read2_b32 v[80:81], v146 offset0:0 offset1:32
ds_read2_b32 v[82:83], v146 offset0:64 offset1:96
ds_read2_b32 v[84:85], v146 offset0:128 offset1:160
ds_read2_b32 v[86:87], v146 offset0:192 offset1:224
s_waitcnt lgkmcnt(4)
s_add_u32 m0, s53, 14336
s_mov_b32 s31, 184320
buffer_load_dwordx4 v2, s[8:11], s31 offen lds
s_add_u32 m0, s53, 15360
s_mov_b32 s31, 194560
buffer_load_dwordx4 v2, s[8:11], s31 offen lds
v_perm_b32 v144, v89, v88, s29
v_accvgpr_write_b32 a104, v144
v_perm_b32 v145, v91, v90, s29
v_accvgpr_write_b32 a105, v145
v_perm_b32 v144, v93, v92, s29
v_accvgpr_write_b32 a106, v144
v_perm_b32 v145, v95, v94, s29
v_accvgpr_write_b32 a107, v145
v_perm_b32 v144, v89, v88, s30
v_accvgpr_write_b32 a152, v144
v_perm_b32 v145, v91, v90, s30
v_accvgpr_write_b32 a153, v145
v_perm_b32 v144, v93, v92, s30
v_accvgpr_write_b32 a154, v144
v_perm_b32 v145, v95, v94, s30
v_accvgpr_write_b32 a155, v145
s_waitcnt vmcnt(36)
v_add_u32 v146, 18432, v14
ds_read2_b32 v[88:89], v146 offset0:0 offset1:32
ds_read2_b32 v[90:91], v146 offset0:64 offset1:96
ds_read2_b32 v[92:93], v146 offset0:128 offset1:160
ds_read2_b32 v[94:95], v146 offset0:192 offset1:224
s_waitcnt lgkmcnt(4)
s_add_u32 m0, s53, 16384
s_mov_b32 s31, 184448
buffer_load_dwordx4 v2, s[8:11], s31 offen lds
s_add_u32 m0, s53, 17408
s_mov_b32 s31, 194688
buffer_load_dwordx4 v2, s[8:11], s31 offen lds
v_perm_b32 v144, v81, v80, s52
v_accvgpr_write_b32 a200, v144
v_perm_b32 v145, v83, v82, s52
v_accvgpr_write_b32 a201, v145
v_perm_b32 v144, v85, v84, s52
v_accvgpr_write_b32 a202, v144
v_perm_b32 v145, v87, v86, s52
v_accvgpr_write_b32 a203, v145
s_waitcnt vmcnt(36)
v_add_u32 v146, 20480, v14
ds_read2_b32 v[80:81], v146 offset0:0 offset1:32
ds_read2_b32 v[82:83], v146 offset0:64 offset1:96
ds_read2_b32 v[84:85], v146 offset0:128 offset1:160
ds_read2_b32 v[86:87], v146 offset0:192 offset1:224
s_waitcnt lgkmcnt(4)
s_add_u32 m0, s53, 18432
s_mov_b32 s31, 184320
buffer_load_dwordx4 v3, s[8:11], s31 offen lds
s_add_u32 m0, s53, 19456
s_mov_b32 s31, 194560
buffer_load_dwordx4 v3, s[8:11], s31 offen lds
v_perm_b32 v144, v89, v88, s29
v_accvgpr_write_b32 a12, v144
v_perm_b32 v145, v91, v90, s29
v_accvgpr_write_b32 a13, v145
v_perm_b32 v144, v93, v92, s29
v_accvgpr_write_b32 a14, v144
v_perm_b32 v145, v95, v94, s29
v_accvgpr_write_b32 a15, v145
v_perm_b32 v144, v89, v88, s30
v_accvgpr_write_b32 a60, v144
v_perm_b32 v145, v91, v90, s30
v_accvgpr_write_b32 a61, v145
v_perm_b32 v144, v93, v92, s30
v_accvgpr_write_b32 a62, v144
v_perm_b32 v145, v95, v94, s30
v_accvgpr_write_b32 a63, v145
s_waitcnt vmcnt(36)
v_add_u32 v146, 22528, v14
ds_read2_b32 v[88:89], v146 offset0:0 offset1:32
ds_read2_b32 v[90:91], v146 offset0:64 offset1:96
ds_read2_b32 v[92:93], v146 offset0:128 offset1:160
ds_read2_b32 v[94:95], v146 offset0:192 offset1:224
s_waitcnt lgkmcnt(4)
s_add_u32 m0, s53, 20480
s_mov_b32 s31, 204800
buffer_load_dwordx4 v2, s[8:11], s31 offen lds
s_add_u32 m0, s53, 21504
s_mov_b32 s31, 215040
buffer_load_dwordx4 v2, s[8:11], s31 offen lds
v_perm_b32 v144, v81, v80, s29
v_accvgpr_write_b32 a108, v144
v_perm_b32 v145, v83, v82, s29
v_accvgpr_write_b32 a109, v145
v_perm_b32 v144, v85, v84, s29
v_accvgpr_write_b32 a110, v144
v_perm_b32 v145, v87, v86, s29
v_accvgpr_write_b32 a111, v145
v_perm_b32 v144, v81, v80, s30
v_accvgpr_write_b32 a156, v144
v_perm_b32 v145, v83, v82, s30
v_accvgpr_write_b32 a157, v145
v_perm_b32 v144, v85, v84, s30
v_accvgpr_write_b32 a158, v144
v_perm_b32 v145, v87, v86, s30
v_accvgpr_write_b32 a159, v145
s_waitcnt vmcnt(36)
v_add_u32 v146, 24576, v14
ds_read2_b32 v[80:81], v146 offset0:0 offset1:32
ds_read2_b32 v[82:83], v146 offset0:64 offset1:96
ds_read2_b32 v[84:85], v146 offset0:128 offset1:160
ds_read2_b32 v[86:87], v146 offset0:192 offset1:224
s_waitcnt lgkmcnt(4)
s_add_u32 m0, s53, 22528
s_mov_b32 s31, 204928
buffer_load_dwordx4 v2, s[8:11], s31 offen lds
s_add_u32 m0, s53, 23552
s_mov_b32 s31, 215168
buffer_load_dwordx4 v2, s[8:11], s31 offen lds
v_perm_b32 v144, v89, v88, s52
v_accvgpr_write_b32 a204, v144
v_perm_b32 v145, v91, v90, s52
v_accvgpr_write_b32 a205, v145
v_perm_b32 v144, v93, v92, s52
v_accvgpr_write_b32 a206, v144
v_perm_b32 v145, v95, v94, s52
v_accvgpr_write_b32 a207, v145
s_waitcnt vmcnt(36)
v_add_u32 v146, 26624, v14
ds_read2_b32 v[88:89], v146 offset0:0 offset1:32
ds_read2_b32 v[90:91], v146 offset0:64 offset1:96
ds_read2_b32 v[92:93], v146 offset0:128 offset1:160
ds_read2_b32 v[94:95], v146 offset0:192 offset1:224
s_waitcnt lgkmcnt(4)
s_add_u32 m0, s53, 24576
s_mov_b32 s31, 204800
buffer_load_dwordx4 v3, s[8:11], s31 offen lds
s_add_u32 m0, s53, 25600
s_mov_b32 s31, 215040
buffer_load_dwordx4 v3, s[8:11], s31 offen lds
v_perm_b32 v144, v81, v80, s29
v_accvgpr_write_b32 a16, v144
v_perm_b32 v145, v83, v82, s29
v_accvgpr_write_b32 a17, v145
v_perm_b32 v144, v85, v84, s29
v_accvgpr_write_b32 a18, v144
v_perm_b32 v145, v87, v86, s29
v_accvgpr_write_b32 a19, v145
v_perm_b32 v144, v81, v80, s30
v_accvgpr_write_b32 a64, v144
v_perm_b32 v145, v83, v82, s30
v_accvgpr_write_b32 a65, v145
v_perm_b32 v144, v85, v84, s30
v_accvgpr_write_b32 a66, v144
v_perm_b32 v145, v87, v86, s30
v_accvgpr_write_b32 a67, v145
s_waitcnt vmcnt(36)
v_add_u32 v146, 28672, v14
ds_read2_b32 v[80:81], v146 offset0:0 offset1:32
ds_read2_b32 v[82:83], v146 offset0:64 offset1:96
ds_read2_b32 v[84:85], v146 offset0:128 offset1:160
ds_read2_b32 v[86:87], v146 offset0:192 offset1:224
s_waitcnt lgkmcnt(4)
s_add_u32 m0, s53, 26624
s_mov_b32 s31, 225280
buffer_load_dwordx4 v2, s[8:11], s31 offen lds
s_add_u32 m0, s53, 27648
s_mov_b32 s31, 235520
buffer_load_dwordx4 v2, s[8:11], s31 offen lds
v_perm_b32 v144, v89, v88, s29
v_accvgpr_write_b32 a112, v144
v_perm_b32 v145, v91, v90, s29
v_accvgpr_write_b32 a113, v145
v_perm_b32 v144, v93, v92, s29
v_accvgpr_write_b32 a114, v144
v_perm_b32 v145, v95, v94, s29
v_accvgpr_write_b32 a115, v145
v_perm_b32 v144, v89, v88, s30
v_accvgpr_write_b32 a160, v144
v_perm_b32 v145, v91, v90, s30
v_accvgpr_write_b32 a161, v145
v_perm_b32 v144, v93, v92, s30
v_accvgpr_write_b32 a162, v144
v_perm_b32 v145, v95, v94, s30
v_accvgpr_write_b32 a163, v145
s_waitcnt vmcnt(36)
v_add_u32 v146, 30720, v14
ds_read2_b32 v[88:89], v146 offset0:0 offset1:32
ds_read2_b32 v[90:91], v146 offset0:64 offset1:96
ds_read2_b32 v[92:93], v146 offset0:128 offset1:160
ds_read2_b32 v[94:95], v146 offset0:192 offset1:224
s_waitcnt lgkmcnt(4)
s_add_u32 m0, s53, 28672
s_mov_b32 s31, 225408
buffer_load_dwordx4 v2, s[8:11], s31 offen lds
s_add_u32 m0, s53, 29696
s_mov_b32 s31, 235648
buffer_load_dwordx4 v2, s[8:11], s31 offen lds
v_perm_b32 v144, v81, v80, s52
v_accvgpr_write_b32 a208, v144
v_perm_b32 v145, v83, v82, s52
v_accvgpr_write_b32 a209, v145
v_perm_b32 v144, v85, v84, s52
v_accvgpr_write_b32 a210, v144
v_perm_b32 v145, v87, v86, s52
v_accvgpr_write_b32 a211, v145
s_waitcnt vmcnt(36)
v_add_u32 v146, 32768, v14
ds_read2_b32 v[80:81], v146 offset0:0 offset1:32
ds_read2_b32 v[82:83], v146 offset0:64 offset1:96
ds_read2_b32 v[84:85], v146 offset0:128 offset1:160
ds_read2_b32 v[86:87], v146 offset0:192 offset1:224
s_waitcnt lgkmcnt(4)
s_add_u32 m0, s53, 30720
s_mov_b32 s31, 225280
buffer_load_dwordx4 v3, s[8:11], s31 offen lds
s_add_u32 m0, s53, 31744
s_mov_b32 s31, 235520
buffer_load_dwordx4 v3, s[8:11], s31 offen lds
v_perm_b32 v144, v89, v88, s29
v_accvgpr_write_b32 a20, v144
v_perm_b32 v145, v91, v90, s29
v_accvgpr_write_b32 a21, v145
v_perm_b32 v144, v93, v92, s29
v_accvgpr_write_b32 a22, v144
v_perm_b32 v145, v95, v94, s29
v_accvgpr_write_b32 a23, v145
v_perm_b32 v144, v89, v88, s30
v_accvgpr_write_b32 a68, v144
v_perm_b32 v145, v91, v90, s30
v_accvgpr_write_b32 a69, v145
v_perm_b32 v144, v93, v92, s30
v_accvgpr_write_b32 a70, v144
v_perm_b32 v145, v95, v94, s30
v_accvgpr_write_b32 a71, v145
s_waitcnt vmcnt(36)
v_add_u32 v146, 34816, v14
ds_read2_b32 v[88:89], v146 offset0:0 offset1:32
ds_read2_b32 v[90:91], v146 offset0:64 offset1:96
ds_read2_b32 v[92:93], v146 offset0:128 offset1:160
ds_read2_b32 v[94:95], v146 offset0:192 offset1:224
s_waitcnt lgkmcnt(4)
v_perm_b32 v144, v81, v80, s29
v_accvgpr_write_b32 a116, v144
v_perm_b32 v145, v83, v82, s29
v_accvgpr_write_b32 a117, v145
v_perm_b32 v144, v85, v84, s29
v_accvgpr_write_b32 a118, v144
v_perm_b32 v145, v87, v86, s29
v_accvgpr_write_b32 a119, v145
v_perm_b32 v144, v81, v80, s30
v_accvgpr_write_b32 a164, v144
v_perm_b32 v145, v83, v82, s30
v_accvgpr_write_b32 a165, v145
v_perm_b32 v144, v85, v84, s30
v_accvgpr_write_b32 a166, v144
v_perm_b32 v145, v87, v86, s30
v_accvgpr_write_b32 a167, v145
s_waitcnt vmcnt(34)
v_add_u32 v146, 36864, v14
ds_read2_b32 v[80:81], v146 offset0:0 offset1:32
ds_read2_b32 v[82:83], v146 offset0:64 offset1:96
ds_read2_b32 v[84:85], v146 offset0:128 offset1:160
ds_read2_b32 v[86:87], v146 offset0:192 offset1:224
s_waitcnt lgkmcnt(4)
v_perm_b32 v144, v89, v88, s52
v_accvgpr_write_b32 a212, v144
v_perm_b32 v145, v91, v90, s52
v_accvgpr_write_b32 a213, v145
v_perm_b32 v144, v93, v92, s52
v_accvgpr_write_b32 a214, v144
v_perm_b32 v145, v95, v94, s52
v_accvgpr_write_b32 a215, v145
s_waitcnt vmcnt(32)
v_add_u32 v146, 38912, v14
ds_read2_b32 v[88:89], v146 offset0:0 offset1:32
ds_read2_b32 v[90:91], v146 offset0:64 offset1:96
ds_read2_b32 v[92:93], v146 offset0:128 offset1:160
ds_read2_b32 v[94:95], v146 offset0:192 offset1:224
s_waitcnt lgkmcnt(4)
v_perm_b32 v144, v81, v80, s29
v_accvgpr_write_b32 a24, v144
v_perm_b32 v145, v83, v82, s29
v_accvgpr_write_b32 a25, v145
v_perm_b32 v144, v85, v84, s29
v_accvgpr_write_b32 a26, v144
v_perm_b32 v145, v87, v86, s29
v_accvgpr_write_b32 a27, v145
v_perm_b32 v144, v81, v80, s30
v_accvgpr_write_b32 a72, v144
v_perm_b32 v145, v83, v82, s30
v_accvgpr_write_b32 a73, v145
v_perm_b32 v144, v85, v84, s30
v_accvgpr_write_b32 a74, v144
v_perm_b32 v145, v87, v86, s30
v_accvgpr_write_b32 a75, v145
s_waitcnt vmcnt(30)
v_add_u32 v146, 0, v14
ds_read2_b32 v[80:81], v146 offset0:0 offset1:32
ds_read2_b32 v[82:83], v146 offset0:64 offset1:96
ds_read2_b32 v[84:85], v146 offset0:128 offset1:160
ds_read2_b32 v[86:87], v146 offset0:192 offset1:224
s_waitcnt lgkmcnt(4)
v_perm_b32 v144, v89, v88, s29
v_accvgpr_write_b32 a120, v144
v_perm_b32 v145, v91, v90, s29
v_accvgpr_write_b32 a121, v145
v_perm_b32 v144, v93, v92, s29
v_accvgpr_write_b32 a122, v144
v_perm_b32 v145, v95, v94, s29
v_accvgpr_write_b32 a123, v145
v_perm_b32 v144, v89, v88, s30
v_accvgpr_write_b32 a168, v144
v_perm_b32 v145, v91, v90, s30
v_accvgpr_write_b32 a169, v145
v_perm_b32 v144, v93, v92, s30
v_accvgpr_write_b32 a170, v144
v_perm_b32 v145, v95, v94, s30
v_accvgpr_write_b32 a171, v145
s_waitcnt vmcnt(28)
v_add_u32 v146, 2048, v14
ds_read2_b32 v[88:89], v146 offset0:0 offset1:32
ds_read2_b32 v[90:91], v146 offset0:64 offset1:96
ds_read2_b32 v[92:93], v146 offset0:128 offset1:160
ds_read2_b32 v[94:95], v146 offset0:192 offset1:224
s_waitcnt lgkmcnt(4)
v_perm_b32 v144, v81, v80, s52
v_accvgpr_write_b32 a216, v144
v_perm_b32 v145, v83, v82, s52
v_accvgpr_write_b32 a217, v145
v_perm_b32 v144, v85, v84, s52
v_accvgpr_write_b32 a218, v144
v_perm_b32 v145, v87, v86, s52
v_accvgpr_write_b32 a219, v145
s_waitcnt vmcnt(26)
v_add_u32 v146, 4096, v14
ds_read2_b32 v[80:81], v146 offset0:0 offset1:32
ds_read2_b32 v[82:83], v146 offset0:64 offset1:96
ds_read2_b32 v[84:85], v146 offset0:128 offset1:160
ds_read2_b32 v[86:87], v146 offset0:192 offset1:224
s_waitcnt lgkmcnt(4)
v_perm_b32 v144, v89, v88, s29
v_accvgpr_write_b32 a28, v144
v_perm_b32 v145, v91, v90, s29
v_accvgpr_write_b32 a29, v145
v_perm_b32 v144, v93, v92, s29
v_accvgpr_write_b32 a30, v144
v_perm_b32 v145, v95, v94, s29
v_accvgpr_write_b32 a31, v145
v_perm_b32 v144, v89, v88, s30
v_accvgpr_write_b32 a76, v144
v_perm_b32 v145, v91, v90, s30
v_accvgpr_write_b32 a77, v145
v_perm_b32 v144, v93, v92, s30
v_accvgpr_write_b32 a78, v144
v_perm_b32 v145, v95, v94, s30
v_accvgpr_write_b32 a79, v145
s_waitcnt vmcnt(24)
v_add_u32 v146, 6144, v14
ds_read2_b32 v[88:89], v146 offset0:0 offset1:32
ds_read2_b32 v[90:91], v146 offset0:64 offset1:96
ds_read2_b32 v[92:93], v146 offset0:128 offset1:160
ds_read2_b32 v[94:95], v146 offset0:192 offset1:224
s_waitcnt lgkmcnt(4)
v_perm_b32 v144, v81, v80, s29
v_accvgpr_write_b32 a124, v144
v_perm_b32 v145, v83, v82, s29
v_accvgpr_write_b32 a125, v145
v_perm_b32 v144, v85, v84, s29
v_accvgpr_write_b32 a126, v144
v_perm_b32 v145, v87, v86, s29
v_accvgpr_write_b32 a127, v145
v_perm_b32 v144, v81, v80, s30
v_accvgpr_write_b32 a172, v144
v_perm_b32 v145, v83, v82, s30
v_accvgpr_write_b32 a173, v145
v_perm_b32 v144, v85, v84, s30
v_accvgpr_write_b32 a174, v144
v_perm_b32 v145, v87, v86, s30
v_accvgpr_write_b32 a175, v145
s_waitcnt vmcnt(22)
v_add_u32 v146, 8192, v14
ds_read2_b32 v[80:81], v146 offset0:0 offset1:32
ds_read2_b32 v[82:83], v146 offset0:64 offset1:96
ds_read2_b32 v[84:85], v146 offset0:128 offset1:160
ds_read2_b32 v[86:87], v146 offset0:192 offset1:224
s_waitcnt lgkmcnt(4)
v_perm_b32 v144, v89, v88, s52
v_accvgpr_write_b32 a220, v144
v_perm_b32 v145, v91, v90, s52
v_accvgpr_write_b32 a221, v145
v_perm_b32 v144, v93, v92, s52
v_accvgpr_write_b32 a222, v144
v_perm_b32 v145, v95, v94, s52
v_accvgpr_write_b32 a223, v145
s_waitcnt vmcnt(20)
v_add_u32 v146, 10240, v14
ds_read2_b32 v[88:89], v146 offset0:0 offset1:32
ds_read2_b32 v[90:91], v146 offset0:64 offset1:96
ds_read2_b32 v[92:93], v146 offset0:128 offset1:160
ds_read2_b32 v[94:95], v146 offset0:192 offset1:224
s_waitcnt lgkmcnt(4)
v_perm_b32 v144, v81, v80, s29
v_accvgpr_write_b32 a32, v144
v_perm_b32 v145, v83, v82, s29
v_accvgpr_write_b32 a33, v145
v_perm_b32 v144, v85, v84, s29
v_accvgpr_write_b32 a34, v144
v_perm_b32 v145, v87, v86, s29
v_accvgpr_write_b32 a35, v145
v_perm_b32 v144, v81, v80, s30
v_accvgpr_write_b32 a80, v144
v_perm_b32 v145, v83, v82, s30
v_accvgpr_write_b32 a81, v145
v_perm_b32 v144, v85, v84, s30
v_accvgpr_write_b32 a82, v144
v_perm_b32 v145, v87, v86, s30
v_accvgpr_write_b32 a83, v145
s_waitcnt vmcnt(18)
v_add_u32 v146, 12288, v14
ds_read2_b32 v[80:81], v146 offset0:0 offset1:32
ds_read2_b32 v[82:83], v146 offset0:64 offset1:96
ds_read2_b32 v[84:85], v146 offset0:128 offset1:160
ds_read2_b32 v[86:87], v146 offset0:192 offset1:224
s_waitcnt lgkmcnt(4)
v_perm_b32 v144, v89, v88, s29
v_accvgpr_write_b32 a128, v144
v_perm_b32 v145, v91, v90, s29
v_accvgpr_write_b32 a129, v145
v_perm_b32 v144, v93, v92, s29
v_accvgpr_write_b32 a130, v144
v_perm_b32 v145, v95, v94, s29
v_accvgpr_write_b32 a131, v145
v_perm_b32 v144, v89, v88, s30
v_accvgpr_write_b32 a176, v144
v_perm_b32 v145, v91, v90, s30
v_accvgpr_write_b32 a177, v145
v_perm_b32 v144, v93, v92, s30
v_accvgpr_write_b32 a178, v144
v_perm_b32 v145, v95, v94, s30
v_accvgpr_write_b32 a179, v145
s_waitcnt vmcnt(16)
v_add_u32 v146, 14336, v14
ds_read2_b32 v[88:89], v146 offset0:0 offset1:32
ds_read2_b32 v[90:91], v146 offset0:64 offset1:96
ds_read2_b32 v[92:93], v146 offset0:128 offset1:160
ds_read2_b32 v[94:95], v146 offset0:192 offset1:224
s_waitcnt lgkmcnt(4)
v_perm_b32 v144, v81, v80, s52
v_accvgpr_write_b32 a224, v144
v_perm_b32 v145, v83, v82, s52
v_accvgpr_write_b32 a225, v145
v_perm_b32 v144, v85, v84, s52
v_accvgpr_write_b32 a226, v144
v_perm_b32 v145, v87, v86, s52
v_accvgpr_write_b32 a227, v145
s_waitcnt vmcnt(14)
v_add_u32 v146, 16384, v14
ds_read2_b32 v[80:81], v146 offset0:0 offset1:32
ds_read2_b32 v[82:83], v146 offset0:64 offset1:96
ds_read2_b32 v[84:85], v146 offset0:128 offset1:160
ds_read2_b32 v[86:87], v146 offset0:192 offset1:224
s_waitcnt lgkmcnt(4)
v_perm_b32 v144, v89, v88, s29
v_accvgpr_write_b32 a36, v144
v_perm_b32 v145, v91, v90, s29
v_accvgpr_write_b32 a37, v145
v_perm_b32 v144, v93, v92, s29
v_accvgpr_write_b32 a38, v144
v_perm_b32 v145, v95, v94, s29
v_accvgpr_write_b32 a39, v145
v_perm_b32 v144, v89, v88, s30
v_accvgpr_write_b32 a84, v144
v_perm_b32 v145, v91, v90, s30
v_accvgpr_write_b32 a85, v145
v_perm_b32 v144, v93, v92, s30
v_accvgpr_write_b32 a86, v144
v_perm_b32 v145, v95, v94, s30
v_accvgpr_write_b32 a87, v145
s_waitcnt vmcnt(12)
v_add_u32 v146, 18432, v14
ds_read2_b32 v[88:89], v146 offset0:0 offset1:32
ds_read2_b32 v[90:91], v146 offset0:64 offset1:96
ds_read2_b32 v[92:93], v146 offset0:128 offset1:160
ds_read2_b32 v[94:95], v146 offset0:192 offset1:224
s_waitcnt lgkmcnt(4)
v_perm_b32 v144, v81, v80, s29
v_accvgpr_write_b32 a132, v144
v_perm_b32 v145, v83, v82, s29
v_accvgpr_write_b32 a133, v145
v_perm_b32 v144, v85, v84, s29
v_accvgpr_write_b32 a134, v144
v_perm_b32 v145, v87, v86, s29
v_accvgpr_write_b32 a135, v145
v_perm_b32 v144, v81, v80, s30
v_accvgpr_write_b32 a180, v144
v_perm_b32 v145, v83, v82, s30
v_accvgpr_write_b32 a181, v145
v_perm_b32 v144, v85, v84, s30
v_accvgpr_write_b32 a182, v144
v_perm_b32 v145, v87, v86, s30
v_accvgpr_write_b32 a183, v145
s_waitcnt vmcnt(10)
v_add_u32 v146, 20480, v14
ds_read2_b32 v[80:81], v146 offset0:0 offset1:32
ds_read2_b32 v[82:83], v146 offset0:64 offset1:96
ds_read2_b32 v[84:85], v146 offset0:128 offset1:160
ds_read2_b32 v[86:87], v146 offset0:192 offset1:224
s_waitcnt lgkmcnt(4)
v_perm_b32 v144, v89, v88, s52
v_accvgpr_write_b32 a228, v144
v_perm_b32 v145, v91, v90, s52
v_accvgpr_write_b32 a229, v145
v_perm_b32 v144, v93, v92, s52
v_accvgpr_write_b32 a230, v144
v_perm_b32 v145, v95, v94, s52
v_accvgpr_write_b32 a231, v145
s_waitcnt vmcnt(8)
v_add_u32 v146, 22528, v14
ds_read2_b32 v[88:89], v146 offset0:0 offset1:32
ds_read2_b32 v[90:91], v146 offset0:64 offset1:96
ds_read2_b32 v[92:93], v146 offset0:128 offset1:160
ds_read2_b32 v[94:95], v146 offset0:192 offset1:224
s_waitcnt lgkmcnt(4)
v_perm_b32 v144, v81, v80, s29
v_accvgpr_write_b32 a40, v144
v_perm_b32 v145, v83, v82, s29
v_accvgpr_write_b32 a41, v145
v_perm_b32 v144, v85, v84, s29
v_accvgpr_write_b32 a42, v144
v_perm_b32 v145, v87, v86, s29
v_accvgpr_write_b32 a43, v145
v_perm_b32 v144, v81, v80, s30
v_accvgpr_write_b32 a88, v144
v_perm_b32 v145, v83, v82, s30
v_accvgpr_write_b32 a89, v145
v_perm_b32 v144, v85, v84, s30
v_accvgpr_write_b32 a90, v144
v_perm_b32 v145, v87, v86, s30
v_accvgpr_write_b32 a91, v145
s_waitcnt vmcnt(6)
v_add_u32 v146, 24576, v14
ds_read2_b32 v[80:81], v146 offset0:0 offset1:32
ds_read2_b32 v[82:83], v146 offset0:64 offset1:96
ds_read2_b32 v[84:85], v146 offset0:128 offset1:160
ds_read2_b32 v[86:87], v146 offset0:192 offset1:224
s_waitcnt lgkmcnt(4)
v_perm_b32 v144, v89, v88, s29
v_accvgpr_write_b32 a136, v144
v_perm_b32 v145, v91, v90, s29
v_accvgpr_write_b32 a137, v145
v_perm_b32 v144, v93, v92, s29
v_accvgpr_write_b32 a138, v144
v_perm_b32 v145, v95, v94, s29
v_accvgpr_write_b32 a139, v145
v_perm_b32 v144, v89, v88, s30
v_accvgpr_write_b32 a184, v144
v_perm_b32 v145, v91, v90, s30
v_accvgpr_write_b32 a185, v145
v_perm_b32 v144, v93, v92, s30
v_accvgpr_write_b32 a186, v144
v_perm_b32 v145, v95, v94, s30
v_accvgpr_write_b32 a187, v145
s_waitcnt vmcnt(4)
v_add_u32 v146, 26624, v14
ds_read2_b32 v[88:89], v146 offset0:0 offset1:32
ds_read2_b32 v[90:91], v146 offset0:64 offset1:96
ds_read2_b32 v[92:93], v146 offset0:128 offset1:160
ds_read2_b32 v[94:95], v146 offset0:192 offset1:224
s_waitcnt lgkmcnt(4)
v_perm_b32 v144, v81, v80, s52
v_accvgpr_write_b32 a232, v144
v_perm_b32 v145, v83, v82, s52
v_accvgpr_write_b32 a233, v145
v_perm_b32 v144, v85, v84, s52
v_accvgpr_write_b32 a234, v144
v_perm_b32 v145, v87, v86, s52
v_accvgpr_write_b32 a235, v145
s_waitcnt vmcnt(2)
v_add_u32 v146, 28672, v14
ds_read2_b32 v[80:81], v146 offset0:0 offset1:32
ds_read2_b32 v[82:83], v146 offset0:64 offset1:96
ds_read2_b32 v[84:85], v146 offset0:128 offset1:160
ds_read2_b32 v[86:87], v146 offset0:192 offset1:224
s_waitcnt lgkmcnt(4)
v_perm_b32 v144, v89, v88, s29
v_accvgpr_write_b32 a44, v144
v_perm_b32 v145, v91, v90, s29
v_accvgpr_write_b32 a45, v145
v_perm_b32 v144, v93, v92, s29
v_accvgpr_write_b32 a46, v144
v_perm_b32 v145, v95, v94, s29
v_accvgpr_write_b32 a47, v145
v_perm_b32 v144, v89, v88, s30
v_accvgpr_write_b32 a92, v144
v_perm_b32 v145, v91, v90, s30
v_accvgpr_write_b32 a93, v145
v_perm_b32 v144, v93, v92, s30
v_accvgpr_write_b32 a94, v144
v_perm_b32 v145, v95, v94, s30
v_accvgpr_write_b32 a95, v145
s_waitcnt vmcnt(0)
v_add_u32 v146, 30720, v14
ds_read2_b32 v[88:89], v146 offset0:0 offset1:32
ds_read2_b32 v[90:91], v146 offset0:64 offset1:96
ds_read2_b32 v[92:93], v146 offset0:128 offset1:160
ds_read2_b32 v[94:95], v146 offset0:192 offset1:224
s_waitcnt lgkmcnt(4)
v_perm_b32 v144, v81, v80, s29
v_accvgpr_write_b32 a140, v144
v_perm_b32 v145, v83, v82, s29
v_accvgpr_write_b32 a141, v145
v_perm_b32 v144, v85, v84, s29
v_accvgpr_write_b32 a142, v144
v_perm_b32 v145, v87, v86, s29
v_accvgpr_write_b32 a143, v145
v_perm_b32 v144, v81, v80, s30
v_accvgpr_write_b32 a188, v144
v_perm_b32 v145, v83, v82, s30
v_accvgpr_write_b32 a189, v145
v_perm_b32 v144, v85, v84, s30
v_accvgpr_write_b32 a190, v144
v_perm_b32 v145, v87, v86, s30
v_accvgpr_write_b32 a191, v145
s_waitcnt lgkmcnt(0)
v_perm_b32 v144, v89, v88, s52
v_accvgpr_write_b32 a236, v144
v_perm_b32 v145, v91, v90, s52
v_accvgpr_write_b32 a237, v145
v_perm_b32 v144, v93, v92, s52
v_accvgpr_write_b32 a238, v144
v_perm_b32 v145, v95, v94, s52
v_accvgpr_write_b32 a239, v145
s_cmp_lg_u32 s28, 0
s_cbranch_scc1 Lgwd_70
Lgw_69:
buffer_load_dwordx2 v[8:9], off, s[20:23], 0 sc1
s_waitcnt vmcnt(0)
v_cmp_gt_u32 vcc, 255, v8
s_cbranch_vccz Lgwe_71
s_cmp_eq_u32 s25, 0
s_cbranch_scc1 Lgwe_71
s_sub_u32 s25, s25, 1
s_sleep 4
s_branch Lgw_69
Lgwe_71:
Lgwd_70:
s_barrier
s_mov_b32 s50, 1
Lpl_72:
buffer_load_dword v9, v7, s[4:7], 0 offen sc1
s_waitcnt vmcnt(0)
v_cmp_gt_u32 vcc, s50, v9
s_cbranch_vccz Lpld_73
s_cmp_eq_u32 s25, 0
s_cbranch_scc1 Lpld_73
s_sub_u32 s25, s25, 1
s_sleep 1
s_branch Lpl_72
Lpld_73:
s_add_u32 s44, s43, 4096
s_add_u32 s45, s43, 8192
buffer_load_dwordx4 v[16:19], v6, s[4:7], s43 offen offset:0 sc1
buffer_load_dwordx4 v[20:23], v6, s[4:7], s43 offen offset:1024 sc1
buffer_load_dwordx4 v[24:27], v6, s[4:7], s43 offen offset:2048 sc1
buffer_load_dwordx4 v[28:31], v6, s[4:7], s43 offen offset:3072 sc1
buffer_load_dwordx4 v[32:35], v6, s[4:7], s44 offen offset:0 sc1
buffer_load_dwordx4 v[36:39], v6, s[4:7], s44 offen offset:1024 sc1
buffer_load_dwordx4 v[40:43], v6, s[4:7], s44 offen offset:2048 sc1
buffer_load_dwordx4 v[44:47], v6, s[4:7], s44 offen offset:3072 sc1
buffer_load_dwordx4 v[48:51], v6, s[4:7], s45 offen offset:0 sc1
buffer_load_dwordx4 v[52:55], v6, s[4:7], s45 offen offset:1024 sc1
buffer_load_dwordx4 v[56:59], v6, s[4:7], s45 offen offset:2048 sc1
buffer_load_dwordx4 v[60:63], v6, s[4:7], s45 offen offset:3072 sc1
buffer_load_dword v9, v7, s[4:7], 0 offen sc1
Lu_loop:
s_add_u32 s43, s43, 393216
s_add_u32 s44, s43, 4096
s_add_u32 s45, s43, 8192
v_mov_b32 v8, s24
s_add_u32 s50, s24, 2
s_min_u32 s50, s50, 64
s_waitcnt vmcnt(0)
buffer_store_dword v8, v5, s[4:7], 0 offen sc1
v_cmp_gt_u32 vcc, s50, v9
s_cmp_eq_u64 vcc, 0
s_cselect_b32 s51, 1, 0
v_mfma_f32_32x32x16_bf16 v[64:79], v[16:19], a[0:3], 0
v_mfma_f32_32x32x16_bf16 v[80:95], v[16:19], a[48:51], 0
v_mfma_f32_32x32x16_bf16 v[96:111], v[16:19], a[96:99], 0
v_mfma_f32_32x32x16_bf16 v[112:127], v[16:19], a[144:147], 0
v_mfma_f32_32x32x16_bf16 v[128:143], v[16:19], a[192:195], 0
s_cmp_eq_u32 s51, 0
s_cbranch_scc1 Lpf_74
buffer_load_dwordx4 v[16:19], v6, s[4:7], s43 offen offset:0 sc1
Lpf_74:
v_mfma_f32_32x32x16_bf16 v[64:79], v[20:23], a[4:7], v[64:79]
v_mfma_f32_32x32x16_bf16 v[80:95], v[20:23], a[52:55], v[80:95]
v_mfma_f32_32x32x16_bf16 v[96:111], v[20:23], a[100:103], v[96:111]
v_mfma_f32_32x32x16_bf16 v[112:127], v[20:23], a[148:151], v[112:127]
v_mfma_f32_32x32x16_bf16 v[128:143], v[20:23], a[196:199], v[128:143]
s_cmp_eq_u32 s51, 0
s_cbranch_scc1 Lpf_75
buffer_load_dwordx4 v[20:23], v6, s[4:7], s43 offen offset:1024 sc1
Lpf_75:
v_mfma_f32_32x32x16_bf16 v[64:79], v[24:27], a[8:11], v[64:79]
v_mfma_f32_32x32x16_bf16 v[80:95], v[24:27], a[56:59], v[80:95]
v_mfma_f32_32x32x16_bf16 v[96:111], v[24:27], a[104:107], v[96:111]
v_mfma_f32_32x32x16_bf16 v[112:127], v[24:27], a[152:155], v[112:127]
v_mfma_f32_32x32x16_bf16 v[128:143], v[24:27], a[200:203], v[128:143]
s_cmp_eq_u32 s51, 0
s_cbranch_scc1 Lpf_76
buffer_load_dwordx4 v[24:27], v6, s[4:7], s43 offen offset:2048 sc1
Lpf_76:
s_cmp_eq_u32 s51, 1
s_cbranch_scc1 Lsl_77
buffer_load_dword v9, v7, s[4:7], 0 offen sc1
Lsl_77:
v_mfma_f32_32x32x16_bf16 v[64:79], v[28:31], a[12:15], v[64:79]
v_mfma_f32_32x32x16_bf16 v[80:95], v[28:31], a[60:63], v[80:95]
v_mfma_f32_32x32x16_bf16 v[96:111], v[28:31], a[108:111], v[96:111]
v_mfma_f32_32x32x16_bf16 v[112:127], v[28:31], a[156:159], v[112:127]
v_mfma_f32_32x32x16_bf16 v[128:143], v[28:31], a[204:207], v[128:143]
s_cmp_eq_u32 s51, 0
s_cbranch_scc1 Lpf_78
buffer_load_dwordx4 v[28:31], v6, s[4:7], s43 offen offset:3072 sc1
Lpf_78:
v_mfma_f32_32x32x16_bf16 v[64:79], v[32:35], a[16:19], v[64:79]
v_mfma_f32_32x32x16_bf16 v[80:95], v[32:35], a[64:67], v[80:95]
v_mfma_f32_32x32x16_bf16 v[96:111], v[32:35], a[112:115], v[96:111]
v_mfma_f32_32x32x16_bf16 v[112:127], v[32:35], a[160:163], v[112:127]
v_mfma_f32_32x32x16_bf16 v[128:143], v[32:35], a[208:211], v[128:143]
s_cmp_eq_u32 s51, 0
s_cbranch_scc1 Lpf_79
buffer_load_dwordx4 v[32:35], v6, s[4:7], s44 offen offset:0 sc1
Lpf_79:
v_mfma_f32_32x32x16_bf16 v[64:79], v[36:39], a[20:23], v[64:79]
v_mfma_f32_32x32x16_bf16 v[80:95], v[36:39], a[68:71], v[80:95]
v_mfma_f32_32x32x16_bf16 v[96:111], v[36:39], a[116:119], v[96:111]
v_mfma_f32_32x32x16_bf16 v[112:127], v[36:39], a[164:167], v[112:127]
v_mfma_f32_32x32x16_bf16 v[128:143], v[36:39], a[212:215], v[128:143]
s_cmp_eq_u32 s51, 0
s_cbranch_scc1 Lpf_80
buffer_load_dwordx4 v[36:39], v6, s[4:7], s44 offen offset:1024 sc1
Lpf_80:
v_mfma_f32_32x32x16_bf16 v[64:79], v[40:43], a[24:27], v[64:79]
v_mfma_f32_32x32x16_bf16 v[80:95], v[40:43], a[72:75], v[80:95]
v_mfma_f32_32x32x16_bf16 v[96:111], v[40:43], a[120:123], v[96:111]
v_mfma_f32_32x32x16_bf16 v[112:127], v[40:43], a[168:171], v[112:127]
v_mfma_f32_32x32x16_bf16 v[128:143], v[40:43], a[216:219], v[128:143]
s_cmp_eq_u32 s51, 0
s_cbranch_scc1 Lpf_81
buffer_load_dwordx4 v[40:43], v6, s[4:7], s44 offen offset:2048 sc1
Lpf_81:
s_cmp_eq_u32 s51, 1
s_cbranch_scc1 Lsc_82
s_waitcnt vmcnt(0)
v_cmp_gt_u32 vcc, s50, v9
s_cbranch_vccnz Lsc_82
s_mov_b32 s51, 1
buffer_load_dwordx4 v[16:19], v6, s[4:7], s43 offen offset:0 sc1
buffer_load_dwordx4 v[20:23], v6, s[4:7], s43 offen offset:1024 sc1
buffer_load_dwordx4 v[24:27], v6, s[4:7], s43 offen offset:2048 sc1
buffer_load_dwordx4 v[28:31], v6, s[4:7], s43 offen offset:3072 sc1
buffer_load_dwordx4 v[32:35], v6, s[4:7], s44 offen offset:0 sc1
buffer_load_dwordx4 v[36:39], v6, s[4:7], s44 offen offset:1024 sc1
buffer_load_dwordx4 v[40:43], v6, s[4:7], s44 offen offset:2048 sc1
Lsc_82:
v_mfma_f32_32x32x16_bf16 v[64:79], v[44:47], a[28:31], v[64:79]
v_mfma_f32_32x32x16_bf16 v[80:95], v[44:47], a[76:79], v[80:95]
v_mfma_f32_32x32x16_bf16 v[96:111], v[44:47], a[124:127], v[96:111]
v_mfma_f32_32x32x16_bf16 v[112:127], v[44:47], a[172:175], v[112:127]
v_mfma_f32_32x32x16_bf16 v[128:143], v[44:47], a[220:223], v[128:143]
s_cmp_eq_u32 s51, 0
s_cbranch_scc1 Lpf_83
buffer_load_dwordx4 v[44:47], v6, s[4:7], s44 offen offset:3072 sc1
Lpf_83:
v_mfma_f32_32x32x16_bf16 v[64:79], v[48:51], a[32:35], v[64:79]
v_mfma_f32_32x32x16_bf16 v[80:95], v[48:51], a[80:83], v[80:95]
v_mfma_f32_32x32x16_bf16 v[96:111], v[48:51], a[128:131], v[96:111]
v_mfma_f32_32x32x16_bf16 v[112:127], v[48:51], a[176:179], v[112:127]
v_mfma_f32_32x32x16_bf16 v[128:143], v[48:51], a[224:227], v[128:143]
s_cmp_eq_u32 s51, 0
s_cbranch_scc1 Lpf_84
buffer_load_dwordx4 v[48:51], v6, s[4:7], s45 offen offset:0 sc1
Lpf_84:
v_mfma_f32_32x32x16_bf16 v[64:79], v[52:55], a[36:39], v[64:79]
v_mfma_f32_32x32x16_bf16 v[80:95], v[52:55], a[84:87], v[80:95]
v_mfma_f32_32x32x16_bf16 v[96:111], v[52:55], a[132:135], v[96:111]
v_mfma_f32_32x32x16_bf16 v[112:127], v[52:55], a[180:183], v[112:127]
v_mfma_f32_32x32x16_bf16 v[128:143], v[52:55], a[228:231], v[128:143]
s_cmp_eq_u32 s51, 0
s_cbranch_scc1 Lpf_85
buffer_load_dwordx4 v[52:55], v6, s[4:7], s45 offen offset:1024 sc1
Lpf_85:
v_mfma_f32_32x32x16_bf16 v[64:79], v[56:59], a[40:43], v[64:79]
v_mfma_f32_32x32x16_bf16 v[80:95], v[56:59], a[88:91], v[80:95]
v_mfma_f32_32x32x16_bf16 v[96:111], v[56:59], a[136:139], v[96:111]
v_mfma_f32_32x32x16_bf16 v[112:127], v[56:59], a[184:187], v[112:127]
v_mfma_f32_32x32x16_bf16 v[128:143], v[56:59], a[232:235], v[128:143]
s_cmp_eq_u32 s51, 0
s_cbranch_scc1 Lpf_86
buffer_load_dwordx4 v[56:59], v6, s[4:7], s45 offen offset:2048 sc1
Lpf_86:
v_mfma_f32_32x32x16_bf16 v[64:79], v[60:63], a[44:47], v[64:79]
v_mfma_f32_32x32x16_bf16 v[80:95], v[60:63], a[92:95], v[80:95]
v_mfma_f32_32x32x16_bf16 v[96:111], v[60:63], a[140:143], v[96:111]
v_mfma_f32_32x32x16_bf16 v[112:127], v[60:63], a[188:191], v[112:127]
v_mfma_f32_32x32x16_bf16 v[128:143], v[60:63], a[236:239], v[128:143]
s_cmp_eq_u32 s51, 0
s_cbranch_scc1 Lpf_87
buffer_load_dwordx4 v[60:63], v6, s[4:7], s45 offen offset:3072 sc1
Lpf_87:
s_add_u32 s38, s37, 131072
v_cvt_pk_bf16_f32 v144, v64, v65
v_cvt_pk_bf16_f32 v145, v66, v67
v_cvt_pk_bf16_f32 v146, v68, v69
v_cvt_pk_bf16_f32 v147, v70, v71
buffer_store_dwordx4 v[144:147], v4, s[4:7], s37 offen offset:0 sc1
v_cvt_pk_bf16_f32 v148, v72, v73
v_cvt_pk_bf16_f32 v149, v74, v75
v_cvt_pk_bf16_f32 v150, v76, v77
v_cvt_pk_bf16_f32 v151, v78, v79
buffer_store_dwordx4 v[148:151], v4, s[4:7], s37 offen offset:512 sc1
v_cvt_pk_bf16_f32 v152, v80, v81
v_cvt_pk_bf16_f32 v153, v82, v83
v_cvt_pk_bf16_f32 v154, v84, v85
v_cvt_pk_bf16_f32 v155, v86, v87
buffer_store_dwordx4 v[152:155], v4, s[4:7], s37 offen offset:128 sc1
v_cvt_pk_bf16_f32 v156, v88, v89
v_cvt_pk_bf16_f32 v157, v90, v91
v_cvt_pk_bf16_f32 v158, v92, v93
v_cvt_pk_bf16_f32 v159, v94, v95
buffer_store_dwordx4 v[156:159], v4, s[4:7], s37 offen offset:640 sc1
v_cvt_pk_bf16_f32 v160, v96, v97
v_cvt_pk_bf16_f32 v161, v98, v99
v_cvt_pk_bf16_f32 v162, v100, v101
v_cvt_pk_bf16_f32 v163, v102, v103
buffer_store_dwordx4 v[160:163], v4, s[4:7], s38 offen offset:0 sc1
v_cvt_pk_bf16_f32 v164, v104, v105
v_cvt_pk_bf16_f32 v165, v106, v107
v_cvt_pk_bf16_f32 v166, v108, v109
v_cvt_pk_bf16_f32 v167, v110, v111
buffer_store_dwordx4 v[164:167], v4, s[4:7], s38 offen offset:512 sc1
v_cvt_pk_bf16_f32 v168, v112, v113
v_cvt_pk_bf16_f32 v169, v114, v115
v_cvt_pk_bf16_f32 v170, v116, v117
v_cvt_pk_bf16_f32 v171, v118, v119
buffer_store_dwordx4 v[168:171], v4, s[4:7], s38 offen offset:128 sc1
v_cvt_pk_bf16_f32 v172, v120, v121
v_cvt_pk_bf16_f32 v173, v122, v123
v_cvt_pk_bf16_f32 v174, v124, v125
v_cvt_pk_bf16_f32 v175, v126, v127
buffer_store_dwordx4 v[172:175], v4, s[4:7], s38 offen offset:640 sc1
v_cvt_pk_bf16_f32 v176, v128, v129
v_cvt_pk_bf16_f32 v177, v130, v131
v_cvt_pk_bf16_f32 v178, v132, v133
v_cvt_pk_bf16_f32 v179, v134, v135
buffer_store_dwordx4 v[176:179], v4, s[4:7], s39 offen offset:0 sc1
v_cvt_pk_bf16_f32 v180, v136, v137
v_cvt_pk_bf16_f32 v181, v138, v139
v_cvt_pk_bf16_f32 v182, v140, v141
v_cvt_pk_bf16_f32 v183, v142, v143
buffer_store_dwordx4 v[180:183], v4, s[4:7], s39 offen offset:512 sc1
s_add_u32 s37, s37, 1310720
s_add_u32 s39, s39, 1310720
s_cmp_eq_u32 s51, 1
s_cbranch_scc1 Llate_88
v_add_u32 v8, 1, v8
s_waitcnt vmcnt(0)
buffer_store_dword v8, v5, s[4:7], 0 offen sc1
Lpl_89:
buffer_load_dword v9, v7, s[4:7], 0 offen sc1
s_waitcnt vmcnt(0)
v_cmp_gt_u32 vcc, s50, v9
s_cbranch_vccz Lpld_90
s_cmp_eq_u32 s25, 0
s_cbranch_scc1 Lpld_90
s_sub_u32 s25, s25, 1
s_sleep 1
s_branch Lpl_89
Lpld_90:
buffer_load_dwordx4 v[16:19], v6, s[4:7], s43 offen offset:0 sc1
buffer_load_dwordx4 v[20:23], v6, s[4:7], s43 offen offset:1024 sc1
buffer_load_dwordx4 v[24:27], v6, s[4:7], s43 offen offset:2048 sc1
buffer_load_dwordx4 v[28:31], v6, s[4:7], s43 offen offset:3072 sc1
buffer_load_dwordx4 v[32:35], v6, s[4:7], s44 offen offset:0 sc1
buffer_load_dwordx4 v[36:39], v6, s[4:7], s44 offen offset:1024 sc1
buffer_load_dwordx4 v[40:43], v6, s[4:7], s44 offen offset:2048 sc1
buffer_load_dwordx4 v[44:47], v6, s[4:7], s44 offen offset:3072 sc1
buffer_load_dwordx4 v[48:51], v6, s[4:7], s45 offen offset:0 sc1
buffer_load_dwordx4 v[52:55], v6, s[4:7], s45 offen offset:1024 sc1
buffer_load_dwordx4 v[56:59], v6, s[4:7], s45 offen offset:2048 sc1
buffer_load_dwordx4 v[60:63], v6, s[4:7], s45 offen offset:3072 sc1
Llate_88:
s_add_u32 s46, s24, 3
s_min_u32 s46, s46, 64
v_cmp_gt_u32 vcc, s46, v9
s_cbranch_vccz Lrf_91
buffer_load_dword v9, v7, s[4:7], 0 offen sc1
Lrf_91:
s_add_u32 s24, s24, 1
s_cmp_lt_u32 s24, 64
s_cbranch_scc1 Lu_loop
v_mov_b32 v8, 64
s_waitcnt vmcnt(0)
buffer_store_dword v8, v5, s[4:7], 0 offen sc1
s_endpgm
Lf1:
v_and_b32 v9, 31, v0
v_lshrrev_b32 v10, 5, v0
v_lshlrev_b32 v6, 4, v0
s_load_dwordx2 s[8:9], s[0:1], 64
s_load_dwordx2 s[12:13], s[0:1], 72
s_lshl_b32 s32, s32, 2
s_add_u32 s32, s32, s28
s_lshl_b32 s46, s32, 7
s_add_u32 s46, s46, 81920
v_mov_b32 v5, s46
v_mov_b32 v1, 2146435072
v_cmp_eq_u32 vcc, 0, v0
s_nop 1
v_cndmask_b32 v5, v1, v5, vcc
s_mov_b32 s10, 1966080
s_mov_b32 s11, 0x20000
s_mov_b32 s14, 1966080
s_mov_b32 s15, 0x20000
s_lshl_b32 s46, s32, 6
v_lshrrev_b32 v12, 2, v0
v_mul_u32_u24 v12, 3072, v12
v_and_b32 v13, 3, v0
v_lshl_add_u32 v2, v13, 4, s46
v_add_u32 v2, v2, v12
v_and_b32 v11, 15, v9
v_lshlrev_b32 v14, 2, v11
v_lshl_add_u32 v14, v10, 9, v14
v_lshrrev_b32 v11, 4, v9
v_lshl_add_u32 v14, v11, 10, v14
v_mov_b32 v4, v6
s_movk_i32 s38, 1024
s_lshl_b32 s37, s32, 11
s_add_u32 s37, s37, 170172416
s_mov_b32 s42, 98304
s_waitcnt lgkmcnt(0)
s_and_b32 s9, s9, 0xffff
s_and_b32 s13, s13, 0xffff
v_mov_b32 v8, 0
buffer_store_dword v8, v5, s[4:7], 0 offen sc1
s_load_dwordx2 s[16:17], s[0:1], 0
s_mov_b32 s18, 2621440
s_mov_b32 s19, 0x20000
v_lshrrev_b32 v18, 3, v0
s_lshl_b32 s46, s28, 3
v_add_u32 v18, s46, v18
v_and_b32 v19, 7, v0
v_mul_u32_u24 v16, 1280, v18
v_lshl_add_u32 v16, v19, 4, v16
v_lshlrev_b32 v17, 4, v18
v_and_b32 v20, 1, v19
v_lshl_add_u32 v17, v20, 9, v17
v_lshrrev_b32 v20, 1, v19
v_lshl_add_u32 v17, v20, 10, v17
s_waitcnt lgkmcnt(0)
s_and_b32 s17, s17, 0xffff
s_mul_i32 s53, s28, 30720
s_add_u32 s53, s53, 40960
v_add_u32 v14, s53, v14
s_add_u32 m0, s53, 0
s_mov_b32 s31, 0
buffer_load_dwordx4 v2, s[8:11], s31 offen lds
s_add_u32 m0, s53, 1024
s_nop 0
buffer_load_dwordx4 v2, s[12:15], s31 offen lds
s_add_u32 m0, s53, 2048
s_mov_b32 s31, 49152
buffer_load_dwordx4 v2, s[8:11], s31 offen lds
s_add_u32 m0, s53, 3072
s_nop 0
buffer_load_dwordx4 v2, s[12:15], s31 offen lds
s_add_u32 m0, s53, 4096
s_mov_b32 s31, 98304
buffer_load_dwordx4 v2, s[8:11], s31 offen lds
s_add_u32 m0, s53, 5120
s_nop 0
buffer_load_dwordx4 v2, s[12:15], s31 offen lds
s_waitcnt vmcnt(6)
s_barrier
s_cmp_lg_u32 s28, 0
s_cbranch_scc1 Larr_92
v_mov_b32 v8, 1
s_mov_b64 exec, 1
buffer_atomic_add v8, off, s[20:23], 0 sc1
s_mov_b64 exec, -1
Larr_92:
buffer_load_dwordx4 v[20:23], v16, s[16:19], 0 offen offset:0
buffer_load_dwordx4 v[24:27], v16, s[16:19], 0 offen offset:128
buffer_load_dwordx4 v[28:31], v16, s[16:19], 0 offen offset:256
buffer_load_dwordx4 v[32:35], v16, s[16:19], 0 offen offset:384
buffer_load_dwordx4 v[36:39], v16, s[16:19], 0 offen offset:512
buffer_load_dwordx4 v[40:43], v16, s[16:19], 0 offen offset:640
buffer_load_dwordx4 v[44:47], v16, s[16:19], 0 offen offset:768
buffer_load_dwordx4 v[48:51], v16, s[16:19], 0 offen offset:896
buffer_load_dwordx4 v[52:55], v16, s[16:19], 0 offen offset:1024
buffer_load_dwordx4 v[56:59], v16, s[16:19], 0 offen offset:1152
s_add_u32 m0, s53, 6144
s_mov_b32 s31, 147456
buffer_load_dwordx4 v2, s[8:11], s31 offen lds
s_add_u32 m0, s53, 7168
s_nop 0
buffer_load_dwordx4 v2, s[12:15], s31 offen lds
s_add_u32 m0, s53, 8192
s_mov_b32 s31, 196608
buffer_load_dwordx4 v2, s[8:11], s31 offen lds
s_add_u32 m0, s53, 9216
s_nop 0
buffer_load_dwordx4 v2, s[12:15], s31 offen lds
s_add_u32 m0, s53, 10240
s_mov_b32 s31, 245760
buffer_load_dwordx4 v2, s[8:11], s31 offen lds
s_add_u32 m0, s53, 11264
s_nop 0
buffer_load_dwordx4 v2, s[12:15], s31 offen lds
s_add_u32 m0, s53, 12288
s_mov_b32 s31, 294912
buffer_load_dwordx4 v2, s[8:11], s31 offen lds
s_add_u32 m0, s53, 13312
s_nop 0
buffer_load_dwordx4 v2, s[12:15], s31 offen lds
s_add_u32 m0, s53, 14336
s_mov_b32 s31, 344064
buffer_load_dwordx4 v2, s[8:11], s31 offen lds
s_add_u32 m0, s53, 15360
s_nop 0
buffer_load_dwordx4 v2, s[12:15], s31 offen lds
s_add_u32 m0, s53, 16384
s_mov_b32 s31, 393216
buffer_load_dwordx4 v2, s[8:11], s31 offen lds
s_add_u32 m0, s53, 17408
s_nop 0
buffer_load_dwordx4 v2, s[12:15], s31 offen lds
s_add_u32 m0, s53, 18432
s_mov_b32 s31, 442368
buffer_load_dwordx4 v2, s[8:11], s31 offen lds
s_add_u32 m0, s53, 19456
s_nop 0
buffer_load_dwordx4 v2, s[12:15], s31 offen lds
s_add_u32 m0, s53, 20480
s_mov_b32 s31, 491520
buffer_load_dwordx4 v2, s[8:11], s31 offen lds
s_add_u32 m0, s53, 21504
s_nop 0
buffer_load_dwordx4 v2, s[12:15], s31 offen lds
s_add_u32 m0, s53, 22528
s_mov_b32 s31, 540672
buffer_load_dwordx4 v2, s[8:11], s31 offen lds
s_add_u32 m0, s53, 23552
s_nop 0
buffer_load_dwordx4 v2, s[12:15], s31 offen lds
s_add_u32 m0, s53, 24576
s_mov_b32 s31, 589824
buffer_load_dwordx4 v2, s[8:11], s31 offen lds
s_add_u32 m0, s53, 25600
s_nop 0
buffer_load_dwordx4 v2, s[12:15], s31 offen lds
s_add_u32 m0, s53, 26624
s_mov_b32 s31, 638976
buffer_load_dwordx4 v2, s[8:11], s31 offen lds
s_add_u32 m0, s53, 27648
s_nop 0
buffer_load_dwordx4 v2, s[12:15], s31 offen lds
s_add_u32 m0, s53, 28672
s_mov_b32 s31, 688128
buffer_load_dwordx4 v2, s[8:11], s31 offen lds
s_add_u32 m0, s53, 29696
s_nop 0
buffer_load_dwordx4 v2, s[12:15], s31 offen lds
s_waitcnt vmcnt(28)
v_add_u32 v146, 0, v14
ds_read2_b32 v[148:149], v146 offset0:0 offset1:16
ds_read2_b32 v[150:151], v146 offset0:32 offset1:48
ds_read2_b32 v[152:153], v146 offset0:64 offset1:80
ds_read2_b32 v[154:155], v146 offset0:96 offset1:112
s_waitcnt vmcnt(26)
v_add_u32 v146, 2048, v14
ds_read2_b32 v[156:157], v146 offset0:0 offset1:16
ds_read2_b32 v[158:159], v146 offset0:32 offset1:48
ds_read2_b32 v[160:161], v146 offset0:64 offset1:80
ds_read2_b32 v[162:163], v146 offset0:96 offset1:112
s_waitcnt lgkmcnt(4)
s_add_u32 m0, s53, 0
s_mov_b32 s31, 737280
buffer_load_dwordx4 v2, s[8:11], s31 offen lds
s_add_u32 m0, s53, 1024
s_nop 0
buffer_load_dwordx4 v2, s[12:15], s31 offen lds
v_perm_b32 v144, v149, v148, s29
v_accvgpr_write_b32 a0, v144
v_perm_b32 v145, v151, v150, s29
v_accvgpr_write_b32 a1, v145
v_perm_b32 v144, v153, v152, s29
v_accvgpr_write_b32 a2, v144
v_perm_b32 v145, v155, v154, s29
v_accvgpr_write_b32 a3, v145
v_perm_b32 v144, v149, v148, s30
v_accvgpr_write_b32 a4, v144
v_perm_b32 v145, v151, v150, s30
v_accvgpr_write_b32 a5, v145
v_perm_b32 v144, v153, v152, s30
v_accvgpr_write_b32 a6, v144
v_perm_b32 v145, v155, v154, s30
v_accvgpr_write_b32 a7, v145
s_waitcnt vmcnt(26)
v_add_u32 v146, 4096, v14
ds_read2_b32 v[148:149], v146 offset0:0 offset1:16
ds_read2_b32 v[150:151], v146 offset0:32 offset1:48
ds_read2_b32 v[152:153], v146 offset0:64 offset1:80
ds_read2_b32 v[154:155], v146 offset0:96 offset1:112
s_waitcnt lgkmcnt(4)
s_add_u32 m0, s53, 2048
s_mov_b32 s31, 786432
buffer_load_dwordx4 v2, s[8:11], s31 offen lds
s_add_u32 m0, s53, 3072
s_nop 0
buffer_load_dwordx4 v2, s[12:15], s31 offen lds
v_perm_b32 v144, v157, v156, s29
v_accvgpr_write_b32 a8, v144
v_perm_b32 v145, v159, v158, s29
v_accvgpr_write_b32 a9, v145
v_perm_b32 v144, v161, v160, s29
v_accvgpr_write_b32 a10, v144
v_perm_b32 v145, v163, v162, s29
v_accvgpr_write_b32 a11, v145
v_perm_b32 v144, v157, v156, s30
v_accvgpr_write_b32 a12, v144
v_perm_b32 v145, v159, v158, s30
v_accvgpr_write_b32 a13, v145
v_perm_b32 v144, v161, v160, s30
v_accvgpr_write_b32 a14, v144
v_perm_b32 v145, v163, v162, s30
v_accvgpr_write_b32 a15, v145
s_waitcnt vmcnt(26)
v_add_u32 v146, 6144, v14
ds_read2_b32 v[156:157], v146 offset0:0 offset1:16
ds_read2_b32 v[158:159], v146 offset0:32 offset1:48
ds_read2_b32 v[160:161], v146 offset0:64 offset1:80
ds_read2_b32 v[162:163], v146 offset0:96 offset1:112
s_waitcnt lgkmcnt(4)
s_add_u32 m0, s53, 4096
s_mov_b32 s31, 835584
buffer_load_dwordx4 v2, s[8:11], s31 offen lds
s_add_u32 m0, s53, 5120
s_nop 0
buffer_load_dwordx4 v2, s[12:15], s31 offen lds
v_perm_b32 v144, v149, v148, s29
v_accvgpr_write_b32 a16, v144
v_perm_b32 v145, v151, v150, s29
v_accvgpr_write_b32 a17, v145
v_perm_b32 v144, v153, v152, s29
v_accvgpr_write_b32 a18, v144
v_perm_b32 v145, v155, v154, s29
v_accvgpr_write_b32 a19, v145
v_perm_b32 v144, v149, v148, s30
v_accvgpr_write_b32 a20, v144
v_perm_b32 v145, v151, v150, s30
v_accvgpr_write_b32 a21, v145
v_perm_b32 v144, v153, v152, s30
v_accvgpr_write_b32 a22, v144
v_perm_b32 v145, v155, v154, s30
v_accvgpr_write_b32 a23, v145
s_waitcnt vmcnt(26)
v_add_u32 v146, 8192, v14
ds_read2_b32 v[148:149], v146 offset0:0 offset1:16
ds_read2_b32 v[150:151], v146 offset0:32 offset1:48
ds_read2_b32 v[152:153], v146 offset0:64 offset1:80
ds_read2_b32 v[154:155], v146 offset0:96 offset1:112
s_waitcnt lgkmcnt(4)
s_add_u32 m0, s53, 6144
s_mov_b32 s31, 884736
buffer_load_dwordx4 v2, s[8:11], s31 offen lds
s_add_u32 m0, s53, 7168
s_nop 0
buffer_load_dwordx4 v2, s[12:15], s31 offen lds
v_perm_b32 v144, v157, v156, s29
v_accvgpr_write_b32 a24, v144
v_perm_b32 v145, v159, v158, s29
v_accvgpr_write_b32 a25, v145
v_perm_b32 v144, v161, v160, s29
v_accvgpr_write_b32 a26, v144
v_perm_b32 v145, v163, v162, s29
v_accvgpr_write_b32 a27, v145
v_perm_b32 v144, v157, v156, s30
v_accvgpr_write_b32 a28, v144
v_perm_b32 v145, v159, v158, s30
v_accvgpr_write_b32 a29, v145
v_perm_b32 v144, v161, v160, s30
v_accvgpr_write_b32 a30, v144
v_perm_b32 v145, v163, v162, s30
v_accvgpr_write_b32 a31, v145
v_lshlrev_b32 v64, 16, v20
v_and_b32 v65, 0xffff0000, v20
v_lshlrev_b32 v66, 16, v21
v_and_b32 v67, 0xffff0000, v21
v_lshlrev_b32 v68, 16, v22
v_and_b32 v69, 0xffff0000, v22
v_lshlrev_b32 v70, 16, v23
v_and_b32 v71, 0xffff0000, v23
v_lshlrev_b32 v72, 16, v24
v_and_b32 v73, 0xffff0000, v24
v_lshlrev_b32 v74, 16, v25
v_and_b32 v75, 0xffff0000, v25
v_lshlrev_b32 v76, 16, v26
v_and_b32 v77, 0xffff0000, v26
v_lshlrev_b32 v78, 16, v27
v_and_b32 v79, 0xffff0000, v27
v_lshlrev_b32 v80, 16, v28
v_and_b32 v81, 0xffff0000, v28
v_lshlrev_b32 v82, 16, v29
v_and_b32 v83, 0xffff0000, v29
v_lshlrev_b32 v84, 16, v30
v_and_b32 v85, 0xffff0000, v30
v_lshlrev_b32 v86, 16, v31
v_and_b32 v87, 0xffff0000, v31
v_lshlrev_b32 v88, 16, v32
v_and_b32 v89, 0xffff0000, v32
v_lshlrev_b32 v90, 16, v33
v_and_b32 v91, 0xffff0000, v33
v_lshlrev_b32 v92, 16, v34
v_and_b32 v93, 0xffff0000, v34
v_lshlrev_b32 v94, 16, v35
v_and_b32 v95, 0xffff0000, v35
v_lshlrev_b32 v96, 16, v36
v_and_b32 v97, 0xffff0000, v36
v_lshlrev_b32 v98, 16, v37
v_and_b32 v99, 0xffff0000, v37
v_lshlrev_b32 v100, 16, v38
v_and_b32 v101, 0xffff0000, v38
v_lshlrev_b32 v102, 16, v39
v_and_b32 v103, 0xffff0000, v39
v_lshlrev_b32 v104, 16, v40
v_and_b32 v105, 0xffff0000, v40
v_lshlrev_b32 v106, 16, v41
v_and_b32 v107, 0xffff0000, v41
v_lshlrev_b32 v108, 16, v42
v_and_b32 v109, 0xffff0000, v42
v_lshlrev_b32 v110, 16, v43
v_and_b32 v111, 0xffff0000, v43
v_lshlrev_b32 v112, 16, v44
v_and_b32 v113, 0xffff0000, v44
v_lshlrev_b32 v114, 16, v45
v_and_b32 v115, 0xffff0000, v45
v_lshlrev_b32 v116, 16, v46
v_and_b32 v117, 0xffff0000, v46
v_lshlrev_b32 v118, 16, v47
v_and_b32 v119, 0xffff0000, v47
v_lshlrev_b32 v120, 16, v48
v_and_b32 v121, 0xffff0000, v48
v_lshlrev_b32 v122, 16, v49
v_and_b32 v123, 0xffff0000, v49
v_lshlrev_b32 v124, 16, v50
v_and_b32 v125, 0xffff0000, v50
v_lshlrev_b32 v126, 16, v51
v_and_b32 v127, 0xffff0000, v51
v_lshlrev_b32 v128, 16, v52
v_and_b32 v129, 0xffff0000, v52
v_lshlrev_b32 v130, 16, v53
v_and_b32 v131, 0xffff0000, v53
v_lshlrev_b32 v132, 16, v54
v_and_b32 v133, 0xffff0000, v54
v_lshlrev_b32 v134, 16, v55
v_and_b32 v135, 0xffff0000, v55
v_lshlrev_b32 v136, 16, v56
v_and_b32 v137, 0xffff0000, v56
v_lshlrev_b32 v138, 16, v57
v_and_b32 v139, 0xffff0000, v57
v_lshlrev_b32 v140, 16, v58
v_and_b32 v141, 0xffff0000, v58
v_lshlrev_b32 v142, 16, v59
v_and_b32 v143, 0xffff0000, v59
v_pk_add_f32 v[18:19], v[64:65], v[66:67]
v_pk_add_f32 v[18:19], v[18:19], v[68:69]
v_pk_add_f32 v[18:19], v[18:19], v[70:71]
v_pk_add_f32 v[18:19], v[18:19], v[72:73]
v_pk_add_f32 v[18:19], v[18:19], v[74:75]
v_pk_add_f32 v[18:19], v[18:19], v[76:77]
v_pk_add_f32 v[18:19], v[18:19], v[78:79]
v_pk_add_f32 v[18:19], v[18:19], v[80:81]
v_pk_add_f32 v[18:19], v[18:19], v[82:83]
v_pk_add_f32 v[18:19], v[18:19], v[84:85]
v_pk_add_f32 v[18:19], v[18:19], v[86:87]
v_pk_add_f32 v[18:19], v[18:19], v[88:89]
v_pk_add_f32 v[18:19], v[18:19], v[90:91]
v_pk_add_f32 v[18:19], v[18:19], v[92:93]
v_pk_add_f32 v[18:19], v[18:19], v[94:95]
v_pk_add_f32 v[18:19], v[18:19], v[96:97]
v_pk_add_f32 v[18:19], v[18:19], v[98:99]
v_pk_add_f32 v[18:19], v[18:19], v[100:101]
v_pk_add_f32 v[18:19], v[18:19], v[102:103]
v_pk_add_f32 v[18:19], v[18:19], v[104:105]
v_pk_add_f32 v[18:19], v[18:19], v[106:107]
v_pk_add_f32 v[18:19], v[18:19], v[108:109]
v_pk_add_f32 v[18:19], v[18:19], v[110:111]
v_pk_add_f32 v[18:19], v[18:19], v[112:113]
v_pk_add_f32 v[18:19], v[18:19], v[114:115]
v_pk_add_f32 v[18:19], v[18:19], v[116:117]
v_pk_add_f32 v[18:19], v[18:19], v[118:119]
v_pk_add_f32 v[18:19], v[18:19], v[120:121]
v_pk_add_f32 v[18:19], v[18:19], v[122:123]
v_pk_add_f32 v[18:19], v[18:19], v[124:125]
v_pk_add_f32 v[18:19], v[18:19], v[126:127]
v_pk_add_f32 v[18:19], v[18:19], v[128:129]
v_pk_add_f32 v[18:19], v[18:19], v[130:131]
v_pk_add_f32 v[18:19], v[18:19], v[132:133]
v_pk_add_f32 v[18:19], v[18:19], v[134:135]
v_pk_add_f32 v[18:19], v[18:19], v[136:137]
v_pk_add_f32 v[18:19], v[18:19], v[138:139]
v_pk_add_f32 v[18:19], v[18:19], v[140:141]
v_pk_add_f32 v[18:19], v[18:19], v[142:143]
v_add_f32 v18, v18, v19
s_nop 1
v_add_f32_dpp v18, v18, v18 quad_perm:[1,0,3,2] row_mask:0xf bank_mask:0xf
s_nop 1
v_add_f32_dpp v18, v18, v18 quad_perm:[2,3,0,1] row_mask:0xf bank_mask:0xf
s_nop 1
v_add_f32_dpp v18, v18, v18 row_half_mirror row_mask:0xf bank_mask:0xf
v_mul_f32 v18, 0x3acccccd, v18
v_mov_b32 v60, 0
v_mov_b32 v61, 0
v_sub_f32 v62, v64, v18
v_fmac_f32 v60, v62, v62
v_sub_f32 v63, v65, v18
v_fmac_f32 v61, v63, v63
v_sub_f32 v62, v66, v18
v_fmac_f32 v60, v62, v62
v_sub_f32 v63, v67, v18
v_fmac_f32 v61, v63, v63
v_sub_f32 v62, v68, v18
v_fmac_f32 v60, v62, v62
v_sub_f32 v63, v69, v18
v_fmac_f32 v61, v63, v63
v_sub_f32 v62, v70, v18
v_fmac_f32 v60, v62, v62
v_sub_f32 v63, v71, v18
v_fmac_f32 v61, v63, v63
v_sub_f32 v62, v72, v18
v_fmac_f32 v60, v62, v62
v_sub_f32 v63, v73, v18
v_fmac_f32 v61, v63, v63
v_sub_f32 v62, v74, v18
v_fmac_f32 v60, v62, v62
v_sub_f32 v63, v75, v18
v_fmac_f32 v61, v63, v63
v_sub_f32 v62, v76, v18
v_fmac_f32 v60, v62, v62
v_sub_f32 v63, v77, v18
v_fmac_f32 v61, v63, v63
v_sub_f32 v62, v78, v18
v_fmac_f32 v60, v62, v62
v_sub_f32 v63, v79, v18
v_fmac_f32 v61, v63, v63
v_sub_f32 v62, v80, v18
v_fmac_f32 v60, v62, v62
v_sub_f32 v63, v81, v18
v_fmac_f32 v61, v63, v63
v_sub_f32 v62, v82, v18
v_fmac_f32 v60, v62, v62
v_sub_f32 v63, v83, v18
v_fmac_f32 v61, v63, v63
v_sub_f32 v62, v84, v18
v_fmac_f32 v60, v62, v62
v_sub_f32 v63, v85, v18
v_fmac_f32 v61, v63, v63
v_sub_f32 v62, v86, v18
v_fmac_f32 v60, v62, v62
v_sub_f32 v63, v87, v18
v_fmac_f32 v61, v63, v63
v_sub_f32 v62, v88, v18
v_fmac_f32 v60, v62, v62
v_sub_f32 v63, v89, v18
v_fmac_f32 v61, v63, v63
v_sub_f32 v62, v90, v18
v_fmac_f32 v60, v62, v62
v_sub_f32 v63, v91, v18
v_fmac_f32 v61, v63, v63
v_sub_f32 v62, v92, v18
v_fmac_f32 v60, v62, v62
v_sub_f32 v63, v93, v18
v_fmac_f32 v61, v63, v63
v_sub_f32 v62, v94, v18
v_fmac_f32 v60, v62, v62
v_sub_f32 v63, v95, v18
v_fmac_f32 v61, v63, v63
v_sub_f32 v62, v96, v18
v_fmac_f32 v60, v62, v62
v_sub_f32 v63, v97, v18
v_fmac_f32 v61, v63, v63
v_sub_f32 v62, v98, v18
v_fmac_f32 v60, v62, v62
v_sub_f32 v63, v99, v18
v_fmac_f32 v61, v63, v63
v_sub_f32 v62, v100, v18
v_fmac_f32 v60, v62, v62
v_sub_f32 v63, v101, v18
v_fmac_f32 v61, v63, v63
v_sub_f32 v62, v102, v18
v_fmac_f32 v60, v62, v62
v_sub_f32 v63, v103, v18
v_fmac_f32 v61, v63, v63
v_sub_f32 v62, v104, v18
v_fmac_f32 v60, v62, v62
v_sub_f32 v63, v105, v18
v_fmac_f32 v61, v63, v63
v_sub_f32 v62, v106, v18
v_fmac_f32 v60, v62, v62
v_sub_f32 v63, v107, v18
v_fmac_f32 v61, v63, v63
v_sub_f32 v62, v108, v18
v_fmac_f32 v60, v62, v62
v_sub_f32 v63, v109, v18
v_fmac_f32 v61, v63, v63
v_sub_f32 v62, v110, v18
v_fmac_f32 v60, v62, v62
v_sub_f32 v63, v111, v18
v_fmac_f32 v61, v63, v63
v_sub_f32 v62, v112, v18
v_fmac_f32 v60, v62, v62
v_sub_f32 v63, v113, v18
v_fmac_f32 v61, v63, v63
v_sub_f32 v62, v114, v18
v_fmac_f32 v60, v62, v62
v_sub_f32 v63, v115, v18
v_fmac_f32 v61, v63, v63
v_sub_f32 v62, v116, v18
v_fmac_f32 v60, v62, v62
v_sub_f32 v63, v117, v18
v_fmac_f32 v61, v63, v63
v_sub_f32 v62, v118, v18
v_fmac_f32 v60, v62, v62
v_sub_f32 v63, v119, v18
v_fmac_f32 v61, v63, v63
v_sub_f32 v62, v120, v18
v_fmac_f32 v60, v62, v62
v_sub_f32 v63, v121, v18
v_fmac_f32 v61, v63, v63
v_sub_f32 v62, v122, v18
v_fmac_f32 v60, v62, v62
v_sub_f32 v63, v123, v18
v_fmac_f32 v61, v63, v63
v_sub_f32 v62, v124, v18
v_fmac_f32 v60, v62, v62
v_sub_f32 v63, v125, v18
v_fmac_f32 v61, v63, v63
v_sub_f32 v62, v126, v18
v_fmac_f32 v60, v62, v62
v_sub_f32 v63, v127, v18
v_fmac_f32 v61, v63, v63
v_sub_f32 v62, v128, v18
v_fmac_f32 v60, v62, v62
v_sub_f32 v63, v129, v18
v_fmac_f32 v61, v63, v63
v_sub_f32 v62, v130, v18
v_fmac_f32 v60, v62, v62
v_sub_f32 v63, v131, v18
v_fmac_f32 v61, v63, v63
v_sub_f32 v62, v132, v18
v_fmac_f32 v60, v62, v62
v_sub_f32 v63, v133, v18
v_fmac_f32 v61, v63, v63
v_sub_f32 v62, v134, v18
v_fmac_f32 v60, v62, v62
v_sub_f32 v63, v135, v18
v_fmac_f32 v61, v63, v63
v_sub_f32 v62, v136, v18
v_fmac_f32 v60, v62, v62
v_sub_f32 v63, v137, v18
v_fmac_f32 v61, v63, v63
v_sub_f32 v62, v138, v18
v_fmac_f32 v60, v62, v62
v_sub_f32 v63, v139, v18
v_fmac_f32 v61, v63, v63
v_sub_f32 v62, v140, v18
v_fmac_f32 v60, v62, v62
v_sub_f32 v63, v141, v18
v_fmac_f32 v61, v63, v63
v_sub_f32 v62, v142, v18
v_fmac_f32 v60, v62, v62
v_sub_f32 v63, v143, v18
v_fmac_f32 v61, v63, v63
v_add_f32 v60, v60, v61
s_nop 1
v_add_f32_dpp v60, v60, v60 quad_perm:[1,0,3,2] row_mask:0xf bank_mask:0xf
s_nop 1
v_add_f32_dpp v60, v60, v60 quad_perm:[2,3,0,1] row_mask:0xf bank_mask:0xf
s_nop 1
v_add_f32_dpp v60, v60, v60 row_half_mirror row_mask:0xf bank_mask:0xf
v_mul_f32 v60, 0x3acccccd, v60
v_cvt_pk_bf16_f32 v18, v18, v18
v_and_b32 v18, 0xffff0000, v18
v_cvt_pk_bf16_f32 v60, v60, v60
v_and_b32 v60, 0xffff0000, v60
v_add_f32 v60, 0x3727c5ac, v60
v_cvt_pk_bf16_f32 v60, v60, v60
v_and_b32 v60, 0xffff0000, v60
v_sqrt_f32 v60, v60
s_nop 0
v_cvt_pk_bf16_f32 v60, v60, v60
v_and_b32 v60, 0xffff0000, v60
v_rcp_f32 v60, v60
v_sub_f32 v64, v64, v18
v_sub_f32 v65, v65, v18
v_cvt_pk_bf16_f32 v64, v64, v65
v_and_b32 v65, 0xffff0000, v64
v_lshlrev_b32 v64, 16, v64
v_mul_f32 v64, v64, v60
v_mul_f32 v65, v65, v60
v_cvt_pk_bf16_f32 v20, v64, v65
v_sub_f32 v66, v66, v18
v_sub_f32 v67, v67, v18
v_cvt_pk_bf16_f32 v66, v66, v67
v_and_b32 v67, 0xffff0000, v66
v_lshlrev_b32 v66, 16, v66
v_mul_f32 v66, v66, v60
v_mul_f32 v67, v67, v60
v_cvt_pk_bf16_f32 v21, v66, v67
v_sub_f32 v68, v68, v18
v_sub_f32 v69, v69, v18
v_cvt_pk_bf16_f32 v68, v68, v69
v_and_b32 v69, 0xffff0000, v68
v_lshlrev_b32 v68, 16, v68
v_mul_f32 v68, v68, v60
v_mul_f32 v69, v69, v60
v_cvt_pk_bf16_f32 v22, v68, v69
v_sub_f32 v70, v70, v18
v_sub_f32 v71, v71, v18
v_cvt_pk_bf16_f32 v70, v70, v71
v_and_b32 v71, 0xffff0000, v70
v_lshlrev_b32 v70, 16, v70
v_mul_f32 v70, v70, v60
v_mul_f32 v71, v71, v60
v_cvt_pk_bf16_f32 v23, v70, v71
ds_write_b128 v17, v[20:23] offset:0
v_sub_f32 v72, v72, v18
v_sub_f32 v73, v73, v18
v_cvt_pk_bf16_f32 v72, v72, v73
v_and_b32 v73, 0xffff0000, v72
v_lshlrev_b32 v72, 16, v72
v_mul_f32 v72, v72, v60
v_mul_f32 v73, v73, v60
v_cvt_pk_bf16_f32 v24, v72, v73
v_sub_f32 v74, v74, v18
v_sub_f32 v75, v75, v18
v_cvt_pk_bf16_f32 v74, v74, v75
v_and_b32 v75, 0xffff0000, v74
v_lshlrev_b32 v74, 16, v74
v_mul_f32 v74, v74, v60
v_mul_f32 v75, v75, v60
v_cvt_pk_bf16_f32 v25, v74, v75
v_sub_f32 v76, v76, v18
v_sub_f32 v77, v77, v18
v_cvt_pk_bf16_f32 v76, v76, v77
v_and_b32 v77, 0xffff0000, v76
v_lshlrev_b32 v76, 16, v76
v_mul_f32 v76, v76, v60
v_mul_f32 v77, v77, v60
v_cvt_pk_bf16_f32 v26, v76, v77
v_sub_f32 v78, v78, v18
v_sub_f32 v79, v79, v18
v_cvt_pk_bf16_f32 v78, v78, v79
v_and_b32 v79, 0xffff0000, v78
v_lshlrev_b32 v78, 16, v78
v_mul_f32 v78, v78, v60
v_mul_f32 v79, v79, v60
v_cvt_pk_bf16_f32 v27, v78, v79
ds_write_b128 v17, v[24:27] offset:4096
v_sub_f32 v80, v80, v18
v_sub_f32 v81, v81, v18
v_cvt_pk_bf16_f32 v80, v80, v81
v_and_b32 v81, 0xffff0000, v80
v_lshlrev_b32 v80, 16, v80
v_mul_f32 v80, v80, v60
v_mul_f32 v81, v81, v60
v_cvt_pk_bf16_f32 v28, v80, v81
v_sub_f32 v82, v82, v18
v_sub_f32 v83, v83, v18
v_cvt_pk_bf16_f32 v82, v82, v83
v_and_b32 v83, 0xffff0000, v82
v_lshlrev_b32 v82, 16, v82
v_mul_f32 v82, v82, v60
v_mul_f32 v83, v83, v60
v_cvt_pk_bf16_f32 v29, v82, v83
v_sub_f32 v84, v84, v18
v_sub_f32 v85, v85, v18
v_cvt_pk_bf16_f32 v84, v84, v85
v_and_b32 v85, 0xffff0000, v84
v_lshlrev_b32 v84, 16, v84
v_mul_f32 v84, v84, v60
v_mul_f32 v85, v85, v60
v_cvt_pk_bf16_f32 v30, v84, v85
v_sub_f32 v86, v86, v18
v_sub_f32 v87, v87, v18
v_cvt_pk_bf16_f32 v86, v86, v87
v_and_b32 v87, 0xffff0000, v86
v_lshlrev_b32 v86, 16, v86
v_mul_f32 v86, v86, v60
v_mul_f32 v87, v87, v60
v_cvt_pk_bf16_f32 v31, v86, v87
ds_write_b128 v17, v[28:31] offset:8192
v_sub_f32 v88, v88, v18
v_sub_f32 v89, v89, v18
v_cvt_pk_bf16_f32 v88, v88, v89
v_and_b32 v89, 0xffff0000, v88
v_lshlrev_b32 v88, 16, v88
v_mul_f32 v88, v88, v60
v_mul_f32 v89, v89, v60
v_cvt_pk_bf16_f32 v32, v88, v89
v_sub_f32 v90, v90, v18
v_sub_f32 v91, v91, v18
v_cvt_pk_bf16_f32 v90, v90, v91
v_and_b32 v91, 0xffff0000, v90
v_lshlrev_b32 v90, 16, v90
v_mul_f32 v90, v90, v60
v_mul_f32 v91, v91, v60
v_cvt_pk_bf16_f32 v33, v90, v91
v_sub_f32 v92, v92, v18
v_sub_f32 v93, v93, v18
v_cvt_pk_bf16_f32 v92, v92, v93
v_and_b32 v93, 0xffff0000, v92
v_lshlrev_b32 v92, 16, v92
v_mul_f32 v92, v92, v60
v_mul_f32 v93, v93, v60
v_cvt_pk_bf16_f32 v34, v92, v93
v_sub_f32 v94, v94, v18
v_sub_f32 v95, v95, v18
v_cvt_pk_bf16_f32 v94, v94, v95
v_and_b32 v95, 0xffff0000, v94
v_lshlrev_b32 v94, 16, v94
v_mul_f32 v94, v94, v60
v_mul_f32 v95, v95, v60
v_cvt_pk_bf16_f32 v35, v94, v95
ds_write_b128 v17, v[32:35] offset:12288
v_sub_f32 v96, v96, v18
v_sub_f32 v97, v97, v18
v_cvt_pk_bf16_f32 v96, v96, v97
v_and_b32 v97, 0xffff0000, v96
v_lshlrev_b32 v96, 16, v96
v_mul_f32 v96, v96, v60
v_mul_f32 v97, v97, v60
v_cvt_pk_bf16_f32 v36, v96, v97
v_sub_f32 v98, v98, v18
v_sub_f32 v99, v99, v18
v_cvt_pk_bf16_f32 v98, v98, v99
v_and_b32 v99, 0xffff0000, v98
v_lshlrev_b32 v98, 16, v98
v_mul_f32 v98, v98, v60
v_mul_f32 v99, v99, v60
v_cvt_pk_bf16_f32 v37, v98, v99
v_sub_f32 v100, v100, v18
v_sub_f32 v101, v101, v18
v_cvt_pk_bf16_f32 v100, v100, v101
v_and_b32 v101, 0xffff0000, v100
v_lshlrev_b32 v100, 16, v100
v_mul_f32 v100, v100, v60
v_mul_f32 v101, v101, v60
v_cvt_pk_bf16_f32 v38, v100, v101
v_sub_f32 v102, v102, v18
v_sub_f32 v103, v103, v18
v_cvt_pk_bf16_f32 v102, v102, v103
v_and_b32 v103, 0xffff0000, v102
v_lshlrev_b32 v102, 16, v102
v_mul_f32 v102, v102, v60
v_mul_f32 v103, v103, v60
v_cvt_pk_bf16_f32 v39, v102, v103
ds_write_b128 v17, v[36:39] offset:16384
v_sub_f32 v104, v104, v18
v_sub_f32 v105, v105, v18
v_cvt_pk_bf16_f32 v104, v104, v105
v_and_b32 v105, 0xffff0000, v104
v_lshlrev_b32 v104, 16, v104
v_mul_f32 v104, v104, v60
v_mul_f32 v105, v105, v60
v_cvt_pk_bf16_f32 v40, v104, v105
v_sub_f32 v106, v106, v18
v_sub_f32 v107, v107, v18
v_cvt_pk_bf16_f32 v106, v106, v107
v_and_b32 v107, 0xffff0000, v106
v_lshlrev_b32 v106, 16, v106
v_mul_f32 v106, v106, v60
v_mul_f32 v107, v107, v60
v_cvt_pk_bf16_f32 v41, v106, v107
v_sub_f32 v108, v108, v18
v_sub_f32 v109, v109, v18
v_cvt_pk_bf16_f32 v108, v108, v109
v_and_b32 v109, 0xffff0000, v108
v_lshlrev_b32 v108, 16, v108
v_mul_f32 v108, v108, v60
v_mul_f32 v109, v109, v60
v_cvt_pk_bf16_f32 v42, v108, v109
v_sub_f32 v110, v110, v18
v_sub_f32 v111, v111, v18
v_cvt_pk_bf16_f32 v110, v110, v111
v_and_b32 v111, 0xffff0000, v110
v_lshlrev_b32 v110, 16, v110
v_mul_f32 v110, v110, v60
v_mul_f32 v111, v111, v60
v_cvt_pk_bf16_f32 v43, v110, v111
ds_write_b128 v17, v[40:43] offset:20480
v_sub_f32 v112, v112, v18
v_sub_f32 v113, v113, v18
v_cvt_pk_bf16_f32 v112, v112, v113
v_and_b32 v113, 0xffff0000, v112
v_lshlrev_b32 v112, 16, v112
v_mul_f32 v112, v112, v60
v_mul_f32 v113, v113, v60
v_cvt_pk_bf16_f32 v44, v112, v113
v_sub_f32 v114, v114, v18
v_sub_f32 v115, v115, v18
v_cvt_pk_bf16_f32 v114, v114, v115
v_and_b32 v115, 0xffff0000, v114
v_lshlrev_b32 v114, 16, v114
v_mul_f32 v114, v114, v60
v_mul_f32 v115, v115, v60
v_cvt_pk_bf16_f32 v45, v114, v115
v_sub_f32 v116, v116, v18
v_sub_f32 v117, v117, v18
v_cvt_pk_bf16_f32 v116, v116, v117
v_and_b32 v117, 0xffff0000, v116
v_lshlrev_b32 v116, 16, v116
v_mul_f32 v116, v116, v60
v_mul_f32 v117, v117, v60
v_cvt_pk_bf16_f32 v46, v116, v117
v_sub_f32 v118, v118, v18
v_sub_f32 v119, v119, v18
v_cvt_pk_bf16_f32 v118, v118, v119
v_and_b32 v119, 0xffff0000, v118
v_lshlrev_b32 v118, 16, v118
v_mul_f32 v118, v118, v60
v_mul_f32 v119, v119, v60
v_cvt_pk_bf16_f32 v47, v118, v119
ds_write_b128 v17, v[44:47] offset:24576
v_sub_f32 v120, v120, v18
v_sub_f32 v121, v121, v18
v_cvt_pk_bf16_f32 v120, v120, v121
v_and_b32 v121, 0xffff0000, v120
v_lshlrev_b32 v120, 16, v120
v_mul_f32 v120, v120, v60
v_mul_f32 v121, v121, v60
v_cvt_pk_bf16_f32 v48, v120, v121
v_sub_f32 v122, v122, v18
v_sub_f32 v123, v123, v18
v_cvt_pk_bf16_f32 v122, v122, v123
v_and_b32 v123, 0xffff0000, v122
v_lshlrev_b32 v122, 16, v122
v_mul_f32 v122, v122, v60
v_mul_f32 v123, v123, v60
v_cvt_pk_bf16_f32 v49, v122, v123
v_sub_f32 v124, v124, v18
v_sub_f32 v125, v125, v18
v_cvt_pk_bf16_f32 v124, v124, v125
v_and_b32 v125, 0xffff0000, v124
v_lshlrev_b32 v124, 16, v124
v_mul_f32 v124, v124, v60
v_mul_f32 v125, v125, v60
v_cvt_pk_bf16_f32 v50, v124, v125
v_sub_f32 v126, v126, v18
v_sub_f32 v127, v127, v18
v_cvt_pk_bf16_f32 v126, v126, v127
v_and_b32 v127, 0xffff0000, v126
v_lshlrev_b32 v126, 16, v126
v_mul_f32 v126, v126, v60
v_mul_f32 v127, v127, v60
v_cvt_pk_bf16_f32 v51, v126, v127
ds_write_b128 v17, v[48:51] offset:28672
v_sub_f32 v128, v128, v18
v_sub_f32 v129, v129, v18
v_cvt_pk_bf16_f32 v128, v128, v129
v_and_b32 v129, 0xffff0000, v128
v_lshlrev_b32 v128, 16, v128
v_mul_f32 v128, v128, v60
v_mul_f32 v129, v129, v60
v_cvt_pk_bf16_f32 v52, v128, v129
v_sub_f32 v130, v130, v18
v_sub_f32 v131, v131, v18
v_cvt_pk_bf16_f32 v130, v130, v131
v_and_b32 v131, 0xffff0000, v130
v_lshlrev_b32 v130, 16, v130
v_mul_f32 v130, v130, v60
v_mul_f32 v131, v131, v60
v_cvt_pk_bf16_f32 v53, v130, v131
v_sub_f32 v132, v132, v18
v_sub_f32 v133, v133, v18
v_cvt_pk_bf16_f32 v132, v132, v133
v_and_b32 v133, 0xffff0000, v132
v_lshlrev_b32 v132, 16, v132
v_mul_f32 v132, v132, v60
v_mul_f32 v133, v133, v60
v_cvt_pk_bf16_f32 v54, v132, v133
v_sub_f32 v134, v134, v18
v_sub_f32 v135, v135, v18
v_cvt_pk_bf16_f32 v134, v134, v135
v_and_b32 v135, 0xffff0000, v134
v_lshlrev_b32 v134, 16, v134
v_mul_f32 v134, v134, v60
v_mul_f32 v135, v135, v60
v_cvt_pk_bf16_f32 v55, v134, v135
ds_write_b128 v17, v[52:55] offset:32768
v_sub_f32 v136, v136, v18
v_sub_f32 v137, v137, v18
v_cvt_pk_bf16_f32 v136, v136, v137
v_and_b32 v137, 0xffff0000, v136
v_lshlrev_b32 v136, 16, v136
v_mul_f32 v136, v136, v60
v_mul_f32 v137, v137, v60
v_cvt_pk_bf16_f32 v56, v136, v137
v_sub_f32 v138, v138, v18
v_sub_f32 v139, v139, v18
v_cvt_pk_bf16_f32 v138, v138, v139
v_and_b32 v139, 0xffff0000, v138
v_lshlrev_b32 v138, 16, v138
v_mul_f32 v138, v138, v60
v_mul_f32 v139, v139, v60
v_cvt_pk_bf16_f32 v57, v138, v139
v_sub_f32 v140, v140, v18
v_sub_f32 v141, v141, v18
v_cvt_pk_bf16_f32 v140, v140, v141
v_and_b32 v141, 0xffff0000, v140
v_lshlrev_b32 v140, 16, v140
v_mul_f32 v140, v140, v60
v_mul_f32 v141, v141, v60
v_cvt_pk_bf16_f32 v58, v140, v141
v_sub_f32 v142, v142, v18
v_sub_f32 v143, v143, v18
v_cvt_pk_bf16_f32 v142, v142, v143
v_and_b32 v143, 0xffff0000, v142
v_lshlrev_b32 v142, 16, v142
v_mul_f32 v142, v142, v60
v_mul_f32 v143, v143, v60
v_cvt_pk_bf16_f32 v59, v142, v143
ds_write_b128 v17, v[56:59] offset:36864
s_waitcnt lgkmcnt(0)
s_barrier
ds_read_b128 v[64:67], v6 offset:0
ds_read_b128 v[68:71], v6 offset:1024
ds_read_b128 v[72:75], v6 offset:2048
ds_read_b128 v[76:79], v6 offset:3072
s_waitcnt lgkmcnt(3)
v_mfma_f32_32x32x16_bf16 v[16:31], a[0:3], v[64:67], 0
v_mfma_f32_32x32x16_bf16 v[32:47], a[4:7], v[64:67], 0
s_waitcnt lgkmcnt(2)
v_mfma_f32_32x32x16_bf16 v[16:31], a[8:11], v[68:71], v[16:31]
v_mfma_f32_32x32x16_bf16 v[32:47], a[12:15], v[68:71], v[32:47]
s_waitcnt lgkmcnt(1)
v_mfma_f32_32x32x16_bf16 v[16:31], a[16:19], v[72:75], v[16:31]
v_mfma_f32_32x32x16_bf16 v[32:47], a[20:23], v[72:75], v[32:47]
s_waitcnt lgkmcnt(0)
v_mfma_f32_32x32x16_bf16 v[16:31], a[24:27], v[76:79], v[16:31]
v_mfma_f32_32x32x16_bf16 v[32:47], a[28:31], v[76:79], v[32:47]
s_waitcnt vmcnt(26)
ds_read_b128 v[48:51], v6 offset:4096
v_add_u32 v146, 10240, v14
ds_read2_b32 v[156:157], v146 offset0:0 offset1:16
ds_read2_b32 v[158:159], v146 offset0:32 offset1:48
ds_read2_b32 v[160:161], v146 offset0:64 offset1:80
ds_read2_b32 v[162:163], v146 offset0:96 offset1:112
s_waitcnt lgkmcnt(4)
s_add_u32 m0, s53, 8192
s_mov_b32 s31, 933888
buffer_load_dwordx4 v2, s[8:11], s31 offen lds
s_add_u32 m0, s53, 9216
s_nop 0
buffer_load_dwordx4 v2, s[12:15], s31 offen lds
v_perm_b32 v144, v149, v148, s29
v_accvgpr_write_b32 a32, v144
v_perm_b32 v145, v151, v150, s29
v_accvgpr_write_b32 a33, v145
v_perm_b32 v144, v153, v152, s29
v_accvgpr_write_b32 a34, v144
v_perm_b32 v145, v155, v154, s29
v_accvgpr_write_b32 a35, v145
v_perm_b32 v144, v149, v148, s30
v_accvgpr_write_b32 a36, v144
v_perm_b32 v145, v151, v150, s30
v_accvgpr_write_b32 a37, v145
v_perm_b32 v144, v153, v152, s30
v_accvgpr_write_b32 a38, v144
v_perm_b32 v145, v155, v154, s30
v_accvgpr_write_b32 a39, v145
v_mfma_f32_32x32x16_bf16 v[16:31], a[32:35], v[48:51], v[16:31]
s_nop 0
v_mfma_f32_32x32x16_bf16 v[32:47], a[36:39], v[48:51], v[32:47]
s_waitcnt vmcnt(26)
ds_read_b128 v[52:55], v6 offset:5120
v_add_u32 v146, 12288, v14
ds_read2_b32 v[148:149], v146 offset0:0 offset1:16
ds_read2_b32 v[150:151], v146 offset0:32 offset1:48
ds_read2_b32 v[152:153], v146 offset0:64 offset1:80
ds_read2_b32 v[154:155], v146 offset0:96 offset1:112
s_waitcnt lgkmcnt(4)
s_add_u32 m0, s53, 10240
s_mov_b32 s31, 983040
buffer_load_dwordx4 v2, s[8:11], s31 offen lds
s_add_u32 m0, s53, 11264
s_nop 0
buffer_load_dwordx4 v2, s[12:15], s31 offen lds
v_perm_b32 v144, v157, v156, s29
v_accvgpr_write_b32 a40, v144
v_perm_b32 v145, v159, v158, s29
v_accvgpr_write_b32 a41, v145
v_perm_b32 v144, v161, v160, s29
v_accvgpr_write_b32 a42, v144
v_perm_b32 v145, v163, v162, s29
v_accvgpr_write_b32 a43, v145
v_perm_b32 v144, v157, v156, s30
v_accvgpr_write_b32 a44, v144
v_perm_b32 v145, v159, v158, s30
v_accvgpr_write_b32 a45, v145
v_perm_b32 v144, v161, v160, s30
v_accvgpr_write_b32 a46, v144
v_perm_b32 v145, v163, v162, s30
v_accvgpr_write_b32 a47, v145
v_mfma_f32_32x32x16_bf16 v[16:31], a[40:43], v[52:55], v[16:31]
s_nop 0
v_mfma_f32_32x32x16_bf16 v[32:47], a[44:47], v[52:55], v[32:47]
s_waitcnt vmcnt(26)
ds_read_b128 v[48:51], v6 offset:6144
v_add_u32 v146, 14336, v14
ds_read2_b32 v[156:157], v146 offset0:0 offset1:16
ds_read2_b32 v[158:159], v146 offset0:32 offset1:48
ds_read2_b32 v[160:161], v146 offset0:64 offset1:80
ds_read2_b32 v[162:163], v146 offset0:96 offset1:112
s_waitcnt lgkmcnt(4)
s_add_u32 m0, s53, 12288
s_mov_b32 s31, 1032192
buffer_load_dwordx4 v2, s[8:11], s31 offen lds
s_add_u32 m0, s53, 13312
s_nop 0
buffer_load_dwordx4 v2, s[12:15], s31 offen lds
v_perm_b32 v144, v149, v148, s29
v_accvgpr_write_b32 a48, v144
v_perm_b32 v145, v151, v150, s29
v_accvgpr_write_b32 a49, v145
v_perm_b32 v144, v153, v152, s29
v_accvgpr_write_b32 a50, v144
v_perm_b32 v145, v155, v154, s29
v_accvgpr_write_b32 a51, v145
v_perm_b32 v144, v149, v148, s30
v_accvgpr_write_b32 a52, v144
v_perm_b32 v145, v151, v150, s30
v_accvgpr_write_b32 a53, v145
v_perm_b32 v144, v153, v152, s30
v_accvgpr_write_b32 a54, v144
v_perm_b32 v145, v155, v154, s30
v_accvgpr_write_b32 a55, v145
v_mfma_f32_32x32x16_bf16 v[16:31], a[48:51], v[48:51], v[16:31]
s_nop 0
v_mfma_f32_32x32x16_bf16 v[32:47], a[52:55], v[48:51], v[32:47]
s_waitcnt vmcnt(26)
ds_read_b128 v[52:55], v6 offset:7168
v_add_u32 v146, 16384, v14
ds_read2_b32 v[148:149], v146 offset0:0 offset1:16
ds_read2_b32 v[150:151], v146 offset0:32 offset1:48
ds_read2_b32 v[152:153], v146 offset0:64 offset1:80
ds_read2_b32 v[154:155], v146 offset0:96 offset1:112
s_waitcnt lgkmcnt(4)
s_add_u32 m0, s53, 14336
s_mov_b32 s31, 1081344
buffer_load_dwordx4 v2, s[8:11], s31 offen lds
s_add_u32 m0, s53, 15360
s_nop 0
buffer_load_dwordx4 v2, s[12:15], s31 offen lds
v_perm_b32 v144, v157, v156, s29
v_accvgpr_write_b32 a56, v144
v_perm_b32 v145, v159, v158, s29
v_accvgpr_write_b32 a57, v145
v_perm_b32 v144, v161, v160, s29
v_accvgpr_write_b32 a58, v144
v_perm_b32 v145, v163, v162, s29
v_accvgpr_write_b32 a59, v145
v_perm_b32 v144, v157, v156, s30
v_accvgpr_write_b32 a60, v144
v_perm_b32 v145, v159, v158, s30
v_accvgpr_write_b32 a61, v145
v_perm_b32 v144, v161, v160, s30
v_accvgpr_write_b32 a62, v144
v_perm_b32 v145, v163, v162, s30
v_accvgpr_write_b32 a63, v145
v_mfma_f32_32x32x16_bf16 v[16:31], a[56:59], v[52:55], v[16:31]
s_nop 0
v_mfma_f32_32x32x16_bf16 v[32:47], a[60:63], v[52:55], v[32:47]
s_waitcnt vmcnt(26)
ds_read_b128 v[48:51], v6 offset:8192
v_add_u32 v146, 18432, v14
ds_read2_b32 v[156:157], v146 offset0:0 offset1:16
ds_read2_b32 v[158:159], v146 offset0:32 offset1:48
ds_read2_b32 v[160:161], v146 offset0:64 offset1:80
ds_read2_b32 v[162:163], v146 offset0:96 offset1:112
s_waitcnt lgkmcnt(4)
s_add_u32 m0, s53, 16384
s_mov_b32 s31, 1130496
buffer_load_dwordx4 v2, s[8:11], s31 offen lds
s_add_u32 m0, s53, 17408
s_nop 0
buffer_load_dwordx4 v2, s[12:15], s31 offen lds
v_perm_b32 v144, v149, v148, s29
v_accvgpr_write_b32 a64, v144
v_perm_b32 v145, v151, v150, s29
v_accvgpr_write_b32 a65, v145
v_perm_b32 v144, v153, v152, s29
v_accvgpr_write_b32 a66, v144
v_perm_b32 v145, v155, v154, s29
v_accvgpr_write_b32 a67, v145
v_perm_b32 v144, v149, v148, s30
v_accvgpr_write_b32 a68, v144
v_perm_b32 v145, v151, v150, s30
v_accvgpr_write_b32 a69, v145
v_perm_b32 v144, v153, v152, s30
v_accvgpr_write_b32 a70, v144
v_perm_b32 v145, v155, v154, s30
v_accvgpr_write_b32 a71, v145
v_mfma_f32_32x32x16_bf16 v[16:31], a[64:67], v[48:51], v[16:31]
s_nop 0
v_mfma_f32_32x32x16_bf16 v[32:47], a[68:71], v[48:51], v[32:47]
s_waitcnt vmcnt(26)
ds_read_b128 v[52:55], v6 offset:9216
v_add_u32 v146, 20480, v14
ds_read2_b32 v[148:149], v146 offset0:0 offset1:16
ds_read2_b32 v[150:151], v146 offset0:32 offset1:48
ds_read2_b32 v[152:153], v146 offset0:64 offset1:80
ds_read2_b32 v[154:155], v146 offset0:96 offset1:112
s_waitcnt lgkmcnt(4)
s_add_u32 m0, s53, 18432
s_mov_b32 s31, 1179648
buffer_load_dwordx4 v2, s[8:11], s31 offen lds
s_add_u32 m0, s53, 19456
s_nop 0
buffer_load_dwordx4 v2, s[12:15], s31 offen lds
v_perm_b32 v144, v157, v156, s29
v_accvgpr_write_b32 a72, v144
v_perm_b32 v145, v159, v158, s29
v_accvgpr_write_b32 a73, v145
v_perm_b32 v144, v161, v160, s29
v_accvgpr_write_b32 a74, v144
v_perm_b32 v145, v163, v162, s29
v_accvgpr_write_b32 a75, v145
v_perm_b32 v144, v157, v156, s30
v_accvgpr_write_b32 a76, v144
v_perm_b32 v145, v159, v158, s30
v_accvgpr_write_b32 a77, v145
v_perm_b32 v144, v161, v160, s30
v_accvgpr_write_b32 a78, v144
v_perm_b32 v145, v163, v162, s30
v_accvgpr_write_b32 a79, v145
v_mfma_f32_32x32x16_bf16 v[16:31], a[72:75], v[52:55], v[16:31]
s_nop 0
v_mfma_f32_32x32x16_bf16 v[32:47], a[76:79], v[52:55], v[32:47]
s_waitcnt vmcnt(26)
ds_read_b128 v[48:51], v6 offset:10240
v_add_u32 v146, 22528, v14
ds_read2_b32 v[156:157], v146 offset0:0 offset1:16
ds_read2_b32 v[158:159], v146 offset0:32 offset1:48
ds_read2_b32 v[160:161], v146 offset0:64 offset1:80
ds_read2_b32 v[162:163], v146 offset0:96 offset1:112
s_waitcnt lgkmcnt(4)
s_add_u32 m0, s53, 20480
s_mov_b32 s31, 1228800
buffer_load_dwordx4 v2, s[8:11], s31 offen lds
s_add_u32 m0, s53, 21504
s_nop 0
buffer_load_dwordx4 v2, s[12:15], s31 offen lds
v_perm_b32 v144, v149, v148, s29
v_accvgpr_write_b32 a80, v144
v_perm_b32 v145, v151, v150, s29
v_accvgpr_write_b32 a81, v145
v_perm_b32 v144, v153, v152, s29
v_accvgpr_write_b32 a82, v144
v_perm_b32 v145, v155, v154, s29
v_accvgpr_write_b32 a83, v145
v_perm_b32 v144, v149, v148, s30
v_accvgpr_write_b32 a84, v144
v_perm_b32 v145, v151, v150, s30
v_accvgpr_write_b32 a85, v145
v_perm_b32 v144, v153, v152, s30
v_accvgpr_write_b32 a86, v144
v_perm_b32 v145, v155, v154, s30
v_accvgpr_write_b32 a87, v145
v_mfma_f32_32x32x16_bf16 v[16:31], a[80:83], v[48:51], v[16:31]
s_nop 0
v_mfma_f32_32x32x16_bf16 v[32:47], a[84:87], v[48:51], v[32:47]
s_waitcnt vmcnt(26)
ds_read_b128 v[52:55], v6 offset:11264
v_add_u32 v146, 24576, v14
ds_read2_b32 v[148:149], v146 offset0:0 offset1:16
ds_read2_b32 v[150:151], v146 offset0:32 offset1:48
ds_read2_b32 v[152:153], v146 offset0:64 offset1:80
ds_read2_b32 v[154:155], v146 offset0:96 offset1:112
s_waitcnt lgkmcnt(4)
s_add_u32 m0, s53, 22528
s_mov_b32 s31, 1277952
buffer_load_dwordx4 v2, s[8:11], s31 offen lds
s_add_u32 m0, s53, 23552
s_nop 0
buffer_load_dwordx4 v2, s[12:15], s31 offen lds
v_perm_b32 v144, v157, v156, s29
v_accvgpr_write_b32 a88, v144
v_perm_b32 v145, v159, v158, s29
v_accvgpr_write_b32 a89, v145
v_perm_b32 v144, v161, v160, s29
v_accvgpr_write_b32 a90, v144
v_perm_b32 v145, v163, v162, s29
v_accvgpr_write_b32 a91, v145
v_perm_b32 v144, v157, v156, s30
v_accvgpr_write_b32 a92, v144
v_perm_b32 v145, v159, v158, s30
v_accvgpr_write_b32 a93, v145
v_perm_b32 v144, v161, v160, s30
v_accvgpr_write_b32 a94, v144
v_perm_b32 v145, v163, v162, s30
v_accvgpr_write_b32 a95, v145
v_mfma_f32_32x32x16_bf16 v[16:31], a[88:91], v[52:55], v[16:31]
s_nop 0
v_mfma_f32_32x32x16_bf16 v[32:47], a[92:95], v[52:55], v[32:47]
s_waitcnt vmcnt(26)
ds_read_b128 v[48:51], v6 offset:12288
v_add_u32 v146, 26624, v14
ds_read2_b32 v[156:157], v146 offset0:0 offset1:16
ds_read2_b32 v[158:159], v146 offset0:32 offset1:48
ds_read2_b32 v[160:161], v146 offset0:64 offset1:80
ds_read2_b32 v[162:163], v146 offset0:96 offset1:112
s_waitcnt lgkmcnt(4)
s_add_u32 m0, s53, 24576
s_mov_b32 s31, 1327104
buffer_load_dwordx4 v2, s[8:11], s31 offen lds
s_add_u32 m0, s53, 25600
s_nop 0
buffer_load_dwordx4 v2, s[12:15], s31 offen lds
v_perm_b32 v144, v149, v148, s29
v_accvgpr_write_b32 a96, v144
v_perm_b32 v145, v151, v150, s29
v_accvgpr_write_b32 a97, v145
v_perm_b32 v144, v153, v152, s29
v_accvgpr_write_b32 a98, v144
v_perm_b32 v145, v155, v154, s29
v_accvgpr_write_b32 a99, v145
v_perm_b32 v144, v149, v148, s30
v_accvgpr_write_b32 a100, v144
v_perm_b32 v145, v151, v150, s30
v_accvgpr_write_b32 a101, v145
v_perm_b32 v144, v153, v152, s30
v_accvgpr_write_b32 a102, v144
v_perm_b32 v145, v155, v154, s30
v_accvgpr_write_b32 a103, v145
v_mfma_f32_32x32x16_bf16 v[16:31], a[96:99], v[48:51], v[16:31]
s_nop 0
v_mfma_f32_32x32x16_bf16 v[32:47], a[100:103], v[48:51], v[32:47]
s_waitcnt vmcnt(26)
ds_read_b128 v[52:55], v6 offset:13312
v_add_u32 v146, 28672, v14
ds_read2_b32 v[148:149], v146 offset0:0 offset1:16
ds_read2_b32 v[150:151], v146 offset0:32 offset1:48
ds_read2_b32 v[152:153], v146 offset0:64 offset1:80
ds_read2_b32 v[154:155], v146 offset0:96 offset1:112
s_waitcnt lgkmcnt(4)
s_add_u32 m0, s53, 26624
s_mov_b32 s31, 1376256
buffer_load_dwordx4 v2, s[8:11], s31 offen lds
s_add_u32 m0, s53, 27648
s_nop 0
buffer_load_dwordx4 v2, s[12:15], s31 offen lds
v_perm_b32 v144, v157, v156, s29
v_accvgpr_write_b32 a104, v144
v_perm_b32 v145, v159, v158, s29
v_accvgpr_write_b32 a105, v145
v_perm_b32 v144, v161, v160, s29
v_accvgpr_write_b32 a106, v144
v_perm_b32 v145, v163, v162, s29
v_accvgpr_write_b32 a107, v145
v_perm_b32 v144, v157, v156, s30
v_accvgpr_write_b32 a108, v144
v_perm_b32 v145, v159, v158, s30
v_accvgpr_write_b32 a109, v145
v_perm_b32 v144, v161, v160, s30
v_accvgpr_write_b32 a110, v144
v_perm_b32 v145, v163, v162, s30
v_accvgpr_write_b32 a111, v145
v_mfma_f32_32x32x16_bf16 v[16:31], a[104:107], v[52:55], v[16:31]
s_nop 0
v_mfma_f32_32x32x16_bf16 v[32:47], a[108:111], v[52:55], v[32:47]
s_waitcnt vmcnt(26)
ds_read_b128 v[48:51], v6 offset:14336
v_add_u32 v146, 0, v14
ds_read2_b32 v[156:157], v146 offset0:0 offset1:16
ds_read2_b32 v[158:159], v146 offset0:32 offset1:48
ds_read2_b32 v[160:161], v146 offset0:64 offset1:80
ds_read2_b32 v[162:163], v146 offset0:96 offset1:112
s_waitcnt lgkmcnt(4)
s_add_u32 m0, s53, 28672
s_mov_b32 s31, 1425408
buffer_load_dwordx4 v2, s[8:11], s31 offen lds
s_add_u32 m0, s53, 29696
s_nop 0
buffer_load_dwordx4 v2, s[12:15], s31 offen lds
v_perm_b32 v144, v149, v148, s29
v_accvgpr_write_b32 a112, v144
v_perm_b32 v145, v151, v150, s29
v_accvgpr_write_b32 a113, v145
v_perm_b32 v144, v153, v152, s29
v_accvgpr_write_b32 a114, v144
v_perm_b32 v145, v155, v154, s29
v_accvgpr_write_b32 a115, v145
v_perm_b32 v144, v149, v148, s30
v_accvgpr_write_b32 a116, v144
v_perm_b32 v145, v151, v150, s30
v_accvgpr_write_b32 a117, v145
v_perm_b32 v144, v153, v152, s30
v_accvgpr_write_b32 a118, v144
v_perm_b32 v145, v155, v154, s30
v_accvgpr_write_b32 a119, v145
v_mfma_f32_32x32x16_bf16 v[16:31], a[112:115], v[48:51], v[16:31]
s_nop 0
v_mfma_f32_32x32x16_bf16 v[32:47], a[116:119], v[48:51], v[32:47]
s_waitcnt vmcnt(26)
ds_read_b128 v[52:55], v6 offset:15360
v_add_u32 v146, 2048, v14
ds_read2_b32 v[148:149], v146 offset0:0 offset1:16
ds_read2_b32 v[150:151], v146 offset0:32 offset1:48
ds_read2_b32 v[152:153], v146 offset0:64 offset1:80
ds_read2_b32 v[154:155], v146 offset0:96 offset1:112
s_waitcnt lgkmcnt(4)
s_add_u32 m0, s53, 0
s_mov_b32 s31, 1474560
buffer_load_dwordx4 v2, s[8:11], s31 offen lds
s_add_u32 m0, s53, 1024
s_nop 0
buffer_load_dwordx4 v2, s[12:15], s31 offen lds
v_perm_b32 v144, v157, v156, s29
v_accvgpr_write_b32 a120, v144
v_perm_b32 v145, v159, v158, s29
v_accvgpr_write_b32 a121, v145
v_perm_b32 v144, v161, v160, s29
v_accvgpr_write_b32 a122, v144
v_perm_b32 v145, v163, v162, s29
v_accvgpr_write_b32 a123, v145
v_perm_b32 v144, v157, v156, s30
v_accvgpr_write_b32 a124, v144
v_perm_b32 v145, v159, v158, s30
v_accvgpr_write_b32 a125, v145
v_perm_b32 v144, v161, v160, s30
v_accvgpr_write_b32 a126, v144
v_perm_b32 v145, v163, v162, s30
v_accvgpr_write_b32 a127, v145
v_mfma_f32_32x32x16_bf16 v[16:31], a[120:123], v[52:55], v[16:31]
s_nop 0
v_mfma_f32_32x32x16_bf16 v[32:47], a[124:127], v[52:55], v[32:47]
s_waitcnt vmcnt(26)
ds_read_b128 v[48:51], v6 offset:16384
v_add_u32 v146, 4096, v14
ds_read2_b32 v[156:157], v146 offset0:0 offset1:16
ds_read2_b32 v[158:159], v146 offset0:32 offset1:48
ds_read2_b32 v[160:161], v146 offset0:64 offset1:80
ds_read2_b32 v[162:163], v146 offset0:96 offset1:112
s_waitcnt lgkmcnt(4)
s_add_u32 m0, s53, 2048
s_mov_b32 s31, 1523712
buffer_load_dwordx4 v2, s[8:11], s31 offen lds
s_add_u32 m0, s53, 3072
s_nop 0
buffer_load_dwordx4 v2, s[12:15], s31 offen lds
v_perm_b32 v144, v149, v148, s29
v_accvgpr_write_b32 a128, v144
v_perm_b32 v145, v151, v150, s29
v_accvgpr_write_b32 a129, v145
v_perm_b32 v144, v153, v152, s29
v_accvgpr_write_b32 a130, v144
v_perm_b32 v145, v155, v154, s29
v_accvgpr_write_b32 a131, v145
v_perm_b32 v144, v149, v148, s30
v_accvgpr_write_b32 a132, v144
v_perm_b32 v145, v151, v150, s30
v_accvgpr_write_b32 a133, v145
v_perm_b32 v144, v153, v152, s30
v_accvgpr_write_b32 a134, v144
v_perm_b32 v145, v155, v154, s30
v_accvgpr_write_b32 a135, v145
v_mfma_f32_32x32x16_bf16 v[16:31], a[128:131], v[48:51], v[16:31]
s_nop 0
v_mfma_f32_32x32x16_bf16 v[32:47], a[132:135], v[48:51], v[32:47]
s_waitcnt vmcnt(26)
ds_read_b128 v[52:55], v6 offset:17408
v_add_u32 v146, 6144, v14
ds_read2_b32 v[148:149], v146 offset0:0 offset1:16
ds_read2_b32 v[150:151], v146 offset0:32 offset1:48
ds_read2_b32 v[152:153], v146 offset0:64 offset1:80
ds_read2_b32 v[154:155], v146 offset0:96 offset1:112
s_waitcnt lgkmcnt(4)
s_add_u32 m0, s53, 4096
s_mov_b32 s31, 1572864
buffer_load_dwordx4 v2, s[8:11], s31 offen lds
s_add_u32 m0, s53, 5120
s_nop 0
buffer_load_dwordx4 v2, s[12:15], s31 offen lds
v_perm_b32 v144, v157, v156, s29
v_accvgpr_write_b32 a136, v144
v_perm_b32 v145, v159, v158, s29
v_accvgpr_write_b32 a137, v145
v_perm_b32 v144, v161, v160, s29
v_accvgpr_write_b32 a138, v144
v_perm_b32 v145, v163, v162, s29
v_accvgpr_write_b32 a139, v145
v_perm_b32 v144, v157, v156, s30
v_accvgpr_write_b32 a140, v144
v_perm_b32 v145, v159, v158, s30
v_accvgpr_write_b32 a141, v145
v_perm_b32 v144, v161, v160, s30
v_accvgpr_write_b32 a142, v144
v_perm_b32 v145, v163, v162, s30
v_accvgpr_write_b32 a143, v145
v_mfma_f32_32x32x16_bf16 v[16:31], a[136:139], v[52:55], v[16:31]
s_nop 0
v_mfma_f32_32x32x16_bf16 v[32:47], a[140:143], v[52:55], v[32:47]
s_waitcnt vmcnt(26)
ds_read_b128 v[48:51], v6 offset:18432
v_add_u32 v146, 8192, v14
ds_read2_b32 v[156:157], v146 offset0:0 offset1:16
ds_read2_b32 v[158:159], v146 offset0:32 offset1:48
ds_read2_b32 v[160:161], v146 offset0:64 offset1:80
ds_read2_b32 v[162:163], v146 offset0:96 offset1:112
s_waitcnt lgkmcnt(4)
s_add_u32 m0, s53, 6144
s_mov_b32 s31, 1622016
buffer_load_dwordx4 v2, s[8:11], s31 offen lds
s_add_u32 m0, s53, 7168
s_nop 0
buffer_load_dwordx4 v2, s[12:15], s31 offen lds
v_perm_b32 v144, v149, v148, s29
v_accvgpr_write_b32 a144, v144
v_perm_b32 v145, v151, v150, s29
v_accvgpr_write_b32 a145, v145
v_perm_b32 v144, v153, v152, s29
v_accvgpr_write_b32 a146, v144
v_perm_b32 v145, v155, v154, s29
v_accvgpr_write_b32 a147, v145
v_perm_b32 v144, v149, v148, s30
v_accvgpr_write_b32 a148, v144
v_perm_b32 v145, v151, v150, s30
v_accvgpr_write_b32 a149, v145
v_perm_b32 v144, v153, v152, s30
v_accvgpr_write_b32 a150, v144
v_perm_b32 v145, v155, v154, s30
v_accvgpr_write_b32 a151, v145
v_mfma_f32_32x32x16_bf16 v[16:31], a[144:147], v[48:51], v[16:31]
s_nop 0
v_mfma_f32_32x32x16_bf16 v[32:47], a[148:151], v[48:51], v[32:47]
s_waitcnt vmcnt(26)
ds_read_b128 v[52:55], v6 offset:19456
v_add_u32 v146, 10240, v14
ds_read2_b32 v[148:149], v146 offset0:0 offset1:16
ds_read2_b32 v[150:151], v146 offset0:32 offset1:48
ds_read2_b32 v[152:153], v146 offset0:64 offset1:80
ds_read2_b32 v[154:155], v146 offset0:96 offset1:112
s_waitcnt lgkmcnt(4)
s_add_u32 m0, s53, 8192
s_mov_b32 s31, 1671168
buffer_load_dwordx4 v2, s[8:11], s31 offen lds
s_add_u32 m0, s53, 9216
s_nop 0
buffer_load_dwordx4 v2, s[12:15], s31 offen lds
v_perm_b32 v144, v157, v156, s29
v_accvgpr_write_b32 a152, v144
v_perm_b32 v145, v159, v158, s29
v_accvgpr_write_b32 a153, v145
v_perm_b32 v144, v161, v160, s29
v_accvgpr_write_b32 a154, v144
v_perm_b32 v145, v163, v162, s29
v_accvgpr_write_b32 a155, v145
v_perm_b32 v144, v157, v156, s30
v_accvgpr_write_b32 a156, v144
v_perm_b32 v145, v159, v158, s30
v_accvgpr_write_b32 a157, v145
v_perm_b32 v144, v161, v160, s30
v_accvgpr_write_b32 a158, v144
v_perm_b32 v145, v163, v162, s30
v_accvgpr_write_b32 a159, v145
v_mfma_f32_32x32x16_bf16 v[16:31], a[152:155], v[52:55], v[16:31]
s_nop 0
v_mfma_f32_32x32x16_bf16 v[32:47], a[156:159], v[52:55], v[32:47]
s_waitcnt vmcnt(26)
ds_read_b128 v[48:51], v6 offset:20480
v_add_u32 v146, 12288, v14
ds_read2_b32 v[156:157], v146 offset0:0 offset1:16
ds_read2_b32 v[158:159], v146 offset0:32 offset1:48
ds_read2_b32 v[160:161], v146 offset0:64 offset1:80
ds_read2_b32 v[162:163], v146 offset0:96 offset1:112
s_waitcnt lgkmcnt(4)
s_add_u32 m0, s53, 10240
s_mov_b32 s31, 1720320
buffer_load_dwordx4 v2, s[8:11], s31 offen lds
s_add_u32 m0, s53, 11264
s_nop 0
buffer_load_dwordx4 v2, s[12:15], s31 offen lds
v_perm_b32 v144, v149, v148, s29
v_accvgpr_write_b32 a160, v144
v_perm_b32 v145, v151, v150, s29
v_accvgpr_write_b32 a161, v145
v_perm_b32 v144, v153, v152, s29
v_accvgpr_write_b32 a162, v144
v_perm_b32 v145, v155, v154, s29
v_accvgpr_write_b32 a163, v145
v_perm_b32 v144, v149, v148, s30
v_accvgpr_write_b32 a164, v144
v_perm_b32 v145, v151, v150, s30
v_accvgpr_write_b32 a165, v145
v_perm_b32 v144, v153, v152, s30
v_accvgpr_write_b32 a166, v144
v_perm_b32 v145, v155, v154, s30
v_accvgpr_write_b32 a167, v145
v_mfma_f32_32x32x16_bf16 v[16:31], a[160:163], v[48:51], v[16:31]
s_nop 0
v_mfma_f32_32x32x16_bf16 v[32:47], a[164:167], v[48:51], v[32:47]
s_waitcnt vmcnt(26)
ds_read_b128 v[52:55], v6 offset:21504
v_add_u32 v146, 14336, v14
ds_read2_b32 v[148:149], v146 offset0:0 offset1:16
ds_read2_b32 v[150:151], v146 offset0:32 offset1:48
ds_read2_b32 v[152:153], v146 offset0:64 offset1:80
ds_read2_b32 v[154:155], v146 offset0:96 offset1:112
s_waitcnt lgkmcnt(4)
s_add_u32 m0, s53, 12288
s_mov_b32 s31, 1769472
buffer_load_dwordx4 v2, s[8:11], s31 offen lds
s_add_u32 m0, s53, 13312
s_nop 0
buffer_load_dwordx4 v2, s[12:15], s31 offen lds
v_perm_b32 v144, v157, v156, s29
v_accvgpr_write_b32 a168, v144
v_perm_b32 v145, v159, v158, s29
v_accvgpr_write_b32 a169, v145
v_perm_b32 v144, v161, v160, s29
v_accvgpr_write_b32 a170, v144
v_perm_b32 v145, v163, v162, s29
v_accvgpr_write_b32 a171, v145
v_perm_b32 v144, v157, v156, s30
v_accvgpr_write_b32 a172, v144
v_perm_b32 v145, v159, v158, s30
v_accvgpr_write_b32 a173, v145
v_perm_b32 v144, v161, v160, s30
v_accvgpr_write_b32 a174, v144
v_perm_b32 v145, v163, v162, s30
v_accvgpr_write_b32 a175, v145
v_mfma_f32_32x32x16_bf16 v[16:31], a[168:171], v[52:55], v[16:31]
s_nop 0
v_mfma_f32_32x32x16_bf16 v[32:47], a[172:175], v[52:55], v[32:47]
s_waitcnt vmcnt(26)
ds_read_b128 v[48:51], v6 offset:22528
v_add_u32 v146, 16384, v14
ds_read2_b32 v[156:157], v146 offset0:0 offset1:16
ds_read2_b32 v[158:159], v146 offset0:32 offset1:48
ds_read2_b32 v[160:161], v146 offset0:64 offset1:80
ds_read2_b32 v[162:163], v146 offset0:96 offset1:112
s_waitcnt lgkmcnt(4)
s_add_u32 m0, s53, 14336
s_mov_b32 s31, 1818624
buffer_load_dwordx4 v2, s[8:11], s31 offen lds
s_add_u32 m0, s53, 15360
s_nop 0
buffer_load_dwordx4 v2, s[12:15], s31 offen lds
v_perm_b32 v144, v149, v148, s29
v_accvgpr_write_b32 a176, v144
v_perm_b32 v145, v151, v150, s29
v_accvgpr_write_b32 a177, v145
v_perm_b32 v144, v153, v152, s29
v_accvgpr_write_b32 a178, v144
v_perm_b32 v145, v155, v154, s29
v_accvgpr_write_b32 a179, v145
v_perm_b32 v144, v149, v148, s30
v_accvgpr_write_b32 a180, v144
v_perm_b32 v145, v151, v150, s30
v_accvgpr_write_b32 a181, v145
v_perm_b32 v144, v153, v152, s30
v_accvgpr_write_b32 a182, v144
v_perm_b32 v145, v155, v154, s30
v_accvgpr_write_b32 a183, v145
v_mfma_f32_32x32x16_bf16 v[16:31], a[176:179], v[48:51], v[16:31]
s_nop 0
v_mfma_f32_32x32x16_bf16 v[32:47], a[180:183], v[48:51], v[32:47]
s_waitcnt vmcnt(26)
ds_read_b128 v[52:55], v6 offset:23552
v_add_u32 v146, 18432, v14
ds_read2_b32 v[148:149], v146 offset0:0 offset1:16
ds_read2_b32 v[150:151], v146 offset0:32 offset1:48
ds_read2_b32 v[152:153], v146 offset0:64 offset1:80
ds_read2_b32 v[154:155], v146 offset0:96 offset1:112
s_waitcnt lgkmcnt(4)
s_add_u32 m0, s53, 16384
s_mov_b32 s31, 1867776
buffer_load_dwordx4 v2, s[8:11], s31 offen lds
s_add_u32 m0, s53, 17408
s_nop 0
buffer_load_dwordx4 v2, s[12:15], s31 offen lds
v_perm_b32 v144, v157, v156, s29
v_accvgpr_write_b32 a184, v144
v_perm_b32 v145, v159, v158, s29
v_accvgpr_write_b32 a185, v145
v_perm_b32 v144, v161, v160, s29
v_accvgpr_write_b32 a186, v144
v_perm_b32 v145, v163, v162, s29
v_accvgpr_write_b32 a187, v145
v_perm_b32 v144, v157, v156, s30
v_accvgpr_write_b32 a188, v144
v_perm_b32 v145, v159, v158, s30
v_accvgpr_write_b32 a189, v145
v_perm_b32 v144, v161, v160, s30
v_accvgpr_write_b32 a190, v144
v_perm_b32 v145, v163, v162, s30
v_accvgpr_write_b32 a191, v145
v_mfma_f32_32x32x16_bf16 v[16:31], a[184:187], v[52:55], v[16:31]
s_nop 0
v_mfma_f32_32x32x16_bf16 v[32:47], a[188:191], v[52:55], v[32:47]
s_waitcnt vmcnt(26)
ds_read_b128 v[48:51], v6 offset:24576
v_add_u32 v146, 20480, v14
ds_read2_b32 v[156:157], v146 offset0:0 offset1:16
ds_read2_b32 v[158:159], v146 offset0:32 offset1:48
ds_read2_b32 v[160:161], v146 offset0:64 offset1:80
ds_read2_b32 v[162:163], v146 offset0:96 offset1:112
s_waitcnt lgkmcnt(4)
s_add_u32 m0, s53, 18432
s_mov_b32 s31, 1916928
buffer_load_dwordx4 v2, s[8:11], s31 offen lds
s_add_u32 m0, s53, 19456
s_nop 0
buffer_load_dwordx4 v2, s[12:15], s31 offen lds
v_perm_b32 v144, v149, v148, s29
v_accvgpr_write_b32 a192, v144
v_perm_b32 v145, v151, v150, s29
v_accvgpr_write_b32 a193, v145
v_perm_b32 v144, v153, v152, s29
v_accvgpr_write_b32 a194, v144
v_perm_b32 v145, v155, v154, s29
v_accvgpr_write_b32 a195, v145
v_perm_b32 v144, v149, v148, s30
v_accvgpr_write_b32 a196, v144
v_perm_b32 v145, v151, v150, s30
v_accvgpr_write_b32 a197, v145
v_perm_b32 v144, v153, v152, s30
v_accvgpr_write_b32 a198, v144
v_perm_b32 v145, v155, v154, s30
v_accvgpr_write_b32 a199, v145
v_mfma_f32_32x32x16_bf16 v[16:31], a[192:195], v[48:51], v[16:31]
s_nop 0
v_mfma_f32_32x32x16_bf16 v[32:47], a[196:199], v[48:51], v[32:47]
s_waitcnt vmcnt(26)
ds_read_b128 v[52:55], v6 offset:25600
v_add_u32 v146, 22528, v14
ds_read2_b32 v[148:149], v146 offset0:0 offset1:16
ds_read2_b32 v[150:151], v146 offset0:32 offset1:48
ds_read2_b32 v[152:153], v146 offset0:64 offset1:80
ds_read2_b32 v[154:155], v146 offset0:96 offset1:112
s_waitcnt lgkmcnt(4)
v_perm_b32 v144, v157, v156, s29
v_accvgpr_write_b32 a200, v144
v_perm_b32 v145, v159, v158, s29
v_accvgpr_write_b32 a201, v145
v_perm_b32 v144, v161, v160, s29
v_accvgpr_write_b32 a202, v144
v_perm_b32 v145, v163, v162, s29
v_accvgpr_write_b32 a203, v145
v_perm_b32 v144, v157, v156, s30
v_accvgpr_write_b32 a204, v144
v_perm_b32 v145, v159, v158, s30
v_accvgpr_write_b32 a205, v145
v_perm_b32 v144, v161, v160, s30
v_accvgpr_write_b32 a206, v144
v_perm_b32 v145, v163, v162, s30
v_accvgpr_write_b32 a207, v145
v_mfma_f32_32x32x16_bf16 v[16:31], a[200:203], v[52:55], v[16:31]
s_nop 0
v_mfma_f32_32x32x16_bf16 v[32:47], a[204:207], v[52:55], v[32:47]
s_waitcnt vmcnt(24)
ds_read_b128 v[48:51], v6 offset:26624
v_add_u32 v146, 24576, v14
ds_read2_b32 v[156:157], v146 offset0:0 offset1:16
ds_read2_b32 v[158:159], v146 offset0:32 offset1:48
ds_read2_b32 v[160:161], v146 offset0:64 offset1:80
ds_read2_b32 v[162:163], v146 offset0:96 offset1:112
s_waitcnt lgkmcnt(4)
v_perm_b32 v144, v149, v148, s29
v_accvgpr_write_b32 a208, v144
v_perm_b32 v145, v151, v150, s29
v_accvgpr_write_b32 a209, v145
v_perm_b32 v144, v153, v152, s29
v_accvgpr_write_b32 a210, v144
v_perm_b32 v145, v155, v154, s29
v_accvgpr_write_b32 a211, v145
v_perm_b32 v144, v149, v148, s30
v_accvgpr_write_b32 a212, v144
v_perm_b32 v145, v151, v150, s30
v_accvgpr_write_b32 a213, v145
v_perm_b32 v144, v153, v152, s30
v_accvgpr_write_b32 a214, v144
v_perm_b32 v145, v155, v154, s30
v_accvgpr_write_b32 a215, v145
v_mfma_f32_32x32x16_bf16 v[16:31], a[208:211], v[48:51], v[16:31]
s_nop 0
v_mfma_f32_32x32x16_bf16 v[32:47], a[212:215], v[48:51], v[32:47]
s_waitcnt vmcnt(22)
ds_read_b128 v[52:55], v6 offset:27648
v_add_u32 v146, 26624, v14
ds_read2_b32 v[148:149], v146 offset0:0 offset1:16
ds_read2_b32 v[150:151], v146 offset0:32 offset1:48
ds_read2_b32 v[152:153], v146 offset0:64 offset1:80
ds_read2_b32 v[154:155], v146 offset0:96 offset1:112
s_waitcnt lgkmcnt(4)
v_perm_b32 v144, v157, v156, s29
v_accvgpr_write_b32 a216, v144
v_perm_b32 v145, v159, v158, s29
v_accvgpr_write_b32 a217, v145
v_perm_b32 v144, v161, v160, s29
v_accvgpr_write_b32 a218, v144
v_perm_b32 v145, v163, v162, s29
v_accvgpr_write_b32 a219, v145
v_perm_b32 v144, v157, v156, s30
v_accvgpr_write_b32 a220, v144
v_perm_b32 v145, v159, v158, s30
v_accvgpr_write_b32 a221, v145
v_perm_b32 v144, v161, v160, s30
v_accvgpr_write_b32 a222, v144
v_perm_b32 v145, v163, v162, s30
v_accvgpr_write_b32 a223, v145
v_mfma_f32_32x32x16_bf16 v[16:31], a[216:219], v[52:55], v[16:31]
s_nop 0
v_mfma_f32_32x32x16_bf16 v[32:47], a[220:223], v[52:55], v[32:47]
s_waitcnt vmcnt(20)
ds_read_b128 v[48:51], v6 offset:28672
v_add_u32 v146, 28672, v14
ds_read2_b32 v[156:157], v146 offset0:0 offset1:16
ds_read2_b32 v[158:159], v146 offset0:32 offset1:48
ds_read2_b32 v[160:161], v146 offset0:64 offset1:80
ds_read2_b32 v[162:163], v146 offset0:96 offset1:112
s_waitcnt lgkmcnt(4)
v_perm_b32 v144, v149, v148, s29
v_accvgpr_write_b32 a224, v144
v_perm_b32 v145, v151, v150, s29
v_accvgpr_write_b32 a225, v145
v_perm_b32 v144, v153, v152, s29
v_accvgpr_write_b32 a226, v144
v_perm_b32 v145, v155, v154, s29
v_accvgpr_write_b32 a227, v145
v_perm_b32 v144, v149, v148, s30
v_accvgpr_write_b32 a228, v144
v_perm_b32 v145, v151, v150, s30
v_accvgpr_write_b32 a229, v145
v_perm_b32 v144, v153, v152, s30
v_accvgpr_write_b32 a230, v144
v_perm_b32 v145, v155, v154, s30
v_accvgpr_write_b32 a231, v145
v_mfma_f32_32x32x16_bf16 v[16:31], a[224:227], v[48:51], v[16:31]
s_nop 0
v_mfma_f32_32x32x16_bf16 v[32:47], a[228:231], v[48:51], v[32:47]
s_waitcnt vmcnt(18)
ds_read_b128 v[52:55], v6 offset:29696
v_add_u32 v146, 0, v14
ds_read2_b32 v[148:149], v146 offset0:0 offset1:16
ds_read2_b32 v[150:151], v146 offset0:32 offset1:48
ds_read2_b32 v[152:153], v146 offset0:64 offset1:80
ds_read2_b32 v[154:155], v146 offset0:96 offset1:112
s_waitcnt lgkmcnt(4)
v_perm_b32 v144, v157, v156, s29
v_accvgpr_write_b32 a232, v144
v_perm_b32 v145, v159, v158, s29
v_accvgpr_write_b32 a233, v145
v_perm_b32 v144, v161, v160, s29
v_accvgpr_write_b32 a234, v144
v_perm_b32 v145, v163, v162, s29
v_accvgpr_write_b32 a235, v145
v_perm_b32 v144, v157, v156, s30
v_accvgpr_write_b32 a236, v144
v_perm_b32 v145, v159, v158, s30
v_accvgpr_write_b32 a237, v145
v_perm_b32 v144, v161, v160, s30
v_accvgpr_write_b32 a238, v144
v_perm_b32 v145, v163, v162, s30
v_accvgpr_write_b32 a239, v145
v_mfma_f32_32x32x16_bf16 v[16:31], a[232:235], v[52:55], v[16:31]
s_nop 0
v_mfma_f32_32x32x16_bf16 v[32:47], a[236:239], v[52:55], v[32:47]
s_waitcnt vmcnt(16)
ds_read_b128 v[48:51], v6 offset:30720
v_add_u32 v146, 2048, v14
ds_read2_b32 v[156:157], v146 offset0:0 offset1:16
ds_read2_b32 v[158:159], v146 offset0:32 offset1:48
ds_read2_b32 v[160:161], v146 offset0:64 offset1:80
ds_read2_b32 v[162:163], v146 offset0:96 offset1:112
s_waitcnt lgkmcnt(4)
v_perm_b32 v144, v149, v148, s29
v_accvgpr_write_b32 a240, v144
v_perm_b32 v145, v151, v150, s29
v_accvgpr_write_b32 a241, v145
v_perm_b32 v144, v153, v152, s29
v_accvgpr_write_b32 a242, v144
v_perm_b32 v145, v155, v154, s29
v_accvgpr_write_b32 a243, v145
v_perm_b32 v144, v149, v148, s30
v_accvgpr_write_b32 a244, v144
v_perm_b32 v145, v151, v150, s30
v_accvgpr_write_b32 a245, v145
v_perm_b32 v144, v153, v152, s30
v_accvgpr_write_b32 a246, v144
v_perm_b32 v145, v155, v154, s30
v_accvgpr_write_b32 a247, v145
v_mfma_f32_32x32x16_bf16 v[16:31], a[240:243], v[48:51], v[16:31]
s_nop 0
v_mfma_f32_32x32x16_bf16 v[32:47], a[244:247], v[48:51], v[32:47]
s_waitcnt vmcnt(14)
ds_read_b128 v[52:55], v6 offset:31744
v_add_u32 v146, 4096, v14
ds_read2_b32 v[148:149], v146 offset0:0 offset1:16
ds_read2_b32 v[150:151], v146 offset0:32 offset1:48
ds_read2_b32 v[152:153], v146 offset0:64 offset1:80
ds_read2_b32 v[154:155], v146 offset0:96 offset1:112
s_waitcnt lgkmcnt(4)
v_perm_b32 v144, v157, v156, s29
v_accvgpr_write_b32 a248, v144
v_perm_b32 v145, v159, v158, s29
v_accvgpr_write_b32 a249, v145
v_perm_b32 v144, v161, v160, s29
v_accvgpr_write_b32 a250, v144
v_perm_b32 v145, v163, v162, s29
v_accvgpr_write_b32 a251, v145
v_perm_b32 v144, v157, v156, s30
v_accvgpr_write_b32 a252, v144
v_perm_b32 v145, v159, v158, s30
v_accvgpr_write_b32 a253, v145
v_perm_b32 v144, v161, v160, s30
v_accvgpr_write_b32 a254, v144
v_perm_b32 v145, v163, v162, s30
v_accvgpr_write_b32 a255, v145
v_mfma_f32_32x32x16_bf16 v[16:31], a[248:251], v[52:55], v[16:31]
s_nop 0
v_mfma_f32_32x32x16_bf16 v[32:47], a[252:255], v[52:55], v[32:47]
s_waitcnt vmcnt(12)
ds_read_b128 v[48:51], v6 offset:32768
v_add_u32 v146, 6144, v14
ds_read2_b32 v[156:157], v146 offset0:0 offset1:16
ds_read2_b32 v[158:159], v146 offset0:32 offset1:48
ds_read2_b32 v[160:161], v146 offset0:64 offset1:80
ds_read2_b32 v[162:163], v146 offset0:96 offset1:112
s_waitcnt lgkmcnt(4)
v_perm_b32 v192, v149, v148, s29
v_perm_b32 v193, v151, v150, s29
v_perm_b32 v194, v153, v152, s29
v_perm_b32 v195, v155, v154, s29
v_perm_b32 v196, v149, v148, s30
v_perm_b32 v197, v151, v150, s30
v_perm_b32 v198, v153, v152, s30
v_perm_b32 v199, v155, v154, s30
v_mfma_f32_32x32x16_bf16 v[16:31], v[192:195], v[48:51], v[16:31]
s_nop 0
v_mfma_f32_32x32x16_bf16 v[32:47], v[196:199], v[48:51], v[32:47]
s_waitcnt vmcnt(10)
ds_read_b128 v[52:55], v6 offset:33792
v_add_u32 v146, 8192, v14
ds_read2_b32 v[148:149], v146 offset0:0 offset1:16
ds_read2_b32 v[150:151], v146 offset0:32 offset1:48
ds_read2_b32 v[152:153], v146 offset0:64 offset1:80
ds_read2_b32 v[154:155], v146 offset0:96 offset1:112
s_waitcnt lgkmcnt(4)
v_perm_b32 v200, v157, v156, s29
v_perm_b32 v201, v159, v158, s29
v_perm_b32 v202, v161, v160, s29
v_perm_b32 v203, v163, v162, s29
v_perm_b32 v204, v157, v156, s30
v_perm_b32 v205, v159, v158, s30
v_perm_b32 v206, v161, v160, s30
v_perm_b32 v207, v163, v162, s30
v_mfma_f32_32x32x16_bf16 v[16:31], v[200:203], v[52:55], v[16:31]
s_nop 0
v_mfma_f32_32x32x16_bf16 v[32:47], v[204:207], v[52:55], v[32:47]
s_waitcnt vmcnt(8)
ds_read_b128 v[48:51], v6 offset:34816
v_add_u32 v146, 10240, v14
ds_read2_b32 v[156:157], v146 offset0:0 offset1:16
ds_read2_b32 v[158:159], v146 offset0:32 offset1:48
ds_read2_b32 v[160:161], v146 offset0:64 offset1:80
ds_read2_b32 v[162:163], v146 offset0:96 offset1:112
s_waitcnt lgkmcnt(4)
v_perm_b32 v208, v149, v148, s29
v_perm_b32 v209, v151, v150, s29
v_perm_b32 v210, v153, v152, s29
v_perm_b32 v211, v155, v154, s29
v_perm_b32 v212, v149, v148, s30
v_perm_b32 v213, v151, v150, s30
v_perm_b32 v214, v153, v152, s30
v_perm_b32 v215, v155, v154, s30
v_mfma_f32_32x32x16_bf16 v[16:31], v[208:211], v[48:51], v[16:31]
s_nop 0
v_mfma_f32_32x32x16_bf16 v[32:47], v[212:215], v[48:51], v[32:47]
s_waitcnt vmcnt(6)
ds_read_b128 v[52:55], v6 offset:35840
v_add_u32 v146, 12288, v14
ds_read2_b32 v[148:149], v146 offset0:0 offset1:16
ds_read2_b32 v[150:151], v146 offset0:32 offset1:48
ds_read2_b32 v[152:153], v146 offset0:64 offset1:80
ds_read2_b32 v[154:155], v146 offset0:96 offset1:112
s_waitcnt lgkmcnt(4)
v_perm_b32 v216, v157, v156, s29
v_perm_b32 v217, v159, v158, s29
v_perm_b32 v218, v161, v160, s29
v_perm_b32 v219, v163, v162, s29
v_perm_b32 v220, v157, v156, s30
v_perm_b32 v221, v159, v158, s30
v_perm_b32 v222, v161, v160, s30
v_perm_b32 v223, v163, v162, s30
v_mfma_f32_32x32x16_bf16 v[16:31], v[216:219], v[52:55], v[16:31]
s_nop 0
v_mfma_f32_32x32x16_bf16 v[32:47], v[220:223], v[52:55], v[32:47]
s_waitcnt vmcnt(4)
ds_read_b128 v[48:51], v6 offset:36864
v_add_u32 v146, 14336, v14
ds_read2_b32 v[156:157], v146 offset0:0 offset1:16
ds_read2_b32 v[158:159], v146 offset0:32 offset1:48
ds_read2_b32 v[160:161], v146 offset0:64 offset1:80
ds_read2_b32 v[162:163], v146 offset0:96 offset1:112
s_waitcnt lgkmcnt(4)
v_perm_b32 v224, v149, v148, s29
v_perm_b32 v225, v151, v150, s29
v_perm_b32 v226, v153, v152, s29
v_perm_b32 v227, v155, v154, s29
v_perm_b32 v228, v149, v148, s30
v_perm_b32 v229, v151, v150, s30
v_perm_b32 v230, v153, v152, s30
v_perm_b32 v231, v155, v154, s30
v_mfma_f32_32x32x16_bf16 v[16:31], v[224:227], v[48:51], v[16:31]
s_nop 0
v_mfma_f32_32x32x16_bf16 v[32:47], v[228:231], v[48:51], v[32:47]
s_waitcnt vmcnt(2)
ds_read_b128 v[52:55], v6 offset:37888
v_add_u32 v146, 16384, v14
ds_read2_b32 v[148:149], v146 offset0:0 offset1:16
ds_read2_b32 v[150:151], v146 offset0:32 offset1:48
ds_read2_b32 v[152:153], v146 offset0:64 offset1:80
ds_read2_b32 v[154:155], v146 offset0:96 offset1:112
s_waitcnt lgkmcnt(4)
v_perm_b32 v232, v157, v156, s29
v_perm_b32 v233, v159, v158, s29
v_perm_b32 v234, v161, v160, s29
v_perm_b32 v235, v163, v162, s29
v_perm_b32 v236, v157, v156, s30
v_perm_b32 v237, v159, v158, s30
v_perm_b32 v238, v161, v160, s30
v_perm_b32 v239, v163, v162, s30
v_mfma_f32_32x32x16_bf16 v[16:31], v[232:235], v[52:55], v[16:31]
s_nop 0
v_mfma_f32_32x32x16_bf16 v[32:47], v[236:239], v[52:55], v[32:47]
s_waitcnt vmcnt(0)
ds_read_b128 v[48:51], v6 offset:38912
v_add_u32 v146, 18432, v14
ds_read2_b32 v[156:157], v146 offset0:0 offset1:16
ds_read2_b32 v[158:159], v146 offset0:32 offset1:48
ds_read2_b32 v[160:161], v146 offset0:64 offset1:80
ds_read2_b32 v[162:163], v146 offset0:96 offset1:112
s_waitcnt lgkmcnt(4)
v_perm_b32 v240, v149, v148, s29
v_perm_b32 v241, v151, v150, s29
v_perm_b32 v242, v153, v152, s29
v_perm_b32 v243, v155, v154, s29
v_perm_b32 v244, v149, v148, s30
v_perm_b32 v245, v151, v150, s30
v_perm_b32 v246, v153, v152, s30
v_perm_b32 v247, v155, v154, s30
v_mfma_f32_32x32x16_bf16 v[16:31], v[240:243], v[48:51], v[16:31]
s_nop 0
v_mfma_f32_32x32x16_bf16 v[32:47], v[244:247], v[48:51], v[32:47]
ds_read_b128 v[52:55], v6 offset:39936
s_waitcnt lgkmcnt(0)
v_perm_b32 v248, v157, v156, s29
v_perm_b32 v249, v159, v158, s29
v_perm_b32 v250, v161, v160, s29
v_perm_b32 v251, v163, v162, s29
v_perm_b32 v252, v157, v156, s30
v_perm_b32 v253, v159, v158, s30
v_perm_b32 v254, v161, v160, s30
v_perm_b32 v255, v163, v162, s30
v_mfma_f32_32x32x16_bf16 v[16:31], v[248:251], v[52:55], v[16:31]
s_nop 0
v_mfma_f32_32x32x16_bf16 v[32:47], v[252:255], v[52:55], v[32:47]
s_cmp_lg_u32 s28, 0
s_cbranch_scc1 Lgwd_94
Lgw_93:
buffer_load_dwordx2 v[8:9], off, s[20:23], 0 sc1
s_waitcnt vmcnt(0)
v_cmp_gt_u32 vcc, 255, v8
s_cbranch_vccz Lgwe_95
s_cmp_eq_u32 s25, 0
s_cbranch_scc1 Lgwe_95
s_sub_u32 s25, s25, 1
s_sleep 4
s_branch Lgw_93
Lgwe_95:
Lgwd_94:
s_barrier
s_add_u32 s39, s37, s38
s_add_u32 s40, s39, s38
s_add_u32 s41, s40, s38
v_mul_f32 v72, 0xbfb8aa3b, v16
v_mul_f32 v73, 0xbfb8aa3b, v17
v_mul_f32 v74, 0xbfb8aa3b, v18
v_mul_f32 v75, 0xbfb8aa3b, v19
s_nop 1
v_mul_f32 v76, 0xbfb8aa3b, v32
v_mul_f32 v77, 0xbfb8aa3b, v33
v_mul_f32 v78, 0xbfb8aa3b, v34
v_mul_f32 v79, 0xbfb8aa3b, v35
v_exp_f32 v72, v72
v_exp_f32 v73, v73
v_exp_f32 v74, v74
v_exp_f32 v75, v75
v_exp_f32 v76, v76
v_exp_f32 v77, v77
v_exp_f32 v78, v78
v_exp_f32 v79, v79
v_add_f32 v72, 1.0, v72
v_add_f32 v73, 1.0, v73
v_add_f32 v74, 1.0, v74
v_add_f32 v75, 1.0, v75
v_add_f32 v76, 1.0, v76
v_add_f32 v77, 1.0, v77
v_add_f32 v78, 1.0, v78
v_add_f32 v79, 1.0, v79
v_rcp_f32 v72, v72
v_rcp_f32 v73, v73
v_rcp_f32 v74, v74
v_rcp_f32 v75, v75
v_rcp_f32 v76, v76
v_rcp_f32 v77, v77
v_rcp_f32 v78, v78
v_rcp_f32 v79, v79
v_mul_f32 v16, v16, v24
v_mul_f32 v17, v17, v25
v_mul_f32 v18, v18, v26
v_mul_f32 v19, v19, v27
v_mul_f32 v32, v32, v40
v_mul_f32 v33, v33, v41
v_mul_f32 v34, v34, v42
v_mul_f32 v35, v35, v43
v_mul_f32 v16, v16, v72
v_mul_f32 v17, v17, v73
v_mul_f32 v18, v18, v74
v_mul_f32 v19, v19, v75
v_mul_f32 v32, v32, v76
v_mul_f32 v33, v33, v77
v_mul_f32 v34, v34, v78
v_mul_f32 v35, v35, v79
v_cvt_pk_bf16_f32 v64, v16, v32
v_cvt_pk_bf16_f32 v65, v17, v33
v_cvt_pk_bf16_f32 v66, v18, v34
v_cvt_pk_bf16_f32 v67, v19, v35
buffer_store_dwordx4 v[64:67], v4, s[4:7], s37 offen sc1
v_mul_f32 v72, 0xbfb8aa3b, v20
v_mul_f32 v73, 0xbfb8aa3b, v21
v_mul_f32 v74, 0xbfb8aa3b, v22
v_mul_f32 v75, 0xbfb8aa3b, v23
v_mul_f32 v76, 0xbfb8aa3b, v36
v_mul_f32 v77, 0xbfb8aa3b, v37
v_mul_f32 v78, 0xbfb8aa3b, v38
v_mul_f32 v79, 0xbfb8aa3b, v39
v_exp_f32 v72, v72
v_exp_f32 v73, v73
v_exp_f32 v74, v74
v_exp_f32 v75, v75
v_exp_f32 v76, v76
v_exp_f32 v77, v77
v_exp_f32 v78, v78
v_exp_f32 v79, v79
v_add_f32 v72, 1.0, v72
v_add_f32 v73, 1.0, v73
v_add_f32 v74, 1.0, v74
v_add_f32 v75, 1.0, v75
v_add_f32 v76, 1.0, v76
v_add_f32 v77, 1.0, v77
v_add_f32 v78, 1.0, v78
v_add_f32 v79, 1.0, v79
v_rcp_f32 v72, v72
v_rcp_f32 v73, v73
v_rcp_f32 v74, v74
v_rcp_f32 v75, v75
v_rcp_f32 v76, v76
v_rcp_f32 v77, v77
v_rcp_f32 v78, v78
v_rcp_f32 v79, v79
v_mul_f32 v20, v20, v28
v_mul_f32 v21, v21, v29
v_mul_f32 v22, v22, v30
v_mul_f32 v23, v23, v31
v_mul_f32 v36, v36, v44
v_mul_f32 v37, v37, v45
v_mul_f32 v38, v38, v46
v_mul_f32 v39, v39, v47
v_mul_f32 v20, v20, v72
v_mul_f32 v21, v21, v73
v_mul_f32 v22, v22, v74
v_mul_f32 v23, v23, v75
v_mul_f32 v36, v36, v76
v_mul_f32 v37, v37, v77
v_mul_f32 v38, v38, v78
v_mul_f32 v39, v39, v79
v_cvt_pk_bf16_f32 v68, v20, v36
v_cvt_pk_bf16_f32 v69, v21, v37
v_cvt_pk_bf16_f32 v70, v22, v38
v_cvt_pk_bf16_f32 v71, v23, v39
buffer_store_dwordx4 v[68:71], v4, s[4:7], s39 offen sc1
s_mul_i32 s44, s28, 10240
s_add_u32 s44, s44, 40960
s_add_u32 s43, s44, 7340032
s_add_u32 m0, s44, 0
s_add_u32 s46, s43, 0
buffer_load_dwordx4 v6, s[4:7], s46 offen offset:0 sc1 lds
buffer_load_dwordx4 v6, s[4:7], s46 offen offset:1024 sc1 lds
buffer_load_dwordx4 v6, s[4:7], s46 offen offset:2048 sc1 lds
buffer_load_dwordx4 v6, s[4:7], s46 offen offset:3072 sc1 lds
s_add_u32 m0, s44, 4096
s_add_u32 s46, s43, 4096
buffer_load_dwordx4 v6, s[4:7], s46 offen offset:0 sc1 lds
buffer_load_dwordx4 v6, s[4:7], s46 offen offset:1024 sc1 lds
buffer_load_dwordx4 v6, s[4:7], s46 offen offset:2048 sc1 lds
buffer_load_dwordx4 v6, s[4:7], s46 offen offset:3072 sc1 lds
s_add_u32 m0, s44, 8192
s_add_u32 s46, s43, 8192
buffer_load_dwordx4 v6, s[4:7], s46 offen offset:0 sc1 lds
buffer_load_dwordx4 v6, s[4:7], s46 offen offset:1024 sc1 lds
s_add_u32 s37, s37, s42
s_mov_b32 s24, 1
v_mov_b32 v8, 1
s_mov_b32 s45, 40960
s_waitcnt vmcnt(10)
buffer_store_dword v8, v5, s[4:7], 0 offen sc1
s_waitcnt vmcnt(1)
Lf1_loop:
s_waitcnt vmcnt(3)
s_barrier
v_add_u32 v7, s45, v6
s_xor_b32 s45, s45, 40960
s_mul_i32 s44, s28, 10240
s_add_u32 s44, s44, s45
s_add_u32 s43, s43, 40960
ds_read_b128 v[48:51], v7 offset:0
ds_read_b128 v[52:55], v7 offset:1024
ds_read_b128 v[56:59], v7 offset:2048
v_mov_b32 v8, s24
ds_read_b128 v[60:63], v7 offset:3072
s_waitcnt lgkmcnt(3)
v_mfma_f32_32x32x16_bf16 v[16:31], a[0:3], v[48:51], 0
v_mfma_f32_32x32x16_bf16 v[32:47], a[4:7], v[48:51], 0
s_add_u32 m0, s44, 0
s_add_u32 s46, s43, 0
buffer_load_dwordx4 v6, s[4:7], s46 offen offset:0 sc1 lds
ds_read_b128 v[48:51], v7 offset:4096
s_waitcnt lgkmcnt(3)
v_mfma_f32_32x32x16_bf16 v[16:31], a[8:11], v[52:55], v[16:31]
v_mfma_f32_32x32x16_bf16 v[32:47], a[12:15], v[52:55], v[32:47]
buffer_load_dwordx4 v6, s[4:7], s46 offen offset:1024 sc1 lds
ds_read_b128 v[52:55], v7 offset:5120
s_waitcnt lgkmcnt(3)
v_mfma_f32_32x32x16_bf16 v[16:31], a[16:19], v[56:59], v[16:31]
v_mfma_f32_32x32x16_bf16 v[32:47], a[20:23], v[56:59], v[32:47]
buffer_load_dwordx4 v6, s[4:7], s46 offen offset:2048 sc1 lds
ds_read_b128 v[56:59], v7 offset:6144
s_waitcnt lgkmcnt(3)
v_mfma_f32_32x32x16_bf16 v[16:31], a[24:27], v[60:63], v[16:31]
v_mfma_f32_32x32x16_bf16 v[32:47], a[28:31], v[60:63], v[32:47]
buffer_load_dwordx4 v6, s[4:7], s46 offen offset:3072 sc1 lds
ds_read_b128 v[60:63], v7 offset:7168
s_waitcnt lgkmcnt(3)
v_mfma_f32_32x32x16_bf16 v[16:31], a[32:35], v[48:51], v[16:31]
v_mfma_f32_32x32x16_bf16 v[32:47], a[36:39], v[48:51], v[32:47]
s_add_u32 m0, s44, 4096
s_add_u32 s46, s43, 4096
buffer_load_dwordx4 v6, s[4:7], s46 offen offset:0 sc1 lds
ds_read_b128 v[48:51], v7 offset:8192
s_waitcnt lgkmcnt(3)
v_mfma_f32_32x32x16_bf16 v[16:31], a[40:43], v[52:55], v[16:31]
v_mfma_f32_32x32x16_bf16 v[32:47], a[44:47], v[52:55], v[32:47]
buffer_load_dwordx4 v6, s[4:7], s46 offen offset:1024 sc1 lds
ds_read_b128 v[52:55], v7 offset:9216
s_waitcnt lgkmcnt(3)
v_mfma_f32_32x32x16_bf16 v[16:31], a[48:51], v[56:59], v[16:31]
v_mfma_f32_32x32x16_bf16 v[32:47], a[52:55], v[56:59], v[32:47]
buffer_load_dwordx4 v6, s[4:7], s46 offen offset:2048 sc1 lds
ds_read_b128 v[56:59], v7 offset:10240
s_waitcnt lgkmcnt(3)
v_mfma_f32_32x32x16_bf16 v[16:31], a[56:59], v[60:63], v[16:31]
v_mfma_f32_32x32x16_bf16 v[32:47], a[60:63], v[60:63], v[32:47]
buffer_load_dwordx4 v6, s[4:7], s46 offen offset:3072 sc1 lds
ds_read_b128 v[60:63], v7 offset:11264
s_waitcnt lgkmcnt(3)
v_mfma_f32_32x32x16_bf16 v[16:31], a[64:67], v[48:51], v[16:31]
v_mfma_f32_32x32x16_bf16 v[32:47], a[68:71], v[48:51], v[32:47]
s_add_u32 m0, s44, 8192
s_add_u32 s46, s43, 8192
buffer_load_dwordx4 v6, s[4:7], s46 offen offset:0 sc1 lds
ds_read_b128 v[48:51], v7 offset:12288
s_waitcnt lgkmcnt(3)
v_mfma_f32_32x32x16_bf16 v[16:31], a[72:75], v[52:55], v[16:31]
v_mfma_f32_32x32x16_bf16 v[32:47], a[76:79], v[52:55], v[32:47]
buffer_load_dwordx4 v6, s[4:7], s46 offen offset:1024 sc1 lds
ds_read_b128 v[52:55], v7 offset:13312
s_waitcnt lgkmcnt(3)
v_mfma_f32_32x32x16_bf16 v[16:31], a[80:83], v[56:59], v[16:31]
v_mfma_f32_32x32x16_bf16 v[32:47], a[84:87], v[56:59], v[32:47]
s_cmp_gt_i32 s24, 4
s_cbranch_scc1 Lef_96
s_waitcnt vmcnt(10)
buffer_store_dword v8, v5, s[4:7], 0 offen sc1
Lef_96:
ds_read_b128 v[56:59], v7 offset:14336
s_waitcnt lgkmcnt(3)
v_mfma_f32_32x32x16_bf16 v[16:31], a[88:91], v[60:63], v[16:31]
v_mfma_f32_32x32x16_bf16 v[32:47], a[92:95], v[60:63], v[32:47]
ds_read_b128 v[60:63], v7 offset:15360
s_waitcnt lgkmcnt(3)
v_mfma_f32_32x32x16_bf16 v[16:31], a[96:99], v[48:51], v[16:31]
v_mfma_f32_32x32x16_bf16 v[32:47], a[100:103], v[48:51], v[32:47]
ds_read_b128 v[48:51], v7 offset:16384
s_waitcnt lgkmcnt(3)
v_mfma_f32_32x32x16_bf16 v[16:31], a[104:107], v[52:55], v[16:31]
v_mfma_f32_32x32x16_bf16 v[32:47], a[108:111], v[52:55], v[32:47]
ds_read_b128 v[52:55], v7 offset:17408
s_waitcnt lgkmcnt(3)
v_mfma_f32_32x32x16_bf16 v[16:31], a[112:115], v[56:59], v[16:31]
v_mfma_f32_32x32x16_bf16 v[32:47], a[116:119], v[56:59], v[32:47]
ds_read_b128 v[56:59], v7 offset:18432
s_waitcnt lgkmcnt(3)
v_mfma_f32_32x32x16_bf16 v[16:31], a[120:123], v[60:63], v[16:31]
v_mfma_f32_32x32x16_bf16 v[32:47], a[124:127], v[60:63], v[32:47]
ds_read_b128 v[60:63], v7 offset:19456
s_waitcnt lgkmcnt(3)
v_mfma_f32_32x32x16_bf16 v[16:31], a[128:131], v[48:51], v[16:31]
v_mfma_f32_32x32x16_bf16 v[32:47], a[132:135], v[48:51], v[32:47]
ds_read_b128 v[48:51], v7 offset:20480
s_waitcnt lgkmcnt(3)
v_mfma_f32_32x32x16_bf16 v[16:31], a[136:139], v[52:55], v[16:31]
v_mfma_f32_32x32x16_bf16 v[32:47], a[140:143], v[52:55], v[32:47]
ds_read_b128 v[52:55], v7 offset:21504
s_waitcnt lgkmcnt(3)
v_mfma_f32_32x32x16_bf16 v[16:31], a[144:147], v[56:59], v[16:31]
v_mfma_f32_32x32x16_bf16 v[32:47], a[148:151], v[56:59], v[32:47]
ds_read_b128 v[56:59], v7 offset:22528
s_waitcnt lgkmcnt(3)
v_mfma_f32_32x32x16_bf16 v[16:31], a[152:155], v[60:63], v[16:31]
v_mfma_f32_32x32x16_bf16 v[32:47], a[156:159], v[60:63], v[32:47]
ds_read_b128 v[60:63], v7 offset:23552
s_waitcnt lgkmcnt(3)
v_mfma_f32_32x32x16_bf16 v[16:31], a[160:163], v[48:51], v[16:31]
v_mfma_f32_32x32x16_bf16 v[32:47], a[164:167], v[48:51], v[32:47]
ds_read_b128 v[48:51], v7 offset:24576
s_waitcnt lgkmcnt(3)
v_mfma_f32_32x32x16_bf16 v[16:31], a[168:171], v[52:55], v[16:31]
v_mfma_f32_32x32x16_bf16 v[32:47], a[172:175], v[52:55], v[32:47]
ds_read_b128 v[52:55], v7 offset:25600
s_waitcnt lgkmcnt(3)
v_mfma_f32_32x32x16_bf16 v[16:31], a[176:179], v[56:59], v[16:31]
v_mfma_f32_32x32x16_bf16 v[32:47], a[180:183], v[56:59], v[32:47]
ds_read_b128 v[56:59], v7 offset:26624
s_waitcnt lgkmcnt(3)
v_mfma_f32_32x32x16_bf16 v[16:31], a[184:187], v[60:63], v[16:31]
v_mfma_f32_32x32x16_bf16 v[32:47], a[188:191], v[60:63], v[32:47]
ds_read_b128 v[60:63], v7 offset:27648
s_waitcnt lgkmcnt(3)
v_mfma_f32_32x32x16_bf16 v[16:31], a[192:195], v[48:51], v[16:31]
v_mfma_f32_32x32x16_bf16 v[32:47], a[196:199], v[48:51], v[32:47]
ds_read_b128 v[48:51], v7 offset:28672
s_waitcnt lgkmcnt(3)
v_mfma_f32_32x32x16_bf16 v[16:31], a[200:203], v[52:55], v[16:31]
v_mfma_f32_32x32x16_bf16 v[32:47], a[204:207], v[52:55], v[32:47]
ds_read_b128 v[52:55], v7 offset:29696
s_waitcnt lgkmcnt(3)
v_mfma_f32_32x32x16_bf16 v[16:31], a[208:211], v[56:59], v[16:31]
v_mfma_f32_32x32x16_bf16 v[32:47], a[212:215], v[56:59], v[32:47]
ds_read_b128 v[56:59], v7 offset:30720
s_waitcnt lgkmcnt(3)
v_mfma_f32_32x32x16_bf16 v[16:31], a[216:219], v[60:63], v[16:31]
v_mfma_f32_32x32x16_bf16 v[32:47], a[220:223], v[60:63], v[32:47]
ds_read_b128 v[60:63], v7 offset:31744
s_waitcnt lgkmcnt(3)
v_mfma_f32_32x32x16_bf16 v[16:31], a[224:227], v[48:51], v[16:31]
v_mfma_f32_32x32x16_bf16 v[32:47], a[228:231], v[48:51], v[32:47]
s_cmp_gt_i32 s24, 4
s_cbranch_scc0 Lef_97
s_waitcnt vmcnt(10)
buffer_store_dword v8, v5, s[4:7], 0 offen sc1
Lef_97:
ds_read_b128 v[48:51], v7 offset:32768
s_waitcnt lgkmcnt(3)
v_mfma_f32_32x32x16_bf16 v[16:31], a[232:235], v[52:55], v[16:31]
v_mfma_f32_32x32x16_bf16 v[32:47], a[236:239], v[52:55], v[32:47]
ds_read_b128 v[52:55], v7 offset:33792
s_waitcnt lgkmcnt(3)
v_mfma_f32_32x32x16_bf16 v[16:31], a[240:243], v[56:59], v[16:31]
v_mfma_f32_32x32x16_bf16 v[32:47], a[244:247], v[56:59], v[32:47]
ds_read_b128 v[56:59], v7 offset:34816
s_waitcnt lgkmcnt(3)
v_mfma_f32_32x32x16_bf16 v[16:31], a[248:251], v[60:63], v[16:31]
v_mfma_f32_32x32x16_bf16 v[32:47], a[252:255], v[60:63], v[32:47]
ds_read_b128 v[60:63], v7 offset:35840
s_waitcnt lgkmcnt(3)
v_mfma_f32_32x32x16_bf16 v[16:31], v[192:195], v[48:51], v[16:31]
v_mfma_f32_32x32x16_bf16 v[32:47], v[196:199], v[48:51], v[32:47]
ds_read_b128 v[48:51], v7 offset:36864
s_waitcnt lgkmcnt(3)
v_mfma_f32_32x32x16_bf16 v[16:31], v[200:203], v[52:55], v[16:31]
v_mfma_f32_32x32x16_bf16 v[32:47], v[204:207], v[52:55], v[32:47]
ds_read_b128 v[52:55], v7 offset:37888
s_waitcnt lgkmcnt(3)
v_mfma_f32_32x32x16_bf16 v[16:31], v[208:211], v[56:59], v[16:31]
v_mfma_f32_32x32x16_bf16 v[32:47], v[212:215], v[56:59], v[32:47]
ds_read_b128 v[56:59], v7 offset:38912
s_waitcnt lgkmcnt(3)
v_mfma_f32_32x32x16_bf16 v[16:31], v[216:219], v[60:63], v[16:31]
v_mfma_f32_32x32x16_bf16 v[32:47], v[220:223], v[60:63], v[32:47]
ds_read_b128 v[60:63], v7 offset:39936
s_waitcnt lgkmcnt(3)
v_mfma_f32_32x32x16_bf16 v[16:31], v[224:227], v[48:51], v[16:31]
v_mfma_f32_32x32x16_bf16 v[32:47], v[228:231], v[48:51], v[32:47]
s_waitcnt lgkmcnt(2)
v_mfma_f32_32x32x16_bf16 v[16:31], v[232:235], v[52:55], v[16:31]
v_mfma_f32_32x32x16_bf16 v[32:47], v[236:239], v[52:55], v[32:47]
s_waitcnt lgkmcnt(1)
v_mfma_f32_32x32x16_bf16 v[16:31], v[240:243], v[56:59], v[16:31]
v_mfma_f32_32x32x16_bf16 v[32:47], v[244:247], v[56:59], v[32:47]
s_waitcnt lgkmcnt(0)
v_mfma_f32_32x32x16_bf16 v[16:31], v[248:251], v[60:63], v[16:31]
v_mfma_f32_32x32x16_bf16 v[32:47], v[252:255], v[60:63], v[32:47]
s_add_u32 s39, s37, s38
s_add_u32 s40, s39, s38
s_add_u32 s41, s40, s38
s_nop 0
v_mul_f32 v72, 0xbfb8aa3b, v16
v_mul_f32 v73, 0xbfb8aa3b, v17
v_mul_f32 v74, 0xbfb8aa3b, v18
v_mul_f32 v75, 0xbfb8aa3b, v19
s_nop 3
v_mul_f32 v76, 0xbfb8aa3b, v32
v_mul_f32 v77, 0xbfb8aa3b, v33
v_mul_f32 v78, 0xbfb8aa3b, v34
v_mul_f32 v79, 0xbfb8aa3b, v35
v_exp_f32 v72, v72
v_exp_f32 v73, v73
v_exp_f32 v74, v74
v_exp_f32 v75, v75
v_exp_f32 v76, v76
v_exp_f32 v77, v77
v_exp_f32 v78, v78
v_exp_f32 v79, v79
v_add_f32 v72, 1.0, v72
v_add_f32 v73, 1.0, v73
v_add_f32 v74, 1.0, v74
v_add_f32 v75, 1.0, v75
v_add_f32 v76, 1.0, v76
v_add_f32 v77, 1.0, v77
v_add_f32 v78, 1.0, v78
v_add_f32 v79, 1.0, v79
v_rcp_f32 v72, v72
v_rcp_f32 v73, v73
v_rcp_f32 v74, v74
v_rcp_f32 v75, v75
v_rcp_f32 v76, v76
v_rcp_f32 v77, v77
v_rcp_f32 v78, v78
v_rcp_f32 v79, v79
v_mul_f32 v16, v16, v24
v_mul_f32 v17, v17, v25
v_mul_f32 v18, v18, v26
v_mul_f32 v19, v19, v27
v_mul_f32 v32, v32, v40
v_mul_f32 v33, v33, v41
v_mul_f32 v34, v34, v42
v_mul_f32 v35, v35, v43
v_mul_f32 v16, v16, v72
v_mul_f32 v17, v17, v73
v_mul_f32 v18, v18, v74
v_mul_f32 v19, v19, v75
v_mul_f32 v32, v32, v76
v_mul_f32 v33, v33, v77
v_mul_f32 v34, v34, v78
v_mul_f32 v35, v35, v79
v_cvt_pk_bf16_f32 v64, v16, v32
v_cvt_pk_bf16_f32 v65, v17, v33
v_cvt_pk_bf16_f32 v66, v18, v34
v_cvt_pk_bf16_f32 v67, v19, v35
buffer_store_dwordx4 v[64:67], v4, s[4:7], s37 offen sc1
v_mul_f32 v72, 0xbfb8aa3b, v20
v_mul_f32 v73, 0xbfb8aa3b, v21
v_mul_f32 v74, 0xbfb8aa3b, v22
v_mul_f32 v75, 0xbfb8aa3b, v23
v_mul_f32 v76, 0xbfb8aa3b, v36
v_mul_f32 v77, 0xbfb8aa3b, v37
v_mul_f32 v78, 0xbfb8aa3b, v38
v_mul_f32 v79, 0xbfb8aa3b, v39
v_exp_f32 v72, v72
v_exp_f32 v73, v73
v_exp_f32 v74, v74
v_exp_f32 v75, v75
v_exp_f32 v76, v76
v_exp_f32 v77, v77
v_exp_f32 v78, v78
v_exp_f32 v79, v79
v_add_f32 v72, 1.0, v72
v_add_f32 v73, 1.0, v73
v_add_f32 v74, 1.0, v74
v_add_f32 v75, 1.0, v75
v_add_f32 v76, 1.0, v76
v_add_f32 v77, 1.0, v77
v_add_f32 v78, 1.0, v78
v_add_f32 v79, 1.0, v79
v_rcp_f32 v72, v72
v_rcp_f32 v73, v73
v_rcp_f32 v74, v74
v_rcp_f32 v75, v75
v_rcp_f32 v76, v76
v_rcp_f32 v77, v77
v_rcp_f32 v78, v78
v_rcp_f32 v79, v79
v_mul_f32 v20, v20, v28
v_mul_f32 v21, v21, v29
v_mul_f32 v22, v22, v30
v_mul_f32 v23, v23, v31
v_mul_f32 v36, v36, v44
v_mul_f32 v37, v37, v45
v_mul_f32 v38, v38, v46
v_mul_f32 v39, v39, v47
v_mul_f32 v20, v20, v72
v_mul_f32 v21, v21, v73
v_mul_f32 v22, v22, v74
v_mul_f32 v23, v23, v75
v_mul_f32 v36, v36, v76
v_mul_f32 v37, v37, v77
v_mul_f32 v38, v38, v78
v_mul_f32 v39, v39, v79
v_cvt_pk_bf16_f32 v68, v20, v36
v_cvt_pk_bf16_f32 v69, v21, v37
v_cvt_pk_bf16_f32 v70, v22, v38
v_cvt_pk_bf16_f32 v71, v23, v39
buffer_store_dwordx4 v[68:71], v4, s[4:7], s39 offen sc1
s_add_u32 s37, s37, s42
s_add_u32 s24, s24, 1
s_cmp_lt_u32 s24, 64
s_cbranch_scc1 Lf1_loop
v_mov_b32 v8, 64
s_waitcnt vmcnt(0)
buffer_store_dword v8, v5, s[4:7], 0 offen sc1
s_endpgm
Lf2:
s_load_dwordx2 s[8:9], s[0:1], 80
s_mov_b32 s10, 1966080
s_mov_b32 s11, 0x20000
s_sub_u32 s33, s32, 12
v_and_b32 v9, 31, v0
v_lshrrev_b32 v10, 5, v0
v_lshlrev_b32 v6, 4, v0
s_lshl_b32 s34, s33, 2
s_add_u32 s34, s34, s28
s_lshl_b32 s46, s34, 7
s_add_u32 s46, s46, 90112
v_mov_b32 v5, s46
v_mov_b32 v1, 2146435072
v_cmp_eq_u32 vcc, 0, v0
s_nop 1
v_cndmask_b32 v5, v1, v5, vcc
v_and_b32 v11, 15, v0
v_min_u32 v11, 11, v11
s_mul_i32 s46, s28, 1536
s_add_u32 s46, s46, 81920
v_lshl_add_u32 v7, v11, 7, s46
s_mul_i32 s46, s28, 491520
s_lshl_b32 s47, s33, 7
s_add_u32 s46, s46, s47
v_lshrrev_b32 v11, 3, v0
v_mul_u32_u24 v11, 1280, v11
v_and_b32 v12, 7, v0
v_lshl_add_u32 v11, v12, 4, v11
v_add_u32 v2, s46, v11
v_lshlrev_b32 v14, 2, v9
v_lshl_add_u32 v14, v10, 10, v14
v_lshlrev_b32 v11, 5, v9
v_lshl_add_u32 v4, v10, 4, v11
s_lshl_b32 s37, s34, 10
s_add_u32 s37, s37, 176562176
s_mul_i32 s43, s28, 24576
s_add_u32 s43, s43, 170172416
s_lshl_b32 s46, s28, 13
v_add_u32 v12, s46, v6
s_lshl_b32 s46, s28, 11
v_add_u32 v13, s46, v6
v_mov_b32 v8, 0
buffer_store_dword v8, v5, s[4:7], 0 offen sc1
s_waitcnt lgkmcnt(0)
s_and_b32 s9, s9, 0xffff
s_mul_i32 s53, s28, 40960
v_add_u32 v14, s53, v14
s_add_u32 m0, s53, 0
s_mov_b32 s31, 0
buffer_load_dwordx4 v2, s[8:11], s31 offen lds
s_add_u32 m0, s53, 1024
s_mov_b32 s31, 10240
buffer_load_dwordx4 v2, s[8:11], s31 offen lds
s_add_u32 m0, s53, 2048
s_mov_b32 s31, 20480
buffer_load_dwordx4 v2, s[8:11], s31 offen lds
s_add_u32 m0, s53, 3072
s_mov_b32 s31, 30720
buffer_load_dwordx4 v2, s[8:11], s31 offen lds
s_add_u32 m0, s53, 4096
s_mov_b32 s31, 40960
buffer_load_dwordx4 v2, s[8:11], s31 offen lds
s_add_u32 m0, s53, 5120
s_mov_b32 s31, 51200
buffer_load_dwordx4 v2, s[8:11], s31 offen lds
s_waitcnt vmcnt(6)
s_barrier
s_cmp_lg_u32 s28, 0
s_cbranch_scc1 Larr_98
v_mov_b32 v8, 1
s_mov_b64 exec, 1
buffer_atomic_add v8, off, s[20:23], 0 sc1
s_mov_b64 exec, -1
Larr_98:
s_add_u32 m0, s53, 6144
s_mov_b32 s31, 61440
buffer_load_dwordx4 v2, s[8:11], s31 offen lds
s_add_u32 m0, s53, 7168
s_mov_b32 s31, 71680
buffer_load_dwordx4 v2, s[8:11], s31 offen lds
s_add_u32 m0, s53, 8192
s_mov_b32 s31, 81920
buffer_load_dwordx4 v2, s[8:11], s31 offen lds
s_add_u32 m0, s53, 9216
s_mov_b32 s31, 92160
buffer_load_dwordx4 v2, s[8:11], s31 offen lds
s_add_u32 m0, s53, 10240
s_mov_b32 s31, 102400
buffer_load_dwordx4 v2, s[8:11], s31 offen lds
s_add_u32 m0, s53, 11264
s_mov_b32 s31, 112640
buffer_load_dwordx4 v2, s[8:11], s31 offen lds
s_add_u32 m0, s53, 12288
s_mov_b32 s31, 122880
buffer_load_dwordx4 v2, s[8:11], s31 offen lds
s_add_u32 m0, s53, 13312
s_mov_b32 s31, 133120
buffer_load_dwordx4 v2, s[8:11], s31 offen lds
s_add_u32 m0, s53, 14336
s_mov_b32 s31, 143360
buffer_load_dwordx4 v2, s[8:11], s31 offen lds
s_add_u32 m0, s53, 15360
s_mov_b32 s31, 153600
buffer_load_dwordx4 v2, s[8:11], s31 offen lds
s_add_u32 m0, s53, 16384
s_mov_b32 s31, 163840
buffer_load_dwordx4 v2, s[8:11], s31 offen lds
s_add_u32 m0, s53, 17408
s_mov_b32 s31, 174080
buffer_load_dwordx4 v2, s[8:11], s31 offen lds
s_add_u32 m0, s53, 18432
s_mov_b32 s31, 184320
buffer_load_dwordx4 v2, s[8:11], s31 offen lds
s_add_u32 m0, s53, 19456
s_mov_b32 s31, 194560
buffer_load_dwordx4 v2, s[8:11], s31 offen lds
s_add_u32 m0, s53, 20480
s_mov_b32 s31, 204800
buffer_load_dwordx4 v2, s[8:11], s31 offen lds
s_add_u32 m0, s53, 21504
s_mov_b32 s31, 215040
buffer_load_dwordx4 v2, s[8:11], s31 offen lds
s_add_u32 m0, s53, 22528
s_mov_b32 s31, 225280
buffer_load_dwordx4 v2, s[8:11], s31 offen lds
s_add_u32 m0, s53, 23552
s_mov_b32 s31, 235520
buffer_load_dwordx4 v2, s[8:11], s31 offen lds
s_add_u32 m0, s53, 24576
s_mov_b32 s31, 245760
buffer_load_dwordx4 v2, s[8:11], s31 offen lds
s_add_u32 m0, s53, 25600
s_mov_b32 s31, 256000
buffer_load_dwordx4 v2, s[8:11], s31 offen lds
s_add_u32 m0, s53, 26624
s_mov_b32 s31, 266240
buffer_load_dwordx4 v2, s[8:11], s31 offen lds
s_add_u32 m0, s53, 27648
s_mov_b32 s31, 276480
buffer_load_dwordx4 v2, s[8:11], s31 offen lds
s_add_u32 m0, s53, 28672
s_mov_b32 s31, 286720
buffer_load_dwordx4 v2, s[8:11], s31 offen lds
s_add_u32 m0, s53, 29696
s_mov_b32 s31, 296960
buffer_load_dwordx4 v2, s[8:11], s31 offen lds
s_add_u32 m0, s53, 30720
s_mov_b32 s31, 307200
buffer_load_dwordx4 v2, s[8:11], s31 offen lds
s_add_u32 m0, s53, 31744
s_mov_b32 s31, 317440
buffer_load_dwordx4 v2, s[8:11], s31 offen lds
s_add_u32 m0, s53, 32768
s_mov_b32 s31, 327680
buffer_load_dwordx4 v2, s[8:11], s31 offen lds
s_add_u32 m0, s53, 33792
s_mov_b32 s31, 337920
buffer_load_dwordx4 v2, s[8:11], s31 offen lds
s_add_u32 m0, s53, 34816
s_mov_b32 s31, 348160
buffer_load_dwordx4 v2, s[8:11], s31 offen lds
s_add_u32 m0, s53, 35840
s_mov_b32 s31, 358400
buffer_load_dwordx4 v2, s[8:11], s31 offen lds
s_add_u32 m0, s53, 36864
s_mov_b32 s31, 368640
buffer_load_dwordx4 v2, s[8:11], s31 offen lds
s_add_u32 m0, s53, 37888
s_mov_b32 s31, 378880
buffer_load_dwordx4 v2, s[8:11], s31 offen lds
s_add_u32 m0, s53, 38912
s_mov_b32 s31, 389120
buffer_load_dwordx4 v2, s[8:11], s31 offen lds
s_add_u32 m0, s53, 39936
s_mov_b32 s31, 399360
buffer_load_dwordx4 v2, s[8:11], s31 offen lds
s_waitcnt vmcnt(38)
v_add_u32 v146, 0, v14
ds_read2_b32 v[80:81], v146 offset0:0 offset1:32
ds_read2_b32 v[82:83], v146 offset0:64 offset1:96
ds_read2_b32 v[84:85], v146 offset0:128 offset1:160
ds_read2_b32 v[86:87], v146 offset0:192 offset1:224
s_waitcnt vmcnt(36)
v_add_u32 v146, 2048, v14
ds_read2_b32 v[88:89], v146 offset0:0 offset1:32
ds_read2_b32 v[90:91], v146 offset0:64 offset1:96
ds_read2_b32 v[92:93], v146 offset0:128 offset1:160
ds_read2_b32 v[94:95], v146 offset0:192 offset1:224
s_waitcnt lgkmcnt(4)
s_add_u32 m0, s53, 0
s_mov_b32 s31, 409600
buffer_load_dwordx4 v2, s[8:11], s31 offen lds
s_add_u32 m0, s53, 1024
s_mov_b32 s31, 419840
buffer_load_dwordx4 v2, s[8:11], s31 offen lds
v_perm_b32 v144, v81, v80, s29
v_accvgpr_write_b32 a0, v144
v_perm_b32 v145, v83, v82, s29
v_accvgpr_write_b32 a1, v145
v_perm_b32 v144, v85, v84, s29
v_accvgpr_write_b32 a2, v144
v_perm_b32 v145, v87, v86, s29
v_accvgpr_write_b32 a3, v145
v_perm_b32 v144, v81, v80, s30
v_accvgpr_write_b32 a4, v144
v_perm_b32 v145, v83, v82, s30
v_accvgpr_write_b32 a5, v145
v_perm_b32 v144, v85, v84, s30
v_accvgpr_write_b32 a6, v144
v_perm_b32 v145, v87, v86, s30
v_accvgpr_write_b32 a7, v145
s_waitcnt vmcnt(36)
v_add_u32 v146, 4096, v14
ds_read2_b32 v[80:81], v146 offset0:0 offset1:32
ds_read2_b32 v[82:83], v146 offset0:64 offset1:96
ds_read2_b32 v[84:85], v146 offset0:128 offset1:160
ds_read2_b32 v[86:87], v146 offset0:192 offset1:224
s_waitcnt lgkmcnt(4)
s_add_u32 m0, s53, 2048
s_mov_b32 s31, 430080
buffer_load_dwordx4 v2, s[8:11], s31 offen lds
s_add_u32 m0, s53, 3072
s_mov_b32 s31, 440320
buffer_load_dwordx4 v2, s[8:11], s31 offen lds
v_perm_b32 v144, v89, v88, s29
v_accvgpr_write_b32 a8, v144
v_perm_b32 v145, v91, v90, s29
v_accvgpr_write_b32 a9, v145
v_perm_b32 v144, v93, v92, s29
v_accvgpr_write_b32 a10, v144
v_perm_b32 v145, v95, v94, s29
v_accvgpr_write_b32 a11, v145
v_perm_b32 v144, v89, v88, s30
v_accvgpr_write_b32 a12, v144
v_perm_b32 v145, v91, v90, s30
v_accvgpr_write_b32 a13, v145
v_perm_b32 v144, v93, v92, s30
v_accvgpr_write_b32 a14, v144
v_perm_b32 v145, v95, v94, s30
v_accvgpr_write_b32 a15, v145
s_waitcnt vmcnt(36)
v_add_u32 v146, 6144, v14
ds_read2_b32 v[88:89], v146 offset0:0 offset1:32
ds_read2_b32 v[90:91], v146 offset0:64 offset1:96
ds_read2_b32 v[92:93], v146 offset0:128 offset1:160
ds_read2_b32 v[94:95], v146 offset0:192 offset1:224
s_waitcnt lgkmcnt(4)
s_add_u32 m0, s53, 4096
s_mov_b32 s31, 450560
buffer_load_dwordx4 v2, s[8:11], s31 offen lds
s_add_u32 m0, s53, 5120
s_mov_b32 s31, 460800
buffer_load_dwordx4 v2, s[8:11], s31 offen lds
v_perm_b32 v144, v81, v80, s29
v_accvgpr_write_b32 a16, v144
v_perm_b32 v145, v83, v82, s29
v_accvgpr_write_b32 a17, v145
v_perm_b32 v144, v85, v84, s29
v_accvgpr_write_b32 a18, v144
v_perm_b32 v145, v87, v86, s29
v_accvgpr_write_b32 a19, v145
v_perm_b32 v144, v81, v80, s30
v_accvgpr_write_b32 a20, v144
v_perm_b32 v145, v83, v82, s30
v_accvgpr_write_b32 a21, v145
v_perm_b32 v144, v85, v84, s30
v_accvgpr_write_b32 a22, v144
v_perm_b32 v145, v87, v86, s30
v_accvgpr_write_b32 a23, v145
s_waitcnt vmcnt(36)
v_add_u32 v146, 8192, v14
ds_read2_b32 v[80:81], v146 offset0:0 offset1:32
ds_read2_b32 v[82:83], v146 offset0:64 offset1:96
ds_read2_b32 v[84:85], v146 offset0:128 offset1:160
ds_read2_b32 v[86:87], v146 offset0:192 offset1:224
s_waitcnt lgkmcnt(4)
s_add_u32 m0, s53, 6144
s_mov_b32 s31, 471040
buffer_load_dwordx4 v2, s[8:11], s31 offen lds
s_add_u32 m0, s53, 7168
s_mov_b32 s31, 481280
buffer_load_dwordx4 v2, s[8:11], s31 offen lds
v_perm_b32 v144, v89, v88, s29
v_accvgpr_write_b32 a24, v144
v_perm_b32 v145, v91, v90, s29
v_accvgpr_write_b32 a25, v145
v_perm_b32 v144, v93, v92, s29
v_accvgpr_write_b32 a26, v144
v_perm_b32 v145, v95, v94, s29
v_accvgpr_write_b32 a27, v145
v_perm_b32 v144, v89, v88, s30
v_accvgpr_write_b32 a28, v144
v_perm_b32 v145, v91, v90, s30
v_accvgpr_write_b32 a29, v145
v_perm_b32 v144, v93, v92, s30
v_accvgpr_write_b32 a30, v144
v_perm_b32 v145, v95, v94, s30
v_accvgpr_write_b32 a31, v145
s_waitcnt vmcnt(36)
v_add_u32 v146, 10240, v14
ds_read2_b32 v[88:89], v146 offset0:0 offset1:32
ds_read2_b32 v[90:91], v146 offset0:64 offset1:96
ds_read2_b32 v[92:93], v146 offset0:128 offset1:160
ds_read2_b32 v[94:95], v146 offset0:192 offset1:224
s_waitcnt lgkmcnt(4)
v_perm_b32 v144, v81, v80, s29
v_accvgpr_write_b32 a32, v144
v_perm_b32 v145, v83, v82, s29
v_accvgpr_write_b32 a33, v145
v_perm_b32 v144, v85, v84, s29
v_accvgpr_write_b32 a34, v144
v_perm_b32 v145, v87, v86, s29
v_accvgpr_write_b32 a35, v145
v_perm_b32 v144, v81, v80, s30
v_accvgpr_write_b32 a36, v144
v_perm_b32 v145, v83, v82, s30
v_accvgpr_write_b32 a37, v145
v_perm_b32 v144, v85, v84, s30
v_accvgpr_write_b32 a38, v144
v_perm_b32 v145, v87, v86, s30
v_accvgpr_write_b32 a39, v145
s_waitcnt vmcnt(34)
v_add_u32 v146, 12288, v14
ds_read2_b32 v[80:81], v146 offset0:0 offset1:32
ds_read2_b32 v[82:83], v146 offset0:64 offset1:96
ds_read2_b32 v[84:85], v146 offset0:128 offset1:160
ds_read2_b32 v[86:87], v146 offset0:192 offset1:224
s_waitcnt lgkmcnt(4)
v_perm_b32 v144, v89, v88, s29
v_accvgpr_write_b32 a40, v144
v_perm_b32 v145, v91, v90, s29
v_accvgpr_write_b32 a41, v145
v_perm_b32 v144, v93, v92, s29
v_accvgpr_write_b32 a42, v144
v_perm_b32 v145, v95, v94, s29
v_accvgpr_write_b32 a43, v145
v_perm_b32 v144, v89, v88, s30
v_accvgpr_write_b32 a44, v144
v_perm_b32 v145, v91, v90, s30
v_accvgpr_write_b32 a45, v145
v_perm_b32 v144, v93, v92, s30
v_accvgpr_write_b32 a46, v144
v_perm_b32 v145, v95, v94, s30
v_accvgpr_write_b32 a47, v145
s_waitcnt vmcnt(32)
v_add_u32 v146, 14336, v14
ds_read2_b32 v[88:89], v146 offset0:0 offset1:32
ds_read2_b32 v[90:91], v146 offset0:64 offset1:96
ds_read2_b32 v[92:93], v146 offset0:128 offset1:160
ds_read2_b32 v[94:95], v146 offset0:192 offset1:224
s_waitcnt lgkmcnt(4)
v_perm_b32 v144, v81, v80, s29
v_accvgpr_write_b32 a48, v144
v_perm_b32 v145, v83, v82, s29
v_accvgpr_write_b32 a49, v145
v_perm_b32 v144, v85, v84, s29
v_accvgpr_write_b32 a50, v144
v_perm_b32 v145, v87, v86, s29
v_accvgpr_write_b32 a51, v145
v_perm_b32 v144, v81, v80, s30
v_accvgpr_write_b32 a52, v144
v_perm_b32 v145, v83, v82, s30
v_accvgpr_write_b32 a53, v145
v_perm_b32 v144, v85, v84, s30
v_accvgpr_write_b32 a54, v144
v_perm_b32 v145, v87, v86, s30
v_accvgpr_write_b32 a55, v145
s_waitcnt vmcnt(30)
v_add_u32 v146, 16384, v14
ds_read2_b32 v[80:81], v146 offset0:0 offset1:32
ds_read2_b32 v[82:83], v146 offset0:64 offset1:96
ds_read2_b32 v[84:85], v146 offset0:128 offset1:160
ds_read2_b32 v[86:87], v146 offset0:192 offset1:224
s_waitcnt lgkmcnt(4)
v_perm_b32 v144, v89, v88, s29
v_accvgpr_write_b32 a56, v144
v_perm_b32 v145, v91, v90, s29
v_accvgpr_write_b32 a57, v145
v_perm_b32 v144, v93, v92, s29
v_accvgpr_write_b32 a58, v144
v_perm_b32 v145, v95, v94, s29
v_accvgpr_write_b32 a59, v145
v_perm_b32 v144, v89, v88, s30
v_accvgpr_write_b32 a60, v144
v_perm_b32 v145, v91, v90, s30
v_accvgpr_write_b32 a61, v145
v_perm_b32 v144, v93, v92, s30
v_accvgpr_write_b32 a62, v144
v_perm_b32 v145, v95, v94, s30
v_accvgpr_write_b32 a63, v145
s_waitcnt vmcnt(28)
v_add_u32 v146, 18432, v14
ds_read2_b32 v[88:89], v146 offset0:0 offset1:32
ds_read2_b32 v[90:91], v146 offset0:64 offset1:96
ds_read2_b32 v[92:93], v146 offset0:128 offset1:160
ds_read2_b32 v[94:95], v146 offset0:192 offset1:224
s_waitcnt lgkmcnt(4)
v_perm_b32 v144, v81, v80, s29
v_accvgpr_write_b32 a64, v144
v_perm_b32 v145, v83, v82, s29
v_accvgpr_write_b32 a65, v145
v_perm_b32 v144, v85, v84, s29
v_accvgpr_write_b32 a66, v144
v_perm_b32 v145, v87, v86, s29
v_accvgpr_write_b32 a67, v145
v_perm_b32 v144, v81, v80, s30
v_accvgpr_write_b32 a68, v144
v_perm_b32 v145, v83, v82, s30
v_accvgpr_write_b32 a69, v145
v_perm_b32 v144, v85, v84, s30
v_accvgpr_write_b32 a70, v144
v_perm_b32 v145, v87, v86, s30
v_accvgpr_write_b32 a71, v145
s_waitcnt vmcnt(26)
v_add_u32 v146, 20480, v14
ds_read2_b32 v[80:81], v146 offset0:0 offset1:32
ds_read2_b32 v[82:83], v146 offset0:64 offset1:96
ds_read2_b32 v[84:85], v146 offset0:128 offset1:160
ds_read2_b32 v[86:87], v146 offset0:192 offset1:224
s_waitcnt lgkmcnt(4)
v_perm_b32 v144, v89, v88, s29
v_accvgpr_write_b32 a72, v144
v_perm_b32 v145, v91, v90, s29
v_accvgpr_write_b32 a73, v145
v_perm_b32 v144, v93, v92, s29
v_accvgpr_write_b32 a74, v144
v_perm_b32 v145, v95, v94, s29
v_accvgpr_write_b32 a75, v145
v_perm_b32 v144, v89, v88, s30
v_accvgpr_write_b32 a76, v144
v_perm_b32 v145, v91, v90, s30
v_accvgpr_write_b32 a77, v145
v_perm_b32 v144, v93, v92, s30
v_accvgpr_write_b32 a78, v144
v_perm_b32 v145, v95, v94, s30
v_accvgpr_write_b32 a79, v145
s_waitcnt vmcnt(24)
v_add_u32 v146, 22528, v14
ds_read2_b32 v[88:89], v146 offset0:0 offset1:32
ds_read2_b32 v[90:91], v146 offset0:64 offset1:96
ds_read2_b32 v[92:93], v146 offset0:128 offset1:160
ds_read2_b32 v[94:95], v146 offset0:192 offset1:224
s_waitcnt lgkmcnt(4)
v_perm_b32 v144, v81, v80, s29
v_accvgpr_write_b32 a80, v144
v_perm_b32 v145, v83, v82, s29
v_accvgpr_write_b32 a81, v145
v_perm_b32 v144, v85, v84, s29
v_accvgpr_write_b32 a82, v144
v_perm_b32 v145, v87, v86, s29
v_accvgpr_write_b32 a83, v145
v_perm_b32 v144, v81, v80, s30
v_accvgpr_write_b32 a84, v144
v_perm_b32 v145, v83, v82, s30
v_accvgpr_write_b32 a85, v145
v_perm_b32 v144, v85, v84, s30
v_accvgpr_write_b32 a86, v144
v_perm_b32 v145, v87, v86, s30
v_accvgpr_write_b32 a87, v145
s_waitcnt vmcnt(22)
v_add_u32 v146, 24576, v14
ds_read2_b32 v[80:81], v146 offset0:0 offset1:32
ds_read2_b32 v[82:83], v146 offset0:64 offset1:96
ds_read2_b32 v[84:85], v146 offset0:128 offset1:160
ds_read2_b32 v[86:87], v146 offset0:192 offset1:224
s_waitcnt lgkmcnt(4)
v_perm_b32 v144, v89, v88, s29
v_accvgpr_write_b32 a88, v144
v_perm_b32 v145, v91, v90, s29
v_accvgpr_write_b32 a89, v145
v_perm_b32 v144, v93, v92, s29
v_accvgpr_write_b32 a90, v144
v_perm_b32 v145, v95, v94, s29
v_accvgpr_write_b32 a91, v145
v_perm_b32 v144, v89, v88, s30
v_accvgpr_write_b32 a92, v144
v_perm_b32 v145, v91, v90, s30
v_accvgpr_write_b32 a93, v145
v_perm_b32 v144, v93, v92, s30
v_accvgpr_write_b32 a94, v144
v_perm_b32 v145, v95, v94, s30
v_accvgpr_write_b32 a95, v145
s_waitcnt vmcnt(20)
v_add_u32 v146, 26624, v14
ds_read2_b32 v[88:89], v146 offset0:0 offset1:32
ds_read2_b32 v[90:91], v146 offset0:64 offset1:96
ds_read2_b32 v[92:93], v146 offset0:128 offset1:160
ds_read2_b32 v[94:95], v146 offset0:192 offset1:224
s_waitcnt lgkmcnt(4)
v_perm_b32 v144, v81, v80, s29
v_accvgpr_write_b32 a96, v144
v_perm_b32 v145, v83, v82, s29
v_accvgpr_write_b32 a97, v145
v_perm_b32 v144, v85, v84, s29
v_accvgpr_write_b32 a98, v144
v_perm_b32 v145, v87, v86, s29
v_accvgpr_write_b32 a99, v145
v_perm_b32 v144, v81, v80, s30
v_accvgpr_write_b32 a100, v144
v_perm_b32 v145, v83, v82, s30
v_accvgpr_write_b32 a101, v145
v_perm_b32 v144, v85, v84, s30
v_accvgpr_write_b32 a102, v144
v_perm_b32 v145, v87, v86, s30
v_accvgpr_write_b32 a103, v145
s_waitcnt vmcnt(18)
v_add_u32 v146, 28672, v14
ds_read2_b32 v[80:81], v146 offset0:0 offset1:32
ds_read2_b32 v[82:83], v146 offset0:64 offset1:96
ds_read2_b32 v[84:85], v146 offset0:128 offset1:160
ds_read2_b32 v[86:87], v146 offset0:192 offset1:224
s_waitcnt lgkmcnt(4)
v_perm_b32 v144, v89, v88, s29
v_accvgpr_write_b32 a104, v144
v_perm_b32 v145, v91, v90, s29
v_accvgpr_write_b32 a105, v145
v_perm_b32 v144, v93, v92, s29
v_accvgpr_write_b32 a106, v144
v_perm_b32 v145, v95, v94, s29
v_accvgpr_write_b32 a107, v145
v_perm_b32 v144, v89, v88, s30
v_accvgpr_write_b32 a108, v144
v_perm_b32 v145, v91, v90, s30
v_accvgpr_write_b32 a109, v145
v_perm_b32 v144, v93, v92, s30
v_accvgpr_write_b32 a110, v144
v_perm_b32 v145, v95, v94, s30
v_accvgpr_write_b32 a111, v145
s_waitcnt vmcnt(16)
v_add_u32 v146, 30720, v14
ds_read2_b32 v[88:89], v146 offset0:0 offset1:32
ds_read2_b32 v[90:91], v146 offset0:64 offset1:96
ds_read2_b32 v[92:93], v146 offset0:128 offset1:160
ds_read2_b32 v[94:95], v146 offset0:192 offset1:224
s_waitcnt lgkmcnt(4)
v_perm_b32 v144, v81, v80, s29
v_accvgpr_write_b32 a112, v144
v_perm_b32 v145, v83, v82, s29
v_accvgpr_write_b32 a113, v145
v_perm_b32 v144, v85, v84, s29
v_accvgpr_write_b32 a114, v144
v_perm_b32 v145, v87, v86, s29
v_accvgpr_write_b32 a115, v145
v_perm_b32 v144, v81, v80, s30
v_accvgpr_write_b32 a116, v144
v_perm_b32 v145, v83, v82, s30
v_accvgpr_write_b32 a117, v145
v_perm_b32 v144, v85, v84, s30
v_accvgpr_write_b32 a118, v144
v_perm_b32 v145, v87, v86, s30
v_accvgpr_write_b32 a119, v145
s_waitcnt vmcnt(14)
v_add_u32 v146, 32768, v14
ds_read2_b32 v[80:81], v146 offset0:0 offset1:32
ds_read2_b32 v[82:83], v146 offset0:64 offset1:96
ds_read2_b32 v[84:85], v146 offset0:128 offset1:160
ds_read2_b32 v[86:87], v146 offset0:192 offset1:224
s_waitcnt lgkmcnt(4)
v_perm_b32 v144, v89, v88, s29
v_accvgpr_write_b32 a120, v144
v_perm_b32 v145, v91, v90, s29
v_accvgpr_write_b32 a121, v145
v_perm_b32 v144, v93, v92, s29
v_accvgpr_write_b32 a122, v144
v_perm_b32 v145, v95, v94, s29
v_accvgpr_write_b32 a123, v145
v_perm_b32 v144, v89, v88, s30
v_accvgpr_write_b32 a124, v144
v_perm_b32 v145, v91, v90, s30
v_accvgpr_write_b32 a125, v145
v_perm_b32 v144, v93, v92, s30
v_accvgpr_write_b32 a126, v144
v_perm_b32 v145, v95, v94, s30
v_accvgpr_write_b32 a127, v145
s_waitcnt vmcnt(12)
v_add_u32 v146, 34816, v14
ds_read2_b32 v[88:89], v146 offset0:0 offset1:32
ds_read2_b32 v[90:91], v146 offset0:64 offset1:96
ds_read2_b32 v[92:93], v146 offset0:128 offset1:160
ds_read2_b32 v[94:95], v146 offset0:192 offset1:224
s_waitcnt lgkmcnt(4)
v_perm_b32 v144, v81, v80, s29
v_accvgpr_write_b32 a128, v144
v_perm_b32 v145, v83, v82, s29
v_accvgpr_write_b32 a129, v145
v_perm_b32 v144, v85, v84, s29
v_accvgpr_write_b32 a130, v144
v_perm_b32 v145, v87, v86, s29
v_accvgpr_write_b32 a131, v145
v_perm_b32 v144, v81, v80, s30
v_accvgpr_write_b32 a132, v144
v_perm_b32 v145, v83, v82, s30
v_accvgpr_write_b32 a133, v145
v_perm_b32 v144, v85, v84, s30
v_accvgpr_write_b32 a134, v144
v_perm_b32 v145, v87, v86, s30
v_accvgpr_write_b32 a135, v145
s_waitcnt vmcnt(10)
v_add_u32 v146, 36864, v14
ds_read2_b32 v[80:81], v146 offset0:0 offset1:32
ds_read2_b32 v[82:83], v146 offset0:64 offset1:96
ds_read2_b32 v[84:85], v146 offset0:128 offset1:160
ds_read2_b32 v[86:87], v146 offset0:192 offset1:224
s_waitcnt lgkmcnt(4)
v_perm_b32 v144, v89, v88, s29
v_accvgpr_write_b32 a136, v144
v_perm_b32 v145, v91, v90, s29
v_accvgpr_write_b32 a137, v145
v_perm_b32 v144, v93, v92, s29
v_accvgpr_write_b32 a138, v144
v_perm_b32 v145, v95, v94, s29
v_accvgpr_write_b32 a139, v145
v_perm_b32 v144, v89, v88, s30
v_accvgpr_write_b32 a140, v144
v_perm_b32 v145, v91, v90, s30
v_accvgpr_write_b32 a141, v145
v_perm_b32 v144, v93, v92, s30
v_accvgpr_write_b32 a142, v144
v_perm_b32 v145, v95, v94, s30
v_accvgpr_write_b32 a143, v145
s_waitcnt vmcnt(8)
v_add_u32 v146, 38912, v14
ds_read2_b32 v[88:89], v146 offset0:0 offset1:32
ds_read2_b32 v[90:91], v146 offset0:64 offset1:96
ds_read2_b32 v[92:93], v146 offset0:128 offset1:160
ds_read2_b32 v[94:95], v146 offset0:192 offset1:224
s_waitcnt lgkmcnt(4)
v_perm_b32 v144, v81, v80, s29
v_accvgpr_write_b32 a144, v144
v_perm_b32 v145, v83, v82, s29
v_accvgpr_write_b32 a145, v145
v_perm_b32 v144, v85, v84, s29
v_accvgpr_write_b32 a146, v144
v_perm_b32 v145, v87, v86, s29
v_accvgpr_write_b32 a147, v145
v_perm_b32 v144, v81, v80, s30
v_accvgpr_write_b32 a148, v144
v_perm_b32 v145, v83, v82, s30
v_accvgpr_write_b32 a149, v145
v_perm_b32 v144, v85, v84, s30
v_accvgpr_write_b32 a150, v144
v_perm_b32 v145, v87, v86, s30
v_accvgpr_write_b32 a151, v145
s_waitcnt vmcnt(6)
v_add_u32 v146, 0, v14
ds_read2_b32 v[80:81], v146 offset0:0 offset1:32
ds_read2_b32 v[82:83], v146 offset0:64 offset1:96
ds_read2_b32 v[84:85], v146 offset0:128 offset1:160
ds_read2_b32 v[86:87], v146 offset0:192 offset1:224
s_waitcnt lgkmcnt(4)
v_perm_b32 v144, v89, v88, s29
v_accvgpr_write_b32 a152, v144
v_perm_b32 v145, v91, v90, s29
v_accvgpr_write_b32 a153, v145
v_perm_b32 v144, v93, v92, s29
v_accvgpr_write_b32 a154, v144
v_perm_b32 v145, v95, v94, s29
v_accvgpr_write_b32 a155, v145
v_perm_b32 v144, v89, v88, s30
v_accvgpr_write_b32 a156, v144
v_perm_b32 v145, v91, v90, s30
v_accvgpr_write_b32 a157, v145
v_perm_b32 v144, v93, v92, s30
v_accvgpr_write_b32 a158, v144
v_perm_b32 v145, v95, v94, s30
v_accvgpr_write_b32 a159, v145
s_waitcnt vmcnt(4)
v_add_u32 v146, 2048, v14
ds_read2_b32 v[88:89], v146 offset0:0 offset1:32
ds_read2_b32 v[90:91], v146 offset0:64 offset1:96
ds_read2_b32 v[92:93], v146 offset0:128 offset1:160
ds_read2_b32 v[94:95], v146 offset0:192 offset1:224
s_waitcnt lgkmcnt(4)
v_perm_b32 v144, v81, v80, s29
v_accvgpr_write_b32 a160, v144
v_perm_b32 v145, v83, v82, s29
v_accvgpr_write_b32 a161, v145
v_perm_b32 v144, v85, v84, s29
v_accvgpr_write_b32 a162, v144
v_perm_b32 v145, v87, v86, s29
v_accvgpr_write_b32 a163, v145
v_perm_b32 v144, v81, v80, s30
v_accvgpr_write_b32 a164, v144
v_perm_b32 v145, v83, v82, s30
v_accvgpr_write_b32 a165, v145
v_perm_b32 v144, v85, v84, s30
v_accvgpr_write_b32 a166, v144
v_perm_b32 v145, v87, v86, s30
v_accvgpr_write_b32 a167, v145
s_waitcnt vmcnt(2)
v_add_u32 v146, 4096, v14
ds_read2_b32 v[80:81], v146 offset0:0 offset1:32
ds_read2_b32 v[82:83], v146 offset0:64 offset1:96
ds_read2_b32 v[84:85], v146 offset0:128 offset1:160
ds_read2_b32 v[86:87], v146 offset0:192 offset1:224
s_waitcnt lgkmcnt(4)
v_perm_b32 v144, v89, v88, s29
v_accvgpr_write_b32 a168, v144
v_perm_b32 v145, v91, v90, s29
v_accvgpr_write_b32 a169, v145
v_perm_b32 v144, v93, v92, s29
v_accvgpr_write_b32 a170, v144
v_perm_b32 v145, v95, v94, s29
v_accvgpr_write_b32 a171, v145
v_perm_b32 v144, v89, v88, s30
v_accvgpr_write_b32 a172, v144
v_perm_b32 v145, v91, v90, s30
v_accvgpr_write_b32 a173, v145
v_perm_b32 v144, v93, v92, s30
v_accvgpr_write_b32 a174, v144
v_perm_b32 v145, v95, v94, s30
v_accvgpr_write_b32 a175, v145
s_waitcnt vmcnt(0)
v_add_u32 v146, 6144, v14
ds_read2_b32 v[88:89], v146 offset0:0 offset1:32
ds_read2_b32 v[90:91], v146 offset0:64 offset1:96
ds_read2_b32 v[92:93], v146 offset0:128 offset1:160
ds_read2_b32 v[94:95], v146 offset0:192 offset1:224
s_waitcnt lgkmcnt(4)
v_perm_b32 v144, v81, v80, s29
v_accvgpr_write_b32 a176, v144
v_perm_b32 v145, v83, v82, s29
v_accvgpr_write_b32 a177, v145
v_perm_b32 v144, v85, v84, s29
v_accvgpr_write_b32 a178, v144
v_perm_b32 v145, v87, v86, s29
v_accvgpr_write_b32 a179, v145
v_perm_b32 v144, v81, v80, s30
v_accvgpr_write_b32 a180, v144
v_perm_b32 v145, v83, v82, s30
v_accvgpr_write_b32 a181, v145
v_perm_b32 v144, v85, v84, s30
v_accvgpr_write_b32 a182, v144
v_perm_b32 v145, v87, v86, s30
v_accvgpr_write_b32 a183, v145
s_waitcnt lgkmcnt(0)
v_perm_b32 v144, v89, v88, s29
v_accvgpr_write_b32 a184, v144
v_perm_b32 v145, v91, v90, s29
v_accvgpr_write_b32 a185, v145
v_perm_b32 v144, v93, v92, s29
v_accvgpr_write_b32 a186, v144
v_perm_b32 v145, v95, v94, s29
v_accvgpr_write_b32 a187, v145
v_perm_b32 v144, v89, v88, s30
v_accvgpr_write_b32 a188, v144
v_perm_b32 v145, v91, v90, s30
v_accvgpr_write_b32 a189, v145
v_perm_b32 v144, v93, v92, s30
v_accvgpr_write_b32 a190, v144
v_perm_b32 v145, v95, v94, s30
v_accvgpr_write_b32 a191, v145
s_cmp_lg_u32 s28, 0
s_cbranch_scc1 Lgwd_100
Lgw_99:
buffer_load_dwordx2 v[8:9], off, s[20:23], 0 sc1
s_waitcnt vmcnt(0)
v_cmp_gt_u32 vcc, 255, v8
s_cbranch_vccz Lgwe_101
s_cmp_eq_u32 s25, 0
s_cbranch_scc1 Lgwe_101
s_sub_u32 s25, s25, 1
s_sleep 4
s_branch Lgw_99
Lgwe_101:
Lgwd_100:
s_barrier
s_mov_b32 s50, 1
Lpl_102:
buffer_load_dword v9, v7, s[4:7], 0 offen sc1
s_waitcnt vmcnt(0)
v_cmp_gt_u32 vcc, s50, v9
s_cbranch_vccz Lpld_103
s_cmp_eq_u32 s25, 0
s_cbranch_scc1 Lpld_103
s_sub_u32 s25, s25, 1
s_sleep 1
s_branch Lpl_102
Lpld_103:
s_add_u32 s44, s43, 4096
s_add_u32 s45, s43, 8192
s_add_u32 s46, s43, 12288
s_add_u32 s47, s43, 16384
s_add_u32 s48, s43, 20480
buffer_load_dwordx4 v[16:19], v6, s[4:7], s43 offen offset:0 sc1
buffer_load_dwordx4 v[20:23], v6, s[4:7], s43 offen offset:1024 sc1
buffer_load_dwordx4 v[24:27], v6, s[4:7], s43 offen offset:2048 sc1
buffer_load_dwordx4 v[28:31], v6, s[4:7], s43 offen offset:3072 sc1
buffer_load_dwordx4 v[32:35], v6, s[4:7], s44 offen offset:0 sc1
buffer_load_dwordx4 v[36:39], v6, s[4:7], s44 offen offset:1024 sc1
buffer_load_dwordx4 v[40:43], v6, s[4:7], s44 offen offset:2048 sc1
buffer_load_dwordx4 v[44:47], v6, s[4:7], s44 offen offset:3072 sc1
buffer_load_dwordx4 v[48:51], v6, s[4:7], s45 offen offset:0 sc1
buffer_load_dwordx4 v[52:55], v6, s[4:7], s45 offen offset:1024 sc1
buffer_load_dwordx4 v[56:59], v6, s[4:7], s45 offen offset:2048 sc1
buffer_load_dwordx4 v[60:63], v6, s[4:7], s45 offen offset:3072 sc1
buffer_load_dwordx4 v[64:67], v6, s[4:7], s46 offen offset:0 sc1
buffer_load_dwordx4 v[68:71], v6, s[4:7], s46 offen offset:1024 sc1
buffer_load_dwordx4 v[72:75], v6, s[4:7], s46 offen offset:2048 sc1
buffer_load_dwordx4 v[76:79], v6, s[4:7], s46 offen offset:3072 sc1
buffer_load_dwordx4 v[80:83], v6, s[4:7], s47 offen offset:0 sc1
buffer_load_dwordx4 v[84:87], v6, s[4:7], s47 offen offset:1024 sc1
buffer_load_dwordx4 v[88:91], v6, s[4:7], s47 offen offset:2048 sc1
buffer_load_dwordx4 v[92:95], v6, s[4:7], s47 offen offset:3072 sc1
buffer_load_dwordx4 v[96:99], v6, s[4:7], s48 offen offset:0 sc1
buffer_load_dwordx4 v[100:103], v6, s[4:7], s48 offen offset:1024 sc1
buffer_load_dwordx4 v[104:107], v6, s[4:7], s48 offen offset:2048 sc1
buffer_load_dwordx4 v[108:111], v6, s[4:7], s48 offen offset:3072 sc1
buffer_load_dword v9, v7, s[4:7], 0 offen sc1
Lf2_loop:
s_add_u32 s43, s43, 98304
s_add_u32 s44, s43, 4096
s_add_u32 s45, s43, 8192
s_add_u32 s46, s43, 12288
s_add_u32 s47, s43, 16384
s_add_u32 s48, s43, 20480
v_mov_b32 v8, s24
s_add_u32 s50, s24, 2
s_min_u32 s50, s50, 64
s_waitcnt vmcnt(0)
buffer_store_dword v8, v5, s[4:7], 0 offen sc1
v_cmp_gt_u32 vcc, s50, v9
s_cmp_eq_u64 vcc, 0
s_cselect_b32 s51, 1, 0
v_mfma_f32_32x32x16_bf16 v[112:127], a[0:3], v[16:19], 0
v_mfma_f32_32x32x16_bf16 v[128:143], a[4:7], v[16:19], 0
s_cmp_eq_u32 s51, 0
s_cbranch_scc1 Lpf_104
buffer_load_dwordx4 v[16:19], v6, s[4:7], s43 offen offset:0 sc1
Lpf_104:
v_mfma_f32_32x32x16_bf16 v[112:127], a[8:11], v[20:23], v[112:127]
v_mfma_f32_32x32x16_bf16 v[128:143], a[12:15], v[20:23], v[128:143]
s_cmp_eq_u32 s51, 0
s_cbranch_scc1 Lpf_105
buffer_load_dwordx4 v[20:23], v6, s[4:7], s43 offen offset:1024 sc1
Lpf_105:
v_mfma_f32_32x32x16_bf16 v[112:127], a[16:19], v[24:27], v[112:127]
v_mfma_f32_32x32x16_bf16 v[128:143], a[20:23], v[24:27], v[128:143]
s_cmp_eq_u32 s51, 0
s_cbranch_scc1 Lpf_106
buffer_load_dwordx4 v[24:27], v6, s[4:7], s43 offen offset:2048 sc1
Lpf_106:
v_mfma_f32_32x32x16_bf16 v[112:127], a[24:27], v[28:31], v[112:127]
v_mfma_f32_32x32x16_bf16 v[128:143], a[28:31], v[28:31], v[128:143]
s_cmp_eq_u32 s51, 0
s_cbranch_scc1 Lpf_107
buffer_load_dwordx4 v[28:31], v6, s[4:7], s43 offen offset:3072 sc1
Lpf_107:
v_mfma_f32_32x32x16_bf16 v[112:127], a[32:35], v[32:35], v[112:127]
v_mfma_f32_32x32x16_bf16 v[128:143], a[36:39], v[32:35], v[128:143]
s_cmp_eq_u32 s51, 0
s_cbranch_scc1 Lpf_108
buffer_load_dwordx4 v[32:35], v6, s[4:7], s44 offen offset:0 sc1
Lpf_108:
v_mfma_f32_32x32x16_bf16 v[112:127], a[40:43], v[36:39], v[112:127]
v_mfma_f32_32x32x16_bf16 v[128:143], a[44:47], v[36:39], v[128:143]
s_cmp_eq_u32 s51, 0
s_cbranch_scc1 Lpf_109
buffer_load_dwordx4 v[36:39], v6, s[4:7], s44 offen offset:1024 sc1
Lpf_109:
s_cmp_eq_u32 s51, 1
s_cbranch_scc1 Lsl_110
buffer_load_dword v9, v7, s[4:7], 0 offen sc1
Lsl_110:
v_mfma_f32_32x32x16_bf16 v[112:127], a[48:51], v[40:43], v[112:127]
v_mfma_f32_32x32x16_bf16 v[128:143], a[52:55], v[40:43], v[128:143]
s_cmp_eq_u32 s51, 0
s_cbranch_scc1 Lpf_111
buffer_load_dwordx4 v[40:43], v6, s[4:7], s44 offen offset:2048 sc1
Lpf_111:
v_mfma_f32_32x32x16_bf16 v[112:127], a[56:59], v[44:47], v[112:127]
v_mfma_f32_32x32x16_bf16 v[128:143], a[60:63], v[44:47], v[128:143]
s_cmp_eq_u32 s51, 0
s_cbranch_scc1 Lpf_112
buffer_load_dwordx4 v[44:47], v6, s[4:7], s44 offen offset:3072 sc1
Lpf_112:
v_mfma_f32_32x32x16_bf16 v[112:127], a[64:67], v[48:51], v[112:127]
v_mfma_f32_32x32x16_bf16 v[128:143], a[68:71], v[48:51], v[128:143]
s_cmp_eq_u32 s51, 0
s_cbranch_scc1 Lpf_113
buffer_load_dwordx4 v[48:51], v6, s[4:7], s45 offen offset:0 sc1
Lpf_113:
v_mfma_f32_32x32x16_bf16 v[112:127], a[72:75], v[52:55], v[112:127]
v_mfma_f32_32x32x16_bf16 v[128:143], a[76:79], v[52:55], v[128:143]
s_cmp_eq_u32 s51, 0
s_cbranch_scc1 Lpf_114
buffer_load_dwordx4 v[52:55], v6, s[4:7], s45 offen offset:1024 sc1
Lpf_114:
v_mfma_f32_32x32x16_bf16 v[112:127], a[80:83], v[56:59], v[112:127]
v_mfma_f32_32x32x16_bf16 v[128:143], a[84:87], v[56:59], v[128:143]
s_cmp_eq_u32 s51, 0
s_cbranch_scc1 Lpf_115
buffer_load_dwordx4 v[56:59], v6, s[4:7], s45 offen offset:2048 sc1
Lpf_115:
v_mfma_f32_32x32x16_bf16 v[112:127], a[88:91], v[60:63], v[112:127]
v_mfma_f32_32x32x16_bf16 v[128:143], a[92:95], v[60:63], v[128:143]
s_cmp_eq_u32 s51, 0
s_cbranch_scc1 Lpf_116
buffer_load_dwordx4 v[60:63], v6, s[4:7], s45 offen offset:3072 sc1
Lpf_116:
v_mfma_f32_32x32x16_bf16 v[112:127], a[96:99], v[64:67], v[112:127]
v_mfma_f32_32x32x16_bf16 v[128:143], a[100:103], v[64:67], v[128:143]
s_cmp_eq_u32 s51, 0
s_cbranch_scc1 Lpf_117
buffer_load_dwordx4 v[64:67], v6, s[4:7], s46 offen offset:0 sc1
Lpf_117:
v_mfma_f32_32x32x16_bf16 v[112:127], a[104:107], v[68:71], v[112:127]
v_mfma_f32_32x32x16_bf16 v[128:143], a[108:111], v[68:71], v[128:143]
s_cmp_eq_u32 s51, 0
s_cbranch_scc1 Lpf_118
buffer_load_dwordx4 v[68:71], v6, s[4:7], s46 offen offset:1024 sc1
Lpf_118:
s_cmp_eq_u32 s51, 1
s_cbranch_scc1 Lsc_119
s_waitcnt vmcnt(0)
v_cmp_gt_u32 vcc, s50, v9
s_cbranch_vccnz Lsc_119
s_mov_b32 s51, 1
buffer_load_dwordx4 v[16:19], v6, s[4:7], s43 offen offset:0 sc1
buffer_load_dwordx4 v[20:23], v6, s[4:7], s43 offen offset:1024 sc1
buffer_load_dwordx4 v[24:27], v6, s[4:7], s43 offen offset:2048 sc1
buffer_load_dwordx4 v[28:31], v6, s[4:7], s43 offen offset:3072 sc1
buffer_load_dwordx4 v[32:35], v6, s[4:7], s44 offen offset:0 sc1
buffer_load_dwordx4 v[36:39], v6, s[4:7], s44 offen offset:1024 sc1
buffer_load_dwordx4 v[40:43], v6, s[4:7], s44 offen offset:2048 sc1
buffer_load_dwordx4 v[44:47], v6, s[4:7], s44 offen offset:3072 sc1
buffer_load_dwordx4 v[48:51], v6, s[4:7], s45 offen offset:0 sc1
buffer_load_dwordx4 v[52:55], v6, s[4:7], s45 offen offset:1024 sc1
buffer_load_dwordx4 v[56:59], v6, s[4:7], s45 offen offset:2048 sc1
buffer_load_dwordx4 v[60:63], v6, s[4:7], s45 offen offset:3072 sc1
buffer_load_dwordx4 v[64:67], v6, s[4:7], s46 offen offset:0 sc1
buffer_load_dwordx4 v[68:71], v6, s[4:7], s46 offen offset:1024 sc1
Lsc_119:
v_mfma_f32_32x32x16_bf16 v[112:127], a[112:115], v[72:75], v[112:127]
v_mfma_f32_32x32x16_bf16 v[128:143], a[116:119], v[72:75], v[128:143]
s_cmp_eq_u32 s51, 0
s_cbranch_scc1 Lpf_120
buffer_load_dwordx4 v[72:75], v6, s[4:7], s46 offen offset:2048 sc1
Lpf_120:
v_mfma_f32_32x32x16_bf16 v[112:127], a[120:123], v[76:79], v[112:127]
v_mfma_f32_32x32x16_bf16 v[128:143], a[124:127], v[76:79], v[128:143]
s_cmp_eq_u32 s51, 0
s_cbranch_scc1 Lpf_121
buffer_load_dwordx4 v[76:79], v6, s[4:7], s46 offen offset:3072 sc1
Lpf_121:
v_mfma_f32_32x32x16_bf16 v[112:127], a[128:131], v[80:83], v[112:127]
v_mfma_f32_32x32x16_bf16 v[128:143], a[132:135], v[80:83], v[128:143]
s_cmp_eq_u32 s51, 0
s_cbranch_scc1 Lpf_122
buffer_load_dwordx4 v[80:83], v6, s[4:7], s47 offen offset:0 sc1
Lpf_122:
v_mfma_f32_32x32x16_bf16 v[112:127], a[136:139], v[84:87], v[112:127]
v_mfma_f32_32x32x16_bf16 v[128:143], a[140:143], v[84:87], v[128:143]
s_cmp_eq_u32 s51, 0
s_cbranch_scc1 Lpf_123
buffer_load_dwordx4 v[84:87], v6, s[4:7], s47 offen offset:1024 sc1
Lpf_123:
v_mfma_f32_32x32x16_bf16 v[112:127], a[144:147], v[88:91], v[112:127]
v_mfma_f32_32x32x16_bf16 v[128:143], a[148:151], v[88:91], v[128:143]
s_cmp_eq_u32 s51, 0
s_cbranch_scc1 Lpf_124
buffer_load_dwordx4 v[88:91], v6, s[4:7], s47 offen offset:2048 sc1
Lpf_124:
v_mfma_f32_32x32x16_bf16 v[112:127], a[152:155], v[92:95], v[112:127]
v_mfma_f32_32x32x16_bf16 v[128:143], a[156:159], v[92:95], v[128:143]
s_cmp_eq_u32 s51, 0
s_cbranch_scc1 Lpf_125
buffer_load_dwordx4 v[92:95], v6, s[4:7], s47 offen offset:3072 sc1
Lpf_125:
v_mfma_f32_32x32x16_bf16 v[112:127], a[160:163], v[96:99], v[112:127]
v_mfma_f32_32x32x16_bf16 v[128:143], a[164:167], v[96:99], v[128:143]
s_cmp_eq_u32 s51, 0
s_cbranch_scc1 Lpf_126
buffer_load_dwordx4 v[96:99], v6, s[4:7], s48 offen offset:0 sc1
Lpf_126:
v_mfma_f32_32x32x16_bf16 v[112:127], a[168:171], v[100:103], v[112:127]
v_mfma_f32_32x32x16_bf16 v[128:143], a[172:175], v[100:103], v[128:143]
s_cmp_eq_u32 s51, 0
s_cbranch_scc1 Lpf_127
buffer_load_dwordx4 v[100:103], v6, s[4:7], s48 offen offset:1024 sc1
Lpf_127:
v_mfma_f32_32x32x16_bf16 v[112:127], a[176:179], v[104:107], v[112:127]
v_mfma_f32_32x32x16_bf16 v[128:143], a[180:183], v[104:107], v[128:143]
s_cmp_eq_u32 s51, 0
s_cbranch_scc1 Lpf_128
buffer_load_dwordx4 v[104:107], v6, s[4:7], s48 offen offset:2048 sc1
Lpf_128:
v_mfma_f32_32x32x16_bf16 v[112:127], a[184:187], v[108:111], v[112:127]
v_mfma_f32_32x32x16_bf16 v[128:143], a[188:191], v[108:111], v[128:143]
s_cmp_eq_u32 s51, 0
s_cbranch_scc1 Lpf_129
buffer_load_dwordx4 v[108:111], v6, s[4:7], s48 offen offset:3072 sc1
Lpf_129:
s_nop 1
ds_write_b128 v12, v[112:115] offset:0
s_nop 6
ds_write_b128 v12, v[128:131] offset:1024
ds_write_b128 v12, v[116:119] offset:2048
ds_write_b128 v12, v[132:135] offset:3072
ds_write_b128 v12, v[120:123] offset:4096
ds_write_b128 v12, v[136:139] offset:5120
ds_write_b128 v12, v[124:127] offset:6144
ds_write_b128 v12, v[140:143] offset:7168
s_waitcnt lgkmcnt(0)
s_barrier
ds_read_b128 v[144:147], v13 offset:0
ds_read_b128 v[148:151], v13 offset:1024
ds_read_b128 v[152:155], v13 offset:8192
ds_read_b128 v[156:159], v13 offset:9216
ds_read_b128 v[160:163], v13 offset:16384
ds_read_b128 v[164:167], v13 offset:17408
ds_read_b128 v[168:171], v13 offset:24576
ds_read_b128 v[172:175], v13 offset:25600
v_xor_b32 v12, 0x8000, v12
v_xor_b32 v13, 0x8000, v13
s_waitcnt lgkmcnt(4)
v_pk_add_f32 v[144:145], v[144:145], v[152:153]
v_pk_add_f32 v[146:147], v[146:147], v[154:155]
v_pk_add_f32 v[148:149], v[148:149], v[156:157]
v_pk_add_f32 v[150:151], v[150:151], v[158:159]
s_waitcnt lgkmcnt(2)
v_pk_add_f32 v[144:145], v[144:145], v[160:161]
v_pk_add_f32 v[146:147], v[146:147], v[162:163]
v_pk_add_f32 v[148:149], v[148:149], v[164:165]
v_pk_add_f32 v[150:151], v[150:151], v[166:167]
s_waitcnt lgkmcnt(0)
v_pk_add_f32 v[144:145], v[144:145], v[168:169]
v_pk_add_f32 v[146:147], v[146:147], v[170:171]
v_pk_add_f32 v[148:149], v[148:149], v[172:173]
v_pk_add_f32 v[150:151], v[150:151], v[174:175]
v_mul_f32 v152, 0xbfb8aa3b, v144
v_mul_f32 v153, 0xbfb8aa3b, v145
v_mul_f32 v154, 0xbfb8aa3b, v146
v_mul_f32 v155, 0xbfb8aa3b, v147
v_mul_f32 v156, 0xbfb8aa3b, v148
v_mul_f32 v157, 0xbfb8aa3b, v149
v_mul_f32 v158, 0xbfb8aa3b, v150
v_mul_f32 v159, 0xbfb8aa3b, v151
v_exp_f32 v152, v152
v_exp_f32 v153, v153
v_exp_f32 v154, v154
v_exp_f32 v155, v155
v_exp_f32 v156, v156
v_exp_f32 v157, v157
v_exp_f32 v158, v158
v_exp_f32 v159, v159
v_add_f32 v152, 1.0, v152
v_add_f32 v153, 1.0, v153
v_add_f32 v154, 1.0, v154
v_add_f32 v155, 1.0, v155
v_add_f32 v156, 1.0, v156
v_add_f32 v157, 1.0, v157
v_add_f32 v158, 1.0, v158
v_add_f32 v159, 1.0, v159
v_rcp_f32 v152, v152
v_rcp_f32 v153, v153
v_rcp_f32 v154, v154
v_rcp_f32 v155, v155
v_rcp_f32 v156, v156
v_rcp_f32 v157, v157
v_rcp_f32 v158, v158
v_rcp_f32 v159, v159
v_mul_f32 v144, v144, v152
v_mul_f32 v145, v145, v153
v_mul_f32 v146, v146, v154
v_mul_f32 v147, v147, v155
v_mul_f32 v148, v148, v156
v_mul_f32 v149, v149, v157
v_mul_f32 v150, v150, v158
v_mul_f32 v151, v151, v159
v_cvt_pk_bf16_f32 v176, v144, v148
v_cvt_pk_bf16_f32 v177, v145, v149
v_cvt_pk_bf16_f32 v178, v146, v150
v_cvt_pk_bf16_f32 v179, v147, v151
buffer_store_dwordx4 v[176:179], v4, s[4:7], s37 offen sc1
s_add_u32 s37, s37, 40960
s_cmp_eq_u32 s51, 1
s_cbranch_scc1 Llate_130
v_add_u32 v8, 1, v8
s_waitcnt vmcnt(0)
buffer_store_dword v8, v5, s[4:7], 0 offen sc1
Lpl_131:
buffer_load_dword v9, v7, s[4:7], 0 offen sc1
s_waitcnt vmcnt(0)
v_cmp_gt_u32 vcc, s50, v9
s_cbranch_vccz Lpld_132
s_cmp_eq_u32 s25, 0
s_cbranch_scc1 Lpld_132
s_sub_u32 s25, s25, 1
s_sleep 1
s_branch Lpl_131
Lpld_132:
buffer_load_dwordx4 v[16:19], v6, s[4:7], s43 offen offset:0 sc1
buffer_load_dwordx4 v[20:23], v6, s[4:7], s43 offen offset:1024 sc1
buffer_load_dwordx4 v[24:27], v6, s[4:7], s43 offen offset:2048 sc1
buffer_load_dwordx4 v[28:31], v6, s[4:7], s43 offen offset:3072 sc1
buffer_load_dwordx4 v[32:35], v6, s[4:7], s44 offen offset:0 sc1
buffer_load_dwordx4 v[36:39], v6, s[4:7], s44 offen offset:1024 sc1
buffer_load_dwordx4 v[40:43], v6, s[4:7], s44 offen offset:2048 sc1
buffer_load_dwordx4 v[44:47], v6, s[4:7], s44 offen offset:3072 sc1
buffer_load_dwordx4 v[48:51], v6, s[4:7], s45 offen offset:0 sc1
buffer_load_dwordx4 v[52:55], v6, s[4:7], s45 offen offset:1024 sc1
buffer_load_dwordx4 v[56:59], v6, s[4:7], s45 offen offset:2048 sc1
buffer_load_dwordx4 v[60:63], v6, s[4:7], s45 offen offset:3072 sc1
buffer_load_dwordx4 v[64:67], v6, s[4:7], s46 offen offset:0 sc1
buffer_load_dwordx4 v[68:71], v6, s[4:7], s46 offen offset:1024 sc1
buffer_load_dwordx4 v[72:75], v6, s[4:7], s46 offen offset:2048 sc1
buffer_load_dwordx4 v[76:79], v6, s[4:7], s46 offen offset:3072 sc1
buffer_load_dwordx4 v[80:83], v6, s[4:7], s47 offen offset:0 sc1
buffer_load_dwordx4 v[84:87], v6, s[4:7], s47 offen offset:1024 sc1
buffer_load_dwordx4 v[88:91], v6, s[4:7], s47 offen offset:2048 sc1
buffer_load_dwordx4 v[92:95], v6, s[4:7], s47 offen offset:3072 sc1
buffer_load_dwordx4 v[96:99], v6, s[4:7], s48 offen offset:0 sc1
buffer_load_dwordx4 v[100:103], v6, s[4:7], s48 offen offset:1024 sc1
buffer_load_dwordx4 v[104:107], v6, s[4:7], s48 offen offset:2048 sc1
buffer_load_dwordx4 v[108:111], v6, s[4:7], s48 offen offset:3072 sc1
Llate_130:
s_add_u32 s46, s24, 3
s_min_u32 s46, s46, 64
v_cmp_gt_u32 vcc, s46, v9
s_cbranch_vccz Lrf_133
buffer_load_dword v9, v7, s[4:7], 0 offen sc1
Lrf_133:
s_add_u32 s24, s24, 1
s_cmp_lt_u32 s24, 64
s_cbranch_scc1 Lf2_loop
v_mov_b32 v8, 64
s_waitcnt vmcnt(0)
buffer_store_dword v8, v5, s[4:7], 0 offen sc1
s_endpgm
.section .rodata,"a"
.p2align 6
.amdhsa_kernel recurrent_scan__memory_aug_recurrent_mem_tr__swiglu_ffn__prompt_kernel
  .amdhsa_next_free_vgpr 512
  .amdhsa_next_free_sgpr 102
  .amdhsa_accum_offset 256
  .amdhsa_group_segment_fixed_size 0
  .amdhsa_kernarg_size 112
  .amdhsa_user_sgpr_count 2
  .amdhsa_user_sgpr_kernarg_segment_ptr 1
  .amdhsa_system_sgpr_workgroup_id_x 1
.end_amdhsa_kernel
```
